```python
import torch

def _softmax(x, axis=-1):
    return torch.softmax(x, dim=axis)
def _gelu(x):
    return torch.nn.functional.gelu(x, approximate="tanh")
def _silu(x):
    return torch.nn.functional.silu(x)
def _sigmoid(x):
    return torch.sigmoid(x)
def _layernorm(x, axis=-1, eps=1e-5):
    m = x.mean(dim=axis, keepdim=True)
    v = x.var(dim=axis, keepdim=True, unbiased=False)
    return (x - m) / torch.sqrt(v + eps)
def _scatter_add(tgt, idx, src, axis=0):
    return tgt.clone().index_add_(axis, idx, src)
def _segment_sum(src, seg, n):
    out = torch.zeros((n,) + src.shape[1:], dtype=src.dtype)
    return out.index_add_(0, seg, src)
def _pad(x, pw):
    flat = tuple(v for pair in reversed(pw) for v in pair)
    return torch.nn.functional.pad(x, flat)

kernel_name = 'concat_heads__gqa_block_cached__gqa_block_cached__near_ridge'

def setup_inputs():

    _w = (lambda a: (lambda t: t.to(torch.bfloat16) if t.is_floating_point() else t)(torch.as_tensor(a)))
    def _A_setup():
        B, Sq, D = 32, 64, 448
        Hq, Hkv, Sk, Dh = 16, 8, 512, 256
        assert Hq % Hkv == 0, (Hq, Hkv)
        return {
            "x": _w((lambda *s: torch.randn(*s, dtype=torch.bfloat16) * 0.8)(B, Sq, D)),
            "k_cache": _w((lambda *s: torch.randn(*s, dtype=torch.bfloat16) * 0.8)(B, Hkv, Sk, Dh)),
            "v_cache": _w((lambda *s: torch.randn(*s, dtype=torch.bfloat16) * 0.05)(B, Hkv, Sk, Dh)),
            "wq": _w((lambda *s: torch.randn(*s, dtype=torch.bfloat16) * 0.8)(D, Hq * Dh) * (D ** -0.5)),
            "wo": _w((lambda *s: torch.randn(*s, dtype=torch.bfloat16) * 0.05)(Hq * Dh, D) * ((Hq * Dh) ** -0.5)),
        }
    _A_in = _A_setup()

    def _B_setup():
        B, Sq, D = 32, 64, 448
        Hq, Hkv, Sk, Dh = 16, 8, 512, 256
        assert Hq % Hkv == 0, (Hq, Hkv)
        return {
            "x": _w((lambda *s: torch.randn(*s, dtype=torch.bfloat16) * 0.8)(B, Sq, D)),
            "k_cache": _w((lambda *s: torch.randn(*s, dtype=torch.bfloat16) * 0.8)(B, Hkv, Sk, Dh)),
            "v_cache": _w((lambda *s: torch.randn(*s, dtype=torch.bfloat16) * 0.05)(B, Hkv, Sk, Dh)),
            "wq": _w((lambda *s: torch.randn(*s, dtype=torch.bfloat16) * 0.8)(D, Hq * Dh) * (D ** -0.5)),
            "wo": _w((lambda *s: torch.randn(*s, dtype=torch.bfloat16) * 0.05)(Hq * Dh, D) * ((Hq * Dh) ** -0.5)),
        }
    _B_in = _B_setup()

    return {
        "A_x": _A_in["x"],
        "A_k_cache": _A_in["k_cache"],
        "A_v_cache": _A_in["v_cache"],
        "A_wq": _A_in["wq"],
        "A_wo": _A_in["wo"],
        "B_x": _B_in["x"],
        "B_k_cache": _B_in["k_cache"],
        "B_v_cache": _B_in["v_cache"],
        "B_wq": _B_in["wq"],
        "B_wo": _B_in["wo"],
    }

def reference(A_x, A_k_cache, A_v_cache, A_wq, A_wo, B_x, B_k_cache, B_v_cache, B_wq, B_wo):
    def _A_ref(x, k_cache, v_cache, wq, wo):
        B, Sq, D = x.shape
        Hq, Dh = 16, 256
        Hkv = k_cache.shape[1]
        rep = Hq // Hkv
        q = (lambda x, *d: x.permute(*d))((x @ wq).reshape(B, Sq, Hq, Dh), 0, 2, 1, 3)
        k = (lambda x, n, axis: torch.repeat_interleave(x, n, dim=axis))(k_cache, rep, axis=1)
        v = (lambda x, n, axis: torch.repeat_interleave(x, n, dim=axis))(v_cache, rep, axis=1)
        scores = torch.einsum("bhqd,bhkd->bhqk", q, k) * (Dh ** -0.5)
        p = _softmax(scores, axis=-1)
        o = torch.einsum("bhqk,bhkd->bhqd", p, v)
        return (lambda x, *d: x.permute(*d))(o, 0, 2, 1, 3).reshape(B, Sq, Hq * Dh) @ wo

    def _B_ref(x, k_cache, v_cache, wq, wo):
        B, Sq, D = x.shape
        Hq, Dh = 16, 256
        Hkv = k_cache.shape[1]
        rep = Hq // Hkv
        q = (lambda x, *d: x.permute(*d))((x @ wq).reshape(B, Sq, Hq, Dh), 0, 2, 1, 3)
        k = (lambda x, n, axis: torch.repeat_interleave(x, n, dim=axis))(k_cache, rep, axis=1)
        v = (lambda x, n, axis: torch.repeat_interleave(x, n, dim=axis))(v_cache, rep, axis=1)
        scores = torch.einsum("bhqd,bhkd->bhqk", q, k) * (Dh ** -0.5)
        p = _softmax(scores, axis=-1)
        o = torch.einsum("bhqk,bhkd->bhqd", p, v)
        return (lambda x, *d: x.permute(*d))(o, 0, 2, 1, 3).reshape(B, Sq, Hq * Dh) @ wo

    a = _A_ref(A_x, A_k_cache, A_v_cache, A_wq, A_wo)
    b = _B_ref(B_x, B_k_cache, B_v_cache, B_wq, B_wo)
    return torch.concatenate([a, b], axis=-1)
```

```asm
; @launch grid=(256,1,1) block=(512,1,1) lds=160256
.amdgcn_target "amdgcn-amd-amdhsa--gfx950"
.text
.globl concat_heads__gqa_block_cached__gqa_block_cached__near_ridge_kernel
.p2align 8
.type concat_heads__gqa_block_cached__gqa_block_cached__near_ridge_kernel,@function
concat_heads__gqa_block_cached__gqa_block_cached__near_ridge_kernel:
s_cmp_ge_u32 s2, 256
s_cbranch_scc1 L_end
s_load_dwordx16 s[32:47], s[0:1], 0
s_load_dwordx8 s[48:55], s[0:1], 64
s_load_dwordx2 s[56:57], s[0:1], 96
v_lshrrev_b32 v1, 6, v0
s_mov_b32 s83, s2
s_and_b32 s62, s2, 3
v_readfirstlane_b32 s3, v1
s_lshr_b32 s61, s2, 3
s_bfe_u32 s63, s2, 0x10002
s_mov_b32 s82, 0
v_and_b32 v0, 63, v0
s_and_b32 s60, s3, 3
s_cmp_eq_u32 s3, 1
s_cbranch_scc0 L_noct
s_getpc_b64 s[58:59]
L_pc:
s_sub_u32 s58, s58, L_pc-concat_heads__gqa_block_cached__gqa_block_cached__near_ridge_kernel
s_subb_u32 s59, s59, 0
v_lshl_add_u32 v2, v0, 5, s61
v_lshlrev_b32 v2, 7, v2
v_min_u32 v2, L_end-concat_heads__gqa_block_cached__gqa_block_cached__near_ridge_kernel, v2
v_mov_b32 v3, s59
v_add_co_u32 v2, vcc, s58, v2
s_nop 1
v_addc_co_u32 v3, vcc, 0, v3, vcc
global_load_dword v4, v[2:3], off
L_noct:
s_waitcnt lgkmcnt(0)
s_bitcmp1_b32 s2, 2
s_cselect_b64 s[4:5], s[42:43], s[32:33]
s_cselect_b64 s[8:9], s[44:45], s[34:35]
s_cselect_b64 s[12:13], s[46:47], s[36:37]
s_cselect_b64 s[16:17], s[48:49], s[38:39]
s_cselect_b64 s[20:21], s[50:51], s[40:41]
s_mul_i32 s64, s61, 57344
s_add_u32 s4, s4, s64
s_addc_u32 s5, s5, 0
s_lshl_b32 s64, s61, 21
s_lshl_b32 s65, s62, 19
s_add_u32 s64, s64, s65
s_add_u32 s8, s8, s64
s_addc_u32 s9, s9, 0
s_add_u32 s12, s12, s64
s_addc_u32 s13, s13, 0
s_lshl_b32 s64, s62, 11
s_add_u32 s16, s16, s64
s_addc_u32 s17, s17, 0
s_sub_u32 s18, 3670016, s64
s_mul_i32 s64, s62, 917504
s_add_u32 s20, s20, s64
s_addc_u32 s21, s21, 0
s_mov_b32 s6, 57344
s_mov_b32 s10, 524288
s_mov_b32 s14, 524288
s_mov_b32 s22, 917504
s_mov_b64 s[24:25], s[52:53]
s_mov_b32 s26, 3670016
s_mov_b64 s[28:29], s[56:57]
s_mov_b32 s30, 67108864
s_mov_b64 s[88:89], s[54:55]
s_mov_b32 s90, 256
s_mov_b32 s7, 0x20000
s_mov_b32 s11, 0x20000
s_mov_b32 s15, 0x20000
s_mov_b32 s19, 0x20000
s_mov_b32 s23, 0x20000
s_mov_b32 s27, 0x20000
s_mov_b32 s31, 0x20000
s_mov_b32 s91, 0x20000
s_cmp_lt_u32 s3, 4
s_cbranch_scc1 L_A
L_B:
s_mul_i32 s71, s60, 2176
s_mul_i32 s72, s60, 14336
v_lshrrev_b32 v132, 3, v0
v_bfe_u32 v133, v0, 4, 2
v_and_b32 v134, 7, v0
v_xor_b32 v170, v134, v133
v_lshlrev_b32 v170, 4, v170
v_mul_u32_u24 v135, 896, v132
v_add_u32 v170, v170, v135
v_and_b32 v151, 3, v0
v_lshlrev_b32 v150, 2, v151
s_lshl_b32 s64, s83, 7
s_add_u32 s64, s64, 41943040
v_add_u32 v150, s64, v150
s_mul_i32 s65, s62, 124
s_sub_u32 s64, s64, s65
v_lshl_add_u32 v151, v151, 7, s64
buffer_load_dword v148, v150, s[28:31], 0 offen sc1
buffer_load_dword v149, v151, s[28:31], 0 offen sc1
s_add_u32 m0, s71, 68608
s_add_u32 s64, s72, 0
buffer_load_dwordx4 v170, s[4:7], s64 offen lds
s_add_u32 m0, s71, 69696
s_add_u32 s64, s72, 7168
buffer_load_dwordx4 v170, s[4:7], s64 offen lds
s_add_u32 m0, s71, 33792
s_add_u32 s64, s72, 128
buffer_load_dwordx4 v170, s[4:7], s64 offen lds
s_add_u32 m0, s71, 34880
s_add_u32 s64, s72, 7296
buffer_load_dwordx4 v170, s[4:7], s64 offen lds
s_lshl_b32 s66, s60, 14
s_add_u32 s66, s66, 77312
s_lshl_b32 s67, s60, 8
s_mul_i32 s68, s60, 8448
s_lshl_b32 s69, s60, 15
s_and_b32 s44, s61, 3
s_bfe_u32 s45, s61, 0x20002
s_add_u32 s70, s60, s44
s_and_b32 s70, s70, 3
s_lshl_b32 s70, s70, 9
s_lshr_b32 s64, s60, 2
s_lshl_b32 s64, s64, 17
s_add_u32 s70, s70, s64
s_add_u32 s64, s44, 0
s_and_b32 s64, s64, 3
s_lshl_b32 s64, s64, 9
s_add_u32 s32, s69, s64
s_add_u32 s64, s45, 0
s_and_b32 s64, s64, 3
s_lshl_b32 s65, s64, 7
s_add_u32 s36, s70, s65
s_mul_i32 s65, s64, 57344
s_add_u32 s40, s67, s65
s_add_u32 s64, s44, 1
s_and_b32 s64, s64, 3
s_lshl_b32 s64, s64, 9
s_add_u32 s33, s69, s64
s_add_u32 s64, s45, 1
s_and_b32 s64, s64, 3
s_lshl_b32 s65, s64, 7
s_add_u32 s37, s70, s65
s_mul_i32 s65, s64, 57344
s_add_u32 s41, s67, s65
s_add_u32 s64, s44, 2
s_and_b32 s64, s64, 3
s_lshl_b32 s64, s64, 9
s_add_u32 s34, s69, s64
s_add_u32 s64, s45, 2
s_and_b32 s64, s64, 3
s_lshl_b32 s65, s64, 7
s_add_u32 s38, s70, s65
s_mul_i32 s65, s64, 57344
s_add_u32 s42, s67, s65
s_add_u32 s64, s44, 3
s_and_b32 s64, s64, 3
s_lshl_b32 s64, s64, 9
s_add_u32 s35, s69, s64
s_add_u32 s64, s45, 3
s_and_b32 s64, s64, 3
s_lshl_b32 s65, s64, 7
s_add_u32 s39, s70, s65
s_mul_i32 s65, s64, 57344
s_add_u32 s43, s67, s65
s_lshl_b32 s77, s60, 13
v_lshlrev_b32 v133, 1, v133
v_xor_b32 v134, v134, v133
v_lshlrev_b32 v134, 4, v134
v_add_u32 v156, v134, v135
v_lshl_add_u32 v168, v132, 11, v134
v_lshrrev_b32 v133, 5, v0
v_and_b32 v135, 3, v132
v_lshl_add_u32 v152, v135, 13, v134
v_lshl_add_u32 v152, v133, 16, v152
v_and_b32 v134, 31, v0
v_xor_b32 v134, v134, v133
v_lshlrev_b32 v134, 4, v134
v_lshl_add_u32 v169, v133, 11, v134
v_add_u32 v153, 130048, v152
v_add_u32 v154, 30720, v152
v_add_u32 v155, 160768, v152
s_add_u32 m0, s66, 0
s_add_u32 s64, s67, 0
buffer_load_dwordx4 v152, s[16:19], s64 offen offset:0 lds
buffer_load_dwordx4 v153, s[16:19], s64 offen offset:1024 lds
buffer_load_dwordx4 v154, s[16:19], s64 offen offset:2048 lds
buffer_load_dwordx4 v155, s[16:19], s64 offen offset:3072 lds
s_add_u32 m0, s66, 4096
s_add_u32 s64, s67, 128
buffer_load_dwordx4 v152, s[16:19], s64 offen offset:0 lds
buffer_load_dwordx4 v153, s[16:19], s64 offen offset:1024 lds
buffer_load_dwordx4 v154, s[16:19], s64 offen offset:2048 lds
buffer_load_dwordx4 v155, s[16:19], s64 offen offset:3072 lds
s_add_u32 m0, s66, 8192
s_add_u32 s64, s67, 262144
buffer_load_dwordx4 v152, s[16:19], s64 offen offset:0 lds
buffer_load_dwordx4 v153, s[16:19], s64 offen offset:1024 lds
buffer_load_dwordx4 v154, s[16:19], s64 offen offset:2048 lds
buffer_load_dwordx4 v155, s[16:19], s64 offen offset:3072 lds
s_add_u32 m0, s66, 12288
s_add_u32 s64, s67, 262272
buffer_load_dwordx4 v152, s[16:19], s64 offen offset:0 lds
buffer_load_dwordx4 v153, s[16:19], s64 offen offset:1024 lds
buffer_load_dwordx4 v154, s[16:19], s64 offen offset:2048 lds
buffer_load_dwordx4 v155, s[16:19], s64 offen offset:3072 lds
v_bfe_u32 v132, v0, 2, 3
v_lshrrev_b32 v133, 5, v0
v_lshlrev_b32 v133, 10, v133
v_lshl_add_u32 v133, v132, 7, v133
v_and_b32 v134, 3, v0
v_lshl_add_u32 v133, v134, 3, v133
v_add_u32 v133, s66, v133
v_lshrrev_b32 v132, 1, v132
v_xor_b32 v134, 0, v132
v_lshl_add_u32 v160, v134, 5, v133
v_xor_b32 v134, 1, v132
v_lshl_add_u32 v161, v134, 5, v133
v_xor_b32 v134, 2, v132
v_lshl_add_u32 v162, v134, 5, v133
v_xor_b32 v134, 3, v132
v_lshl_add_u32 v163, v134, 5, v133
v_bfe_u32 v132, v0, 3, 1
v_mul_u32_u24 v165, 1088, v132
v_and_b32 v132, 7, v0
v_lshl_add_u32 v165, v132, 7, v165
v_lshrrev_b32 v132, 1, v132
v_lshrrev_b32 v133, 4, v0
v_xor_b32 v132, v132, v133
v_lshl_add_u32 v165, v132, 4, v165
v_add_u32 v164, 142848, v165
v_add_u32 v165, 33792, v165
s_add_u32 s64, s62, 0
s_and_b32 s64, s64, 3
s_lshl_b32 s64, s64, 10
s_add_u32 s64, s64, 142848
v_lshl_add_u32 v128, v0, 4, s64
s_add_u32 s64, s62, 1
s_and_b32 s64, s64, 3
s_lshl_b32 s64, s64, 10
s_add_u32 s64, s64, 142848
v_lshl_add_u32 v129, v0, 4, s64
s_add_u32 s64, s62, 2
s_and_b32 s64, s64, 3
s_lshl_b32 s64, s64, 10
s_add_u32 s64, s64, 142848
v_lshl_add_u32 v130, v0, 4, s64
s_add_u32 s64, s62, 3
s_and_b32 s64, s64, 3
s_lshl_b32 s64, s64, 10
s_add_u32 s64, s64, 142848
v_lshl_add_u32 v131, v0, 4, s64
v_lshrrev_b32 v132, 5, v0
v_lshlrev_b32 v132, 8, v132
v_and_b32 v133, 15, v0
v_lshl_add_u32 v132, v133, 4, v132
v_bfe_u32 v133, v0, 4, 1
v_lshl_add_u32 v132, v133, 3, v132
v_add_u32 v171, s66, v132
v_mov_b32 v172, v0
v_min_u32 v166, 27, v0
s_mul_i32 s64, s60, 28
v_add_u32 v166, s64, v166
v_lshlrev_b32 v166, 12, v166
s_lshl_b32 s64, s61, 7
v_add_u32 v166, s64, v166
v_add_u32 v157, 6144, v156
v_add_u32 v158, 12288, v156
v_add_u32 v159, 18432, v156
s_add_u32 m0, s71, 42496
s_add_u32 s64, s72, 256
buffer_load_dwordx4 v170, s[4:7], s64 offen lds
s_add_u32 m0, s71, 43584
s_add_u32 s64, s72, 7424
buffer_load_dwordx4 v170, s[4:7], s64 offen lds
s_add_u32 m0, s71, 51200
s_add_u32 s64, s72, 384
buffer_load_dwordx4 v170, s[4:7], s64 offen lds
s_add_u32 m0, s71, 52288
s_add_u32 s64, s72, 7552
buffer_load_dwordx4 v170, s[4:7], s64 offen lds
s_add_u32 m0, s71, 59904
s_add_u32 s64, s72, 512
buffer_load_dwordx4 v170, s[4:7], s64 offen lds
s_add_u32 m0, s71, 60992
s_add_u32 s64, s72, 7680
buffer_load_dwordx4 v170, s[4:7], s64 offen lds
s_add_u32 m0, s71, 142848
s_add_u32 s64, s72, 640
buffer_load_dwordx4 v170, s[4:7], s64 offen lds
s_add_u32 m0, s71, 143936
s_add_u32 s64, s72, 7808
buffer_load_dwordx4 v170, s[4:7], s64 offen lds
s_add_u32 m0, s71, 151552
s_add_u32 s64, s72, 768
buffer_load_dwordx4 v170, s[4:7], s64 offen lds
s_add_u32 m0, s71, 152640
s_add_u32 s64, s72, 7936
buffer_load_dwordx4 v170, s[4:7], s64 offen lds
s_waitcnt vmcnt(26)
s_barrier
s_setprio 3
s_waitcnt vmcnt(22)
ds_read_b64_tr_b16 a[0:1], v160 offset:0
ds_read_b64_tr_b16 a[2:3], v160 offset:2048
ds_read_b64_tr_b16 a[4:5], v161 offset:0
ds_read_b64_tr_b16 a[6:7], v161 offset:2048
ds_read_b64_tr_b16 a[8:9], v162 offset:0
ds_read_b64_tr_b16 a[10:11], v162 offset:2048
ds_read_b64_tr_b16 a[12:13], v163 offset:0
ds_read_b64_tr_b16 a[14:15], v163 offset:2048
ds_read_b128 a[32:35], v165 offset:34816
ds_read_b128 a[36:39], v165 offset:36992
ds_read_b128 a[40:43], v165 offset:39168
ds_read_b128 a[44:47], v165 offset:41344
s_setprio 1
s_waitcnt vmcnt(18) lgkmcnt(0)
v_mfma_f32_16x16x32_bf16 v[0:3], a[0:3], a[32:35], 0
ds_read_b64_tr_b16 a[16:17], v160 offset:4096
v_mfma_f32_16x16x32_bf16 v[4:7], a[0:3], a[36:39], 0
ds_read_b64_tr_b16 a[18:19], v160 offset:6144
v_mfma_f32_16x16x32_bf16 v[20:23], a[4:7], a[36:39], 0
ds_read_b64_tr_b16 a[20:21], v161 offset:4096
v_mfma_f32_16x16x32_bf16 v[16:19], a[4:7], a[32:35], 0
ds_read_b64_tr_b16 a[22:23], v161 offset:6144
v_mfma_f32_16x16x32_bf16 v[32:35], a[8:11], a[32:35], 0
ds_read_b64_tr_b16 a[24:25], v162 offset:4096
v_mfma_f32_16x16x32_bf16 v[36:39], a[8:11], a[36:39], 0
ds_read_b64_tr_b16 a[26:27], v162 offset:6144
v_mfma_f32_16x16x32_bf16 v[52:55], a[12:15], a[36:39], 0
ds_read_b64_tr_b16 a[28:29], v163 offset:4096
v_mfma_f32_16x16x32_bf16 v[48:51], a[12:15], a[32:35], 0
ds_read_b64_tr_b16 a[30:31], v163 offset:6144
v_mfma_f32_16x16x32_bf16 v[56:59], a[12:15], a[40:43], 0
s_add_u32 m0, s66, 0
s_add_u32 s64, s67, 524288
buffer_load_dwordx4 v152, s[16:19], s64 offen offset:0 lds
v_mfma_f32_16x16x32_bf16 v[60:63], a[12:15], a[44:47], 0
buffer_load_dwordx4 v153, s[16:19], s64 offen offset:1024 lds
v_mfma_f32_16x16x32_bf16 v[44:47], a[8:11], a[44:47], 0
buffer_load_dwordx4 v154, s[16:19], s64 offen offset:2048 lds
v_mfma_f32_16x16x32_bf16 v[40:43], a[8:11], a[40:43], 0
buffer_load_dwordx4 v155, s[16:19], s64 offen offset:3072 lds
v_mfma_f32_16x16x32_bf16 v[24:27], a[4:7], a[40:43], 0
v_mfma_f32_16x16x32_bf16 v[28:31], a[4:7], a[44:47], 0
v_mfma_f32_16x16x32_bf16 v[12:15], a[0:3], a[44:47], 0
v_mfma_f32_16x16x32_bf16 v[8:11], a[0:3], a[40:43], 0
s_waitcnt vmcnt(18) lgkmcnt(0)
v_mfma_f32_16x16x32_bf16 v[64:67], a[16:19], a[32:35], 0
ds_read_b128 a[48:51], v165 offset:34880
v_mfma_f32_16x16x32_bf16 v[68:71], a[16:19], a[36:39], 0
ds_read_b128 a[52:55], v165 offset:37056
v_mfma_f32_16x16x32_bf16 v[84:87], a[20:23], a[36:39], 0
ds_read_b128 a[56:59], v165 offset:39232
v_mfma_f32_16x16x32_bf16 v[80:83], a[20:23], a[32:35], 0
ds_read_b128 a[60:63], v165 offset:41408
v_mfma_f32_16x16x32_bf16 v[96:99], a[24:27], a[32:35], 0
ds_read_b64_tr_b16 a[0:1], v160 offset:8192
v_mfma_f32_16x16x32_bf16 v[100:103], a[24:27], a[36:39], 0
ds_read_b64_tr_b16 a[2:3], v160 offset:10240
v_mfma_f32_16x16x32_bf16 v[116:119], a[28:31], a[36:39], 0
ds_read_b64_tr_b16 a[4:5], v161 offset:8192
v_mfma_f32_16x16x32_bf16 v[112:115], a[28:31], a[32:35], 0
ds_read_b64_tr_b16 a[6:7], v161 offset:10240
v_mfma_f32_16x16x32_bf16 v[120:123], a[28:31], a[40:43], 0
ds_read_b64_tr_b16 a[8:9], v162 offset:8192
v_mfma_f32_16x16x32_bf16 v[124:127], a[28:31], a[44:47], 0
ds_read_b64_tr_b16 a[10:11], v162 offset:10240
v_mfma_f32_16x16x32_bf16 v[108:111], a[24:27], a[44:47], 0
ds_read_b64_tr_b16 a[12:13], v163 offset:8192
v_mfma_f32_16x16x32_bf16 v[104:107], a[24:27], a[40:43], 0
ds_read_b64_tr_b16 a[14:15], v163 offset:10240
v_mfma_f32_16x16x32_bf16 v[88:91], a[20:23], a[40:43], 0
s_add_u32 m0, s66, 4096
s_add_u32 s64, s67, 524416
buffer_load_dwordx4 v152, s[16:19], s64 offen offset:0 lds
v_mfma_f32_16x16x32_bf16 v[92:95], a[20:23], a[44:47], 0
buffer_load_dwordx4 v153, s[16:19], s64 offen offset:1024 lds
v_mfma_f32_16x16x32_bf16 v[76:79], a[16:19], a[44:47], 0
buffer_load_dwordx4 v154, s[16:19], s64 offen offset:2048 lds
v_mfma_f32_16x16x32_bf16 v[72:75], a[16:19], a[40:43], 0
buffer_load_dwordx4 v155, s[16:19], s64 offen offset:3072 lds
s_waitcnt vmcnt(18) lgkmcnt(0)
v_mfma_f32_16x16x32_bf16 v[0:3], a[0:3], a[48:51], v[0:3]
ds_read_b64_tr_b16 a[16:17], v160 offset:12288
v_mfma_f32_16x16x32_bf16 v[4:7], a[0:3], a[52:55], v[4:7]
ds_read_b64_tr_b16 a[18:19], v160 offset:14336
v_mfma_f32_16x16x32_bf16 v[20:23], a[4:7], a[52:55], v[20:23]
ds_read_b64_tr_b16 a[20:21], v161 offset:12288
v_mfma_f32_16x16x32_bf16 v[16:19], a[4:7], a[48:51], v[16:19]
ds_read_b64_tr_b16 a[22:23], v161 offset:14336
v_mfma_f32_16x16x32_bf16 v[32:35], a[8:11], a[48:51], v[32:35]
ds_read_b64_tr_b16 a[24:25], v162 offset:12288
v_mfma_f32_16x16x32_bf16 v[36:39], a[8:11], a[52:55], v[36:39]
ds_read_b64_tr_b16 a[26:27], v162 offset:14336
v_mfma_f32_16x16x32_bf16 v[52:55], a[12:15], a[52:55], v[52:55]
ds_read_b64_tr_b16 a[28:29], v163 offset:12288
v_mfma_f32_16x16x32_bf16 v[48:51], a[12:15], a[48:51], v[48:51]
ds_read_b64_tr_b16 a[30:31], v163 offset:14336
v_mfma_f32_16x16x32_bf16 v[56:59], a[12:15], a[56:59], v[56:59]
s_add_u32 m0, s66, 8192
s_add_u32 s64, s67, 786432
buffer_load_dwordx4 v152, s[16:19], s64 offen offset:0 lds
v_mfma_f32_16x16x32_bf16 v[60:63], a[12:15], a[60:63], v[60:63]
buffer_load_dwordx4 v153, s[16:19], s64 offen offset:1024 lds
v_mfma_f32_16x16x32_bf16 v[44:47], a[8:11], a[60:63], v[44:47]
buffer_load_dwordx4 v154, s[16:19], s64 offen offset:2048 lds
v_mfma_f32_16x16x32_bf16 v[40:43], a[8:11], a[56:59], v[40:43]
buffer_load_dwordx4 v155, s[16:19], s64 offen offset:3072 lds
v_mfma_f32_16x16x32_bf16 v[24:27], a[4:7], a[56:59], v[24:27]
v_mfma_f32_16x16x32_bf16 v[28:31], a[4:7], a[60:63], v[28:31]
v_mfma_f32_16x16x32_bf16 v[12:15], a[0:3], a[60:63], v[12:15]
v_mfma_f32_16x16x32_bf16 v[8:11], a[0:3], a[56:59], v[8:11]
s_waitcnt vmcnt(8) lgkmcnt(0)
v_mfma_f32_16x16x32_bf16 v[64:67], a[16:19], a[48:51], v[64:67]
ds_read_b128 a[64:67], v165 offset:0
v_mfma_f32_16x16x32_bf16 v[68:71], a[16:19], a[52:55], v[68:71]
ds_read_b128 a[68:71], v165 offset:2176
v_mfma_f32_16x16x32_bf16 v[84:87], a[20:23], a[52:55], v[84:87]
ds_read_b128 a[72:75], v165 offset:4352
v_mfma_f32_16x16x32_bf16 v[80:83], a[20:23], a[48:51], v[80:83]
ds_read_b128 a[76:79], v165 offset:6528
v_mfma_f32_16x16x32_bf16 v[96:99], a[24:27], a[48:51], v[96:99]
ds_read_b64_tr_b16 a[0:1], v160 offset:0
v_mfma_f32_16x16x32_bf16 v[100:103], a[24:27], a[52:55], v[100:103]
ds_read_b64_tr_b16 a[2:3], v160 offset:2048
v_mfma_f32_16x16x32_bf16 v[116:119], a[28:31], a[52:55], v[116:119]
ds_read_b64_tr_b16 a[4:5], v161 offset:0
v_mfma_f32_16x16x32_bf16 v[112:115], a[28:31], a[48:51], v[112:115]
ds_read_b64_tr_b16 a[6:7], v161 offset:2048
v_mfma_f32_16x16x32_bf16 v[120:123], a[28:31], a[56:59], v[120:123]
ds_read_b64_tr_b16 a[8:9], v162 offset:0
v_mfma_f32_16x16x32_bf16 v[124:127], a[28:31], a[60:63], v[124:127]
ds_read_b64_tr_b16 a[10:11], v162 offset:2048
v_mfma_f32_16x16x32_bf16 v[108:111], a[24:27], a[60:63], v[108:111]
ds_read_b64_tr_b16 a[12:13], v163 offset:0
v_mfma_f32_16x16x32_bf16 v[104:107], a[24:27], a[56:59], v[104:107]
ds_read_b64_tr_b16 a[14:15], v163 offset:2048
v_mfma_f32_16x16x32_bf16 v[88:91], a[20:23], a[56:59], v[88:91]
s_add_u32 m0, s66, 12288
s_add_u32 s64, s67, 786560
buffer_load_dwordx4 v152, s[16:19], s64 offen offset:0 lds
v_mfma_f32_16x16x32_bf16 v[92:95], a[20:23], a[60:63], v[92:95]
buffer_load_dwordx4 v153, s[16:19], s64 offen offset:1024 lds
v_mfma_f32_16x16x32_bf16 v[76:79], a[16:19], a[60:63], v[76:79]
buffer_load_dwordx4 v154, s[16:19], s64 offen offset:2048 lds
v_mfma_f32_16x16x32_bf16 v[72:75], a[16:19], a[56:59], v[72:75]
buffer_load_dwordx4 v155, s[16:19], s64 offen offset:3072 lds
s_waitcnt vmcnt(8) lgkmcnt(0)
v_mfma_f32_16x16x32_bf16 v[0:3], a[0:3], a[64:67], v[0:3]
ds_read_b64_tr_b16 a[16:17], v160 offset:4096
v_mfma_f32_16x16x32_bf16 v[4:7], a[0:3], a[68:71], v[4:7]
ds_read_b64_tr_b16 a[18:19], v160 offset:6144
v_mfma_f32_16x16x32_bf16 v[20:23], a[4:7], a[68:71], v[20:23]
ds_read_b64_tr_b16 a[20:21], v161 offset:4096
v_mfma_f32_16x16x32_bf16 v[16:19], a[4:7], a[64:67], v[16:19]
ds_read_b64_tr_b16 a[22:23], v161 offset:6144
v_mfma_f32_16x16x32_bf16 v[32:35], a[8:11], a[64:67], v[32:35]
ds_read_b64_tr_b16 a[24:25], v162 offset:4096
v_mfma_f32_16x16x32_bf16 v[36:39], a[8:11], a[68:71], v[36:39]
ds_read_b64_tr_b16 a[26:27], v162 offset:6144
v_mfma_f32_16x16x32_bf16 v[52:55], a[12:15], a[68:71], v[52:55]
ds_read_b64_tr_b16 a[28:29], v163 offset:4096
v_mfma_f32_16x16x32_bf16 v[48:51], a[12:15], a[64:67], v[48:51]
ds_read_b64_tr_b16 a[30:31], v163 offset:6144
v_mfma_f32_16x16x32_bf16 v[56:59], a[12:15], a[72:75], v[56:59]
s_add_u32 m0, s66, 0
s_add_u32 s64, s67, 1048576
buffer_load_dwordx4 v152, s[16:19], s64 offen offset:0 lds
v_mfma_f32_16x16x32_bf16 v[60:63], a[12:15], a[76:79], v[60:63]
buffer_load_dwordx4 v153, s[16:19], s64 offen offset:1024 lds
v_mfma_f32_16x16x32_bf16 v[44:47], a[8:11], a[76:79], v[44:47]
buffer_load_dwordx4 v154, s[16:19], s64 offen offset:2048 lds
v_mfma_f32_16x16x32_bf16 v[40:43], a[8:11], a[72:75], v[40:43]
buffer_load_dwordx4 v155, s[16:19], s64 offen offset:3072 lds
v_mfma_f32_16x16x32_bf16 v[24:27], a[4:7], a[72:75], v[24:27]
v_mfma_f32_16x16x32_bf16 v[28:31], a[4:7], a[76:79], v[28:31]
v_mfma_f32_16x16x32_bf16 v[12:15], a[0:3], a[76:79], v[12:15]
v_mfma_f32_16x16x32_bf16 v[8:11], a[0:3], a[72:75], v[8:11]
s_waitcnt vmcnt(8) lgkmcnt(0)
v_mfma_f32_16x16x32_bf16 v[64:67], a[16:19], a[64:67], v[64:67]
ds_read_b128 a[32:35], v165 offset:64
v_mfma_f32_16x16x32_bf16 v[68:71], a[16:19], a[68:71], v[68:71]
ds_read_b128 a[36:39], v165 offset:2240
v_mfma_f32_16x16x32_bf16 v[84:87], a[20:23], a[68:71], v[84:87]
ds_read_b128 a[40:43], v165 offset:4416
v_mfma_f32_16x16x32_bf16 v[80:83], a[20:23], a[64:67], v[80:83]
ds_read_b128 a[44:47], v165 offset:6592
v_mfma_f32_16x16x32_bf16 v[96:99], a[24:27], a[64:67], v[96:99]
ds_read_b64_tr_b16 a[0:1], v160 offset:8192
v_mfma_f32_16x16x32_bf16 v[100:103], a[24:27], a[68:71], v[100:103]
ds_read_b64_tr_b16 a[2:3], v160 offset:10240
v_mfma_f32_16x16x32_bf16 v[116:119], a[28:31], a[68:71], v[116:119]
ds_read_b64_tr_b16 a[4:5], v161 offset:8192
v_mfma_f32_16x16x32_bf16 v[112:115], a[28:31], a[64:67], v[112:115]
ds_read_b64_tr_b16 a[6:7], v161 offset:10240
v_mfma_f32_16x16x32_bf16 v[120:123], a[28:31], a[72:75], v[120:123]
ds_read_b64_tr_b16 a[8:9], v162 offset:8192
v_mfma_f32_16x16x32_bf16 v[124:127], a[28:31], a[76:79], v[124:127]
ds_read_b64_tr_b16 a[10:11], v162 offset:10240
v_mfma_f32_16x16x32_bf16 v[108:111], a[24:27], a[76:79], v[108:111]
ds_read_b64_tr_b16 a[12:13], v163 offset:8192
v_mfma_f32_16x16x32_bf16 v[104:107], a[24:27], a[72:75], v[104:107]
ds_read_b64_tr_b16 a[14:15], v163 offset:10240
v_mfma_f32_16x16x32_bf16 v[88:91], a[20:23], a[72:75], v[88:91]
s_add_u32 m0, s66, 4096
s_add_u32 s64, s67, 1048704
buffer_load_dwordx4 v152, s[16:19], s64 offen offset:0 lds
v_mfma_f32_16x16x32_bf16 v[92:95], a[20:23], a[76:79], v[92:95]
buffer_load_dwordx4 v153, s[16:19], s64 offen offset:1024 lds
v_mfma_f32_16x16x32_bf16 v[76:79], a[16:19], a[76:79], v[76:79]
buffer_load_dwordx4 v154, s[16:19], s64 offen offset:2048 lds
v_mfma_f32_16x16x32_bf16 v[72:75], a[16:19], a[72:75], v[72:75]
buffer_load_dwordx4 v155, s[16:19], s64 offen offset:3072 lds
s_waitcnt vmcnt(8) lgkmcnt(0)
v_mfma_f32_16x16x32_bf16 v[0:3], a[0:3], a[32:35], v[0:3]
ds_read_b64_tr_b16 a[16:17], v160 offset:12288
v_mfma_f32_16x16x32_bf16 v[4:7], a[0:3], a[36:39], v[4:7]
ds_read_b64_tr_b16 a[18:19], v160 offset:14336
v_mfma_f32_16x16x32_bf16 v[20:23], a[4:7], a[36:39], v[20:23]
ds_read_b64_tr_b16 a[20:21], v161 offset:12288
v_mfma_f32_16x16x32_bf16 v[16:19], a[4:7], a[32:35], v[16:19]
ds_read_b64_tr_b16 a[22:23], v161 offset:14336
v_mfma_f32_16x16x32_bf16 v[32:35], a[8:11], a[32:35], v[32:35]
ds_read_b64_tr_b16 a[24:25], v162 offset:12288
v_mfma_f32_16x16x32_bf16 v[36:39], a[8:11], a[36:39], v[36:39]
ds_read_b64_tr_b16 a[26:27], v162 offset:14336
v_mfma_f32_16x16x32_bf16 v[52:55], a[12:15], a[36:39], v[52:55]
ds_read_b64_tr_b16 a[28:29], v163 offset:12288
v_mfma_f32_16x16x32_bf16 v[48:51], a[12:15], a[32:35], v[48:51]
ds_read_b64_tr_b16 a[30:31], v163 offset:14336
v_mfma_f32_16x16x32_bf16 v[56:59], a[12:15], a[40:43], v[56:59]
s_add_u32 m0, s66, 8192
s_add_u32 s64, s67, 1310720
buffer_load_dwordx4 v152, s[16:19], s64 offen offset:0 lds
v_mfma_f32_16x16x32_bf16 v[60:63], a[12:15], a[44:47], v[60:63]
buffer_load_dwordx4 v153, s[16:19], s64 offen offset:1024 lds
v_mfma_f32_16x16x32_bf16 v[44:47], a[8:11], a[44:47], v[44:47]
buffer_load_dwordx4 v154, s[16:19], s64 offen offset:2048 lds
v_mfma_f32_16x16x32_bf16 v[40:43], a[8:11], a[40:43], v[40:43]
buffer_load_dwordx4 v155, s[16:19], s64 offen offset:3072 lds
v_mfma_f32_16x16x32_bf16 v[24:27], a[4:7], a[40:43], v[24:27]
s_barrier
v_mfma_f32_16x16x32_bf16 v[28:31], a[4:7], a[44:47], v[28:31]
v_mfma_f32_16x16x32_bf16 v[12:15], a[0:3], a[44:47], v[12:15]
v_mfma_f32_16x16x32_bf16 v[8:11], a[0:3], a[40:43], v[8:11]
s_waitcnt vmcnt(8) lgkmcnt(0)
v_mfma_f32_16x16x32_bf16 v[64:67], a[16:19], a[32:35], v[64:67]
ds_read_b128 a[48:51], v165 offset:8704
v_mfma_f32_16x16x32_bf16 v[68:71], a[16:19], a[36:39], v[68:71]
ds_read_b128 a[52:55], v165 offset:10880
v_mfma_f32_16x16x32_bf16 v[84:87], a[20:23], a[36:39], v[84:87]
ds_read_b128 a[56:59], v165 offset:13056
v_mfma_f32_16x16x32_bf16 v[80:83], a[20:23], a[32:35], v[80:83]
ds_read_b128 a[60:63], v165 offset:15232
v_mfma_f32_16x16x32_bf16 v[96:99], a[24:27], a[32:35], v[96:99]
ds_read_b64_tr_b16 a[0:1], v160 offset:0
v_mfma_f32_16x16x32_bf16 v[100:103], a[24:27], a[36:39], v[100:103]
ds_read_b64_tr_b16 a[2:3], v160 offset:2048
v_mfma_f32_16x16x32_bf16 v[116:119], a[28:31], a[36:39], v[116:119]
ds_read_b64_tr_b16 a[4:5], v161 offset:0
v_mfma_f32_16x16x32_bf16 v[112:115], a[28:31], a[32:35], v[112:115]
ds_read_b64_tr_b16 a[6:7], v161 offset:2048
v_mfma_f32_16x16x32_bf16 v[120:123], a[28:31], a[40:43], v[120:123]
ds_read_b64_tr_b16 a[8:9], v162 offset:0
v_mfma_f32_16x16x32_bf16 v[124:127], a[28:31], a[44:47], v[124:127]
ds_read_b64_tr_b16 a[10:11], v162 offset:2048
v_mfma_f32_16x16x32_bf16 v[108:111], a[24:27], a[44:47], v[108:111]
ds_read_b64_tr_b16 a[12:13], v163 offset:0
v_mfma_f32_16x16x32_bf16 v[104:107], a[24:27], a[40:43], v[104:107]
ds_read_b64_tr_b16 a[14:15], v163 offset:2048
v_mfma_f32_16x16x32_bf16 v[88:91], a[20:23], a[40:43], v[88:91]
s_add_u32 m0, s66, 12288
s_add_u32 s64, s67, 1310848
buffer_load_dwordx4 v152, s[16:19], s64 offen offset:0 lds
v_mfma_f32_16x16x32_bf16 v[92:95], a[20:23], a[44:47], v[92:95]
buffer_load_dwordx4 v153, s[16:19], s64 offen offset:1024 lds
v_mfma_f32_16x16x32_bf16 v[76:79], a[16:19], a[44:47], v[76:79]
buffer_load_dwordx4 v154, s[16:19], s64 offen offset:2048 lds
v_mfma_f32_16x16x32_bf16 v[72:75], a[16:19], a[40:43], v[72:75]
buffer_load_dwordx4 v155, s[16:19], s64 offen offset:3072 lds
s_waitcnt vmcnt(8) lgkmcnt(0)
v_mfma_f32_16x16x32_bf16 v[0:3], a[0:3], a[48:51], v[0:3]
ds_read_b64_tr_b16 a[16:17], v160 offset:4096
v_mfma_f32_16x16x32_bf16 v[4:7], a[0:3], a[52:55], v[4:7]
ds_read_b64_tr_b16 a[18:19], v160 offset:6144
v_mfma_f32_16x16x32_bf16 v[20:23], a[4:7], a[52:55], v[20:23]
ds_read_b64_tr_b16 a[20:21], v161 offset:4096
v_mfma_f32_16x16x32_bf16 v[16:19], a[4:7], a[48:51], v[16:19]
ds_read_b64_tr_b16 a[22:23], v161 offset:6144
v_mfma_f32_16x16x32_bf16 v[32:35], a[8:11], a[48:51], v[32:35]
ds_read_b64_tr_b16 a[24:25], v162 offset:4096
v_mfma_f32_16x16x32_bf16 v[36:39], a[8:11], a[52:55], v[36:39]
ds_read_b64_tr_b16 a[26:27], v162 offset:6144
v_mfma_f32_16x16x32_bf16 v[52:55], a[12:15], a[52:55], v[52:55]
ds_read_b64_tr_b16 a[28:29], v163 offset:4096
v_mfma_f32_16x16x32_bf16 v[48:51], a[12:15], a[48:51], v[48:51]
ds_read_b64_tr_b16 a[30:31], v163 offset:6144
v_mfma_f32_16x16x32_bf16 v[56:59], a[12:15], a[56:59], v[56:59]
s_add_u32 m0, s66, 0
s_add_u32 s64, s67, 1572864
buffer_load_dwordx4 v152, s[16:19], s64 offen offset:0 lds
v_mfma_f32_16x16x32_bf16 v[60:63], a[12:15], a[60:63], v[60:63]
buffer_load_dwordx4 v153, s[16:19], s64 offen offset:1024 lds
v_mfma_f32_16x16x32_bf16 v[44:47], a[8:11], a[60:63], v[44:47]
buffer_load_dwordx4 v154, s[16:19], s64 offen offset:2048 lds
v_mfma_f32_16x16x32_bf16 v[40:43], a[8:11], a[56:59], v[40:43]
buffer_load_dwordx4 v155, s[16:19], s64 offen offset:3072 lds
v_mfma_f32_16x16x32_bf16 v[24:27], a[4:7], a[56:59], v[24:27]
v_mfma_f32_16x16x32_bf16 v[28:31], a[4:7], a[60:63], v[28:31]
v_mfma_f32_16x16x32_bf16 v[12:15], a[0:3], a[60:63], v[12:15]
v_mfma_f32_16x16x32_bf16 v[8:11], a[0:3], a[56:59], v[8:11]
s_waitcnt vmcnt(8) lgkmcnt(0)
v_mfma_f32_16x16x32_bf16 v[64:67], a[16:19], a[48:51], v[64:67]
ds_read_b128 a[64:67], v165 offset:8768
v_mfma_f32_16x16x32_bf16 v[68:71], a[16:19], a[52:55], v[68:71]
ds_read_b128 a[68:71], v165 offset:10944
v_mfma_f32_16x16x32_bf16 v[84:87], a[20:23], a[52:55], v[84:87]
ds_read_b128 a[72:75], v165 offset:13120
v_mfma_f32_16x16x32_bf16 v[80:83], a[20:23], a[48:51], v[80:83]
ds_read_b128 a[76:79], v165 offset:15296
v_mfma_f32_16x16x32_bf16 v[96:99], a[24:27], a[48:51], v[96:99]
ds_read_b64_tr_b16 a[0:1], v160 offset:8192
v_mfma_f32_16x16x32_bf16 v[100:103], a[24:27], a[52:55], v[100:103]
ds_read_b64_tr_b16 a[2:3], v160 offset:10240
v_mfma_f32_16x16x32_bf16 v[116:119], a[28:31], a[52:55], v[116:119]
ds_read_b64_tr_b16 a[4:5], v161 offset:8192
v_mfma_f32_16x16x32_bf16 v[112:115], a[28:31], a[48:51], v[112:115]
ds_read_b64_tr_b16 a[6:7], v161 offset:10240
v_mfma_f32_16x16x32_bf16 v[120:123], a[28:31], a[56:59], v[120:123]
ds_read_b64_tr_b16 a[8:9], v162 offset:8192
v_mfma_f32_16x16x32_bf16 v[124:127], a[28:31], a[60:63], v[124:127]
ds_read_b64_tr_b16 a[10:11], v162 offset:10240
v_mfma_f32_16x16x32_bf16 v[108:111], a[24:27], a[60:63], v[108:111]
ds_read_b64_tr_b16 a[12:13], v163 offset:8192
v_mfma_f32_16x16x32_bf16 v[104:107], a[24:27], a[56:59], v[104:107]
ds_read_b64_tr_b16 a[14:15], v163 offset:10240
v_mfma_f32_16x16x32_bf16 v[88:91], a[20:23], a[56:59], v[88:91]
s_add_u32 m0, s66, 4096
s_add_u32 s64, s67, 1572992
buffer_load_dwordx4 v152, s[16:19], s64 offen offset:0 lds
v_mfma_f32_16x16x32_bf16 v[92:95], a[20:23], a[60:63], v[92:95]
buffer_load_dwordx4 v153, s[16:19], s64 offen offset:1024 lds
v_mfma_f32_16x16x32_bf16 v[76:79], a[16:19], a[60:63], v[76:79]
buffer_load_dwordx4 v154, s[16:19], s64 offen offset:2048 lds
v_mfma_f32_16x16x32_bf16 v[72:75], a[16:19], a[56:59], v[72:75]
buffer_load_dwordx4 v155, s[16:19], s64 offen offset:3072 lds
s_waitcnt vmcnt(8) lgkmcnt(0)
v_mfma_f32_16x16x32_bf16 v[0:3], a[0:3], a[64:67], v[0:3]
ds_read_b64_tr_b16 a[16:17], v160 offset:12288
v_mfma_f32_16x16x32_bf16 v[4:7], a[0:3], a[68:71], v[4:7]
ds_read_b64_tr_b16 a[18:19], v160 offset:14336
v_mfma_f32_16x16x32_bf16 v[20:23], a[4:7], a[68:71], v[20:23]
ds_read_b64_tr_b16 a[20:21], v161 offset:12288
v_mfma_f32_16x16x32_bf16 v[16:19], a[4:7], a[64:67], v[16:19]
ds_read_b64_tr_b16 a[22:23], v161 offset:14336
v_mfma_f32_16x16x32_bf16 v[32:35], a[8:11], a[64:67], v[32:35]
ds_read_b64_tr_b16 a[24:25], v162 offset:12288
v_mfma_f32_16x16x32_bf16 v[36:39], a[8:11], a[68:71], v[36:39]
ds_read_b64_tr_b16 a[26:27], v162 offset:14336
v_mfma_f32_16x16x32_bf16 v[52:55], a[12:15], a[68:71], v[52:55]
ds_read_b64_tr_b16 a[28:29], v163 offset:12288
v_mfma_f32_16x16x32_bf16 v[48:51], a[12:15], a[64:67], v[48:51]
ds_read_b64_tr_b16 a[30:31], v163 offset:14336
v_mfma_f32_16x16x32_bf16 v[56:59], a[12:15], a[72:75], v[56:59]
s_add_u32 m0, s66, 8192
s_add_u32 s64, s67, 1835008
buffer_load_dwordx4 v152, s[16:19], s64 offen offset:0 lds
v_mfma_f32_16x16x32_bf16 v[60:63], a[12:15], a[76:79], v[60:63]
buffer_load_dwordx4 v153, s[16:19], s64 offen offset:1024 lds
v_mfma_f32_16x16x32_bf16 v[44:47], a[8:11], a[76:79], v[44:47]
buffer_load_dwordx4 v154, s[16:19], s64 offen offset:2048 lds
v_mfma_f32_16x16x32_bf16 v[40:43], a[8:11], a[72:75], v[40:43]
buffer_load_dwordx4 v155, s[16:19], s64 offen offset:3072 lds
v_mfma_f32_16x16x32_bf16 v[24:27], a[4:7], a[72:75], v[24:27]
v_mfma_f32_16x16x32_bf16 v[28:31], a[4:7], a[76:79], v[28:31]
v_mfma_f32_16x16x32_bf16 v[12:15], a[0:3], a[76:79], v[12:15]
v_mfma_f32_16x16x32_bf16 v[8:11], a[0:3], a[72:75], v[8:11]
s_waitcnt vmcnt(8) lgkmcnt(0)
v_mfma_f32_16x16x32_bf16 v[64:67], a[16:19], a[64:67], v[64:67]
ds_read_b128 a[32:35], v165 offset:17408
v_mfma_f32_16x16x32_bf16 v[68:71], a[16:19], a[68:71], v[68:71]
ds_read_b128 a[36:39], v165 offset:19584
v_mfma_f32_16x16x32_bf16 v[84:87], a[20:23], a[68:71], v[84:87]
ds_read_b128 a[40:43], v165 offset:21760
v_mfma_f32_16x16x32_bf16 v[80:83], a[20:23], a[64:67], v[80:83]
ds_read_b128 a[44:47], v165 offset:23936
v_mfma_f32_16x16x32_bf16 v[96:99], a[24:27], a[64:67], v[96:99]
ds_read_b64_tr_b16 a[0:1], v160 offset:0
v_mfma_f32_16x16x32_bf16 v[100:103], a[24:27], a[68:71], v[100:103]
ds_read_b64_tr_b16 a[2:3], v160 offset:2048
v_mfma_f32_16x16x32_bf16 v[116:119], a[28:31], a[68:71], v[116:119]
ds_read_b64_tr_b16 a[4:5], v161 offset:0
v_mfma_f32_16x16x32_bf16 v[112:115], a[28:31], a[64:67], v[112:115]
ds_read_b64_tr_b16 a[6:7], v161 offset:2048
v_mfma_f32_16x16x32_bf16 v[120:123], a[28:31], a[72:75], v[120:123]
ds_read_b64_tr_b16 a[8:9], v162 offset:0
v_mfma_f32_16x16x32_bf16 v[124:127], a[28:31], a[76:79], v[124:127]
ds_read_b64_tr_b16 a[10:11], v162 offset:2048
v_mfma_f32_16x16x32_bf16 v[108:111], a[24:27], a[76:79], v[108:111]
ds_read_b64_tr_b16 a[12:13], v163 offset:0
v_mfma_f32_16x16x32_bf16 v[104:107], a[24:27], a[72:75], v[104:107]
ds_read_b64_tr_b16 a[14:15], v163 offset:2048
v_mfma_f32_16x16x32_bf16 v[88:91], a[20:23], a[72:75], v[88:91]
s_add_u32 m0, s66, 12288
s_add_u32 s64, s67, 1835136
buffer_load_dwordx4 v152, s[16:19], s64 offen offset:0 lds
v_mfma_f32_16x16x32_bf16 v[92:95], a[20:23], a[76:79], v[92:95]
buffer_load_dwordx4 v153, s[16:19], s64 offen offset:1024 lds
v_mfma_f32_16x16x32_bf16 v[76:79], a[16:19], a[76:79], v[76:79]
buffer_load_dwordx4 v154, s[16:19], s64 offen offset:2048 lds
v_mfma_f32_16x16x32_bf16 v[72:75], a[16:19], a[72:75], v[72:75]
buffer_load_dwordx4 v155, s[16:19], s64 offen offset:3072 lds
s_waitcnt vmcnt(8) lgkmcnt(0)
v_mfma_f32_16x16x32_bf16 v[0:3], a[0:3], a[32:35], v[0:3]
ds_read_b64_tr_b16 a[16:17], v160 offset:4096
v_mfma_f32_16x16x32_bf16 v[4:7], a[0:3], a[36:39], v[4:7]
ds_read_b64_tr_b16 a[18:19], v160 offset:6144
v_mfma_f32_16x16x32_bf16 v[20:23], a[4:7], a[36:39], v[20:23]
ds_read_b64_tr_b16 a[20:21], v161 offset:4096
v_mfma_f32_16x16x32_bf16 v[16:19], a[4:7], a[32:35], v[16:19]
ds_read_b64_tr_b16 a[22:23], v161 offset:6144
v_mfma_f32_16x16x32_bf16 v[32:35], a[8:11], a[32:35], v[32:35]
ds_read_b64_tr_b16 a[24:25], v162 offset:4096
v_mfma_f32_16x16x32_bf16 v[36:39], a[8:11], a[36:39], v[36:39]
ds_read_b64_tr_b16 a[26:27], v162 offset:6144
v_mfma_f32_16x16x32_bf16 v[52:55], a[12:15], a[36:39], v[52:55]
ds_read_b64_tr_b16 a[28:29], v163 offset:4096
v_mfma_f32_16x16x32_bf16 v[48:51], a[12:15], a[32:35], v[48:51]
ds_read_b64_tr_b16 a[30:31], v163 offset:6144
v_mfma_f32_16x16x32_bf16 v[56:59], a[12:15], a[40:43], v[56:59]
s_add_u32 m0, s66, 0
s_add_u32 s64, s67, 2097152
buffer_load_dwordx4 v152, s[16:19], s64 offen offset:0 lds
v_mfma_f32_16x16x32_bf16 v[60:63], a[12:15], a[44:47], v[60:63]
buffer_load_dwordx4 v153, s[16:19], s64 offen offset:1024 lds
v_mfma_f32_16x16x32_bf16 v[44:47], a[8:11], a[44:47], v[44:47]
buffer_load_dwordx4 v154, s[16:19], s64 offen offset:2048 lds
v_mfma_f32_16x16x32_bf16 v[40:43], a[8:11], a[40:43], v[40:43]
buffer_load_dwordx4 v155, s[16:19], s64 offen offset:3072 lds
v_mfma_f32_16x16x32_bf16 v[24:27], a[4:7], a[40:43], v[24:27]
v_mfma_f32_16x16x32_bf16 v[28:31], a[4:7], a[44:47], v[28:31]
v_mfma_f32_16x16x32_bf16 v[12:15], a[0:3], a[44:47], v[12:15]
v_mfma_f32_16x16x32_bf16 v[8:11], a[0:3], a[40:43], v[8:11]
s_waitcnt vmcnt(8) lgkmcnt(0)
v_mfma_f32_16x16x32_bf16 v[64:67], a[16:19], a[32:35], v[64:67]
ds_read_b128 a[48:51], v165 offset:17472
v_mfma_f32_16x16x32_bf16 v[68:71], a[16:19], a[36:39], v[68:71]
ds_read_b128 a[52:55], v165 offset:19648
v_mfma_f32_16x16x32_bf16 v[84:87], a[20:23], a[36:39], v[84:87]
ds_read_b128 a[56:59], v165 offset:21824
v_mfma_f32_16x16x32_bf16 v[80:83], a[20:23], a[32:35], v[80:83]
ds_read_b128 a[60:63], v165 offset:24000
v_mfma_f32_16x16x32_bf16 v[96:99], a[24:27], a[32:35], v[96:99]
ds_read_b64_tr_b16 a[0:1], v160 offset:8192
v_mfma_f32_16x16x32_bf16 v[100:103], a[24:27], a[36:39], v[100:103]
ds_read_b64_tr_b16 a[2:3], v160 offset:10240
v_mfma_f32_16x16x32_bf16 v[116:119], a[28:31], a[36:39], v[116:119]
ds_read_b64_tr_b16 a[4:5], v161 offset:8192
v_mfma_f32_16x16x32_bf16 v[112:115], a[28:31], a[32:35], v[112:115]
ds_read_b64_tr_b16 a[6:7], v161 offset:10240
v_mfma_f32_16x16x32_bf16 v[120:123], a[28:31], a[40:43], v[120:123]
ds_read_b64_tr_b16 a[8:9], v162 offset:8192
v_mfma_f32_16x16x32_bf16 v[124:127], a[28:31], a[44:47], v[124:127]
ds_read_b64_tr_b16 a[10:11], v162 offset:10240
v_mfma_f32_16x16x32_bf16 v[108:111], a[24:27], a[44:47], v[108:111]
ds_read_b64_tr_b16 a[12:13], v163 offset:8192
v_mfma_f32_16x16x32_bf16 v[104:107], a[24:27], a[40:43], v[104:107]
ds_read_b64_tr_b16 a[14:15], v163 offset:10240
v_mfma_f32_16x16x32_bf16 v[88:91], a[20:23], a[40:43], v[88:91]
s_add_u32 m0, s66, 4096
s_add_u32 s64, s67, 2097280
buffer_load_dwordx4 v152, s[16:19], s64 offen offset:0 lds
v_mfma_f32_16x16x32_bf16 v[92:95], a[20:23], a[44:47], v[92:95]
buffer_load_dwordx4 v153, s[16:19], s64 offen offset:1024 lds
v_mfma_f32_16x16x32_bf16 v[76:79], a[16:19], a[44:47], v[76:79]
buffer_load_dwordx4 v154, s[16:19], s64 offen offset:2048 lds
v_mfma_f32_16x16x32_bf16 v[72:75], a[16:19], a[40:43], v[72:75]
buffer_load_dwordx4 v155, s[16:19], s64 offen offset:3072 lds
s_waitcnt vmcnt(8) lgkmcnt(0)
v_mfma_f32_16x16x32_bf16 v[0:3], a[0:3], a[48:51], v[0:3]
ds_read_b64_tr_b16 a[16:17], v160 offset:12288
v_mfma_f32_16x16x32_bf16 v[4:7], a[0:3], a[52:55], v[4:7]
ds_read_b64_tr_b16 a[18:19], v160 offset:14336
v_mfma_f32_16x16x32_bf16 v[20:23], a[4:7], a[52:55], v[20:23]
ds_read_b64_tr_b16 a[20:21], v161 offset:12288
v_mfma_f32_16x16x32_bf16 v[16:19], a[4:7], a[48:51], v[16:19]
ds_read_b64_tr_b16 a[22:23], v161 offset:14336
v_mfma_f32_16x16x32_bf16 v[32:35], a[8:11], a[48:51], v[32:35]
ds_read_b64_tr_b16 a[24:25], v162 offset:12288
v_mfma_f32_16x16x32_bf16 v[36:39], a[8:11], a[52:55], v[36:39]
ds_read_b64_tr_b16 a[26:27], v162 offset:14336
v_mfma_f32_16x16x32_bf16 v[52:55], a[12:15], a[52:55], v[52:55]
ds_read_b64_tr_b16 a[28:29], v163 offset:12288
v_mfma_f32_16x16x32_bf16 v[48:51], a[12:15], a[48:51], v[48:51]
ds_read_b64_tr_b16 a[30:31], v163 offset:14336
v_mfma_f32_16x16x32_bf16 v[56:59], a[12:15], a[56:59], v[56:59]
s_add_u32 m0, s66, 8192
s_add_u32 s64, s67, 2359296
buffer_load_dwordx4 v152, s[16:19], s64 offen offset:0 lds
v_mfma_f32_16x16x32_bf16 v[60:63], a[12:15], a[60:63], v[60:63]
buffer_load_dwordx4 v153, s[16:19], s64 offen offset:1024 lds
v_mfma_f32_16x16x32_bf16 v[44:47], a[8:11], a[60:63], v[44:47]
buffer_load_dwordx4 v154, s[16:19], s64 offen offset:2048 lds
v_mfma_f32_16x16x32_bf16 v[40:43], a[8:11], a[56:59], v[40:43]
buffer_load_dwordx4 v155, s[16:19], s64 offen offset:3072 lds
v_mfma_f32_16x16x32_bf16 v[24:27], a[4:7], a[56:59], v[24:27]
v_mfma_f32_16x16x32_bf16 v[28:31], a[4:7], a[60:63], v[28:31]
v_mfma_f32_16x16x32_bf16 v[12:15], a[0:3], a[60:63], v[12:15]
v_mfma_f32_16x16x32_bf16 v[8:11], a[0:3], a[56:59], v[8:11]
s_waitcnt vmcnt(8) lgkmcnt(0)
v_mfma_f32_16x16x32_bf16 v[64:67], a[16:19], a[48:51], v[64:67]
ds_read_b128 a[64:67], v165 offset:26112
v_mfma_f32_16x16x32_bf16 v[68:71], a[16:19], a[52:55], v[68:71]
ds_read_b128 a[68:71], v165 offset:28288
v_mfma_f32_16x16x32_bf16 v[84:87], a[20:23], a[52:55], v[84:87]
ds_read_b128 a[72:75], v165 offset:30464
v_mfma_f32_16x16x32_bf16 v[80:83], a[20:23], a[48:51], v[80:83]
ds_read_b128 a[76:79], v165 offset:32640
v_mfma_f32_16x16x32_bf16 v[96:99], a[24:27], a[48:51], v[96:99]
ds_read_b64_tr_b16 a[0:1], v160 offset:0
v_mfma_f32_16x16x32_bf16 v[100:103], a[24:27], a[52:55], v[100:103]
ds_read_b64_tr_b16 a[2:3], v160 offset:2048
v_mfma_f32_16x16x32_bf16 v[116:119], a[28:31], a[52:55], v[116:119]
ds_read_b64_tr_b16 a[4:5], v161 offset:0
v_mfma_f32_16x16x32_bf16 v[112:115], a[28:31], a[48:51], v[112:115]
ds_read_b64_tr_b16 a[6:7], v161 offset:2048
v_mfma_f32_16x16x32_bf16 v[120:123], a[28:31], a[56:59], v[120:123]
ds_read_b64_tr_b16 a[8:9], v162 offset:0
v_mfma_f32_16x16x32_bf16 v[124:127], a[28:31], a[60:63], v[124:127]
ds_read_b64_tr_b16 a[10:11], v162 offset:2048
v_mfma_f32_16x16x32_bf16 v[108:111], a[24:27], a[60:63], v[108:111]
ds_read_b64_tr_b16 a[12:13], v163 offset:0
v_mfma_f32_16x16x32_bf16 v[104:107], a[24:27], a[56:59], v[104:107]
ds_read_b64_tr_b16 a[14:15], v163 offset:2048
v_mfma_f32_16x16x32_bf16 v[88:91], a[20:23], a[56:59], v[88:91]
s_add_u32 m0, s66, 12288
s_add_u32 s64, s67, 2359424
buffer_load_dwordx4 v152, s[16:19], s64 offen offset:0 lds
v_mfma_f32_16x16x32_bf16 v[92:95], a[20:23], a[60:63], v[92:95]
buffer_load_dwordx4 v153, s[16:19], s64 offen offset:1024 lds
v_mfma_f32_16x16x32_bf16 v[76:79], a[16:19], a[60:63], v[76:79]
buffer_load_dwordx4 v154, s[16:19], s64 offen offset:2048 lds
v_mfma_f32_16x16x32_bf16 v[72:75], a[16:19], a[56:59], v[72:75]
buffer_load_dwordx4 v155, s[16:19], s64 offen offset:3072 lds
s_waitcnt vmcnt(8) lgkmcnt(0)
v_mfma_f32_16x16x32_bf16 v[0:3], a[0:3], a[64:67], v[0:3]
ds_read_b64_tr_b16 a[16:17], v160 offset:4096
v_mfma_f32_16x16x32_bf16 v[4:7], a[0:3], a[68:71], v[4:7]
ds_read_b64_tr_b16 a[18:19], v160 offset:6144
v_mfma_f32_16x16x32_bf16 v[20:23], a[4:7], a[68:71], v[20:23]
ds_read_b64_tr_b16 a[20:21], v161 offset:4096
v_mfma_f32_16x16x32_bf16 v[16:19], a[4:7], a[64:67], v[16:19]
ds_read_b64_tr_b16 a[22:23], v161 offset:6144
v_mfma_f32_16x16x32_bf16 v[32:35], a[8:11], a[64:67], v[32:35]
ds_read_b64_tr_b16 a[24:25], v162 offset:4096
v_mfma_f32_16x16x32_bf16 v[36:39], a[8:11], a[68:71], v[36:39]
ds_read_b64_tr_b16 a[26:27], v162 offset:6144
v_mfma_f32_16x16x32_bf16 v[52:55], a[12:15], a[68:71], v[52:55]
ds_read_b64_tr_b16 a[28:29], v163 offset:4096
v_mfma_f32_16x16x32_bf16 v[48:51], a[12:15], a[64:67], v[48:51]
ds_read_b64_tr_b16 a[30:31], v163 offset:6144
v_mfma_f32_16x16x32_bf16 v[56:59], a[12:15], a[72:75], v[56:59]
s_add_u32 m0, s66, 0
s_add_u32 s64, s67, 2621440
buffer_load_dwordx4 v152, s[16:19], s64 offen offset:0 lds
v_mfma_f32_16x16x32_bf16 v[60:63], a[12:15], a[76:79], v[60:63]
buffer_load_dwordx4 v153, s[16:19], s64 offen offset:1024 lds
v_mfma_f32_16x16x32_bf16 v[44:47], a[8:11], a[76:79], v[44:47]
buffer_load_dwordx4 v154, s[16:19], s64 offen offset:2048 lds
v_mfma_f32_16x16x32_bf16 v[40:43], a[8:11], a[72:75], v[40:43]
buffer_load_dwordx4 v155, s[16:19], s64 offen offset:3072 lds
v_mfma_f32_16x16x32_bf16 v[24:27], a[4:7], a[72:75], v[24:27]
v_mfma_f32_16x16x32_bf16 v[28:31], a[4:7], a[76:79], v[28:31]
v_mfma_f32_16x16x32_bf16 v[12:15], a[0:3], a[76:79], v[12:15]
v_mfma_f32_16x16x32_bf16 v[8:11], a[0:3], a[72:75], v[8:11]
s_waitcnt vmcnt(8) lgkmcnt(0)
v_mfma_f32_16x16x32_bf16 v[64:67], a[16:19], a[64:67], v[64:67]
ds_read_b128 a[32:35], v165 offset:26176
v_mfma_f32_16x16x32_bf16 v[68:71], a[16:19], a[68:71], v[68:71]
ds_read_b128 a[36:39], v165 offset:28352
v_mfma_f32_16x16x32_bf16 v[84:87], a[20:23], a[68:71], v[84:87]
ds_read_b128 a[40:43], v165 offset:30528
v_mfma_f32_16x16x32_bf16 v[80:83], a[20:23], a[64:67], v[80:83]
ds_read_b128 a[44:47], v165 offset:32704
v_mfma_f32_16x16x32_bf16 v[96:99], a[24:27], a[64:67], v[96:99]
ds_read_b64_tr_b16 a[0:1], v160 offset:8192
v_mfma_f32_16x16x32_bf16 v[100:103], a[24:27], a[68:71], v[100:103]
ds_read_b64_tr_b16 a[2:3], v160 offset:10240
v_mfma_f32_16x16x32_bf16 v[116:119], a[28:31], a[68:71], v[116:119]
ds_read_b64_tr_b16 a[4:5], v161 offset:8192
v_mfma_f32_16x16x32_bf16 v[112:115], a[28:31], a[64:67], v[112:115]
ds_read_b64_tr_b16 a[6:7], v161 offset:10240
v_mfma_f32_16x16x32_bf16 v[120:123], a[28:31], a[72:75], v[120:123]
ds_read_b64_tr_b16 a[8:9], v162 offset:8192
v_mfma_f32_16x16x32_bf16 v[124:127], a[28:31], a[76:79], v[124:127]
ds_read_b64_tr_b16 a[10:11], v162 offset:10240
v_mfma_f32_16x16x32_bf16 v[108:111], a[24:27], a[76:79], v[108:111]
ds_read_b64_tr_b16 a[12:13], v163 offset:8192
v_mfma_f32_16x16x32_bf16 v[104:107], a[24:27], a[72:75], v[104:107]
ds_read_b64_tr_b16 a[14:15], v163 offset:10240
v_mfma_f32_16x16x32_bf16 v[88:91], a[20:23], a[72:75], v[88:91]
s_add_u32 m0, s66, 4096
s_add_u32 s64, s67, 2621568
buffer_load_dwordx4 v152, s[16:19], s64 offen offset:0 lds
v_mfma_f32_16x16x32_bf16 v[92:95], a[20:23], a[76:79], v[92:95]
buffer_load_dwordx4 v153, s[16:19], s64 offen offset:1024 lds
v_mfma_f32_16x16x32_bf16 v[76:79], a[16:19], a[76:79], v[76:79]
buffer_load_dwordx4 v154, s[16:19], s64 offen offset:2048 lds
v_mfma_f32_16x16x32_bf16 v[72:75], a[16:19], a[72:75], v[72:75]
buffer_load_dwordx4 v155, s[16:19], s64 offen offset:3072 lds
s_waitcnt vmcnt(8) lgkmcnt(0)
v_mfma_f32_16x16x32_bf16 v[0:3], a[0:3], a[32:35], v[0:3]
ds_read_b64_tr_b16 a[16:17], v160 offset:12288
v_mfma_f32_16x16x32_bf16 v[4:7], a[0:3], a[36:39], v[4:7]
ds_read_b64_tr_b16 a[18:19], v160 offset:14336
v_mfma_f32_16x16x32_bf16 v[20:23], a[4:7], a[36:39], v[20:23]
ds_read_b64_tr_b16 a[20:21], v161 offset:12288
v_mfma_f32_16x16x32_bf16 v[16:19], a[4:7], a[32:35], v[16:19]
ds_read_b64_tr_b16 a[22:23], v161 offset:14336
v_mfma_f32_16x16x32_bf16 v[32:35], a[8:11], a[32:35], v[32:35]
ds_read_b64_tr_b16 a[24:25], v162 offset:12288
v_mfma_f32_16x16x32_bf16 v[36:39], a[8:11], a[36:39], v[36:39]
ds_read_b64_tr_b16 a[26:27], v162 offset:14336
v_mfma_f32_16x16x32_bf16 v[52:55], a[12:15], a[36:39], v[52:55]
ds_read_b64_tr_b16 a[28:29], v163 offset:12288
v_mfma_f32_16x16x32_bf16 v[48:51], a[12:15], a[32:35], v[48:51]
ds_read_b64_tr_b16 a[30:31], v163 offset:14336
v_mfma_f32_16x16x32_bf16 v[56:59], a[12:15], a[40:43], v[56:59]
s_add_u32 m0, s66, 8192
s_add_u32 s64, s67, 2883584
buffer_load_dwordx4 v152, s[16:19], s64 offen offset:0 lds
v_mfma_f32_16x16x32_bf16 v[60:63], a[12:15], a[44:47], v[60:63]
buffer_load_dwordx4 v153, s[16:19], s64 offen offset:1024 lds
v_mfma_f32_16x16x32_bf16 v[44:47], a[8:11], a[44:47], v[44:47]
buffer_load_dwordx4 v154, s[16:19], s64 offen offset:2048 lds
v_mfma_f32_16x16x32_bf16 v[40:43], a[8:11], a[40:43], v[40:43]
buffer_load_dwordx4 v155, s[16:19], s64 offen offset:3072 lds
v_mfma_f32_16x16x32_bf16 v[24:27], a[4:7], a[40:43], v[24:27]
v_mfma_f32_16x16x32_bf16 v[28:31], a[4:7], a[44:47], v[28:31]
v_mfma_f32_16x16x32_bf16 v[12:15], a[0:3], a[44:47], v[12:15]
v_mfma_f32_16x16x32_bf16 v[8:11], a[0:3], a[40:43], v[8:11]
s_waitcnt vmcnt(8) lgkmcnt(0)
v_mfma_f32_16x16x32_bf16 v[64:67], a[16:19], a[32:35], v[64:67]
ds_read_b128 a[48:51], v164 offset:0
v_mfma_f32_16x16x32_bf16 v[68:71], a[16:19], a[36:39], v[68:71]
ds_read_b128 a[52:55], v164 offset:2176
v_mfma_f32_16x16x32_bf16 v[84:87], a[20:23], a[36:39], v[84:87]
ds_read_b128 a[56:59], v164 offset:4352
v_mfma_f32_16x16x32_bf16 v[80:83], a[20:23], a[32:35], v[80:83]
ds_read_b128 a[60:63], v164 offset:6528
v_mfma_f32_16x16x32_bf16 v[96:99], a[24:27], a[32:35], v[96:99]
ds_read_b64_tr_b16 a[0:1], v160 offset:0
v_mfma_f32_16x16x32_bf16 v[100:103], a[24:27], a[36:39], v[100:103]
ds_read_b64_tr_b16 a[2:3], v160 offset:2048
v_mfma_f32_16x16x32_bf16 v[116:119], a[28:31], a[36:39], v[116:119]
ds_read_b64_tr_b16 a[4:5], v161 offset:0
v_mfma_f32_16x16x32_bf16 v[112:115], a[28:31], a[32:35], v[112:115]
ds_read_b64_tr_b16 a[6:7], v161 offset:2048
v_mfma_f32_16x16x32_bf16 v[120:123], a[28:31], a[40:43], v[120:123]
ds_read_b64_tr_b16 a[8:9], v162 offset:0
v_mfma_f32_16x16x32_bf16 v[124:127], a[28:31], a[44:47], v[124:127]
ds_read_b64_tr_b16 a[10:11], v162 offset:2048
v_mfma_f32_16x16x32_bf16 v[108:111], a[24:27], a[44:47], v[108:111]
ds_read_b64_tr_b16 a[12:13], v163 offset:0
v_mfma_f32_16x16x32_bf16 v[104:107], a[24:27], a[40:43], v[104:107]
ds_read_b64_tr_b16 a[14:15], v163 offset:2048
v_mfma_f32_16x16x32_bf16 v[88:91], a[20:23], a[40:43], v[88:91]
s_add_u32 m0, s66, 12288
s_add_u32 s64, s67, 2883712
buffer_load_dwordx4 v152, s[16:19], s64 offen offset:0 lds
v_mfma_f32_16x16x32_bf16 v[92:95], a[20:23], a[44:47], v[92:95]
buffer_load_dwordx4 v153, s[16:19], s64 offen offset:1024 lds
v_mfma_f32_16x16x32_bf16 v[76:79], a[16:19], a[44:47], v[76:79]
buffer_load_dwordx4 v154, s[16:19], s64 offen offset:2048 lds
v_mfma_f32_16x16x32_bf16 v[72:75], a[16:19], a[40:43], v[72:75]
buffer_load_dwordx4 v155, s[16:19], s64 offen offset:3072 lds
s_waitcnt vmcnt(8) lgkmcnt(0)
v_mfma_f32_16x16x32_bf16 v[0:3], a[0:3], a[48:51], v[0:3]
ds_read_b64_tr_b16 a[16:17], v160 offset:4096
v_mfma_f32_16x16x32_bf16 v[4:7], a[0:3], a[52:55], v[4:7]
ds_read_b64_tr_b16 a[18:19], v160 offset:6144
v_mfma_f32_16x16x32_bf16 v[20:23], a[4:7], a[52:55], v[20:23]
ds_read_b64_tr_b16 a[20:21], v161 offset:4096
v_mfma_f32_16x16x32_bf16 v[16:19], a[4:7], a[48:51], v[16:19]
ds_read_b64_tr_b16 a[22:23], v161 offset:6144
v_mfma_f32_16x16x32_bf16 v[32:35], a[8:11], a[48:51], v[32:35]
ds_read_b64_tr_b16 a[24:25], v162 offset:4096
v_mfma_f32_16x16x32_bf16 v[36:39], a[8:11], a[52:55], v[36:39]
ds_read_b64_tr_b16 a[26:27], v162 offset:6144
v_mfma_f32_16x16x32_bf16 v[52:55], a[12:15], a[52:55], v[52:55]
ds_read_b64_tr_b16 a[28:29], v163 offset:4096
v_mfma_f32_16x16x32_bf16 v[48:51], a[12:15], a[48:51], v[48:51]
ds_read_b64_tr_b16 a[30:31], v163 offset:6144
v_mfma_f32_16x16x32_bf16 v[56:59], a[12:15], a[56:59], v[56:59]
s_add_u32 m0, s66, 0
s_add_u32 s64, s67, 3145728
buffer_load_dwordx4 v152, s[16:19], s64 offen offset:0 lds
v_mfma_f32_16x16x32_bf16 v[60:63], a[12:15], a[60:63], v[60:63]
buffer_load_dwordx4 v153, s[16:19], s64 offen offset:1024 lds
v_mfma_f32_16x16x32_bf16 v[44:47], a[8:11], a[60:63], v[44:47]
buffer_load_dwordx4 v154, s[16:19], s64 offen offset:2048 lds
v_mfma_f32_16x16x32_bf16 v[40:43], a[8:11], a[56:59], v[40:43]
buffer_load_dwordx4 v155, s[16:19], s64 offen offset:3072 lds
v_mfma_f32_16x16x32_bf16 v[24:27], a[4:7], a[56:59], v[24:27]
v_mfma_f32_16x16x32_bf16 v[28:31], a[4:7], a[60:63], v[28:31]
v_mfma_f32_16x16x32_bf16 v[12:15], a[0:3], a[60:63], v[12:15]
v_mfma_f32_16x16x32_bf16 v[8:11], a[0:3], a[56:59], v[8:11]
s_waitcnt vmcnt(8) lgkmcnt(0)
v_mfma_f32_16x16x32_bf16 v[64:67], a[16:19], a[48:51], v[64:67]
ds_read_b128 a[64:67], v164 offset:64
v_mfma_f32_16x16x32_bf16 v[68:71], a[16:19], a[52:55], v[68:71]
ds_read_b128 a[68:71], v164 offset:2240
v_mfma_f32_16x16x32_bf16 v[84:87], a[20:23], a[52:55], v[84:87]
ds_read_b128 a[72:75], v164 offset:4416
v_mfma_f32_16x16x32_bf16 v[80:83], a[20:23], a[48:51], v[80:83]
ds_read_b128 a[76:79], v164 offset:6592
v_mfma_f32_16x16x32_bf16 v[96:99], a[24:27], a[48:51], v[96:99]
ds_read_b64_tr_b16 a[0:1], v160 offset:8192
v_mfma_f32_16x16x32_bf16 v[100:103], a[24:27], a[52:55], v[100:103]
ds_read_b64_tr_b16 a[2:3], v160 offset:10240
v_mfma_f32_16x16x32_bf16 v[116:119], a[28:31], a[52:55], v[116:119]
ds_read_b64_tr_b16 a[4:5], v161 offset:8192
v_mfma_f32_16x16x32_bf16 v[112:115], a[28:31], a[48:51], v[112:115]
ds_read_b64_tr_b16 a[6:7], v161 offset:10240
v_mfma_f32_16x16x32_bf16 v[120:123], a[28:31], a[56:59], v[120:123]
ds_read_b64_tr_b16 a[8:9], v162 offset:8192
v_mfma_f32_16x16x32_bf16 v[124:127], a[28:31], a[60:63], v[124:127]
ds_read_b64_tr_b16 a[10:11], v162 offset:10240
v_mfma_f32_16x16x32_bf16 v[108:111], a[24:27], a[60:63], v[108:111]
ds_read_b64_tr_b16 a[12:13], v163 offset:8192
v_mfma_f32_16x16x32_bf16 v[104:107], a[24:27], a[56:59], v[104:107]
ds_read_b64_tr_b16 a[14:15], v163 offset:10240
v_mfma_f32_16x16x32_bf16 v[88:91], a[20:23], a[56:59], v[88:91]
s_add_u32 m0, s66, 4096
s_add_u32 s64, s67, 3145856
buffer_load_dwordx4 v152, s[16:19], s64 offen offset:0 lds
v_mfma_f32_16x16x32_bf16 v[92:95], a[20:23], a[60:63], v[92:95]
buffer_load_dwordx4 v153, s[16:19], s64 offen offset:1024 lds
v_mfma_f32_16x16x32_bf16 v[76:79], a[16:19], a[60:63], v[76:79]
buffer_load_dwordx4 v154, s[16:19], s64 offen offset:2048 lds
v_mfma_f32_16x16x32_bf16 v[72:75], a[16:19], a[56:59], v[72:75]
buffer_load_dwordx4 v155, s[16:19], s64 offen offset:3072 lds
s_waitcnt vmcnt(8) lgkmcnt(0)
v_mfma_f32_16x16x32_bf16 v[0:3], a[0:3], a[64:67], v[0:3]
ds_read_b64_tr_b16 a[16:17], v160 offset:12288
v_mfma_f32_16x16x32_bf16 v[4:7], a[0:3], a[68:71], v[4:7]
ds_read_b64_tr_b16 a[18:19], v160 offset:14336
v_mfma_f32_16x16x32_bf16 v[20:23], a[4:7], a[68:71], v[20:23]
ds_read_b64_tr_b16 a[20:21], v161 offset:12288
v_mfma_f32_16x16x32_bf16 v[16:19], a[4:7], a[64:67], v[16:19]
ds_read_b64_tr_b16 a[22:23], v161 offset:14336
v_mfma_f32_16x16x32_bf16 v[32:35], a[8:11], a[64:67], v[32:35]
ds_read_b64_tr_b16 a[24:25], v162 offset:12288
v_mfma_f32_16x16x32_bf16 v[36:39], a[8:11], a[68:71], v[36:39]
ds_read_b64_tr_b16 a[26:27], v162 offset:14336
v_mfma_f32_16x16x32_bf16 v[52:55], a[12:15], a[68:71], v[52:55]
ds_read_b64_tr_b16 a[28:29], v163 offset:12288
v_mfma_f32_16x16x32_bf16 v[48:51], a[12:15], a[64:67], v[48:51]
ds_read_b64_tr_b16 a[30:31], v163 offset:14336
v_mfma_f32_16x16x32_bf16 v[56:59], a[12:15], a[72:75], v[56:59]
s_add_u32 m0, s66, 8192
s_add_u32 s64, s67, 3407872
buffer_load_dwordx4 v152, s[16:19], s64 offen offset:0 lds
v_mfma_f32_16x16x32_bf16 v[60:63], a[12:15], a[76:79], v[60:63]
buffer_load_dwordx4 v153, s[16:19], s64 offen offset:1024 lds
v_mfma_f32_16x16x32_bf16 v[44:47], a[8:11], a[76:79], v[44:47]
buffer_load_dwordx4 v154, s[16:19], s64 offen offset:2048 lds
v_mfma_f32_16x16x32_bf16 v[40:43], a[8:11], a[72:75], v[40:43]
buffer_load_dwordx4 v155, s[16:19], s64 offen offset:3072 lds
v_mfma_f32_16x16x32_bf16 v[24:27], a[4:7], a[72:75], v[24:27]
v_mfma_f32_16x16x32_bf16 v[28:31], a[4:7], a[76:79], v[28:31]
v_mfma_f32_16x16x32_bf16 v[12:15], a[0:3], a[76:79], v[12:15]
v_mfma_f32_16x16x32_bf16 v[8:11], a[0:3], a[72:75], v[8:11]
s_waitcnt vmcnt(8) lgkmcnt(0)
v_mfma_f32_16x16x32_bf16 v[64:67], a[16:19], a[64:67], v[64:67]
ds_read_b128 a[32:35], v164 offset:8704
v_mfma_f32_16x16x32_bf16 v[68:71], a[16:19], a[68:71], v[68:71]
ds_read_b128 a[36:39], v164 offset:10880
v_mfma_f32_16x16x32_bf16 v[84:87], a[20:23], a[68:71], v[84:87]
ds_read_b128 a[40:43], v164 offset:13056
v_mfma_f32_16x16x32_bf16 v[80:83], a[20:23], a[64:67], v[80:83]
ds_read_b128 a[44:47], v164 offset:15232
v_mfma_f32_16x16x32_bf16 v[96:99], a[24:27], a[64:67], v[96:99]
ds_read_b64_tr_b16 a[0:1], v160 offset:0
v_mfma_f32_16x16x32_bf16 v[100:103], a[24:27], a[68:71], v[100:103]
ds_read_b64_tr_b16 a[2:3], v160 offset:2048
v_mfma_f32_16x16x32_bf16 v[116:119], a[28:31], a[68:71], v[116:119]
ds_read_b64_tr_b16 a[4:5], v161 offset:0
v_mfma_f32_16x16x32_bf16 v[112:115], a[28:31], a[64:67], v[112:115]
ds_read_b64_tr_b16 a[6:7], v161 offset:2048
v_mfma_f32_16x16x32_bf16 v[120:123], a[28:31], a[72:75], v[120:123]
ds_read_b64_tr_b16 a[8:9], v162 offset:0
v_mfma_f32_16x16x32_bf16 v[124:127], a[28:31], a[76:79], v[124:127]
ds_read_b64_tr_b16 a[10:11], v162 offset:2048
v_mfma_f32_16x16x32_bf16 v[108:111], a[24:27], a[76:79], v[108:111]
ds_read_b64_tr_b16 a[12:13], v163 offset:0
v_mfma_f32_16x16x32_bf16 v[104:107], a[24:27], a[72:75], v[104:107]
ds_read_b64_tr_b16 a[14:15], v163 offset:2048
v_mfma_f32_16x16x32_bf16 v[88:91], a[20:23], a[72:75], v[88:91]
s_add_u32 m0, s66, 12288
s_add_u32 s64, s67, 3408000
buffer_load_dwordx4 v152, s[16:19], s64 offen offset:0 lds
v_mfma_f32_16x16x32_bf16 v[92:95], a[20:23], a[76:79], v[92:95]
buffer_load_dwordx4 v153, s[16:19], s64 offen offset:1024 lds
v_mfma_f32_16x16x32_bf16 v[76:79], a[16:19], a[76:79], v[76:79]
buffer_load_dwordx4 v154, s[16:19], s64 offen offset:2048 lds
v_mfma_f32_16x16x32_bf16 v[72:75], a[16:19], a[72:75], v[72:75]
buffer_load_dwordx4 v155, s[16:19], s64 offen offset:3072 lds
s_waitcnt vmcnt(8) lgkmcnt(0)
v_mfma_f32_16x16x32_bf16 v[0:3], a[0:3], a[32:35], v[0:3]
ds_read_b64_tr_b16 a[16:17], v160 offset:4096
v_mfma_f32_16x16x32_bf16 v[4:7], a[0:3], a[36:39], v[4:7]
ds_read_b64_tr_b16 a[18:19], v160 offset:6144
v_mfma_f32_16x16x32_bf16 v[20:23], a[4:7], a[36:39], v[20:23]
ds_read_b64_tr_b16 a[20:21], v161 offset:4096
v_mfma_f32_16x16x32_bf16 v[16:19], a[4:7], a[32:35], v[16:19]
ds_read_b64_tr_b16 a[22:23], v161 offset:6144
v_mfma_f32_16x16x32_bf16 v[32:35], a[8:11], a[32:35], v[32:35]
ds_read_b64_tr_b16 a[24:25], v162 offset:4096
v_mfma_f32_16x16x32_bf16 v[36:39], a[8:11], a[36:39], v[36:39]
ds_read_b64_tr_b16 a[26:27], v162 offset:6144
v_mfma_f32_16x16x32_bf16 v[52:55], a[12:15], a[36:39], v[52:55]
ds_read_b64_tr_b16 a[28:29], v163 offset:4096
v_mfma_f32_16x16x32_bf16 v[48:51], a[12:15], a[32:35], v[48:51]
ds_read_b64_tr_b16 a[30:31], v163 offset:6144
v_mfma_f32_16x16x32_bf16 v[56:59], a[12:15], a[40:43], v[56:59]
s_add_u32 m0, s68, 0
s_add_u32 s64, s32, 0
buffer_load_dwordx4 v169, s[8:11], s64 offen nt lds
v_mfma_f32_16x16x32_bf16 v[60:63], a[12:15], a[44:47], v[60:63]
s_add_u32 m0, s68, 1056
s_add_u32 s64, s32, 4096
buffer_load_dwordx4 v169, s[8:11], s64 offen nt lds
v_mfma_f32_16x16x32_bf16 v[44:47], a[8:11], a[44:47], v[44:47]
v_mfma_f32_16x16x32_bf16 v[40:43], a[8:11], a[40:43], v[40:43]
v_mfma_f32_16x16x32_bf16 v[24:27], a[4:7], a[40:43], v[24:27]
v_mfma_f32_16x16x32_bf16 v[28:31], a[4:7], a[44:47], v[28:31]
v_mfma_f32_16x16x32_bf16 v[12:15], a[0:3], a[44:47], v[12:15]
v_mfma_f32_16x16x32_bf16 v[8:11], a[0:3], a[40:43], v[8:11]
s_waitcnt vmcnt(6) lgkmcnt(0)
v_mfma_f32_16x16x32_bf16 v[64:67], a[16:19], a[32:35], v[64:67]
ds_read_b128 a[48:51], v164 offset:8768
v_mfma_f32_16x16x32_bf16 v[68:71], a[16:19], a[36:39], v[68:71]
ds_read_b128 a[52:55], v164 offset:10944
v_mfma_f32_16x16x32_bf16 v[84:87], a[20:23], a[36:39], v[84:87]
ds_read_b128 a[56:59], v164 offset:13120
v_mfma_f32_16x16x32_bf16 v[80:83], a[20:23], a[32:35], v[80:83]
ds_read_b128 a[60:63], v164 offset:15296
v_mfma_f32_16x16x32_bf16 v[96:99], a[24:27], a[32:35], v[96:99]
ds_read_b64_tr_b16 a[0:1], v160 offset:8192
v_mfma_f32_16x16x32_bf16 v[100:103], a[24:27], a[36:39], v[100:103]
ds_read_b64_tr_b16 a[2:3], v160 offset:10240
v_mfma_f32_16x16x32_bf16 v[116:119], a[28:31], a[36:39], v[116:119]
ds_read_b64_tr_b16 a[4:5], v161 offset:8192
v_mfma_f32_16x16x32_bf16 v[112:115], a[28:31], a[32:35], v[112:115]
ds_read_b64_tr_b16 a[6:7], v161 offset:10240
v_mfma_f32_16x16x32_bf16 v[120:123], a[28:31], a[40:43], v[120:123]
ds_read_b64_tr_b16 a[8:9], v162 offset:8192
v_mfma_f32_16x16x32_bf16 v[124:127], a[28:31], a[44:47], v[124:127]
ds_read_b64_tr_b16 a[10:11], v162 offset:10240
v_mfma_f32_16x16x32_bf16 v[108:111], a[24:27], a[44:47], v[108:111]
ds_read_b64_tr_b16 a[12:13], v163 offset:8192
v_mfma_f32_16x16x32_bf16 v[104:107], a[24:27], a[40:43], v[104:107]
ds_read_b64_tr_b16 a[14:15], v163 offset:10240
v_mfma_f32_16x16x32_bf16 v[88:91], a[20:23], a[40:43], v[88:91]
s_add_u32 m0, s68, 2112
s_add_u32 s64, s32, 8192
buffer_load_dwordx4 v169, s[8:11], s64 offen nt lds
v_mfma_f32_16x16x32_bf16 v[92:95], a[20:23], a[44:47], v[92:95]
s_add_u32 m0, s68, 3168
s_add_u32 s64, s32, 12288
buffer_load_dwordx4 v169, s[8:11], s64 offen nt lds
v_mfma_f32_16x16x32_bf16 v[76:79], a[16:19], a[44:47], v[76:79]
v_mfma_f32_16x16x32_bf16 v[72:75], a[16:19], a[40:43], v[72:75]
s_waitcnt vmcnt(4) lgkmcnt(0)
v_mfma_f32_16x16x32_bf16 v[0:3], a[0:3], a[48:51], v[0:3]
ds_read_b64_tr_b16 a[16:17], v160 offset:12288
v_mfma_f32_16x16x32_bf16 v[4:7], a[0:3], a[52:55], v[4:7]
ds_read_b64_tr_b16 a[18:19], v160 offset:14336
v_mfma_f32_16x16x32_bf16 v[20:23], a[4:7], a[52:55], v[20:23]
ds_read_b64_tr_b16 a[20:21], v161 offset:12288
v_mfma_f32_16x16x32_bf16 v[16:19], a[4:7], a[48:51], v[16:19]
ds_read_b64_tr_b16 a[22:23], v161 offset:14336
v_mfma_f32_16x16x32_bf16 v[32:35], a[8:11], a[48:51], v[32:35]
ds_read_b64_tr_b16 a[24:25], v162 offset:12288
v_mfma_f32_16x16x32_bf16 v[36:39], a[8:11], a[52:55], v[36:39]
ds_read_b64_tr_b16 a[26:27], v162 offset:14336
v_mfma_f32_16x16x32_bf16 v[52:55], a[12:15], a[52:55], v[52:55]
ds_read_b64_tr_b16 a[28:29], v163 offset:12288
v_mfma_f32_16x16x32_bf16 v[48:51], a[12:15], a[48:51], v[48:51]
ds_read_b64_tr_b16 a[30:31], v163 offset:14336
v_mfma_f32_16x16x32_bf16 v[56:59], a[12:15], a[56:59], v[56:59]
s_add_u32 m0, s68, 4224
s_add_u32 s64, s32, 16384
buffer_load_dwordx4 v169, s[8:11], s64 offen nt lds
v_mfma_f32_16x16x32_bf16 v[60:63], a[12:15], a[60:63], v[60:63]
s_add_u32 m0, s68, 5280
s_add_u32 s64, s32, 20480
buffer_load_dwordx4 v169, s[8:11], s64 offen nt lds
v_mfma_f32_16x16x32_bf16 v[44:47], a[8:11], a[60:63], v[44:47]
v_mfma_f32_16x16x32_bf16 v[40:43], a[8:11], a[56:59], v[40:43]
v_mfma_f32_16x16x32_bf16 v[24:27], a[4:7], a[56:59], v[24:27]
v_mfma_f32_16x16x32_bf16 v[28:31], a[4:7], a[60:63], v[28:31]
v_mfma_f32_16x16x32_bf16 v[12:15], a[0:3], a[60:63], v[12:15]
v_mfma_f32_16x16x32_bf16 v[8:11], a[0:3], a[56:59], v[8:11]
s_waitcnt lgkmcnt(0)
v_mfma_f32_16x16x32_bf16 v[64:67], a[16:19], a[48:51], v[64:67]
s_add_u32 m0, s68, 6336
s_add_u32 s64, s32, 24576
buffer_load_dwordx4 v169, s[8:11], s64 offen nt lds
v_mfma_f32_16x16x32_bf16 v[68:71], a[16:19], a[52:55], v[68:71]
s_add_u32 m0, s68, 7392
s_add_u32 s64, s32, 28672
buffer_load_dwordx4 v169, s[8:11], s64 offen nt lds
v_mfma_f32_16x16x32_bf16 v[84:87], a[20:23], a[52:55], v[84:87]
v_cvt_pk_bf16_f32 v132, v0, v1
v_cvt_pk_bf16_f32 v133, v2, v3
ds_write_b64 v171, v[132:133] offset:0
v_mfma_f32_16x16x32_bf16 v[80:83], a[20:23], a[48:51], v[80:83]
v_cvt_pk_bf16_f32 v134, v4, v5
v_cvt_pk_bf16_f32 v135, v6, v7
ds_write_b64 v171, v[134:135] offset:4096
v_mfma_f32_16x16x32_bf16 v[96:99], a[24:27], a[48:51], v[96:99]
v_cvt_pk_bf16_f32 v136, v8, v9
v_cvt_pk_bf16_f32 v137, v10, v11
ds_write_b64 v171, v[136:137] offset:8192
v_mfma_f32_16x16x32_bf16 v[100:103], a[24:27], a[52:55], v[100:103]
v_cvt_pk_bf16_f32 v138, v12, v13
v_cvt_pk_bf16_f32 v139, v14, v15
ds_write_b64 v171, v[138:139] offset:12288
v_mfma_f32_16x16x32_bf16 v[116:119], a[28:31], a[52:55], v[116:119]
v_cvt_pk_bf16_f32 v140, v16, v17
v_cvt_pk_bf16_f32 v141, v18, v19
ds_write_b64 v171, v[140:141] offset:512
v_mfma_f32_16x16x32_bf16 v[112:115], a[28:31], a[48:51], v[112:115]
v_cvt_pk_bf16_f32 v142, v20, v21
v_cvt_pk_bf16_f32 v143, v22, v23
ds_write_b64 v171, v[142:143] offset:4608
v_mfma_f32_16x16x32_bf16 v[120:123], a[28:31], a[56:59], v[120:123]
v_cvt_pk_bf16_f32 v144, v24, v25
v_cvt_pk_bf16_f32 v145, v26, v27
ds_write_b64 v171, v[144:145] offset:8704
v_mfma_f32_16x16x32_bf16 v[124:127], a[28:31], a[60:63], v[124:127]
v_cvt_pk_bf16_f32 v146, v28, v29
v_cvt_pk_bf16_f32 v147, v30, v31
ds_write_b64 v171, v[146:147] offset:12800
v_mfma_f32_16x16x32_bf16 v[108:111], a[24:27], a[60:63], v[108:111]
v_cvt_pk_bf16_f32 v132, v32, v33
v_cvt_pk_bf16_f32 v133, v34, v35
ds_write_b64 v171, v[132:133] offset:1024
v_mfma_f32_16x16x32_bf16 v[104:107], a[24:27], a[56:59], v[104:107]
v_cvt_pk_bf16_f32 v134, v36, v37
v_cvt_pk_bf16_f32 v135, v38, v39
ds_write_b64 v171, v[134:135] offset:5120
v_mfma_f32_16x16x32_bf16 v[88:91], a[20:23], a[56:59], v[88:91]
v_cvt_pk_bf16_f32 v136, v40, v41
v_cvt_pk_bf16_f32 v137, v42, v43
ds_write_b64 v171, v[136:137] offset:9216
v_mfma_f32_16x16x32_bf16 v[92:95], a[20:23], a[60:63], v[92:95]
v_cvt_pk_bf16_f32 v138, v44, v45
v_cvt_pk_bf16_f32 v139, v46, v47
ds_write_b64 v171, v[138:139] offset:13312
v_mfma_f32_16x16x32_bf16 v[76:79], a[16:19], a[60:63], v[76:79]
v_cvt_pk_bf16_f32 v140, v48, v49
v_cvt_pk_bf16_f32 v141, v50, v51
ds_write_b64 v171, v[140:141] offset:1536
v_mfma_f32_16x16x32_bf16 v[72:75], a[16:19], a[56:59], v[72:75]
v_cvt_pk_bf16_f32 v142, v52, v53
v_cvt_pk_bf16_f32 v143, v54, v55
ds_write_b64 v171, v[142:143] offset:5632
v_cvt_pk_bf16_f32 v144, v56, v57
v_cvt_pk_bf16_f32 v145, v58, v59
ds_write_b64 v171, v[144:145] offset:9728
v_cvt_pk_bf16_f32 v146, v60, v61
v_cvt_pk_bf16_f32 v147, v62, v63
ds_write_b64 v171, v[146:147] offset:13824
s_nop 3
v_cvt_pk_bf16_f32 v132, v64, v65
v_cvt_pk_bf16_f32 v133, v66, v67
ds_write_b64 v171, v[132:133] offset:2048
v_cvt_pk_bf16_f32 v134, v68, v69
v_cvt_pk_bf16_f32 v135, v70, v71
ds_write_b64 v171, v[134:135] offset:6144
v_cvt_pk_bf16_f32 v136, v72, v73
v_cvt_pk_bf16_f32 v137, v74, v75
ds_write_b64 v171, v[136:137] offset:10240
v_cvt_pk_bf16_f32 v138, v76, v77
v_cvt_pk_bf16_f32 v139, v78, v79
ds_write_b64 v171, v[138:139] offset:14336
v_cvt_pk_bf16_f32 v140, v80, v81
v_cvt_pk_bf16_f32 v141, v82, v83
ds_write_b64 v171, v[140:141] offset:2560
v_cvt_pk_bf16_f32 v142, v84, v85
v_cvt_pk_bf16_f32 v143, v86, v87
ds_write_b64 v171, v[142:143] offset:6656
v_cvt_pk_bf16_f32 v144, v88, v89
v_cvt_pk_bf16_f32 v145, v90, v91
ds_write_b64 v171, v[144:145] offset:10752
v_cvt_pk_bf16_f32 v146, v92, v93
v_cvt_pk_bf16_f32 v147, v94, v95
ds_write_b64 v171, v[146:147] offset:14848
v_cvt_pk_bf16_f32 v132, v96, v97
v_cvt_pk_bf16_f32 v133, v98, v99
ds_write_b64 v171, v[132:133] offset:3072
v_cvt_pk_bf16_f32 v134, v100, v101
v_cvt_pk_bf16_f32 v135, v102, v103
ds_write_b64 v171, v[134:135] offset:7168
v_cvt_pk_bf16_f32 v136, v104, v105
v_cvt_pk_bf16_f32 v137, v106, v107
ds_write_b64 v171, v[136:137] offset:11264
v_cvt_pk_bf16_f32 v138, v108, v109
v_cvt_pk_bf16_f32 v139, v110, v111
ds_write_b64 v171, v[138:139] offset:15360
v_cvt_pk_bf16_f32 v140, v112, v113
v_cvt_pk_bf16_f32 v141, v114, v115
ds_write_b64 v171, v[140:141] offset:3584
v_cvt_pk_bf16_f32 v142, v116, v117
v_cvt_pk_bf16_f32 v143, v118, v119
ds_write_b64 v171, v[142:143] offset:7680
v_cvt_pk_bf16_f32 v144, v120, v121
v_cvt_pk_bf16_f32 v145, v122, v123
ds_write_b64 v171, v[144:145] offset:11776
v_cvt_pk_bf16_f32 v146, v124, v125
v_cvt_pk_bf16_f32 v147, v126, v127
ds_write_b64 v171, v[146:147] offset:15872
s_waitcnt lgkmcnt(0)
s_barrier
s_waitcnt vmcnt(0)
s_barrier
s_add_u32 m0, s66, 0
s_add_u32 s64, s67, 1024
buffer_load_dwordx4 v152, s[16:19], s64 offen offset:0 lds
buffer_load_dwordx4 v153, s[16:19], s64 offen offset:1024 lds
buffer_load_dwordx4 v154, s[16:19], s64 offen offset:2048 lds
buffer_load_dwordx4 v155, s[16:19], s64 offen offset:3072 lds
s_add_u32 m0, s66, 4096
s_add_u32 s64, s67, 1152
buffer_load_dwordx4 v152, s[16:19], s64 offen offset:0 lds
buffer_load_dwordx4 v153, s[16:19], s64 offen offset:1024 lds
buffer_load_dwordx4 v154, s[16:19], s64 offen offset:2048 lds
buffer_load_dwordx4 v155, s[16:19], s64 offen offset:3072 lds
s_setprio 3
s_waitcnt vmcnt(4)
ds_read_b64_tr_b16 a[0:1], v160 offset:0
ds_read_b64_tr_b16 a[2:3], v160 offset:2048
ds_read_b64_tr_b16 a[4:5], v161 offset:0
ds_read_b64_tr_b16 a[6:7], v161 offset:2048
ds_read_b64_tr_b16 a[8:9], v162 offset:0
ds_read_b64_tr_b16 a[10:11], v162 offset:2048
ds_read_b64_tr_b16 a[12:13], v163 offset:0
ds_read_b64_tr_b16 a[14:15], v163 offset:2048
ds_read_b128 a[32:35], v165 offset:34816
ds_read_b128 a[36:39], v165 offset:36992
ds_read_b128 a[40:43], v165 offset:39168
ds_read_b128 a[44:47], v165 offset:41344
s_add_u32 m0, s68, 33792
s_add_u32 s64, s33, 0
buffer_load_dwordx4 v169, s[8:11], s64 offen nt lds
s_add_u32 m0, s68, 34848
s_add_u32 s64, s33, 4096
buffer_load_dwordx4 v169, s[8:11], s64 offen nt lds
s_add_u32 m0, s68, 35904
s_add_u32 s64, s33, 8192
buffer_load_dwordx4 v169, s[8:11], s64 offen nt lds
s_add_u32 m0, s68, 36960
s_add_u32 s64, s33, 12288
buffer_load_dwordx4 v169, s[8:11], s64 offen nt lds
s_add_u32 m0, s68, 38016
s_add_u32 s64, s33, 16384
buffer_load_dwordx4 v169, s[8:11], s64 offen nt lds
s_add_u32 m0, s68, 39072
s_add_u32 s64, s33, 20480
buffer_load_dwordx4 v169, s[8:11], s64 offen nt lds
s_add_u32 m0, s68, 40128
s_add_u32 s64, s33, 24576
buffer_load_dwordx4 v169, s[8:11], s64 offen nt lds
s_add_u32 m0, s68, 41184
s_add_u32 s64, s33, 28672
buffer_load_dwordx4 v169, s[8:11], s64 offen nt lds
s_setprio 1
s_waitcnt vmcnt(8) lgkmcnt(0)
v_mfma_f32_16x16x32_bf16 v[0:3], a[0:3], a[32:35], 0
ds_read_b64_tr_b16 a[16:17], v160 offset:4096
v_mfma_f32_16x16x32_bf16 v[4:7], a[0:3], a[36:39], 0
ds_read_b64_tr_b16 a[18:19], v160 offset:6144
v_mfma_f32_16x16x32_bf16 v[20:23], a[4:7], a[36:39], 0
ds_read_b64_tr_b16 a[20:21], v161 offset:4096
v_mfma_f32_16x16x32_bf16 v[16:19], a[4:7], a[32:35], 0
ds_read_b64_tr_b16 a[22:23], v161 offset:6144
v_mfma_f32_16x16x32_bf16 v[32:35], a[8:11], a[32:35], 0
ds_read_b64_tr_b16 a[24:25], v162 offset:4096
v_mfma_f32_16x16x32_bf16 v[36:39], a[8:11], a[36:39], 0
ds_read_b64_tr_b16 a[26:27], v162 offset:6144
v_mfma_f32_16x16x32_bf16 v[52:55], a[12:15], a[36:39], 0
ds_read_b64_tr_b16 a[28:29], v163 offset:4096
v_mfma_f32_16x16x32_bf16 v[48:51], a[12:15], a[32:35], 0
ds_read_b64_tr_b16 a[30:31], v163 offset:6144
v_mfma_f32_16x16x32_bf16 v[56:59], a[12:15], a[40:43], 0
v_mfma_f32_16x16x32_bf16 v[60:63], a[12:15], a[44:47], 0
v_mfma_f32_16x16x32_bf16 v[44:47], a[8:11], a[44:47], 0
v_mfma_f32_16x16x32_bf16 v[40:43], a[8:11], a[40:43], 0
v_mfma_f32_16x16x32_bf16 v[24:27], a[4:7], a[40:43], 0
v_mfma_f32_16x16x32_bf16 v[28:31], a[4:7], a[44:47], 0
v_mfma_f32_16x16x32_bf16 v[12:15], a[0:3], a[44:47], 0
v_mfma_f32_16x16x32_bf16 v[8:11], a[0:3], a[40:43], 0
s_waitcnt lgkmcnt(0)
v_mfma_f32_16x16x32_bf16 v[64:67], a[16:19], a[32:35], 0
s_add_u32 m0, s66, 8192
s_add_u32 s64, s67, 263168
buffer_load_dwordx4 v152, s[16:19], s64 offen offset:0 lds
v_mfma_f32_16x16x32_bf16 v[68:71], a[16:19], a[36:39], 0
buffer_load_dwordx4 v153, s[16:19], s64 offen offset:1024 lds
v_mfma_f32_16x16x32_bf16 v[84:87], a[20:23], a[36:39], 0
buffer_load_dwordx4 v154, s[16:19], s64 offen offset:2048 lds
v_mfma_f32_16x16x32_bf16 v[80:83], a[20:23], a[32:35], 0
buffer_load_dwordx4 v155, s[16:19], s64 offen offset:3072 lds
v_mfma_f32_16x16x32_bf16 v[96:99], a[24:27], a[32:35], 0
s_add_u32 m0, s66, 12288
s_add_u32 s64, s67, 263296
buffer_load_dwordx4 v152, s[16:19], s64 offen offset:0 lds
v_mfma_f32_16x16x32_bf16 v[100:103], a[24:27], a[36:39], 0
buffer_load_dwordx4 v153, s[16:19], s64 offen offset:1024 lds
v_mfma_f32_16x16x32_bf16 v[116:119], a[28:31], a[36:39], 0
buffer_load_dwordx4 v154, s[16:19], s64 offen offset:2048 lds
v_mfma_f32_16x16x32_bf16 v[112:115], a[28:31], a[32:35], 0
buffer_load_dwordx4 v155, s[16:19], s64 offen offset:3072 lds
v_mfma_f32_16x16x32_bf16 v[120:123], a[28:31], a[40:43], 0
v_mfma_f32_16x16x32_bf16 v[124:127], a[28:31], a[44:47], 0
v_mfma_f32_16x16x32_bf16 v[108:111], a[24:27], a[44:47], 0
v_mfma_f32_16x16x32_bf16 v[104:107], a[24:27], a[40:43], 0
v_mfma_f32_16x16x32_bf16 v[88:91], a[20:23], a[40:43], 0
v_mfma_f32_16x16x32_bf16 v[92:95], a[20:23], a[44:47], 0
v_mfma_f32_16x16x32_bf16 v[76:79], a[16:19], a[44:47], 0
v_mfma_f32_16x16x32_bf16 v[72:75], a[16:19], a[40:43], 0
s_waitcnt vmcnt(8)
s_barrier
s_setprio 3
s_waitcnt vmcnt(4)
ds_read_b64_tr_b16 a[0:1], v160 offset:8192
ds_read_b64_tr_b16 a[2:3], v160 offset:10240
ds_read_b64_tr_b16 a[4:5], v161 offset:8192
ds_read_b64_tr_b16 a[6:7], v161 offset:10240
ds_read_b64_tr_b16 a[8:9], v162 offset:8192
ds_read_b64_tr_b16 a[10:11], v162 offset:10240
ds_read_b64_tr_b16 a[12:13], v163 offset:8192
ds_read_b64_tr_b16 a[14:15], v163 offset:10240
ds_read_b128 a[48:51], v165 offset:34880
ds_read_b128 a[52:55], v165 offset:37056
ds_read_b128 a[56:59], v165 offset:39232
ds_read_b128 a[60:63], v165 offset:41408
s_add_u32 m0, s68, 0
s_add_u32 s64, s34, 0
buffer_load_dwordx4 v169, s[8:11], s64 offen nt lds
s_add_u32 m0, s68, 1056
s_add_u32 s64, s34, 4096
buffer_load_dwordx4 v169, s[8:11], s64 offen nt lds
s_add_u32 m0, s68, 2112
s_add_u32 s64, s34, 8192
buffer_load_dwordx4 v169, s[8:11], s64 offen nt lds
s_add_u32 m0, s68, 3168
s_add_u32 s64, s34, 12288
buffer_load_dwordx4 v169, s[8:11], s64 offen nt lds
s_add_u32 m0, s68, 4224
s_add_u32 s64, s34, 16384
buffer_load_dwordx4 v169, s[8:11], s64 offen nt lds
s_add_u32 m0, s68, 5280
s_add_u32 s64, s34, 20480
buffer_load_dwordx4 v169, s[8:11], s64 offen nt lds
s_add_u32 m0, s68, 6336
s_add_u32 s64, s34, 24576
buffer_load_dwordx4 v169, s[8:11], s64 offen nt lds
s_add_u32 m0, s68, 7392
s_add_u32 s64, s34, 28672
buffer_load_dwordx4 v169, s[8:11], s64 offen nt lds
s_setprio 1
s_waitcnt vmcnt(8) lgkmcnt(0)
v_mfma_f32_16x16x32_bf16 v[0:3], a[0:3], a[48:51], v[0:3]
ds_read_b64_tr_b16 a[16:17], v160 offset:12288
v_mfma_f32_16x16x32_bf16 v[4:7], a[0:3], a[52:55], v[4:7]
ds_read_b64_tr_b16 a[18:19], v160 offset:14336
v_mfma_f32_16x16x32_bf16 v[20:23], a[4:7], a[52:55], v[20:23]
ds_read_b64_tr_b16 a[20:21], v161 offset:12288
v_mfma_f32_16x16x32_bf16 v[16:19], a[4:7], a[48:51], v[16:19]
ds_read_b64_tr_b16 a[22:23], v161 offset:14336
v_mfma_f32_16x16x32_bf16 v[32:35], a[8:11], a[48:51], v[32:35]
ds_read_b64_tr_b16 a[24:25], v162 offset:12288
v_mfma_f32_16x16x32_bf16 v[36:39], a[8:11], a[52:55], v[36:39]
ds_read_b64_tr_b16 a[26:27], v162 offset:14336
v_mfma_f32_16x16x32_bf16 v[52:55], a[12:15], a[52:55], v[52:55]
ds_read_b64_tr_b16 a[28:29], v163 offset:12288
v_mfma_f32_16x16x32_bf16 v[48:51], a[12:15], a[48:51], v[48:51]
ds_read_b64_tr_b16 a[30:31], v163 offset:14336
v_mfma_f32_16x16x32_bf16 v[56:59], a[12:15], a[56:59], v[56:59]
v_mfma_f32_16x16x32_bf16 v[60:63], a[12:15], a[60:63], v[60:63]
v_mfma_f32_16x16x32_bf16 v[44:47], a[8:11], a[60:63], v[44:47]
v_mfma_f32_16x16x32_bf16 v[40:43], a[8:11], a[56:59], v[40:43]
v_mfma_f32_16x16x32_bf16 v[24:27], a[4:7], a[56:59], v[24:27]
v_mfma_f32_16x16x32_bf16 v[28:31], a[4:7], a[60:63], v[28:31]
v_mfma_f32_16x16x32_bf16 v[12:15], a[0:3], a[60:63], v[12:15]
v_mfma_f32_16x16x32_bf16 v[8:11], a[0:3], a[56:59], v[8:11]
s_waitcnt lgkmcnt(0)
v_mfma_f32_16x16x32_bf16 v[64:67], a[16:19], a[48:51], v[64:67]
s_add_u32 m0, s66, 0
s_add_u32 s64, s67, 525312
buffer_load_dwordx4 v152, s[16:19], s64 offen offset:0 lds
v_mfma_f32_16x16x32_bf16 v[68:71], a[16:19], a[52:55], v[68:71]
buffer_load_dwordx4 v153, s[16:19], s64 offen offset:1024 lds
v_mfma_f32_16x16x32_bf16 v[84:87], a[20:23], a[52:55], v[84:87]
buffer_load_dwordx4 v154, s[16:19], s64 offen offset:2048 lds
v_mfma_f32_16x16x32_bf16 v[80:83], a[20:23], a[48:51], v[80:83]
buffer_load_dwordx4 v155, s[16:19], s64 offen offset:3072 lds
v_mfma_f32_16x16x32_bf16 v[96:99], a[24:27], a[48:51], v[96:99]
s_add_u32 m0, s66, 4096
s_add_u32 s64, s67, 525440
buffer_load_dwordx4 v152, s[16:19], s64 offen offset:0 lds
v_mfma_f32_16x16x32_bf16 v[100:103], a[24:27], a[52:55], v[100:103]
buffer_load_dwordx4 v153, s[16:19], s64 offen offset:1024 lds
v_mfma_f32_16x16x32_bf16 v[116:119], a[28:31], a[52:55], v[116:119]
buffer_load_dwordx4 v154, s[16:19], s64 offen offset:2048 lds
v_mfma_f32_16x16x32_bf16 v[112:115], a[28:31], a[48:51], v[112:115]
buffer_load_dwordx4 v155, s[16:19], s64 offen offset:3072 lds
v_mfma_f32_16x16x32_bf16 v[120:123], a[28:31], a[56:59], v[120:123]
v_mfma_f32_16x16x32_bf16 v[124:127], a[28:31], a[60:63], v[124:127]
v_mfma_f32_16x16x32_bf16 v[108:111], a[24:27], a[60:63], v[108:111]
v_mfma_f32_16x16x32_bf16 v[104:107], a[24:27], a[56:59], v[104:107]
v_mfma_f32_16x16x32_bf16 v[88:91], a[20:23], a[56:59], v[88:91]
v_mfma_f32_16x16x32_bf16 v[92:95], a[20:23], a[60:63], v[92:95]
v_mfma_f32_16x16x32_bf16 v[76:79], a[16:19], a[60:63], v[76:79]
v_mfma_f32_16x16x32_bf16 v[72:75], a[16:19], a[56:59], v[72:75]
s_waitcnt vmcnt(8)
s_barrier
s_setprio 3
s_waitcnt vmcnt(4)
ds_read_b64_tr_b16 a[0:1], v160 offset:0
ds_read_b64_tr_b16 a[2:3], v160 offset:2048
ds_read_b64_tr_b16 a[4:5], v161 offset:0
ds_read_b64_tr_b16 a[6:7], v161 offset:2048
ds_read_b64_tr_b16 a[8:9], v162 offset:0
ds_read_b64_tr_b16 a[10:11], v162 offset:2048
ds_read_b64_tr_b16 a[12:13], v163 offset:0
ds_read_b64_tr_b16 a[14:15], v163 offset:2048
ds_read_b128 a[64:67], v164 offset:0
ds_read_b128 a[68:71], v164 offset:2176
ds_read_b128 a[72:75], v164 offset:4352
ds_read_b128 a[76:79], v164 offset:6528
s_add_u32 m0, s68, 33792
s_add_u32 s64, s35, 0
buffer_load_dwordx4 v169, s[8:11], s64 offen nt lds
s_add_u32 m0, s68, 34848
s_add_u32 s64, s35, 4096
buffer_load_dwordx4 v169, s[8:11], s64 offen nt lds
s_add_u32 m0, s68, 35904
s_add_u32 s64, s35, 8192
buffer_load_dwordx4 v169, s[8:11], s64 offen nt lds
s_add_u32 m0, s68, 36960
s_add_u32 s64, s35, 12288
buffer_load_dwordx4 v169, s[8:11], s64 offen nt lds
s_add_u32 m0, s68, 38016
s_add_u32 s64, s35, 16384
buffer_load_dwordx4 v169, s[8:11], s64 offen nt lds
s_add_u32 m0, s68, 39072
s_add_u32 s64, s35, 20480
buffer_load_dwordx4 v169, s[8:11], s64 offen nt lds
s_add_u32 m0, s68, 40128
s_add_u32 s64, s35, 24576
buffer_load_dwordx4 v169, s[8:11], s64 offen nt lds
s_add_u32 m0, s68, 41184
s_add_u32 s64, s35, 28672
buffer_load_dwordx4 v169, s[8:11], s64 offen nt lds
s_setprio 1
s_waitcnt vmcnt(8) lgkmcnt(0)
v_mfma_f32_16x16x32_bf16 v[0:3], a[0:3], a[64:67], v[0:3]
ds_read_b64_tr_b16 a[16:17], v160 offset:4096
v_mfma_f32_16x16x32_bf16 v[4:7], a[0:3], a[68:71], v[4:7]
ds_read_b64_tr_b16 a[18:19], v160 offset:6144
v_mfma_f32_16x16x32_bf16 v[20:23], a[4:7], a[68:71], v[20:23]
ds_read_b64_tr_b16 a[20:21], v161 offset:4096
v_mfma_f32_16x16x32_bf16 v[16:19], a[4:7], a[64:67], v[16:19]
ds_read_b64_tr_b16 a[22:23], v161 offset:6144
v_mfma_f32_16x16x32_bf16 v[32:35], a[8:11], a[64:67], v[32:35]
ds_read_b64_tr_b16 a[24:25], v162 offset:4096
v_mfma_f32_16x16x32_bf16 v[36:39], a[8:11], a[68:71], v[36:39]
ds_read_b64_tr_b16 a[26:27], v162 offset:6144
v_mfma_f32_16x16x32_bf16 v[52:55], a[12:15], a[68:71], v[52:55]
ds_read_b64_tr_b16 a[28:29], v163 offset:4096
v_mfma_f32_16x16x32_bf16 v[48:51], a[12:15], a[64:67], v[48:51]
ds_read_b64_tr_b16 a[30:31], v163 offset:6144
v_mfma_f32_16x16x32_bf16 v[56:59], a[12:15], a[72:75], v[56:59]
v_mfma_f32_16x16x32_bf16 v[60:63], a[12:15], a[76:79], v[60:63]
v_mfma_f32_16x16x32_bf16 v[44:47], a[8:11], a[76:79], v[44:47]
v_mfma_f32_16x16x32_bf16 v[40:43], a[8:11], a[72:75], v[40:43]
v_mfma_f32_16x16x32_bf16 v[24:27], a[4:7], a[72:75], v[24:27]
v_mfma_f32_16x16x32_bf16 v[28:31], a[4:7], a[76:79], v[28:31]
v_mfma_f32_16x16x32_bf16 v[12:15], a[0:3], a[76:79], v[12:15]
v_mfma_f32_16x16x32_bf16 v[8:11], a[0:3], a[72:75], v[8:11]
s_waitcnt lgkmcnt(0)
v_mfma_f32_16x16x32_bf16 v[64:67], a[16:19], a[64:67], v[64:67]
s_add_u32 m0, s66, 8192
s_add_u32 s64, s67, 787456
buffer_load_dwordx4 v152, s[16:19], s64 offen offset:0 lds
v_mfma_f32_16x16x32_bf16 v[68:71], a[16:19], a[68:71], v[68:71]
buffer_load_dwordx4 v153, s[16:19], s64 offen offset:1024 lds
v_mfma_f32_16x16x32_bf16 v[84:87], a[20:23], a[68:71], v[84:87]
buffer_load_dwordx4 v154, s[16:19], s64 offen offset:2048 lds
v_mfma_f32_16x16x32_bf16 v[80:83], a[20:23], a[64:67], v[80:83]
buffer_load_dwordx4 v155, s[16:19], s64 offen offset:3072 lds
v_mfma_f32_16x16x32_bf16 v[96:99], a[24:27], a[64:67], v[96:99]
s_add_u32 m0, s66, 12288
s_add_u32 s64, s67, 787584
buffer_load_dwordx4 v152, s[16:19], s64 offen offset:0 lds
v_mfma_f32_16x16x32_bf16 v[100:103], a[24:27], a[68:71], v[100:103]
buffer_load_dwordx4 v153, s[16:19], s64 offen offset:1024 lds
v_mfma_f32_16x16x32_bf16 v[116:119], a[28:31], a[68:71], v[116:119]
buffer_load_dwordx4 v154, s[16:19], s64 offen offset:2048 lds
v_mfma_f32_16x16x32_bf16 v[112:115], a[28:31], a[64:67], v[112:115]
buffer_load_dwordx4 v155, s[16:19], s64 offen offset:3072 lds
v_mfma_f32_16x16x32_bf16 v[120:123], a[28:31], a[72:75], v[120:123]
s_add_u32 m0, s66, 0
s_add_u32 s64, s67, 1049600
buffer_load_dwordx4 v152, s[16:19], s64 offen offset:0 lds
v_mfma_f32_16x16x32_bf16 v[124:127], a[28:31], a[76:79], v[124:127]
buffer_load_dwordx4 v153, s[16:19], s64 offen offset:1024 lds
v_mfma_f32_16x16x32_bf16 v[108:111], a[24:27], a[76:79], v[108:111]
buffer_load_dwordx4 v154, s[16:19], s64 offen offset:2048 lds
v_mfma_f32_16x16x32_bf16 v[104:107], a[24:27], a[72:75], v[104:107]
buffer_load_dwordx4 v155, s[16:19], s64 offen offset:3072 lds
v_mfma_f32_16x16x32_bf16 v[88:91], a[20:23], a[72:75], v[88:91]
v_mfma_f32_16x16x32_bf16 v[92:95], a[20:23], a[76:79], v[92:95]
v_mfma_f32_16x16x32_bf16 v[76:79], a[16:19], a[76:79], v[76:79]
v_mfma_f32_16x16x32_bf16 v[72:75], a[16:19], a[72:75], v[72:75]
s_waitcnt vmcnt(12)
s_barrier
s_setprio 3
s_waitcnt vmcnt(8)
ds_read_b64_tr_b16 a[0:1], v160 offset:8192
ds_read_b64_tr_b16 a[2:3], v160 offset:10240
ds_read_b64_tr_b16 a[4:5], v161 offset:8192
ds_read_b64_tr_b16 a[6:7], v161 offset:10240
ds_read_b64_tr_b16 a[8:9], v162 offset:8192
ds_read_b64_tr_b16 a[10:11], v162 offset:10240
ds_read_b64_tr_b16 a[12:13], v163 offset:8192
ds_read_b64_tr_b16 a[14:15], v163 offset:10240
ds_read_b128 a[32:35], v164 offset:64
ds_read_b128 a[36:39], v164 offset:2240
ds_read_b128 a[40:43], v164 offset:4416
ds_read_b128 a[44:47], v164 offset:6592
s_add_u32 m0, s68, 0
s_add_u32 s64, s32, 131072
buffer_load_dwordx4 v169, s[8:11], s64 offen nt lds
s_add_u32 m0, s68, 1056
s_add_u32 s64, s32, 135168
buffer_load_dwordx4 v169, s[8:11], s64 offen nt lds
s_add_u32 m0, s68, 2112
s_add_u32 s64, s32, 139264
buffer_load_dwordx4 v169, s[8:11], s64 offen nt lds
s_add_u32 m0, s68, 3168
s_add_u32 s64, s32, 143360
buffer_load_dwordx4 v169, s[8:11], s64 offen nt lds
s_add_u32 m0, s68, 4224
s_add_u32 s64, s32, 147456
buffer_load_dwordx4 v169, s[8:11], s64 offen nt lds
s_add_u32 m0, s68, 5280
s_add_u32 s64, s32, 151552
buffer_load_dwordx4 v169, s[8:11], s64 offen nt lds
s_add_u32 m0, s68, 6336
s_add_u32 s64, s32, 155648
buffer_load_dwordx4 v169, s[8:11], s64 offen nt lds
s_add_u32 m0, s68, 7392
s_add_u32 s64, s32, 159744
buffer_load_dwordx4 v169, s[8:11], s64 offen nt lds
s_setprio 1
s_waitcnt vmcnt(12) lgkmcnt(0)
v_mfma_f32_16x16x32_bf16 v[0:3], a[0:3], a[32:35], v[0:3]
ds_read_b64_tr_b16 a[16:17], v160 offset:12288
v_mfma_f32_16x16x32_bf16 v[4:7], a[0:3], a[36:39], v[4:7]
ds_read_b64_tr_b16 a[18:19], v160 offset:14336
v_mfma_f32_16x16x32_bf16 v[20:23], a[4:7], a[36:39], v[20:23]
ds_read_b64_tr_b16 a[20:21], v161 offset:12288
v_mfma_f32_16x16x32_bf16 v[16:19], a[4:7], a[32:35], v[16:19]
ds_read_b64_tr_b16 a[22:23], v161 offset:14336
v_mfma_f32_16x16x32_bf16 v[32:35], a[8:11], a[32:35], v[32:35]
ds_read_b64_tr_b16 a[24:25], v162 offset:12288
v_mfma_f32_16x16x32_bf16 v[36:39], a[8:11], a[36:39], v[36:39]
ds_read_b64_tr_b16 a[26:27], v162 offset:14336
v_mfma_f32_16x16x32_bf16 v[52:55], a[12:15], a[36:39], v[52:55]
ds_read_b64_tr_b16 a[28:29], v163 offset:12288
v_mfma_f32_16x16x32_bf16 v[48:51], a[12:15], a[32:35], v[48:51]
ds_read_b64_tr_b16 a[30:31], v163 offset:14336
v_mfma_f32_16x16x32_bf16 v[56:59], a[12:15], a[40:43], v[56:59]
v_mfma_f32_16x16x32_bf16 v[60:63], a[12:15], a[44:47], v[60:63]
v_mfma_f32_16x16x32_bf16 v[44:47], a[8:11], a[44:47], v[44:47]
v_mfma_f32_16x16x32_bf16 v[40:43], a[8:11], a[40:43], v[40:43]
v_mfma_f32_16x16x32_bf16 v[24:27], a[4:7], a[40:43], v[24:27]
v_mfma_f32_16x16x32_bf16 v[28:31], a[4:7], a[44:47], v[28:31]
v_mfma_f32_16x16x32_bf16 v[12:15], a[0:3], a[44:47], v[12:15]
v_mfma_f32_16x16x32_bf16 v[8:11], a[0:3], a[40:43], v[8:11]
s_waitcnt vmcnt(8) lgkmcnt(0)
v_mfma_f32_16x16x32_bf16 v[64:67], a[16:19], a[32:35], v[64:67]
ds_read_b128 a[48:51], v164 offset:8704
v_mfma_f32_16x16x32_bf16 v[68:71], a[16:19], a[36:39], v[68:71]
ds_read_b128 a[52:55], v164 offset:10880
v_mfma_f32_16x16x32_bf16 v[84:87], a[20:23], a[36:39], v[84:87]
ds_read_b128 a[56:59], v164 offset:13056
v_mfma_f32_16x16x32_bf16 v[80:83], a[20:23], a[32:35], v[80:83]
ds_read_b128 a[60:63], v164 offset:15232
v_mfma_f32_16x16x32_bf16 v[96:99], a[24:27], a[32:35], v[96:99]
ds_read_b64_tr_b16 a[0:1], v160 offset:0
v_mfma_f32_16x16x32_bf16 v[100:103], a[24:27], a[36:39], v[100:103]
ds_read_b64_tr_b16 a[2:3], v160 offset:2048
v_mfma_f32_16x16x32_bf16 v[116:119], a[28:31], a[36:39], v[116:119]
ds_read_b64_tr_b16 a[4:5], v161 offset:0
v_mfma_f32_16x16x32_bf16 v[112:115], a[28:31], a[32:35], v[112:115]
ds_read_b64_tr_b16 a[6:7], v161 offset:2048
v_mfma_f32_16x16x32_bf16 v[120:123], a[28:31], a[40:43], v[120:123]
ds_read_b64_tr_b16 a[8:9], v162 offset:0
v_mfma_f32_16x16x32_bf16 v[124:127], a[28:31], a[44:47], v[124:127]
ds_read_b64_tr_b16 a[10:11], v162 offset:2048
v_mfma_f32_16x16x32_bf16 v[108:111], a[24:27], a[44:47], v[108:111]
ds_read_b64_tr_b16 a[12:13], v163 offset:0
v_mfma_f32_16x16x32_bf16 v[104:107], a[24:27], a[40:43], v[104:107]
ds_read_b64_tr_b16 a[14:15], v163 offset:2048
v_mfma_f32_16x16x32_bf16 v[88:91], a[20:23], a[40:43], v[88:91]
s_add_u32 m0, s66, 4096
s_add_u32 s64, s67, 1049728
buffer_load_dwordx4 v152, s[16:19], s64 offen offset:0 lds
v_mfma_f32_16x16x32_bf16 v[92:95], a[20:23], a[44:47], v[92:95]
buffer_load_dwordx4 v153, s[16:19], s64 offen offset:1024 lds
v_mfma_f32_16x16x32_bf16 v[76:79], a[16:19], a[44:47], v[76:79]
buffer_load_dwordx4 v154, s[16:19], s64 offen offset:2048 lds
v_mfma_f32_16x16x32_bf16 v[72:75], a[16:19], a[40:43], v[72:75]
buffer_load_dwordx4 v155, s[16:19], s64 offen offset:3072 lds
s_add_u32 m0, s66, 8192
s_add_u32 s64, s67, 1311744
buffer_load_dwordx4 v152, s[16:19], s64 offen offset:0 lds
buffer_load_dwordx4 v153, s[16:19], s64 offen offset:1024 lds
buffer_load_dwordx4 v154, s[16:19], s64 offen offset:2048 lds
buffer_load_dwordx4 v155, s[16:19], s64 offen offset:3072 lds
s_waitcnt lgkmcnt(0)
v_mfma_f32_16x16x32_bf16 v[0:3], a[0:3], a[48:51], v[0:3]
s_add_u32 m0, s66, 12288
s_add_u32 s64, s67, 1311872
buffer_load_dwordx4 v152, s[16:19], s64 offen offset:0 lds
v_mfma_f32_16x16x32_bf16 v[4:7], a[0:3], a[52:55], v[4:7]
buffer_load_dwordx4 v153, s[16:19], s64 offen offset:1024 lds
v_mfma_f32_16x16x32_bf16 v[20:23], a[4:7], a[52:55], v[20:23]
buffer_load_dwordx4 v154, s[16:19], s64 offen offset:2048 lds
v_mfma_f32_16x16x32_bf16 v[16:19], a[4:7], a[48:51], v[16:19]
buffer_load_dwordx4 v155, s[16:19], s64 offen offset:3072 lds
v_mfma_f32_16x16x32_bf16 v[32:35], a[8:11], a[48:51], v[32:35]
v_mfma_f32_16x16x32_bf16 v[36:39], a[8:11], a[52:55], v[36:39]
v_mfma_f32_16x16x32_bf16 v[52:55], a[12:15], a[52:55], v[52:55]
v_mfma_f32_16x16x32_bf16 v[48:51], a[12:15], a[48:51], v[48:51]
v_mfma_f32_16x16x32_bf16 v[56:59], a[12:15], a[56:59], v[56:59]
v_mfma_f32_16x16x32_bf16 v[60:63], a[12:15], a[60:63], v[60:63]
v_mfma_f32_16x16x32_bf16 v[44:47], a[8:11], a[60:63], v[44:47]
v_mfma_f32_16x16x32_bf16 v[40:43], a[8:11], a[56:59], v[40:43]
v_mfma_f32_16x16x32_bf16 v[24:27], a[4:7], a[56:59], v[24:27]
v_mfma_f32_16x16x32_bf16 v[28:31], a[4:7], a[60:63], v[28:31]
v_mfma_f32_16x16x32_bf16 v[12:15], a[0:3], a[60:63], v[12:15]
v_mfma_f32_16x16x32_bf16 v[8:11], a[0:3], a[56:59], v[8:11]
s_add_u32 m0, s66, 0
s_add_u32 s64, s67, 1573888
buffer_load_dwordx4 v152, s[16:19], s64 offen offset:0 lds
buffer_load_dwordx4 v153, s[16:19], s64 offen offset:1024 lds
buffer_load_dwordx4 v154, s[16:19], s64 offen offset:2048 lds
buffer_load_dwordx4 v155, s[16:19], s64 offen offset:3072 lds
s_waitcnt vmcnt(16)
s_barrier
s_setprio 3
s_waitcnt vmcnt(12)
ds_read_b64_tr_b16 a[0:1], v160 offset:4096
ds_read_b64_tr_b16 a[2:3], v160 offset:6144
ds_read_b64_tr_b16 a[4:5], v161 offset:4096
ds_read_b64_tr_b16 a[6:7], v161 offset:6144
ds_read_b64_tr_b16 a[8:9], v162 offset:4096
ds_read_b64_tr_b16 a[10:11], v162 offset:6144
ds_read_b64_tr_b16 a[12:13], v163 offset:4096
ds_read_b64_tr_b16 a[14:15], v163 offset:6144
s_add_u32 m0, s68, 33792
s_add_u32 s64, s33, 131072
buffer_load_dwordx4 v169, s[8:11], s64 offen nt lds
s_add_u32 m0, s68, 34848
s_add_u32 s64, s33, 135168
buffer_load_dwordx4 v169, s[8:11], s64 offen nt lds
s_add_u32 m0, s68, 35904
s_add_u32 s64, s33, 139264
buffer_load_dwordx4 v169, s[8:11], s64 offen nt lds
s_add_u32 m0, s68, 36960
s_add_u32 s64, s33, 143360
buffer_load_dwordx4 v169, s[8:11], s64 offen nt lds
s_add_u32 m0, s68, 38016
s_add_u32 s64, s33, 147456
buffer_load_dwordx4 v169, s[8:11], s64 offen nt lds
s_add_u32 m0, s68, 39072
s_add_u32 s64, s33, 151552
buffer_load_dwordx4 v169, s[8:11], s64 offen nt lds
s_add_u32 m0, s68, 40128
s_add_u32 s64, s33, 155648
buffer_load_dwordx4 v169, s[8:11], s64 offen nt lds
s_add_u32 m0, s68, 41184
s_add_u32 s64, s33, 159744
buffer_load_dwordx4 v169, s[8:11], s64 offen nt lds
s_setprio 1
s_waitcnt vmcnt(16) lgkmcnt(0)
v_mfma_f32_16x16x32_bf16 v[64:67], a[0:3], a[48:51], v[64:67]
ds_read_b128 a[64:67], v164 offset:8768
v_mfma_f32_16x16x32_bf16 v[68:71], a[0:3], a[52:55], v[68:71]
ds_read_b128 a[68:71], v164 offset:10944
v_mfma_f32_16x16x32_bf16 v[84:87], a[4:7], a[52:55], v[84:87]
ds_read_b128 a[72:75], v164 offset:13120
v_mfma_f32_16x16x32_bf16 v[80:83], a[4:7], a[48:51], v[80:83]
ds_read_b128 a[76:79], v164 offset:15296
v_mfma_f32_16x16x32_bf16 v[96:99], a[8:11], a[48:51], v[96:99]
ds_read_b64_tr_b16 a[16:17], v160 offset:8192
v_mfma_f32_16x16x32_bf16 v[100:103], a[8:11], a[52:55], v[100:103]
ds_read_b64_tr_b16 a[18:19], v160 offset:10240
v_mfma_f32_16x16x32_bf16 v[116:119], a[12:15], a[52:55], v[116:119]
ds_read_b64_tr_b16 a[20:21], v161 offset:8192
v_mfma_f32_16x16x32_bf16 v[112:115], a[12:15], a[48:51], v[112:115]
ds_read_b64_tr_b16 a[22:23], v161 offset:10240
v_mfma_f32_16x16x32_bf16 v[120:123], a[12:15], a[56:59], v[120:123]
ds_read_b64_tr_b16 a[24:25], v162 offset:8192
v_mfma_f32_16x16x32_bf16 v[124:127], a[12:15], a[60:63], v[124:127]
ds_read_b64_tr_b16 a[26:27], v162 offset:10240
v_mfma_f32_16x16x32_bf16 v[108:111], a[8:11], a[60:63], v[108:111]
ds_read_b64_tr_b16 a[28:29], v163 offset:8192
v_mfma_f32_16x16x32_bf16 v[104:107], a[8:11], a[56:59], v[104:107]
ds_read_b64_tr_b16 a[30:31], v163 offset:10240
v_mfma_f32_16x16x32_bf16 v[88:91], a[4:7], a[56:59], v[88:91]
v_mfma_f32_16x16x32_bf16 v[92:95], a[4:7], a[60:63], v[92:95]
v_mfma_f32_16x16x32_bf16 v[76:79], a[0:3], a[60:63], v[76:79]
v_mfma_f32_16x16x32_bf16 v[72:75], a[0:3], a[56:59], v[72:75]
s_waitcnt vmcnt(12) lgkmcnt(0)
v_mfma_f32_16x16x32_bf16 v[0:3], a[16:19], a[64:67], v[0:3]
ds_read_b64_tr_b16 a[0:1], v160 offset:12288
v_mfma_f32_16x16x32_bf16 v[4:7], a[16:19], a[68:71], v[4:7]
ds_read_b64_tr_b16 a[2:3], v160 offset:14336
v_mfma_f32_16x16x32_bf16 v[20:23], a[20:23], a[68:71], v[20:23]
ds_read_b64_tr_b16 a[4:5], v161 offset:12288
v_mfma_f32_16x16x32_bf16 v[16:19], a[20:23], a[64:67], v[16:19]
ds_read_b64_tr_b16 a[6:7], v161 offset:14336
v_mfma_f32_16x16x32_bf16 v[32:35], a[24:27], a[64:67], v[32:35]
ds_read_b64_tr_b16 a[8:9], v162 offset:12288
v_mfma_f32_16x16x32_bf16 v[36:39], a[24:27], a[68:71], v[36:39]
ds_read_b64_tr_b16 a[10:11], v162 offset:14336
v_mfma_f32_16x16x32_bf16 v[52:55], a[28:31], a[68:71], v[52:55]
ds_read_b64_tr_b16 a[12:13], v163 offset:12288
v_mfma_f32_16x16x32_bf16 v[48:51], a[28:31], a[64:67], v[48:51]
ds_read_b64_tr_b16 a[14:15], v163 offset:14336
v_mfma_f32_16x16x32_bf16 v[56:59], a[28:31], a[72:75], v[56:59]
s_add_u32 m0, s66, 4096
s_add_u32 s64, s67, 1574016
buffer_load_dwordx4 v152, s[16:19], s64 offen offset:0 lds
v_mfma_f32_16x16x32_bf16 v[60:63], a[28:31], a[76:79], v[60:63]
buffer_load_dwordx4 v153, s[16:19], s64 offen offset:1024 lds
v_mfma_f32_16x16x32_bf16 v[44:47], a[24:27], a[76:79], v[44:47]
buffer_load_dwordx4 v154, s[16:19], s64 offen offset:2048 lds
v_mfma_f32_16x16x32_bf16 v[40:43], a[24:27], a[72:75], v[40:43]
buffer_load_dwordx4 v155, s[16:19], s64 offen offset:3072 lds
v_mfma_f32_16x16x32_bf16 v[24:27], a[20:23], a[72:75], v[24:27]
v_mfma_f32_16x16x32_bf16 v[28:31], a[20:23], a[76:79], v[28:31]
v_mfma_f32_16x16x32_bf16 v[12:15], a[16:19], a[76:79], v[12:15]
v_mfma_f32_16x16x32_bf16 v[8:11], a[16:19], a[72:75], v[8:11]
s_waitcnt vmcnt(12) lgkmcnt(0)
v_mfma_f32_16x16x32_bf16 v[64:67], a[0:3], a[64:67], v[64:67]
ds_read_b128 a[32:35], v165 offset:34816
v_mfma_f32_16x16x32_bf16 v[68:71], a[0:3], a[68:71], v[68:71]
ds_read_b128 a[36:39], v165 offset:36992
v_mfma_f32_16x16x32_bf16 v[84:87], a[4:7], a[68:71], v[84:87]
ds_read_b128 a[40:43], v165 offset:39168
v_mfma_f32_16x16x32_bf16 v[80:83], a[4:7], a[64:67], v[80:83]
ds_read_b128 a[44:47], v165 offset:41344
v_mfma_f32_16x16x32_bf16 v[96:99], a[8:11], a[64:67], v[96:99]
ds_read_b64_tr_b16 a[16:17], v160 offset:0
v_mfma_f32_16x16x32_bf16 v[100:103], a[8:11], a[68:71], v[100:103]
ds_read_b64_tr_b16 a[18:19], v160 offset:2048
v_mfma_f32_16x16x32_bf16 v[116:119], a[12:15], a[68:71], v[116:119]
ds_read_b64_tr_b16 a[20:21], v161 offset:0
v_mfma_f32_16x16x32_bf16 v[112:115], a[12:15], a[64:67], v[112:115]
ds_read_b64_tr_b16 a[22:23], v161 offset:2048
v_mfma_f32_16x16x32_bf16 v[120:123], a[12:15], a[72:75], v[120:123]
ds_read_b64_tr_b16 a[24:25], v162 offset:0
v_mfma_f32_16x16x32_bf16 v[124:127], a[12:15], a[76:79], v[124:127]
ds_read_b64_tr_b16 a[26:27], v162 offset:2048
v_mfma_f32_16x16x32_bf16 v[108:111], a[8:11], a[76:79], v[108:111]
ds_read_b64_tr_b16 a[28:29], v163 offset:0
v_mfma_f32_16x16x32_bf16 v[104:107], a[8:11], a[72:75], v[104:107]
ds_read_b64_tr_b16 a[30:31], v163 offset:2048
v_mfma_f32_16x16x32_bf16 v[88:91], a[4:7], a[72:75], v[88:91]
s_add_u32 m0, s66, 8192
s_add_u32 s64, s67, 1836032
buffer_load_dwordx4 v152, s[16:19], s64 offen offset:0 lds
v_mfma_f32_16x16x32_bf16 v[92:95], a[4:7], a[76:79], v[92:95]
buffer_load_dwordx4 v153, s[16:19], s64 offen offset:1024 lds
v_mfma_f32_16x16x32_bf16 v[76:79], a[0:3], a[76:79], v[76:79]
buffer_load_dwordx4 v154, s[16:19], s64 offen offset:2048 lds
v_mfma_f32_16x16x32_bf16 v[72:75], a[0:3], a[72:75], v[72:75]
buffer_load_dwordx4 v155, s[16:19], s64 offen offset:3072 lds
s_waitcnt lgkmcnt(0)
v_mfma_f32_16x16x32_bf16 v[0:3], a[16:19], a[32:35], v[0:3]
s_add_u32 m0, s66, 12288
s_add_u32 s64, s67, 1836160
buffer_load_dwordx4 v152, s[16:19], s64 offen offset:0 lds
v_mfma_f32_16x16x32_bf16 v[4:7], a[16:19], a[36:39], v[4:7]
buffer_load_dwordx4 v153, s[16:19], s64 offen offset:1024 lds
v_mfma_f32_16x16x32_bf16 v[20:23], a[20:23], a[36:39], v[20:23]
buffer_load_dwordx4 v154, s[16:19], s64 offen offset:2048 lds
v_mfma_f32_16x16x32_bf16 v[16:19], a[20:23], a[32:35], v[16:19]
buffer_load_dwordx4 v155, s[16:19], s64 offen offset:3072 lds
v_mfma_f32_16x16x32_bf16 v[32:35], a[24:27], a[32:35], v[32:35]
v_mfma_f32_16x16x32_bf16 v[36:39], a[24:27], a[36:39], v[36:39]
v_mfma_f32_16x16x32_bf16 v[52:55], a[28:31], a[36:39], v[52:55]
v_mfma_f32_16x16x32_bf16 v[48:51], a[28:31], a[32:35], v[48:51]
v_mfma_f32_16x16x32_bf16 v[56:59], a[28:31], a[40:43], v[56:59]
v_mfma_f32_16x16x32_bf16 v[60:63], a[28:31], a[44:47], v[60:63]
v_mfma_f32_16x16x32_bf16 v[44:47], a[24:27], a[44:47], v[44:47]
v_mfma_f32_16x16x32_bf16 v[40:43], a[24:27], a[40:43], v[40:43]
v_mfma_f32_16x16x32_bf16 v[24:27], a[20:23], a[40:43], v[24:27]
v_mfma_f32_16x16x32_bf16 v[28:31], a[20:23], a[44:47], v[28:31]
v_mfma_f32_16x16x32_bf16 v[12:15], a[16:19], a[44:47], v[12:15]
v_mfma_f32_16x16x32_bf16 v[8:11], a[16:19], a[40:43], v[8:11]
s_add_u32 m0, s66, 0
s_add_u32 s64, s67, 2098176
buffer_load_dwordx4 v152, s[16:19], s64 offen offset:0 lds
buffer_load_dwordx4 v153, s[16:19], s64 offen offset:1024 lds
buffer_load_dwordx4 v154, s[16:19], s64 offen offset:2048 lds
buffer_load_dwordx4 v155, s[16:19], s64 offen offset:3072 lds
s_waitcnt vmcnt(16)
s_barrier
s_setprio 3
s_add_u32 m0, s68, 0
s_add_u32 s64, s34, 131072
buffer_load_dwordx4 v169, s[8:11], s64 offen nt lds
s_add_u32 m0, s68, 1056
s_add_u32 s64, s34, 135168
buffer_load_dwordx4 v169, s[8:11], s64 offen nt lds
s_add_u32 m0, s68, 2112
s_add_u32 s64, s34, 139264
buffer_load_dwordx4 v169, s[8:11], s64 offen nt lds
s_add_u32 m0, s68, 3168
s_add_u32 s64, s34, 143360
buffer_load_dwordx4 v169, s[8:11], s64 offen nt lds
s_waitcnt vmcnt(16)
ds_read_b64_tr_b16 a[0:1], v160 offset:4096
ds_read_b64_tr_b16 a[2:3], v160 offset:6144
ds_read_b64_tr_b16 a[4:5], v161 offset:4096
ds_read_b64_tr_b16 a[6:7], v161 offset:6144
ds_read_b64_tr_b16 a[8:9], v162 offset:4096
ds_read_b64_tr_b16 a[10:11], v162 offset:6144
ds_read_b64_tr_b16 a[12:13], v163 offset:4096
ds_read_b64_tr_b16 a[14:15], v163 offset:6144
s_add_u32 m0, s68, 4224
s_add_u32 s64, s34, 147456
buffer_load_dwordx4 v169, s[8:11], s64 offen nt lds
s_add_u32 m0, s68, 5280
s_add_u32 s64, s34, 151552
buffer_load_dwordx4 v169, s[8:11], s64 offen nt lds
s_add_u32 m0, s68, 6336
s_add_u32 s64, s34, 155648
buffer_load_dwordx4 v169, s[8:11], s64 offen nt lds
s_add_u32 m0, s68, 7392
s_add_u32 s64, s34, 159744
buffer_load_dwordx4 v169, s[8:11], s64 offen nt lds
s_setprio 1
s_waitcnt vmcnt(16) lgkmcnt(0)
v_mfma_f32_16x16x32_bf16 v[64:67], a[0:3], a[32:35], v[64:67]
ds_read_b128 a[48:51], v165 offset:34880
v_mfma_f32_16x16x32_bf16 v[68:71], a[0:3], a[36:39], v[68:71]
ds_read_b128 a[52:55], v165 offset:37056
v_mfma_f32_16x16x32_bf16 v[84:87], a[4:7], a[36:39], v[84:87]
ds_read_b128 a[56:59], v165 offset:39232
v_mfma_f32_16x16x32_bf16 v[80:83], a[4:7], a[32:35], v[80:83]
ds_read_b128 a[60:63], v165 offset:41408
v_mfma_f32_16x16x32_bf16 v[96:99], a[8:11], a[32:35], v[96:99]
ds_read_b64_tr_b16 a[16:17], v160 offset:8192
v_mfma_f32_16x16x32_bf16 v[100:103], a[8:11], a[36:39], v[100:103]
ds_read_b64_tr_b16 a[18:19], v160 offset:10240
v_mfma_f32_16x16x32_bf16 v[116:119], a[12:15], a[36:39], v[116:119]
ds_read_b64_tr_b16 a[20:21], v161 offset:8192
v_mfma_f32_16x16x32_bf16 v[112:115], a[12:15], a[32:35], v[112:115]
ds_read_b64_tr_b16 a[22:23], v161 offset:10240
v_mfma_f32_16x16x32_bf16 v[120:123], a[12:15], a[40:43], v[120:123]
ds_read_b64_tr_b16 a[24:25], v162 offset:8192
v_mfma_f32_16x16x32_bf16 v[124:127], a[12:15], a[44:47], v[124:127]
ds_read_b64_tr_b16 a[26:27], v162 offset:10240
v_mfma_f32_16x16x32_bf16 v[108:111], a[8:11], a[44:47], v[108:111]
ds_read_b64_tr_b16 a[28:29], v163 offset:8192
v_mfma_f32_16x16x32_bf16 v[104:107], a[8:11], a[40:43], v[104:107]
ds_read_b64_tr_b16 a[30:31], v163 offset:10240
v_mfma_f32_16x16x32_bf16 v[88:91], a[4:7], a[40:43], v[88:91]
v_mfma_f32_16x16x32_bf16 v[92:95], a[4:7], a[44:47], v[92:95]
v_mfma_f32_16x16x32_bf16 v[76:79], a[0:3], a[44:47], v[76:79]
v_mfma_f32_16x16x32_bf16 v[72:75], a[0:3], a[40:43], v[72:75]
s_waitcnt vmcnt(12) lgkmcnt(0)
v_mfma_f32_16x16x32_bf16 v[0:3], a[16:19], a[48:51], v[0:3]
ds_read_b64_tr_b16 a[0:1], v160 offset:12288
v_mfma_f32_16x16x32_bf16 v[4:7], a[16:19], a[52:55], v[4:7]
ds_read_b64_tr_b16 a[2:3], v160 offset:14336
v_mfma_f32_16x16x32_bf16 v[20:23], a[20:23], a[52:55], v[20:23]
ds_read_b64_tr_b16 a[4:5], v161 offset:12288
v_mfma_f32_16x16x32_bf16 v[16:19], a[20:23], a[48:51], v[16:19]
ds_read_b64_tr_b16 a[6:7], v161 offset:14336
v_mfma_f32_16x16x32_bf16 v[32:35], a[24:27], a[48:51], v[32:35]
ds_read_b64_tr_b16 a[8:9], v162 offset:12288
v_mfma_f32_16x16x32_bf16 v[36:39], a[24:27], a[52:55], v[36:39]
ds_read_b64_tr_b16 a[10:11], v162 offset:14336
v_mfma_f32_16x16x32_bf16 v[52:55], a[28:31], a[52:55], v[52:55]
ds_read_b64_tr_b16 a[12:13], v163 offset:12288
v_mfma_f32_16x16x32_bf16 v[48:51], a[28:31], a[48:51], v[48:51]
ds_read_b64_tr_b16 a[14:15], v163 offset:14336
v_mfma_f32_16x16x32_bf16 v[56:59], a[28:31], a[56:59], v[56:59]
s_add_u32 m0, s66, 4096
s_add_u32 s64, s67, 2098304
buffer_load_dwordx4 v152, s[16:19], s64 offen offset:0 lds
v_mfma_f32_16x16x32_bf16 v[60:63], a[28:31], a[60:63], v[60:63]
buffer_load_dwordx4 v153, s[16:19], s64 offen offset:1024 lds
v_mfma_f32_16x16x32_bf16 v[44:47], a[24:27], a[60:63], v[44:47]
buffer_load_dwordx4 v154, s[16:19], s64 offen offset:2048 lds
v_mfma_f32_16x16x32_bf16 v[40:43], a[24:27], a[56:59], v[40:43]
buffer_load_dwordx4 v155, s[16:19], s64 offen offset:3072 lds
v_mfma_f32_16x16x32_bf16 v[24:27], a[20:23], a[56:59], v[24:27]
v_mfma_f32_16x16x32_bf16 v[28:31], a[20:23], a[60:63], v[28:31]
v_mfma_f32_16x16x32_bf16 v[12:15], a[16:19], a[60:63], v[12:15]
v_mfma_f32_16x16x32_bf16 v[8:11], a[16:19], a[56:59], v[8:11]
s_waitcnt vmcnt(12) lgkmcnt(0)
v_mfma_f32_16x16x32_bf16 v[64:67], a[0:3], a[48:51], v[64:67]
ds_read_b128 a[64:67], v164 offset:0
v_mfma_f32_16x16x32_bf16 v[68:71], a[0:3], a[52:55], v[68:71]
ds_read_b128 a[68:71], v164 offset:2176
v_mfma_f32_16x16x32_bf16 v[84:87], a[4:7], a[52:55], v[84:87]
ds_read_b128 a[72:75], v164 offset:4352
v_mfma_f32_16x16x32_bf16 v[80:83], a[4:7], a[48:51], v[80:83]
ds_read_b128 a[76:79], v164 offset:6528
v_mfma_f32_16x16x32_bf16 v[96:99], a[8:11], a[48:51], v[96:99]
ds_read_b64_tr_b16 a[16:17], v160 offset:0
v_mfma_f32_16x16x32_bf16 v[100:103], a[8:11], a[52:55], v[100:103]
ds_read_b64_tr_b16 a[18:19], v160 offset:2048
v_mfma_f32_16x16x32_bf16 v[116:119], a[12:15], a[52:55], v[116:119]
ds_read_b64_tr_b16 a[20:21], v161 offset:0
v_mfma_f32_16x16x32_bf16 v[112:115], a[12:15], a[48:51], v[112:115]
ds_read_b64_tr_b16 a[22:23], v161 offset:2048
v_mfma_f32_16x16x32_bf16 v[120:123], a[12:15], a[56:59], v[120:123]
ds_read_b64_tr_b16 a[24:25], v162 offset:0
v_mfma_f32_16x16x32_bf16 v[124:127], a[12:15], a[60:63], v[124:127]
ds_read_b64_tr_b16 a[26:27], v162 offset:2048
v_mfma_f32_16x16x32_bf16 v[108:111], a[8:11], a[60:63], v[108:111]
ds_read_b64_tr_b16 a[28:29], v163 offset:0
v_mfma_f32_16x16x32_bf16 v[104:107], a[8:11], a[56:59], v[104:107]
ds_read_b64_tr_b16 a[30:31], v163 offset:2048
v_mfma_f32_16x16x32_bf16 v[88:91], a[4:7], a[56:59], v[88:91]
s_add_u32 m0, s66, 8192
s_add_u32 s64, s67, 2360320
buffer_load_dwordx4 v152, s[16:19], s64 offen offset:0 lds
v_mfma_f32_16x16x32_bf16 v[92:95], a[4:7], a[60:63], v[92:95]
buffer_load_dwordx4 v153, s[16:19], s64 offen offset:1024 lds
v_mfma_f32_16x16x32_bf16 v[76:79], a[0:3], a[60:63], v[76:79]
buffer_load_dwordx4 v154, s[16:19], s64 offen offset:2048 lds
v_mfma_f32_16x16x32_bf16 v[72:75], a[0:3], a[56:59], v[72:75]
buffer_load_dwordx4 v155, s[16:19], s64 offen offset:3072 lds
s_waitcnt lgkmcnt(0)
v_mfma_f32_16x16x32_bf16 v[0:3], a[16:19], a[64:67], v[0:3]
s_add_u32 m0, s66, 12288
s_add_u32 s64, s67, 2360448
buffer_load_dwordx4 v152, s[16:19], s64 offen offset:0 lds
v_mfma_f32_16x16x32_bf16 v[4:7], a[16:19], a[68:71], v[4:7]
buffer_load_dwordx4 v153, s[16:19], s64 offen offset:1024 lds
v_mfma_f32_16x16x32_bf16 v[20:23], a[20:23], a[68:71], v[20:23]
buffer_load_dwordx4 v154, s[16:19], s64 offen offset:2048 lds
v_mfma_f32_16x16x32_bf16 v[16:19], a[20:23], a[64:67], v[16:19]
buffer_load_dwordx4 v155, s[16:19], s64 offen offset:3072 lds
v_mfma_f32_16x16x32_bf16 v[32:35], a[24:27], a[64:67], v[32:35]
v_mfma_f32_16x16x32_bf16 v[36:39], a[24:27], a[68:71], v[36:39]
v_mfma_f32_16x16x32_bf16 v[52:55], a[28:31], a[68:71], v[52:55]
v_mfma_f32_16x16x32_bf16 v[48:51], a[28:31], a[64:67], v[48:51]
v_mfma_f32_16x16x32_bf16 v[56:59], a[28:31], a[72:75], v[56:59]
v_mfma_f32_16x16x32_bf16 v[60:63], a[28:31], a[76:79], v[60:63]
v_mfma_f32_16x16x32_bf16 v[44:47], a[24:27], a[76:79], v[44:47]
v_mfma_f32_16x16x32_bf16 v[40:43], a[24:27], a[72:75], v[40:43]
v_mfma_f32_16x16x32_bf16 v[24:27], a[20:23], a[72:75], v[24:27]
v_mfma_f32_16x16x32_bf16 v[28:31], a[20:23], a[76:79], v[28:31]
v_mfma_f32_16x16x32_bf16 v[12:15], a[16:19], a[76:79], v[12:15]
v_mfma_f32_16x16x32_bf16 v[8:11], a[16:19], a[72:75], v[8:11]
s_add_u32 m0, s66, 0
s_add_u32 s64, s67, 2622464
buffer_load_dwordx4 v152, s[16:19], s64 offen offset:0 lds
buffer_load_dwordx4 v153, s[16:19], s64 offen offset:1024 lds
buffer_load_dwordx4 v154, s[16:19], s64 offen offset:2048 lds
buffer_load_dwordx4 v155, s[16:19], s64 offen offset:3072 lds
s_waitcnt vmcnt(16)
s_barrier
s_setprio 3
s_add_u32 m0, s68, 33792
s_add_u32 s64, s35, 131072
buffer_load_dwordx4 v169, s[8:11], s64 offen nt lds
s_add_u32 m0, s68, 34848
s_add_u32 s64, s35, 135168
buffer_load_dwordx4 v169, s[8:11], s64 offen nt lds
s_add_u32 m0, s68, 35904
s_add_u32 s64, s35, 139264
buffer_load_dwordx4 v169, s[8:11], s64 offen nt lds
s_add_u32 m0, s68, 36960
s_add_u32 s64, s35, 143360
buffer_load_dwordx4 v169, s[8:11], s64 offen nt lds
s_waitcnt vmcnt(16)
ds_read_b64_tr_b16 a[0:1], v160 offset:4096
ds_read_b64_tr_b16 a[2:3], v160 offset:6144
ds_read_b64_tr_b16 a[4:5], v161 offset:4096
ds_read_b64_tr_b16 a[6:7], v161 offset:6144
ds_read_b64_tr_b16 a[8:9], v162 offset:4096
ds_read_b64_tr_b16 a[10:11], v162 offset:6144
ds_read_b64_tr_b16 a[12:13], v163 offset:4096
ds_read_b64_tr_b16 a[14:15], v163 offset:6144
s_add_u32 m0, s68, 38016
s_add_u32 s64, s35, 147456
buffer_load_dwordx4 v169, s[8:11], s64 offen nt lds
s_add_u32 m0, s68, 39072
s_add_u32 s64, s35, 151552
buffer_load_dwordx4 v169, s[8:11], s64 offen nt lds
s_add_u32 m0, s68, 40128
s_add_u32 s64, s35, 155648
buffer_load_dwordx4 v169, s[8:11], s64 offen nt lds
s_add_u32 m0, s68, 41184
s_add_u32 s64, s35, 159744
buffer_load_dwordx4 v169, s[8:11], s64 offen nt lds
s_setprio 1
s_waitcnt vmcnt(16) lgkmcnt(0)
v_mfma_f32_16x16x32_bf16 v[64:67], a[0:3], a[64:67], v[64:67]
ds_read_b128 a[32:35], v164 offset:64
v_mfma_f32_16x16x32_bf16 v[68:71], a[0:3], a[68:71], v[68:71]
ds_read_b128 a[36:39], v164 offset:2240
v_mfma_f32_16x16x32_bf16 v[84:87], a[4:7], a[68:71], v[84:87]
ds_read_b128 a[40:43], v164 offset:4416
v_mfma_f32_16x16x32_bf16 v[80:83], a[4:7], a[64:67], v[80:83]
ds_read_b128 a[44:47], v164 offset:6592
v_mfma_f32_16x16x32_bf16 v[96:99], a[8:11], a[64:67], v[96:99]
ds_read_b64_tr_b16 a[16:17], v160 offset:8192
v_mfma_f32_16x16x32_bf16 v[100:103], a[8:11], a[68:71], v[100:103]
ds_read_b64_tr_b16 a[18:19], v160 offset:10240
v_mfma_f32_16x16x32_bf16 v[116:119], a[12:15], a[68:71], v[116:119]
ds_read_b64_tr_b16 a[20:21], v161 offset:8192
v_mfma_f32_16x16x32_bf16 v[112:115], a[12:15], a[64:67], v[112:115]
ds_read_b64_tr_b16 a[22:23], v161 offset:10240
v_mfma_f32_16x16x32_bf16 v[120:123], a[12:15], a[72:75], v[120:123]
ds_read_b64_tr_b16 a[24:25], v162 offset:8192
v_mfma_f32_16x16x32_bf16 v[124:127], a[12:15], a[76:79], v[124:127]
ds_read_b64_tr_b16 a[26:27], v162 offset:10240
v_mfma_f32_16x16x32_bf16 v[108:111], a[8:11], a[76:79], v[108:111]
ds_read_b64_tr_b16 a[28:29], v163 offset:8192
v_mfma_f32_16x16x32_bf16 v[104:107], a[8:11], a[72:75], v[104:107]
ds_read_b64_tr_b16 a[30:31], v163 offset:10240
v_mfma_f32_16x16x32_bf16 v[88:91], a[4:7], a[72:75], v[88:91]
v_mfma_f32_16x16x32_bf16 v[92:95], a[4:7], a[76:79], v[92:95]
v_mfma_f32_16x16x32_bf16 v[76:79], a[0:3], a[76:79], v[76:79]
v_mfma_f32_16x16x32_bf16 v[72:75], a[0:3], a[72:75], v[72:75]
s_waitcnt vmcnt(12) lgkmcnt(0)
v_mfma_f32_16x16x32_bf16 v[0:3], a[16:19], a[32:35], v[0:3]
ds_read_b64_tr_b16 a[0:1], v160 offset:12288
v_mfma_f32_16x16x32_bf16 v[4:7], a[16:19], a[36:39], v[4:7]
ds_read_b64_tr_b16 a[2:3], v160 offset:14336
v_mfma_f32_16x16x32_bf16 v[20:23], a[20:23], a[36:39], v[20:23]
ds_read_b64_tr_b16 a[4:5], v161 offset:12288
v_mfma_f32_16x16x32_bf16 v[16:19], a[20:23], a[32:35], v[16:19]
ds_read_b64_tr_b16 a[6:7], v161 offset:14336
v_mfma_f32_16x16x32_bf16 v[32:35], a[24:27], a[32:35], v[32:35]
ds_read_b64_tr_b16 a[8:9], v162 offset:12288
v_mfma_f32_16x16x32_bf16 v[36:39], a[24:27], a[36:39], v[36:39]
ds_read_b64_tr_b16 a[10:11], v162 offset:14336
v_mfma_f32_16x16x32_bf16 v[52:55], a[28:31], a[36:39], v[52:55]
ds_read_b64_tr_b16 a[12:13], v163 offset:12288
v_mfma_f32_16x16x32_bf16 v[48:51], a[28:31], a[32:35], v[48:51]
ds_read_b64_tr_b16 a[14:15], v163 offset:14336
v_mfma_f32_16x16x32_bf16 v[56:59], a[28:31], a[40:43], v[56:59]
s_add_u32 m0, s66, 4096
s_add_u32 s64, s67, 2622592
buffer_load_dwordx4 v152, s[16:19], s64 offen offset:0 lds
v_mfma_f32_16x16x32_bf16 v[60:63], a[28:31], a[44:47], v[60:63]
buffer_load_dwordx4 v153, s[16:19], s64 offen offset:1024 lds
v_mfma_f32_16x16x32_bf16 v[44:47], a[24:27], a[44:47], v[44:47]
buffer_load_dwordx4 v154, s[16:19], s64 offen offset:2048 lds
v_mfma_f32_16x16x32_bf16 v[40:43], a[24:27], a[40:43], v[40:43]
buffer_load_dwordx4 v155, s[16:19], s64 offen offset:3072 lds
v_mfma_f32_16x16x32_bf16 v[24:27], a[20:23], a[40:43], v[24:27]
v_mfma_f32_16x16x32_bf16 v[28:31], a[20:23], a[44:47], v[28:31]
v_mfma_f32_16x16x32_bf16 v[12:15], a[16:19], a[44:47], v[12:15]
v_mfma_f32_16x16x32_bf16 v[8:11], a[16:19], a[40:43], v[8:11]
s_waitcnt vmcnt(12) lgkmcnt(0)
v_mfma_f32_16x16x32_bf16 v[64:67], a[0:3], a[32:35], v[64:67]
ds_read_b128 a[48:51], v164 offset:8704
v_mfma_f32_16x16x32_bf16 v[68:71], a[0:3], a[36:39], v[68:71]
ds_read_b128 a[52:55], v164 offset:10880
v_mfma_f32_16x16x32_bf16 v[84:87], a[4:7], a[36:39], v[84:87]
ds_read_b128 a[56:59], v164 offset:13056
v_mfma_f32_16x16x32_bf16 v[80:83], a[4:7], a[32:35], v[80:83]
ds_read_b128 a[60:63], v164 offset:15232
v_mfma_f32_16x16x32_bf16 v[96:99], a[8:11], a[32:35], v[96:99]
ds_read_b64_tr_b16 a[16:17], v160 offset:0
v_mfma_f32_16x16x32_bf16 v[100:103], a[8:11], a[36:39], v[100:103]
ds_read_b64_tr_b16 a[18:19], v160 offset:2048
v_mfma_f32_16x16x32_bf16 v[116:119], a[12:15], a[36:39], v[116:119]
ds_read_b64_tr_b16 a[20:21], v161 offset:0
v_mfma_f32_16x16x32_bf16 v[112:115], a[12:15], a[32:35], v[112:115]
ds_read_b64_tr_b16 a[22:23], v161 offset:2048
v_mfma_f32_16x16x32_bf16 v[120:123], a[12:15], a[40:43], v[120:123]
ds_read_b64_tr_b16 a[24:25], v162 offset:0
v_mfma_f32_16x16x32_bf16 v[124:127], a[12:15], a[44:47], v[124:127]
ds_read_b64_tr_b16 a[26:27], v162 offset:2048
v_mfma_f32_16x16x32_bf16 v[108:111], a[8:11], a[44:47], v[108:111]
ds_read_b64_tr_b16 a[28:29], v163 offset:0
v_mfma_f32_16x16x32_bf16 v[104:107], a[8:11], a[40:43], v[104:107]
ds_read_b64_tr_b16 a[30:31], v163 offset:2048
v_mfma_f32_16x16x32_bf16 v[88:91], a[4:7], a[40:43], v[88:91]
s_add_u32 m0, s66, 8192
s_add_u32 s64, s67, 2884608
buffer_load_dwordx4 v152, s[16:19], s64 offen offset:0 lds
v_mfma_f32_16x16x32_bf16 v[92:95], a[4:7], a[44:47], v[92:95]
buffer_load_dwordx4 v153, s[16:19], s64 offen offset:1024 lds
v_mfma_f32_16x16x32_bf16 v[76:79], a[0:3], a[44:47], v[76:79]
buffer_load_dwordx4 v154, s[16:19], s64 offen offset:2048 lds
v_mfma_f32_16x16x32_bf16 v[72:75], a[0:3], a[40:43], v[72:75]
buffer_load_dwordx4 v155, s[16:19], s64 offen offset:3072 lds
s_waitcnt lgkmcnt(0)
v_mfma_f32_16x16x32_bf16 v[0:3], a[16:19], a[48:51], v[0:3]
s_add_u32 m0, s66, 12288
s_add_u32 s64, s67, 2884736
buffer_load_dwordx4 v152, s[16:19], s64 offen offset:0 lds
v_mfma_f32_16x16x32_bf16 v[4:7], a[16:19], a[52:55], v[4:7]
buffer_load_dwordx4 v153, s[16:19], s64 offen offset:1024 lds
v_mfma_f32_16x16x32_bf16 v[20:23], a[20:23], a[52:55], v[20:23]
buffer_load_dwordx4 v154, s[16:19], s64 offen offset:2048 lds
v_mfma_f32_16x16x32_bf16 v[16:19], a[20:23], a[48:51], v[16:19]
buffer_load_dwordx4 v155, s[16:19], s64 offen offset:3072 lds
v_mfma_f32_16x16x32_bf16 v[32:35], a[24:27], a[48:51], v[32:35]
v_mfma_f32_16x16x32_bf16 v[36:39], a[24:27], a[52:55], v[36:39]
v_mfma_f32_16x16x32_bf16 v[52:55], a[28:31], a[52:55], v[52:55]
v_mfma_f32_16x16x32_bf16 v[48:51], a[28:31], a[48:51], v[48:51]
v_mfma_f32_16x16x32_bf16 v[56:59], a[28:31], a[56:59], v[56:59]
v_mfma_f32_16x16x32_bf16 v[60:63], a[28:31], a[60:63], v[60:63]
v_mfma_f32_16x16x32_bf16 v[44:47], a[24:27], a[60:63], v[44:47]
v_mfma_f32_16x16x32_bf16 v[40:43], a[24:27], a[56:59], v[40:43]
v_mfma_f32_16x16x32_bf16 v[24:27], a[20:23], a[56:59], v[24:27]
v_mfma_f32_16x16x32_bf16 v[28:31], a[20:23], a[60:63], v[28:31]
v_mfma_f32_16x16x32_bf16 v[12:15], a[16:19], a[60:63], v[12:15]
v_mfma_f32_16x16x32_bf16 v[8:11], a[16:19], a[56:59], v[8:11]
s_add_u32 m0, s66, 0
s_add_u32 s64, s67, 3146752
buffer_load_dwordx4 v152, s[16:19], s64 offen offset:0 lds
buffer_load_dwordx4 v153, s[16:19], s64 offen offset:1024 lds
buffer_load_dwordx4 v154, s[16:19], s64 offen offset:2048 lds
buffer_load_dwordx4 v155, s[16:19], s64 offen offset:3072 lds
s_waitcnt vmcnt(16)
s_barrier
s_setprio 3
s_add_u32 m0, s77, 0
s_add_u32 s64, s36, 0
buffer_load_dwordx4 v168, s[12:15], s64 offen nt lds
s_add_u32 m0, s77, 1024
s_add_u32 s64, s36, 16384
buffer_load_dwordx4 v168, s[12:15], s64 offen nt lds
s_add_u32 m0, s77, 2048
s_add_u32 s64, s36, 32768
buffer_load_dwordx4 v168, s[12:15], s64 offen nt lds
s_add_u32 m0, s77, 3072
s_add_u32 s64, s36, 49152
buffer_load_dwordx4 v168, s[12:15], s64 offen nt lds
s_waitcnt vmcnt(16)
ds_read_b64_tr_b16 a[0:1], v160 offset:4096
ds_read_b64_tr_b16 a[2:3], v160 offset:6144
ds_read_b64_tr_b16 a[4:5], v161 offset:4096
ds_read_b64_tr_b16 a[6:7], v161 offset:6144
ds_read_b64_tr_b16 a[8:9], v162 offset:4096
ds_read_b64_tr_b16 a[10:11], v162 offset:6144
ds_read_b64_tr_b16 a[12:13], v163 offset:4096
ds_read_b64_tr_b16 a[14:15], v163 offset:6144
s_add_u32 m0, s77, 4096
s_add_u32 s64, s36, 65536
buffer_load_dwordx4 v168, s[12:15], s64 offen nt lds
s_add_u32 m0, s77, 5120
s_add_u32 s64, s36, 81920
buffer_load_dwordx4 v168, s[12:15], s64 offen nt lds
s_add_u32 m0, s77, 6144
s_add_u32 s64, s36, 98304
buffer_load_dwordx4 v168, s[12:15], s64 offen nt lds
s_add_u32 m0, s77, 7168
s_add_u32 s64, s36, 114688
buffer_load_dwordx4 v168, s[12:15], s64 offen nt lds
s_setprio 1
s_waitcnt vmcnt(16) lgkmcnt(0)
v_mfma_f32_16x16x32_bf16 v[64:67], a[0:3], a[48:51], v[64:67]
ds_read_b128 a[64:67], v164 offset:8768
v_mfma_f32_16x16x32_bf16 v[68:71], a[0:3], a[52:55], v[68:71]
ds_read_b128 a[68:71], v164 offset:10944
v_mfma_f32_16x16x32_bf16 v[84:87], a[4:7], a[52:55], v[84:87]
ds_read_b128 a[72:75], v164 offset:13120
v_mfma_f32_16x16x32_bf16 v[80:83], a[4:7], a[48:51], v[80:83]
ds_read_b128 a[76:79], v164 offset:15296
v_mfma_f32_16x16x32_bf16 v[96:99], a[8:11], a[48:51], v[96:99]
ds_read_b64_tr_b16 a[16:17], v160 offset:8192
v_mfma_f32_16x16x32_bf16 v[100:103], a[8:11], a[52:55], v[100:103]
ds_read_b64_tr_b16 a[18:19], v160 offset:10240
v_mfma_f32_16x16x32_bf16 v[116:119], a[12:15], a[52:55], v[116:119]
ds_read_b64_tr_b16 a[20:21], v161 offset:8192
v_mfma_f32_16x16x32_bf16 v[112:115], a[12:15], a[48:51], v[112:115]
ds_read_b64_tr_b16 a[22:23], v161 offset:10240
v_mfma_f32_16x16x32_bf16 v[120:123], a[12:15], a[56:59], v[120:123]
ds_read_b64_tr_b16 a[24:25], v162 offset:8192
v_mfma_f32_16x16x32_bf16 v[124:127], a[12:15], a[60:63], v[124:127]
ds_read_b64_tr_b16 a[26:27], v162 offset:10240
v_mfma_f32_16x16x32_bf16 v[108:111], a[8:11], a[60:63], v[108:111]
ds_read_b64_tr_b16 a[28:29], v163 offset:8192
v_mfma_f32_16x16x32_bf16 v[104:107], a[8:11], a[56:59], v[104:107]
ds_read_b64_tr_b16 a[30:31], v163 offset:10240
v_mfma_f32_16x16x32_bf16 v[88:91], a[4:7], a[56:59], v[88:91]
v_mfma_f32_16x16x32_bf16 v[92:95], a[4:7], a[60:63], v[92:95]
v_mfma_f32_16x16x32_bf16 v[76:79], a[0:3], a[60:63], v[76:79]
v_mfma_f32_16x16x32_bf16 v[72:75], a[0:3], a[56:59], v[72:75]
s_waitcnt vmcnt(12) lgkmcnt(0)
v_mfma_f32_16x16x32_bf16 v[0:3], a[16:19], a[64:67], v[0:3]
ds_read_b64_tr_b16 a[0:1], v160 offset:12288
v_mfma_f32_16x16x32_bf16 v[4:7], a[16:19], a[68:71], v[4:7]
ds_read_b64_tr_b16 a[2:3], v160 offset:14336
v_mfma_f32_16x16x32_bf16 v[20:23], a[20:23], a[68:71], v[20:23]
ds_read_b64_tr_b16 a[4:5], v161 offset:12288
v_mfma_f32_16x16x32_bf16 v[16:19], a[20:23], a[64:67], v[16:19]
ds_read_b64_tr_b16 a[6:7], v161 offset:14336
v_mfma_f32_16x16x32_bf16 v[32:35], a[24:27], a[64:67], v[32:35]
ds_read_b64_tr_b16 a[8:9], v162 offset:12288
v_mfma_f32_16x16x32_bf16 v[36:39], a[24:27], a[68:71], v[36:39]
ds_read_b64_tr_b16 a[10:11], v162 offset:14336
v_mfma_f32_16x16x32_bf16 v[52:55], a[28:31], a[68:71], v[52:55]
ds_read_b64_tr_b16 a[12:13], v163 offset:12288
v_mfma_f32_16x16x32_bf16 v[48:51], a[28:31], a[64:67], v[48:51]
ds_read_b64_tr_b16 a[14:15], v163 offset:14336
v_mfma_f32_16x16x32_bf16 v[56:59], a[28:31], a[72:75], v[56:59]
s_add_u32 m0, s66, 4096
s_add_u32 s64, s67, 3146880
buffer_load_dwordx4 v152, s[16:19], s64 offen offset:0 lds
v_mfma_f32_16x16x32_bf16 v[60:63], a[28:31], a[76:79], v[60:63]
buffer_load_dwordx4 v153, s[16:19], s64 offen offset:1024 lds
v_mfma_f32_16x16x32_bf16 v[44:47], a[24:27], a[76:79], v[44:47]
buffer_load_dwordx4 v154, s[16:19], s64 offen offset:2048 lds
v_mfma_f32_16x16x32_bf16 v[40:43], a[24:27], a[72:75], v[40:43]
buffer_load_dwordx4 v155, s[16:19], s64 offen offset:3072 lds
v_mfma_f32_16x16x32_bf16 v[24:27], a[20:23], a[72:75], v[24:27]
v_mfma_f32_16x16x32_bf16 v[28:31], a[20:23], a[76:79], v[28:31]
v_mfma_f32_16x16x32_bf16 v[12:15], a[16:19], a[76:79], v[12:15]
v_mfma_f32_16x16x32_bf16 v[8:11], a[16:19], a[72:75], v[8:11]
s_waitcnt vmcnt(12) lgkmcnt(0)
v_mfma_f32_16x16x32_bf16 v[64:67], a[0:3], a[64:67], v[64:67]
ds_read_b128 a[32:35], v165 offset:34816
v_mfma_f32_16x16x32_bf16 v[68:71], a[0:3], a[68:71], v[68:71]
ds_read_b128 a[36:39], v165 offset:36992
v_mfma_f32_16x16x32_bf16 v[84:87], a[4:7], a[68:71], v[84:87]
ds_read_b128 a[40:43], v165 offset:39168
v_mfma_f32_16x16x32_bf16 v[80:83], a[4:7], a[64:67], v[80:83]
ds_read_b128 a[44:47], v165 offset:41344
v_mfma_f32_16x16x32_bf16 v[96:99], a[8:11], a[64:67], v[96:99]
ds_read_b64_tr_b16 a[16:17], v160 offset:0
v_mfma_f32_16x16x32_bf16 v[100:103], a[8:11], a[68:71], v[100:103]
ds_read_b64_tr_b16 a[18:19], v160 offset:2048
v_mfma_f32_16x16x32_bf16 v[116:119], a[12:15], a[68:71], v[116:119]
ds_read_b64_tr_b16 a[20:21], v161 offset:0
v_mfma_f32_16x16x32_bf16 v[112:115], a[12:15], a[64:67], v[112:115]
ds_read_b64_tr_b16 a[22:23], v161 offset:2048
v_mfma_f32_16x16x32_bf16 v[120:123], a[12:15], a[72:75], v[120:123]
ds_read_b64_tr_b16 a[24:25], v162 offset:0
v_mfma_f32_16x16x32_bf16 v[124:127], a[12:15], a[76:79], v[124:127]
ds_read_b64_tr_b16 a[26:27], v162 offset:2048
v_mfma_f32_16x16x32_bf16 v[108:111], a[8:11], a[76:79], v[108:111]
ds_read_b64_tr_b16 a[28:29], v163 offset:0
v_mfma_f32_16x16x32_bf16 v[104:107], a[8:11], a[72:75], v[104:107]
ds_read_b64_tr_b16 a[30:31], v163 offset:2048
v_mfma_f32_16x16x32_bf16 v[88:91], a[4:7], a[72:75], v[88:91]
s_add_u32 m0, s66, 8192
s_add_u32 s64, s67, 3408896
buffer_load_dwordx4 v152, s[16:19], s64 offen offset:0 lds
v_mfma_f32_16x16x32_bf16 v[92:95], a[4:7], a[76:79], v[92:95]
buffer_load_dwordx4 v153, s[16:19], s64 offen offset:1024 lds
v_mfma_f32_16x16x32_bf16 v[76:79], a[0:3], a[76:79], v[76:79]
buffer_load_dwordx4 v154, s[16:19], s64 offen offset:2048 lds
v_mfma_f32_16x16x32_bf16 v[72:75], a[0:3], a[72:75], v[72:75]
buffer_load_dwordx4 v155, s[16:19], s64 offen offset:3072 lds
s_waitcnt lgkmcnt(0)
v_mfma_f32_16x16x32_bf16 v[0:3], a[16:19], a[32:35], v[0:3]
s_add_u32 m0, s66, 12288
s_add_u32 s64, s67, 3409024
buffer_load_dwordx4 v152, s[16:19], s64 offen offset:0 lds
v_mfma_f32_16x16x32_bf16 v[4:7], a[16:19], a[36:39], v[4:7]
buffer_load_dwordx4 v153, s[16:19], s64 offen offset:1024 lds
v_mfma_f32_16x16x32_bf16 v[20:23], a[20:23], a[36:39], v[20:23]
buffer_load_dwordx4 v154, s[16:19], s64 offen offset:2048 lds
v_mfma_f32_16x16x32_bf16 v[16:19], a[20:23], a[32:35], v[16:19]
buffer_load_dwordx4 v155, s[16:19], s64 offen offset:3072 lds
v_mfma_f32_16x16x32_bf16 v[32:35], a[24:27], a[32:35], v[32:35]
v_mfma_f32_16x16x32_bf16 v[36:39], a[24:27], a[36:39], v[36:39]
v_mfma_f32_16x16x32_bf16 v[52:55], a[28:31], a[36:39], v[52:55]
v_mfma_f32_16x16x32_bf16 v[48:51], a[28:31], a[32:35], v[48:51]
v_mfma_f32_16x16x32_bf16 v[56:59], a[28:31], a[40:43], v[56:59]
v_mfma_f32_16x16x32_bf16 v[60:63], a[28:31], a[44:47], v[60:63]
v_mfma_f32_16x16x32_bf16 v[44:47], a[24:27], a[44:47], v[44:47]
v_mfma_f32_16x16x32_bf16 v[40:43], a[24:27], a[40:43], v[40:43]
v_mfma_f32_16x16x32_bf16 v[24:27], a[20:23], a[40:43], v[24:27]
v_mfma_f32_16x16x32_bf16 v[28:31], a[20:23], a[44:47], v[28:31]
v_mfma_f32_16x16x32_bf16 v[12:15], a[16:19], a[44:47], v[12:15]
v_mfma_f32_16x16x32_bf16 v[8:11], a[16:19], a[40:43], v[8:11]
s_waitcnt vmcnt(12)
s_barrier
s_setprio 3
s_add_u32 m0, s77, 33792
s_add_u32 s64, s36, 131072
buffer_load_dwordx4 v168, s[12:15], s64 offen nt lds
s_add_u32 m0, s77, 34816
s_add_u32 s64, s36, 147456
buffer_load_dwordx4 v168, s[12:15], s64 offen nt lds
s_add_u32 m0, s77, 35840
s_add_u32 s64, s36, 163840
buffer_load_dwordx4 v168, s[12:15], s64 offen nt lds
s_add_u32 m0, s77, 36864
s_add_u32 s64, s36, 180224
buffer_load_dwordx4 v168, s[12:15], s64 offen nt lds
s_waitcnt vmcnt(12)
ds_read_b64_tr_b16 a[0:1], v160 offset:4096
ds_read_b64_tr_b16 a[2:3], v160 offset:6144
ds_read_b64_tr_b16 a[4:5], v161 offset:4096
ds_read_b64_tr_b16 a[6:7], v161 offset:6144
ds_read_b64_tr_b16 a[8:9], v162 offset:4096
ds_read_b64_tr_b16 a[10:11], v162 offset:6144
ds_read_b64_tr_b16 a[12:13], v163 offset:4096
ds_read_b64_tr_b16 a[14:15], v163 offset:6144
s_add_u32 m0, s77, 37888
s_add_u32 s64, s36, 196608
buffer_load_dwordx4 v168, s[12:15], s64 offen nt lds
s_add_u32 m0, s77, 38912
s_add_u32 s64, s36, 212992
buffer_load_dwordx4 v168, s[12:15], s64 offen nt lds
s_add_u32 m0, s77, 39936
s_add_u32 s64, s36, 229376
buffer_load_dwordx4 v168, s[12:15], s64 offen nt lds
s_add_u32 m0, s77, 40960
s_add_u32 s64, s36, 245760
buffer_load_dwordx4 v168, s[12:15], s64 offen nt lds
s_setprio 1
s_waitcnt vmcnt(12) lgkmcnt(0)
v_mfma_f32_16x16x32_bf16 v[64:67], a[0:3], a[32:35], v[64:67]
ds_read_b128 a[48:51], v165 offset:34880
v_mfma_f32_16x16x32_bf16 v[68:71], a[0:3], a[36:39], v[68:71]
ds_read_b128 a[52:55], v165 offset:37056
v_mfma_f32_16x16x32_bf16 v[84:87], a[4:7], a[36:39], v[84:87]
ds_read_b128 a[56:59], v165 offset:39232
v_mfma_f32_16x16x32_bf16 v[80:83], a[4:7], a[32:35], v[80:83]
ds_read_b128 a[60:63], v165 offset:41408
v_mfma_f32_16x16x32_bf16 v[96:99], a[8:11], a[32:35], v[96:99]
ds_read_b64_tr_b16 a[16:17], v160 offset:8192
v_mfma_f32_16x16x32_bf16 v[100:103], a[8:11], a[36:39], v[100:103]
ds_read_b64_tr_b16 a[18:19], v160 offset:10240
v_mfma_f32_16x16x32_bf16 v[116:119], a[12:15], a[36:39], v[116:119]
ds_read_b64_tr_b16 a[20:21], v161 offset:8192
v_mfma_f32_16x16x32_bf16 v[112:115], a[12:15], a[32:35], v[112:115]
ds_read_b64_tr_b16 a[22:23], v161 offset:10240
v_mfma_f32_16x16x32_bf16 v[120:123], a[12:15], a[40:43], v[120:123]
ds_read_b64_tr_b16 a[24:25], v162 offset:8192
v_mfma_f32_16x16x32_bf16 v[124:127], a[12:15], a[44:47], v[124:127]
ds_read_b64_tr_b16 a[26:27], v162 offset:10240
v_mfma_f32_16x16x32_bf16 v[108:111], a[8:11], a[44:47], v[108:111]
ds_read_b64_tr_b16 a[28:29], v163 offset:8192
v_mfma_f32_16x16x32_bf16 v[104:107], a[8:11], a[40:43], v[104:107]
ds_read_b64_tr_b16 a[30:31], v163 offset:10240
v_mfma_f32_16x16x32_bf16 v[88:91], a[4:7], a[40:43], v[88:91]
v_mfma_f32_16x16x32_bf16 v[92:95], a[4:7], a[44:47], v[92:95]
v_mfma_f32_16x16x32_bf16 v[76:79], a[0:3], a[44:47], v[76:79]
v_mfma_f32_16x16x32_bf16 v[72:75], a[0:3], a[40:43], v[72:75]
s_waitcnt vmcnt(8) lgkmcnt(0)
v_mfma_f32_16x16x32_bf16 v[0:3], a[16:19], a[48:51], v[0:3]
ds_read_b64_tr_b16 a[0:1], v160 offset:12288
v_mfma_f32_16x16x32_bf16 v[4:7], a[16:19], a[52:55], v[4:7]
ds_read_b64_tr_b16 a[2:3], v160 offset:14336
v_mfma_f32_16x16x32_bf16 v[20:23], a[20:23], a[52:55], v[20:23]
ds_read_b64_tr_b16 a[4:5], v161 offset:12288
v_mfma_f32_16x16x32_bf16 v[16:19], a[20:23], a[48:51], v[16:19]
ds_read_b64_tr_b16 a[6:7], v161 offset:14336
v_mfma_f32_16x16x32_bf16 v[32:35], a[24:27], a[48:51], v[32:35]
ds_read_b64_tr_b16 a[8:9], v162 offset:12288
v_mfma_f32_16x16x32_bf16 v[36:39], a[24:27], a[52:55], v[36:39]
ds_read_b64_tr_b16 a[10:11], v162 offset:14336
v_mfma_f32_16x16x32_bf16 v[52:55], a[28:31], a[52:55], v[52:55]
ds_read_b64_tr_b16 a[12:13], v163 offset:12288
v_mfma_f32_16x16x32_bf16 v[48:51], a[28:31], a[48:51], v[48:51]
ds_read_b64_tr_b16 a[14:15], v163 offset:14336
v_mfma_f32_16x16x32_bf16 v[56:59], a[28:31], a[56:59], v[56:59]
v_mfma_f32_16x16x32_bf16 v[60:63], a[28:31], a[60:63], v[60:63]
v_mfma_f32_16x16x32_bf16 v[44:47], a[24:27], a[60:63], v[44:47]
v_mfma_f32_16x16x32_bf16 v[40:43], a[24:27], a[56:59], v[40:43]
v_mfma_f32_16x16x32_bf16 v[24:27], a[20:23], a[56:59], v[24:27]
v_mfma_f32_16x16x32_bf16 v[28:31], a[20:23], a[60:63], v[28:31]
v_mfma_f32_16x16x32_bf16 v[12:15], a[16:19], a[60:63], v[12:15]
v_mfma_f32_16x16x32_bf16 v[8:11], a[16:19], a[56:59], v[8:11]
s_waitcnt lgkmcnt(0)
v_mfma_f32_16x16x32_bf16 v[64:67], a[0:3], a[48:51], v[64:67]
v_cvt_pk_bf16_f32 v132, v0, v1
v_cvt_pk_bf16_f32 v133, v2, v3
ds_write_b64 v171, v[132:133] offset:0
v_mfma_f32_16x16x32_bf16 v[68:71], a[0:3], a[52:55], v[68:71]
v_cvt_pk_bf16_f32 v134, v4, v5
v_cvt_pk_bf16_f32 v135, v6, v7
ds_write_b64 v171, v[134:135] offset:4096
v_mfma_f32_16x16x32_bf16 v[84:87], a[4:7], a[52:55], v[84:87]
v_cvt_pk_bf16_f32 v136, v8, v9
v_cvt_pk_bf16_f32 v137, v10, v11
ds_write_b64 v171, v[136:137] offset:8192
v_mfma_f32_16x16x32_bf16 v[80:83], a[4:7], a[48:51], v[80:83]
v_cvt_pk_bf16_f32 v138, v12, v13
v_cvt_pk_bf16_f32 v139, v14, v15
ds_write_b64 v171, v[138:139] offset:12288
v_mfma_f32_16x16x32_bf16 v[96:99], a[8:11], a[48:51], v[96:99]
v_cvt_pk_bf16_f32 v140, v16, v17
v_cvt_pk_bf16_f32 v141, v18, v19
ds_write_b64 v171, v[140:141] offset:512
v_mfma_f32_16x16x32_bf16 v[100:103], a[8:11], a[52:55], v[100:103]
v_cvt_pk_bf16_f32 v142, v20, v21
v_cvt_pk_bf16_f32 v143, v22, v23
ds_write_b64 v171, v[142:143] offset:4608
v_mfma_f32_16x16x32_bf16 v[116:119], a[12:15], a[52:55], v[116:119]
v_cvt_pk_bf16_f32 v144, v24, v25
v_cvt_pk_bf16_f32 v145, v26, v27
ds_write_b64 v171, v[144:145] offset:8704
v_mfma_f32_16x16x32_bf16 v[112:115], a[12:15], a[48:51], v[112:115]
v_cvt_pk_bf16_f32 v146, v28, v29
v_cvt_pk_bf16_f32 v147, v30, v31
ds_write_b64 v171, v[146:147] offset:12800
v_mfma_f32_16x16x32_bf16 v[120:123], a[12:15], a[56:59], v[120:123]
v_cvt_pk_bf16_f32 v132, v32, v33
v_cvt_pk_bf16_f32 v133, v34, v35
ds_write_b64 v171, v[132:133] offset:1024
v_mfma_f32_16x16x32_bf16 v[124:127], a[12:15], a[60:63], v[124:127]
v_cvt_pk_bf16_f32 v134, v36, v37
v_cvt_pk_bf16_f32 v135, v38, v39
ds_write_b64 v171, v[134:135] offset:5120
v_mfma_f32_16x16x32_bf16 v[108:111], a[8:11], a[60:63], v[108:111]
v_cvt_pk_bf16_f32 v136, v40, v41
v_cvt_pk_bf16_f32 v137, v42, v43
ds_write_b64 v171, v[136:137] offset:9216
v_mfma_f32_16x16x32_bf16 v[104:107], a[8:11], a[56:59], v[104:107]
v_cvt_pk_bf16_f32 v138, v44, v45
v_cvt_pk_bf16_f32 v139, v46, v47
ds_write_b64 v171, v[138:139] offset:13312
v_mfma_f32_16x16x32_bf16 v[88:91], a[4:7], a[56:59], v[88:91]
v_cvt_pk_bf16_f32 v140, v48, v49
v_cvt_pk_bf16_f32 v141, v50, v51
ds_write_b64 v171, v[140:141] offset:1536
v_mfma_f32_16x16x32_bf16 v[92:95], a[4:7], a[60:63], v[92:95]
v_cvt_pk_bf16_f32 v142, v52, v53
v_cvt_pk_bf16_f32 v143, v54, v55
ds_write_b64 v171, v[142:143] offset:5632
v_mfma_f32_16x16x32_bf16 v[76:79], a[0:3], a[60:63], v[76:79]
v_cvt_pk_bf16_f32 v144, v56, v57
v_cvt_pk_bf16_f32 v145, v58, v59
ds_write_b64 v171, v[144:145] offset:9728
v_mfma_f32_16x16x32_bf16 v[72:75], a[0:3], a[56:59], v[72:75]
v_cvt_pk_bf16_f32 v146, v60, v61
v_cvt_pk_bf16_f32 v147, v62, v63
ds_write_b64 v171, v[146:147] offset:13824
s_nop 3
v_cvt_pk_bf16_f32 v132, v64, v65
v_cvt_pk_bf16_f32 v133, v66, v67
ds_write_b64 v171, v[132:133] offset:2048
v_cvt_pk_bf16_f32 v134, v68, v69
v_cvt_pk_bf16_f32 v135, v70, v71
ds_write_b64 v171, v[134:135] offset:6144
v_cvt_pk_bf16_f32 v136, v72, v73
v_cvt_pk_bf16_f32 v137, v74, v75
ds_write_b64 v171, v[136:137] offset:10240
v_cvt_pk_bf16_f32 v138, v76, v77
v_cvt_pk_bf16_f32 v139, v78, v79
ds_write_b64 v171, v[138:139] offset:14336
v_cvt_pk_bf16_f32 v140, v80, v81
v_cvt_pk_bf16_f32 v141, v82, v83
ds_write_b64 v171, v[140:141] offset:2560
v_cvt_pk_bf16_f32 v142, v84, v85
v_cvt_pk_bf16_f32 v143, v86, v87
ds_write_b64 v171, v[142:143] offset:6656
v_cvt_pk_bf16_f32 v144, v88, v89
v_cvt_pk_bf16_f32 v145, v90, v91
ds_write_b64 v171, v[144:145] offset:10752
v_cvt_pk_bf16_f32 v146, v92, v93
v_cvt_pk_bf16_f32 v147, v94, v95
ds_write_b64 v171, v[146:147] offset:14848
v_cvt_pk_bf16_f32 v132, v96, v97
v_cvt_pk_bf16_f32 v133, v98, v99
ds_write_b64 v171, v[132:133] offset:3072
v_cvt_pk_bf16_f32 v134, v100, v101
v_cvt_pk_bf16_f32 v135, v102, v103
ds_write_b64 v171, v[134:135] offset:7168
v_cvt_pk_bf16_f32 v136, v104, v105
v_cvt_pk_bf16_f32 v137, v106, v107
ds_write_b64 v171, v[136:137] offset:11264
v_cvt_pk_bf16_f32 v138, v108, v109
v_cvt_pk_bf16_f32 v139, v110, v111
ds_write_b64 v171, v[138:139] offset:15360
v_cvt_pk_bf16_f32 v140, v112, v113
v_cvt_pk_bf16_f32 v141, v114, v115
ds_write_b64 v171, v[140:141] offset:3584
v_cvt_pk_bf16_f32 v142, v116, v117
v_cvt_pk_bf16_f32 v143, v118, v119
ds_write_b64 v171, v[142:143] offset:7680
v_cvt_pk_bf16_f32 v144, v120, v121
v_cvt_pk_bf16_f32 v145, v122, v123
ds_write_b64 v171, v[144:145] offset:11776
v_cvt_pk_bf16_f32 v146, v124, v125
v_cvt_pk_bf16_f32 v147, v126, v127
ds_write_b64 v171, v[146:147] offset:15872
s_waitcnt lgkmcnt(0)
s_cmp_eq_u32 s60, 3
s_cbranch_scc1 L_B3
s_waitcnt vmcnt(0)
s_barrier
s_add_u32 m0, s77, 0
s_add_u32 s64, s37, 0
buffer_load_dwordx4 v168, s[12:15], s64 offen nt lds
s_add_u32 m0, s77, 1024
s_add_u32 s64, s37, 16384
buffer_load_dwordx4 v168, s[12:15], s64 offen nt lds
s_add_u32 m0, s77, 2048
s_add_u32 s64, s37, 32768
buffer_load_dwordx4 v168, s[12:15], s64 offen nt lds
s_add_u32 m0, s77, 3072
s_add_u32 s64, s37, 49152
buffer_load_dwordx4 v168, s[12:15], s64 offen nt lds
s_add_u32 m0, s77, 4096
s_add_u32 s64, s37, 65536
buffer_load_dwordx4 v168, s[12:15], s64 offen nt lds
s_add_u32 m0, s77, 5120
s_add_u32 s64, s37, 81920
buffer_load_dwordx4 v168, s[12:15], s64 offen nt lds
s_add_u32 m0, s77, 6144
s_add_u32 s64, s37, 98304
buffer_load_dwordx4 v168, s[12:15], s64 offen nt lds
s_add_u32 m0, s77, 7168
s_add_u32 s64, s37, 114688
buffer_load_dwordx4 v168, s[12:15], s64 offen nt lds
s_barrier
s_add_u32 m0, s66, 0
s_add_u32 s64, s40, 0
buffer_load_dwordx4 v156, s[20:23], s64 offen offset:0 lds
buffer_load_dwordx4 v157, s[20:23], s64 offen offset:1024 lds
buffer_load_dwordx4 v158, s[20:23], s64 offen offset:2048 lds
buffer_load_dwordx4 v159, s[20:23], s64 offen offset:3072 lds
s_add_u32 m0, s66, 4096
s_add_u32 s64, s40, 128
buffer_load_dwordx4 v156, s[20:23], s64 offen offset:0 lds
buffer_load_dwordx4 v157, s[20:23], s64 offen offset:1024 lds
buffer_load_dwordx4 v158, s[20:23], s64 offen offset:2048 lds
buffer_load_dwordx4 v159, s[20:23], s64 offen offset:3072 lds
s_waitcnt vmcnt(8)
s_barrier
s_setprio 3
s_add_u32 m0, s77, 33792
s_add_u32 s64, s37, 131072
buffer_load_dwordx4 v168, s[12:15], s64 offen nt lds
s_add_u32 m0, s77, 34816
s_add_u32 s64, s37, 147456
buffer_load_dwordx4 v168, s[12:15], s64 offen nt lds
s_add_u32 m0, s77, 35840
s_add_u32 s64, s37, 163840
buffer_load_dwordx4 v168, s[12:15], s64 offen nt lds
s_add_u32 m0, s77, 36864
s_add_u32 s64, s37, 180224
buffer_load_dwordx4 v168, s[12:15], s64 offen nt lds
s_waitcnt vmcnt(8)
ds_read_b64_tr_b16 a[0:1], v160 offset:0
ds_read_b64_tr_b16 a[2:3], v160 offset:2048
ds_read_b64_tr_b16 a[4:5], v161 offset:0
ds_read_b64_tr_b16 a[6:7], v161 offset:2048
ds_read_b64_tr_b16 a[8:9], v162 offset:0
ds_read_b64_tr_b16 a[10:11], v162 offset:2048
ds_read_b64_tr_b16 a[12:13], v163 offset:0
ds_read_b64_tr_b16 a[14:15], v163 offset:2048
s_add_u32 m0, s77, 37888
s_add_u32 s64, s37, 196608
buffer_load_dwordx4 v168, s[12:15], s64 offen nt lds
s_add_u32 m0, s77, 38912
s_add_u32 s64, s37, 212992
buffer_load_dwordx4 v168, s[12:15], s64 offen nt lds
s_add_u32 m0, s77, 39936
s_add_u32 s64, s37, 229376
buffer_load_dwordx4 v168, s[12:15], s64 offen nt lds
s_add_u32 m0, s77, 40960
s_add_u32 s64, s37, 245760
buffer_load_dwordx4 v168, s[12:15], s64 offen nt lds
s_barrier
ds_read_b128 a[32:35], v128 offset:0
ds_read_b128 a[36:39], v129 offset:0
ds_read_b128 a[40:43], v130 offset:0
ds_read_b128 a[44:47], v131 offset:0
s_setprio 1
s_waitcnt vmcnt(8) lgkmcnt(0)
v_mfma_f32_16x16x32_bf16 v[0:3], a[0:3], a[32:35], 0
ds_read_b64_tr_b16 a[16:17], v160 offset:4096
v_mfma_f32_16x16x32_bf16 v[4:7], a[0:3], a[36:39], 0
ds_read_b64_tr_b16 a[18:19], v160 offset:6144
v_mfma_f32_16x16x32_bf16 v[20:23], a[4:7], a[36:39], 0
ds_read_b64_tr_b16 a[20:21], v161 offset:4096
v_mfma_f32_16x16x32_bf16 v[16:19], a[4:7], a[32:35], 0
ds_read_b64_tr_b16 a[22:23], v161 offset:6144
v_mfma_f32_16x16x32_bf16 v[32:35], a[8:11], a[32:35], 0
ds_read_b64_tr_b16 a[24:25], v162 offset:4096
v_mfma_f32_16x16x32_bf16 v[36:39], a[8:11], a[36:39], 0
ds_read_b64_tr_b16 a[26:27], v162 offset:6144
v_mfma_f32_16x16x32_bf16 v[52:55], a[12:15], a[36:39], 0
ds_read_b64_tr_b16 a[28:29], v163 offset:4096
v_mfma_f32_16x16x32_bf16 v[48:51], a[12:15], a[32:35], 0
ds_read_b64_tr_b16 a[30:31], v163 offset:6144
v_mfma_f32_16x16x32_bf16 v[56:59], a[12:15], a[40:43], 0
v_mfma_f32_16x16x32_bf16 v[60:63], a[12:15], a[44:47], 0
v_mfma_f32_16x16x32_bf16 v[44:47], a[8:11], a[44:47], 0
v_mfma_f32_16x16x32_bf16 v[40:43], a[8:11], a[40:43], 0
v_mfma_f32_16x16x32_bf16 v[24:27], a[4:7], a[40:43], 0
v_mfma_f32_16x16x32_bf16 v[28:31], a[4:7], a[44:47], 0
v_mfma_f32_16x16x32_bf16 v[12:15], a[0:3], a[44:47], 0
v_mfma_f32_16x16x32_bf16 v[8:11], a[0:3], a[40:43], 0
s_waitcnt lgkmcnt(0)
v_mfma_f32_16x16x32_bf16 v[64:67], a[16:19], a[32:35], 0
s_add_u32 m0, s66, 8192
s_add_u32 s64, s40, 28672
buffer_load_dwordx4 v156, s[20:23], s64 offen offset:0 lds
v_mfma_f32_16x16x32_bf16 v[68:71], a[16:19], a[36:39], 0
buffer_load_dwordx4 v157, s[20:23], s64 offen offset:1024 lds
v_mfma_f32_16x16x32_bf16 v[84:87], a[20:23], a[36:39], 0
buffer_load_dwordx4 v158, s[20:23], s64 offen offset:2048 lds
v_mfma_f32_16x16x32_bf16 v[80:83], a[20:23], a[32:35], 0
buffer_load_dwordx4 v159, s[20:23], s64 offen offset:3072 lds
v_mfma_f32_16x16x32_bf16 v[96:99], a[24:27], a[32:35], 0
s_add_u32 m0, s66, 12288
s_add_u32 s64, s40, 28800
buffer_load_dwordx4 v156, s[20:23], s64 offen offset:0 lds
v_mfma_f32_16x16x32_bf16 v[100:103], a[24:27], a[36:39], 0
buffer_load_dwordx4 v157, s[20:23], s64 offen offset:1024 lds
v_mfma_f32_16x16x32_bf16 v[116:119], a[28:31], a[36:39], 0
buffer_load_dwordx4 v158, s[20:23], s64 offen offset:2048 lds
v_mfma_f32_16x16x32_bf16 v[112:115], a[28:31], a[32:35], 0
buffer_load_dwordx4 v159, s[20:23], s64 offen offset:3072 lds
v_mfma_f32_16x16x32_bf16 v[120:123], a[28:31], a[40:43], 0
v_mfma_f32_16x16x32_bf16 v[124:127], a[28:31], a[44:47], 0
v_mfma_f32_16x16x32_bf16 v[108:111], a[24:27], a[44:47], 0
v_mfma_f32_16x16x32_bf16 v[104:107], a[24:27], a[40:43], 0
v_mfma_f32_16x16x32_bf16 v[88:91], a[20:23], a[40:43], 0
v_mfma_f32_16x16x32_bf16 v[92:95], a[20:23], a[44:47], 0
v_mfma_f32_16x16x32_bf16 v[76:79], a[16:19], a[44:47], 0
v_mfma_f32_16x16x32_bf16 v[72:75], a[16:19], a[40:43], 0
s_waitcnt vmcnt(8)
s_barrier
s_setprio 3
s_add_u32 m0, s77, 0
s_add_u32 s64, s38, 0
buffer_load_dwordx4 v168, s[12:15], s64 offen nt lds
s_add_u32 m0, s77, 1024
s_add_u32 s64, s38, 16384
buffer_load_dwordx4 v168, s[12:15], s64 offen nt lds
s_add_u32 m0, s77, 2048
s_add_u32 s64, s38, 32768
buffer_load_dwordx4 v168, s[12:15], s64 offen nt lds
s_add_u32 m0, s77, 3072
s_add_u32 s64, s38, 49152
buffer_load_dwordx4 v168, s[12:15], s64 offen nt lds
s_waitcnt vmcnt(8)
ds_read_b64_tr_b16 a[0:1], v160 offset:8192
ds_read_b64_tr_b16 a[2:3], v160 offset:10240
ds_read_b64_tr_b16 a[4:5], v161 offset:8192
ds_read_b64_tr_b16 a[6:7], v161 offset:10240
ds_read_b64_tr_b16 a[8:9], v162 offset:8192
ds_read_b64_tr_b16 a[10:11], v162 offset:10240
ds_read_b64_tr_b16 a[12:13], v163 offset:8192
ds_read_b64_tr_b16 a[14:15], v163 offset:10240
ds_read_b128 a[48:51], v128 offset:4096
ds_read_b128 a[52:55], v129 offset:4096
ds_read_b128 a[56:59], v130 offset:4096
ds_read_b128 a[60:63], v131 offset:4096
s_add_u32 m0, s77, 4096
s_add_u32 s64, s38, 65536
buffer_load_dwordx4 v168, s[12:15], s64 offen nt lds
s_add_u32 m0, s77, 5120
s_add_u32 s64, s38, 81920
buffer_load_dwordx4 v168, s[12:15], s64 offen nt lds
s_add_u32 m0, s77, 6144
s_add_u32 s64, s38, 98304
buffer_load_dwordx4 v168, s[12:15], s64 offen nt lds
s_add_u32 m0, s77, 7168
s_add_u32 s64, s38, 114688
buffer_load_dwordx4 v168, s[12:15], s64 offen nt lds
s_setprio 1
s_waitcnt vmcnt(8) lgkmcnt(0)
v_mfma_f32_16x16x32_bf16 v[0:3], a[0:3], a[48:51], v[0:3]
ds_read_b64_tr_b16 a[16:17], v160 offset:12288
v_mfma_f32_16x16x32_bf16 v[4:7], a[0:3], a[52:55], v[4:7]
ds_read_b64_tr_b16 a[18:19], v160 offset:14336
v_mfma_f32_16x16x32_bf16 v[20:23], a[4:7], a[52:55], v[20:23]
ds_read_b64_tr_b16 a[20:21], v161 offset:12288
v_mfma_f32_16x16x32_bf16 v[16:19], a[4:7], a[48:51], v[16:19]
ds_read_b64_tr_b16 a[22:23], v161 offset:14336
v_mfma_f32_16x16x32_bf16 v[32:35], a[8:11], a[48:51], v[32:35]
ds_read_b64_tr_b16 a[24:25], v162 offset:12288
v_mfma_f32_16x16x32_bf16 v[36:39], a[8:11], a[52:55], v[36:39]
ds_read_b64_tr_b16 a[26:27], v162 offset:14336
v_mfma_f32_16x16x32_bf16 v[52:55], a[12:15], a[52:55], v[52:55]
ds_read_b64_tr_b16 a[28:29], v163 offset:12288
v_mfma_f32_16x16x32_bf16 v[48:51], a[12:15], a[48:51], v[48:51]
ds_read_b64_tr_b16 a[30:31], v163 offset:14336
v_mfma_f32_16x16x32_bf16 v[56:59], a[12:15], a[56:59], v[56:59]
v_mfma_f32_16x16x32_bf16 v[60:63], a[12:15], a[60:63], v[60:63]
v_mfma_f32_16x16x32_bf16 v[44:47], a[8:11], a[60:63], v[44:47]
v_mfma_f32_16x16x32_bf16 v[40:43], a[8:11], a[56:59], v[40:43]
v_mfma_f32_16x16x32_bf16 v[24:27], a[4:7], a[56:59], v[24:27]
v_mfma_f32_16x16x32_bf16 v[28:31], a[4:7], a[60:63], v[28:31]
v_mfma_f32_16x16x32_bf16 v[12:15], a[0:3], a[60:63], v[12:15]
v_mfma_f32_16x16x32_bf16 v[8:11], a[0:3], a[56:59], v[8:11]
s_waitcnt lgkmcnt(0)
v_mfma_f32_16x16x32_bf16 v[64:67], a[16:19], a[48:51], v[64:67]
ds_read_b128 a[64:67], v128 offset:8192
v_mfma_f32_16x16x32_bf16 v[68:71], a[16:19], a[52:55], v[68:71]
ds_read_b128 a[68:71], v129 offset:8192
v_mfma_f32_16x16x32_bf16 v[84:87], a[20:23], a[52:55], v[84:87]
ds_read_b128 a[72:75], v130 offset:8192
v_mfma_f32_16x16x32_bf16 v[80:83], a[20:23], a[48:51], v[80:83]
ds_read_b128 a[76:79], v131 offset:8192
v_mfma_f32_16x16x32_bf16 v[96:99], a[24:27], a[48:51], v[96:99]
ds_read_b128 v[132:135], v128 offset:12288
v_mfma_f32_16x16x32_bf16 v[100:103], a[24:27], a[52:55], v[100:103]
ds_read_b128 v[136:139], v129 offset:12288
v_mfma_f32_16x16x32_bf16 v[116:119], a[28:31], a[52:55], v[116:119]
ds_read_b128 v[140:143], v130 offset:12288
v_mfma_f32_16x16x32_bf16 v[112:115], a[28:31], a[48:51], v[112:115]
ds_read_b128 v[144:147], v131 offset:12288
v_mfma_f32_16x16x32_bf16 v[120:123], a[28:31], a[56:59], v[120:123]
s_add_u32 m0, s66, 0
s_add_u32 s64, s40, 229376
buffer_load_dwordx4 v156, s[20:23], s64 offen offset:0 lds
v_mfma_f32_16x16x32_bf16 v[124:127], a[28:31], a[60:63], v[124:127]
buffer_load_dwordx4 v157, s[20:23], s64 offen offset:1024 lds
v_mfma_f32_16x16x32_bf16 v[108:111], a[24:27], a[60:63], v[108:111]
buffer_load_dwordx4 v158, s[20:23], s64 offen offset:2048 lds
v_mfma_f32_16x16x32_bf16 v[104:107], a[24:27], a[56:59], v[104:107]
buffer_load_dwordx4 v159, s[20:23], s64 offen offset:3072 lds
v_mfma_f32_16x16x32_bf16 v[88:91], a[20:23], a[56:59], v[88:91]
s_add_u32 m0, s66, 4096
s_add_u32 s64, s40, 229504
buffer_load_dwordx4 v156, s[20:23], s64 offen offset:0 lds
v_mfma_f32_16x16x32_bf16 v[92:95], a[20:23], a[60:63], v[92:95]
buffer_load_dwordx4 v157, s[20:23], s64 offen offset:1024 lds
v_mfma_f32_16x16x32_bf16 v[76:79], a[16:19], a[60:63], v[76:79]
buffer_load_dwordx4 v158, s[20:23], s64 offen offset:2048 lds
v_mfma_f32_16x16x32_bf16 v[72:75], a[16:19], a[56:59], v[72:75]
buffer_load_dwordx4 v159, s[20:23], s64 offen offset:3072 lds
s_waitcnt lgkmcnt(0)
s_waitcnt vmcnt(4)
ds_read_b64_tr_b16 a[0:1], v160 offset:0
ds_read_b64_tr_b16 a[2:3], v160 offset:2048
ds_read_b64_tr_b16 a[4:5], v161 offset:0
ds_read_b64_tr_b16 a[6:7], v161 offset:2048
ds_read_b64_tr_b16 a[8:9], v162 offset:0
ds_read_b64_tr_b16 a[10:11], v162 offset:2048
ds_read_b64_tr_b16 a[12:13], v163 offset:0
ds_read_b64_tr_b16 a[14:15], v163 offset:2048
s_barrier
s_setprio 3
s_setprio 1
s_waitcnt vmcnt(0) lgkmcnt(0)
v_mfma_f32_16x16x32_bf16 v[0:3], a[0:3], a[64:67], v[0:3]
ds_read_b64_tr_b16 a[16:17], v160 offset:4096
v_mfma_f32_16x16x32_bf16 v[4:7], a[0:3], a[68:71], v[4:7]
ds_read_b64_tr_b16 a[18:19], v160 offset:6144
v_mfma_f32_16x16x32_bf16 v[20:23], a[4:7], a[68:71], v[20:23]
ds_read_b64_tr_b16 a[20:21], v161 offset:4096
v_mfma_f32_16x16x32_bf16 v[16:19], a[4:7], a[64:67], v[16:19]
ds_read_b64_tr_b16 a[22:23], v161 offset:6144
v_mfma_f32_16x16x32_bf16 v[32:35], a[8:11], a[64:67], v[32:35]
ds_read_b64_tr_b16 a[24:25], v162 offset:4096
v_mfma_f32_16x16x32_bf16 v[36:39], a[8:11], a[68:71], v[36:39]
ds_read_b64_tr_b16 a[26:27], v162 offset:6144
v_mfma_f32_16x16x32_bf16 v[52:55], a[12:15], a[68:71], v[52:55]
ds_read_b64_tr_b16 a[28:29], v163 offset:4096
v_mfma_f32_16x16x32_bf16 v[48:51], a[12:15], a[64:67], v[48:51]
ds_read_b64_tr_b16 a[30:31], v163 offset:6144
v_mfma_f32_16x16x32_bf16 v[56:59], a[12:15], a[72:75], v[56:59]
s_add_u32 m0, s77, 33792
s_add_u32 s64, s38, 131072
buffer_load_dwordx4 v168, s[12:15], s64 offen nt lds
v_mfma_f32_16x16x32_bf16 v[60:63], a[12:15], a[76:79], v[60:63]
s_add_u32 m0, s77, 34816
s_add_u32 s64, s38, 147456
buffer_load_dwordx4 v168, s[12:15], s64 offen nt lds
v_mfma_f32_16x16x32_bf16 v[44:47], a[8:11], a[76:79], v[44:47]
s_add_u32 m0, s77, 35840
s_add_u32 s64, s38, 163840
buffer_load_dwordx4 v168, s[12:15], s64 offen nt lds
v_mfma_f32_16x16x32_bf16 v[40:43], a[8:11], a[72:75], v[40:43]
s_add_u32 m0, s77, 36864
s_add_u32 s64, s38, 180224
buffer_load_dwordx4 v168, s[12:15], s64 offen nt lds
v_mfma_f32_16x16x32_bf16 v[24:27], a[4:7], a[72:75], v[24:27]
s_add_u32 m0, s77, 37888
s_add_u32 s64, s38, 196608
buffer_load_dwordx4 v168, s[12:15], s64 offen nt lds
v_mfma_f32_16x16x32_bf16 v[28:31], a[4:7], a[76:79], v[28:31]
s_add_u32 m0, s77, 38912
s_add_u32 s64, s38, 212992
buffer_load_dwordx4 v168, s[12:15], s64 offen nt lds
v_mfma_f32_16x16x32_bf16 v[12:15], a[0:3], a[76:79], v[12:15]
s_add_u32 m0, s77, 39936
s_add_u32 s64, s38, 229376
buffer_load_dwordx4 v168, s[12:15], s64 offen nt lds
v_mfma_f32_16x16x32_bf16 v[8:11], a[0:3], a[72:75], v[8:11]
s_add_u32 m0, s77, 40960
s_add_u32 s64, s38, 245760
buffer_load_dwordx4 v168, s[12:15], s64 offen nt lds
s_waitcnt lgkmcnt(0)
v_mfma_f32_16x16x32_bf16 v[64:67], a[16:19], a[64:67], v[64:67]
s_add_u32 m0, s66, 8192
s_add_u32 s64, s40, 258048
buffer_load_dwordx4 v156, s[20:23], s64 offen offset:0 lds
v_mfma_f32_16x16x32_bf16 v[68:71], a[16:19], a[68:71], v[68:71]
buffer_load_dwordx4 v157, s[20:23], s64 offen offset:1024 lds
v_mfma_f32_16x16x32_bf16 v[84:87], a[20:23], a[68:71], v[84:87]
buffer_load_dwordx4 v158, s[20:23], s64 offen offset:2048 lds
v_mfma_f32_16x16x32_bf16 v[80:83], a[20:23], a[64:67], v[80:83]
buffer_load_dwordx4 v159, s[20:23], s64 offen offset:3072 lds
v_mfma_f32_16x16x32_bf16 v[96:99], a[24:27], a[64:67], v[96:99]
s_add_u32 m0, s66, 12288
s_add_u32 s64, s40, 258176
buffer_load_dwordx4 v156, s[20:23], s64 offen offset:0 lds
v_mfma_f32_16x16x32_bf16 v[100:103], a[24:27], a[68:71], v[100:103]
buffer_load_dwordx4 v157, s[20:23], s64 offen offset:1024 lds
v_mfma_f32_16x16x32_bf16 v[116:119], a[28:31], a[68:71], v[116:119]
buffer_load_dwordx4 v158, s[20:23], s64 offen offset:2048 lds
v_mfma_f32_16x16x32_bf16 v[112:115], a[28:31], a[64:67], v[112:115]
buffer_load_dwordx4 v159, s[20:23], s64 offen offset:3072 lds
v_mfma_f32_16x16x32_bf16 v[120:123], a[28:31], a[72:75], v[120:123]
v_mfma_f32_16x16x32_bf16 v[124:127], a[28:31], a[76:79], v[124:127]
v_mfma_f32_16x16x32_bf16 v[108:111], a[24:27], a[76:79], v[108:111]
v_mfma_f32_16x16x32_bf16 v[104:107], a[24:27], a[72:75], v[104:107]
v_mfma_f32_16x16x32_bf16 v[88:91], a[20:23], a[72:75], v[88:91]
v_mfma_f32_16x16x32_bf16 v[92:95], a[20:23], a[76:79], v[92:95]
v_mfma_f32_16x16x32_bf16 v[76:79], a[16:19], a[76:79], v[76:79]
v_mfma_f32_16x16x32_bf16 v[72:75], a[16:19], a[72:75], v[72:75]
s_waitcnt vmcnt(8)
s_barrier
s_setprio 3
s_add_u32 m0, s77, 0
s_add_u32 s64, s39, 0
buffer_load_dwordx4 v168, s[12:15], s64 offen nt lds
s_add_u32 m0, s77, 1024
s_add_u32 s64, s39, 16384
buffer_load_dwordx4 v168, s[12:15], s64 offen nt lds
s_add_u32 m0, s77, 2048
s_add_u32 s64, s39, 32768
buffer_load_dwordx4 v168, s[12:15], s64 offen nt lds
s_add_u32 m0, s77, 3072
s_add_u32 s64, s39, 49152
buffer_load_dwordx4 v168, s[12:15], s64 offen nt lds
s_waitcnt vmcnt(8)
ds_read_b64_tr_b16 a[0:1], v160 offset:8192
ds_read_b64_tr_b16 a[2:3], v160 offset:10240
ds_read_b64_tr_b16 a[4:5], v161 offset:8192
ds_read_b64_tr_b16 a[6:7], v161 offset:10240
ds_read_b64_tr_b16 a[8:9], v162 offset:8192
ds_read_b64_tr_b16 a[10:11], v162 offset:10240
ds_read_b64_tr_b16 a[12:13], v163 offset:8192
ds_read_b64_tr_b16 a[14:15], v163 offset:10240
s_add_u32 m0, s77, 4096
s_add_u32 s64, s39, 65536
buffer_load_dwordx4 v168, s[12:15], s64 offen nt lds
s_add_u32 m0, s77, 5120
s_add_u32 s64, s39, 81920
buffer_load_dwordx4 v168, s[12:15], s64 offen nt lds
s_add_u32 m0, s77, 6144
s_add_u32 s64, s39, 98304
buffer_load_dwordx4 v168, s[12:15], s64 offen nt lds
s_add_u32 m0, s77, 7168
s_add_u32 s64, s39, 114688
buffer_load_dwordx4 v168, s[12:15], s64 offen nt lds
s_setprio 1
s_waitcnt vmcnt(8) lgkmcnt(0)
v_mfma_f32_16x16x32_bf16 v[0:3], a[0:3], v[132:135], v[0:3]
ds_read_b64_tr_b16 a[16:17], v160 offset:12288
v_mfma_f32_16x16x32_bf16 v[4:7], a[0:3], v[136:139], v[4:7]
ds_read_b64_tr_b16 a[18:19], v160 offset:14336
v_mfma_f32_16x16x32_bf16 v[20:23], a[4:7], v[136:139], v[20:23]
ds_read_b64_tr_b16 a[20:21], v161 offset:12288
v_mfma_f32_16x16x32_bf16 v[16:19], a[4:7], v[132:135], v[16:19]
ds_read_b64_tr_b16 a[22:23], v161 offset:14336
v_mfma_f32_16x16x32_bf16 v[32:35], a[8:11], v[132:135], v[32:35]
ds_read_b64_tr_b16 a[24:25], v162 offset:12288
v_mfma_f32_16x16x32_bf16 v[36:39], a[8:11], v[136:139], v[36:39]
ds_read_b64_tr_b16 a[26:27], v162 offset:14336
v_mfma_f32_16x16x32_bf16 v[52:55], a[12:15], v[136:139], v[52:55]
ds_read_b64_tr_b16 a[28:29], v163 offset:12288
v_mfma_f32_16x16x32_bf16 v[48:51], a[12:15], v[132:135], v[48:51]
ds_read_b64_tr_b16 a[30:31], v163 offset:14336
v_mfma_f32_16x16x32_bf16 v[56:59], a[12:15], v[140:143], v[56:59]
v_mfma_f32_16x16x32_bf16 v[60:63], a[12:15], v[144:147], v[60:63]
v_mfma_f32_16x16x32_bf16 v[44:47], a[8:11], v[144:147], v[44:47]
v_mfma_f32_16x16x32_bf16 v[40:43], a[8:11], v[140:143], v[40:43]
v_mfma_f32_16x16x32_bf16 v[24:27], a[4:7], v[140:143], v[24:27]
v_mfma_f32_16x16x32_bf16 v[28:31], a[4:7], v[144:147], v[28:31]
v_mfma_f32_16x16x32_bf16 v[12:15], a[0:3], v[144:147], v[12:15]
v_mfma_f32_16x16x32_bf16 v[8:11], a[0:3], v[140:143], v[8:11]
s_waitcnt lgkmcnt(0)
v_mfma_f32_16x16x32_bf16 v[64:67], a[16:19], v[132:135], v[64:67]
ds_read_b128 a[32:35], v128 offset:0
v_mfma_f32_16x16x32_bf16 v[68:71], a[16:19], v[136:139], v[68:71]
ds_read_b128 a[36:39], v129 offset:0
v_mfma_f32_16x16x32_bf16 v[84:87], a[20:23], v[136:139], v[84:87]
ds_read_b128 a[40:43], v130 offset:0
v_mfma_f32_16x16x32_bf16 v[80:83], a[20:23], v[132:135], v[80:83]
ds_read_b128 a[44:47], v131 offset:0
v_mfma_f32_16x16x32_bf16 v[96:99], a[24:27], v[132:135], v[96:99]
ds_read_b128 a[48:51], v128 offset:4096
v_mfma_f32_16x16x32_bf16 v[100:103], a[24:27], v[136:139], v[100:103]
ds_read_b128 a[52:55], v129 offset:4096
v_mfma_f32_16x16x32_bf16 v[116:119], a[28:31], v[136:139], v[116:119]
ds_read_b128 a[56:59], v130 offset:4096
v_mfma_f32_16x16x32_bf16 v[112:115], a[28:31], v[132:135], v[112:115]
ds_read_b128 a[60:63], v131 offset:4096
v_mfma_f32_16x16x32_bf16 v[120:123], a[28:31], v[140:143], v[120:123]
ds_read_b128 a[64:67], v128 offset:8192
v_mfma_f32_16x16x32_bf16 v[124:127], a[28:31], v[144:147], v[124:127]
ds_read_b128 a[68:71], v129 offset:8192
v_mfma_f32_16x16x32_bf16 v[108:111], a[24:27], v[144:147], v[108:111]
ds_read_b128 a[72:75], v130 offset:8192
v_mfma_f32_16x16x32_bf16 v[104:107], a[24:27], v[140:143], v[104:107]
ds_read_b128 a[76:79], v131 offset:8192
v_mfma_f32_16x16x32_bf16 v[88:91], a[20:23], v[140:143], v[88:91]
s_add_u32 m0, s66, 0
s_add_u32 s64, s41, 0
buffer_load_dwordx4 v156, s[20:23], s64 offen offset:0 lds
v_mfma_f32_16x16x32_bf16 v[92:95], a[20:23], v[144:147], v[92:95]
buffer_load_dwordx4 v157, s[20:23], s64 offen offset:1024 lds
v_mfma_f32_16x16x32_bf16 v[76:79], a[16:19], v[144:147], v[76:79]
buffer_load_dwordx4 v158, s[20:23], s64 offen offset:2048 lds
v_mfma_f32_16x16x32_bf16 v[72:75], a[16:19], v[140:143], v[72:75]
buffer_load_dwordx4 v159, s[20:23], s64 offen offset:3072 lds
s_add_u32 m0, s66, 4096
s_add_u32 s64, s41, 128
buffer_load_dwordx4 v156, s[20:23], s64 offen offset:0 lds
buffer_load_dwordx4 v157, s[20:23], s64 offen offset:1024 lds
buffer_load_dwordx4 v158, s[20:23], s64 offen offset:2048 lds
buffer_load_dwordx4 v159, s[20:23], s64 offen offset:3072 lds
s_add_u32 m0, s66, 8192
s_add_u32 s64, s41, 28672
buffer_load_dwordx4 v156, s[20:23], s64 offen offset:0 lds
buffer_load_dwordx4 v157, s[20:23], s64 offen offset:1024 lds
buffer_load_dwordx4 v158, s[20:23], s64 offen offset:2048 lds
buffer_load_dwordx4 v159, s[20:23], s64 offen offset:3072 lds
ds_read_b128 v[132:135], v128 offset:12288
ds_read_b128 v[136:139], v129 offset:12288
ds_read_b128 v[140:143], v130 offset:12288
ds_read_b128 v[144:147], v131 offset:12288
s_add_u32 m0, s66, 12288
s_add_u32 s64, s41, 28800
buffer_load_dwordx4 v156, s[20:23], s64 offen offset:0 lds
buffer_load_dwordx4 v157, s[20:23], s64 offen offset:1024 lds
buffer_load_dwordx4 v158, s[20:23], s64 offen offset:2048 lds
buffer_load_dwordx4 v159, s[20:23], s64 offen offset:3072 lds
s_waitcnt lgkmcnt(0)
s_waitcnt vmcnt(12)
ds_read_b64_tr_b16 a[0:1], v160 offset:0
ds_read_b64_tr_b16 a[2:3], v160 offset:2048
ds_read_b64_tr_b16 a[4:5], v161 offset:0
ds_read_b64_tr_b16 a[6:7], v161 offset:2048
ds_read_b64_tr_b16 a[8:9], v162 offset:0
ds_read_b64_tr_b16 a[10:11], v162 offset:2048
ds_read_b64_tr_b16 a[12:13], v163 offset:0
ds_read_b64_tr_b16 a[14:15], v163 offset:2048
s_barrier
s_setprio 3
s_setprio 1
s_waitcnt vmcnt(8) lgkmcnt(0)
v_mfma_f32_16x16x32_bf16 v[0:3], a[0:3], a[32:35], v[0:3]
ds_read_b64_tr_b16 a[16:17], v160 offset:4096
v_mfma_f32_16x16x32_bf16 v[4:7], a[0:3], a[36:39], v[4:7]
ds_read_b64_tr_b16 a[18:19], v160 offset:6144
v_mfma_f32_16x16x32_bf16 v[20:23], a[4:7], a[36:39], v[20:23]
ds_read_b64_tr_b16 a[20:21], v161 offset:4096
v_mfma_f32_16x16x32_bf16 v[16:19], a[4:7], a[32:35], v[16:19]
ds_read_b64_tr_b16 a[22:23], v161 offset:6144
v_mfma_f32_16x16x32_bf16 v[32:35], a[8:11], a[32:35], v[32:35]
ds_read_b64_tr_b16 a[24:25], v162 offset:4096
v_mfma_f32_16x16x32_bf16 v[36:39], a[8:11], a[36:39], v[36:39]
ds_read_b64_tr_b16 a[26:27], v162 offset:6144
v_mfma_f32_16x16x32_bf16 v[52:55], a[12:15], a[36:39], v[52:55]
ds_read_b64_tr_b16 a[28:29], v163 offset:4096
v_mfma_f32_16x16x32_bf16 v[48:51], a[12:15], a[32:35], v[48:51]
ds_read_b64_tr_b16 a[30:31], v163 offset:6144
v_mfma_f32_16x16x32_bf16 v[56:59], a[12:15], a[40:43], v[56:59]
s_add_u32 m0, s77, 33792
s_add_u32 s64, s39, 131072
buffer_load_dwordx4 v168, s[12:15], s64 offen nt lds
v_mfma_f32_16x16x32_bf16 v[60:63], a[12:15], a[44:47], v[60:63]
s_add_u32 m0, s77, 34816
s_add_u32 s64, s39, 147456
buffer_load_dwordx4 v168, s[12:15], s64 offen nt lds
v_mfma_f32_16x16x32_bf16 v[44:47], a[8:11], a[44:47], v[44:47]
s_add_u32 m0, s77, 35840
s_add_u32 s64, s39, 163840
buffer_load_dwordx4 v168, s[12:15], s64 offen nt lds
v_mfma_f32_16x16x32_bf16 v[40:43], a[8:11], a[40:43], v[40:43]
s_add_u32 m0, s77, 36864
s_add_u32 s64, s39, 180224
buffer_load_dwordx4 v168, s[12:15], s64 offen nt lds
v_mfma_f32_16x16x32_bf16 v[24:27], a[4:7], a[40:43], v[24:27]
v_mfma_f32_16x16x32_bf16 v[28:31], a[4:7], a[44:47], v[28:31]
v_mfma_f32_16x16x32_bf16 v[12:15], a[0:3], a[44:47], v[12:15]
v_mfma_f32_16x16x32_bf16 v[8:11], a[0:3], a[40:43], v[8:11]
s_waitcnt vmcnt(8) lgkmcnt(0)
v_mfma_f32_16x16x32_bf16 v[64:67], a[16:19], a[32:35], v[64:67]
ds_read_b64_tr_b16 a[0:1], v160 offset:8192
v_mfma_f32_16x16x32_bf16 v[68:71], a[16:19], a[36:39], v[68:71]
ds_read_b64_tr_b16 a[2:3], v160 offset:10240
v_mfma_f32_16x16x32_bf16 v[84:87], a[20:23], a[36:39], v[84:87]
ds_read_b64_tr_b16 a[4:5], v161 offset:8192
v_mfma_f32_16x16x32_bf16 v[80:83], a[20:23], a[32:35], v[80:83]
ds_read_b64_tr_b16 a[6:7], v161 offset:10240
v_mfma_f32_16x16x32_bf16 v[96:99], a[24:27], a[32:35], v[96:99]
ds_read_b64_tr_b16 a[8:9], v162 offset:8192
v_mfma_f32_16x16x32_bf16 v[100:103], a[24:27], a[36:39], v[100:103]
ds_read_b64_tr_b16 a[10:11], v162 offset:10240
v_mfma_f32_16x16x32_bf16 v[116:119], a[28:31], a[36:39], v[116:119]
ds_read_b64_tr_b16 a[12:13], v163 offset:8192
v_mfma_f32_16x16x32_bf16 v[112:115], a[28:31], a[32:35], v[112:115]
ds_read_b64_tr_b16 a[14:15], v163 offset:10240
v_mfma_f32_16x16x32_bf16 v[120:123], a[28:31], a[40:43], v[120:123]
s_add_u32 m0, s77, 37888
s_add_u32 s64, s39, 196608
buffer_load_dwordx4 v168, s[12:15], s64 offen nt lds
v_mfma_f32_16x16x32_bf16 v[124:127], a[28:31], a[44:47], v[124:127]
s_add_u32 m0, s77, 38912
s_add_u32 s64, s39, 212992
buffer_load_dwordx4 v168, s[12:15], s64 offen nt lds
v_mfma_f32_16x16x32_bf16 v[108:111], a[24:27], a[44:47], v[108:111]
s_add_u32 m0, s77, 39936
s_add_u32 s64, s39, 229376
buffer_load_dwordx4 v168, s[12:15], s64 offen nt lds
v_mfma_f32_16x16x32_bf16 v[104:107], a[24:27], a[40:43], v[104:107]
s_add_u32 m0, s77, 40960
s_add_u32 s64, s39, 245760
buffer_load_dwordx4 v168, s[12:15], s64 offen nt lds
v_mfma_f32_16x16x32_bf16 v[88:91], a[20:23], a[40:43], v[88:91]
s_add_u32 m0, s66, 0
s_add_u32 s64, s41, 229376
buffer_load_dwordx4 v156, s[20:23], s64 offen offset:0 lds
v_mfma_f32_16x16x32_bf16 v[92:95], a[20:23], a[44:47], v[92:95]
buffer_load_dwordx4 v157, s[20:23], s64 offen offset:1024 lds
v_mfma_f32_16x16x32_bf16 v[76:79], a[16:19], a[44:47], v[76:79]
buffer_load_dwordx4 v158, s[20:23], s64 offen offset:2048 lds
v_mfma_f32_16x16x32_bf16 v[72:75], a[16:19], a[40:43], v[72:75]
buffer_load_dwordx4 v159, s[20:23], s64 offen offset:3072 lds
s_waitcnt vmcnt(12) lgkmcnt(0)
v_mfma_f32_16x16x32_bf16 v[0:3], a[0:3], a[48:51], v[0:3]
ds_read_b64_tr_b16 a[16:17], v160 offset:12288
v_mfma_f32_16x16x32_bf16 v[4:7], a[0:3], a[52:55], v[4:7]
ds_read_b64_tr_b16 a[18:19], v160 offset:14336
v_mfma_f32_16x16x32_bf16 v[20:23], a[4:7], a[52:55], v[20:23]
ds_read_b64_tr_b16 a[20:21], v161 offset:12288
v_mfma_f32_16x16x32_bf16 v[16:19], a[4:7], a[48:51], v[16:19]
ds_read_b64_tr_b16 a[22:23], v161 offset:14336
v_mfma_f32_16x16x32_bf16 v[32:35], a[8:11], a[48:51], v[32:35]
ds_read_b64_tr_b16 a[24:25], v162 offset:12288
v_mfma_f32_16x16x32_bf16 v[36:39], a[8:11], a[52:55], v[36:39]
ds_read_b64_tr_b16 a[26:27], v162 offset:14336
v_mfma_f32_16x16x32_bf16 v[52:55], a[12:15], a[52:55], v[52:55]
ds_read_b64_tr_b16 a[28:29], v163 offset:12288
v_mfma_f32_16x16x32_bf16 v[48:51], a[12:15], a[48:51], v[48:51]
ds_read_b64_tr_b16 a[30:31], v163 offset:14336
v_mfma_f32_16x16x32_bf16 v[56:59], a[12:15], a[56:59], v[56:59]
s_add_u32 m0, s66, 4096
s_add_u32 s64, s41, 229504
buffer_load_dwordx4 v156, s[20:23], s64 offen offset:0 lds
v_mfma_f32_16x16x32_bf16 v[60:63], a[12:15], a[60:63], v[60:63]
buffer_load_dwordx4 v157, s[20:23], s64 offen offset:1024 lds
v_mfma_f32_16x16x32_bf16 v[44:47], a[8:11], a[60:63], v[44:47]
buffer_load_dwordx4 v158, s[20:23], s64 offen offset:2048 lds
v_mfma_f32_16x16x32_bf16 v[40:43], a[8:11], a[56:59], v[40:43]
buffer_load_dwordx4 v159, s[20:23], s64 offen offset:3072 lds
v_mfma_f32_16x16x32_bf16 v[24:27], a[4:7], a[56:59], v[24:27]
v_mfma_f32_16x16x32_bf16 v[28:31], a[4:7], a[60:63], v[28:31]
v_mfma_f32_16x16x32_bf16 v[12:15], a[0:3], a[60:63], v[12:15]
v_mfma_f32_16x16x32_bf16 v[8:11], a[0:3], a[56:59], v[8:11]
s_waitcnt lgkmcnt(0)
v_mfma_f32_16x16x32_bf16 v[64:67], a[16:19], a[48:51], v[64:67]
s_add_u32 m0, s66, 8192
s_add_u32 s64, s41, 258048
buffer_load_dwordx4 v156, s[20:23], s64 offen offset:0 lds
v_mfma_f32_16x16x32_bf16 v[68:71], a[16:19], a[52:55], v[68:71]
buffer_load_dwordx4 v157, s[20:23], s64 offen offset:1024 lds
v_mfma_f32_16x16x32_bf16 v[84:87], a[20:23], a[52:55], v[84:87]
buffer_load_dwordx4 v158, s[20:23], s64 offen offset:2048 lds
v_mfma_f32_16x16x32_bf16 v[80:83], a[20:23], a[48:51], v[80:83]
buffer_load_dwordx4 v159, s[20:23], s64 offen offset:3072 lds
v_mfma_f32_16x16x32_bf16 v[96:99], a[24:27], a[48:51], v[96:99]
v_mfma_f32_16x16x32_bf16 v[100:103], a[24:27], a[52:55], v[100:103]
v_mfma_f32_16x16x32_bf16 v[116:119], a[28:31], a[52:55], v[116:119]
v_mfma_f32_16x16x32_bf16 v[112:115], a[28:31], a[48:51], v[112:115]
v_mfma_f32_16x16x32_bf16 v[120:123], a[28:31], a[56:59], v[120:123]
v_mfma_f32_16x16x32_bf16 v[124:127], a[28:31], a[60:63], v[124:127]
v_mfma_f32_16x16x32_bf16 v[108:111], a[24:27], a[60:63], v[108:111]
v_mfma_f32_16x16x32_bf16 v[104:107], a[24:27], a[56:59], v[104:107]
v_mfma_f32_16x16x32_bf16 v[88:91], a[20:23], a[56:59], v[88:91]
v_mfma_f32_16x16x32_bf16 v[92:95], a[20:23], a[60:63], v[92:95]
v_mfma_f32_16x16x32_bf16 v[76:79], a[16:19], a[60:63], v[76:79]
v_mfma_f32_16x16x32_bf16 v[72:75], a[16:19], a[56:59], v[72:75]
s_add_u32 m0, s66, 12288
s_add_u32 s64, s41, 258176
buffer_load_dwordx4 v156, s[20:23], s64 offen offset:0 lds
buffer_load_dwordx4 v157, s[20:23], s64 offen offset:1024 lds
buffer_load_dwordx4 v158, s[20:23], s64 offen offset:2048 lds
buffer_load_dwordx4 v159, s[20:23], s64 offen offset:3072 lds
s_waitcnt vmcnt(16)
s_barrier
s_setprio 3
s_add_u32 m0, s68, 0
s_add_u32 s64, s32, 262144
buffer_load_dwordx4 v169, s[8:11], s64 offen nt lds
s_add_u32 m0, s68, 1056
s_add_u32 s64, s32, 266240
buffer_load_dwordx4 v169, s[8:11], s64 offen nt lds
s_add_u32 m0, s68, 2112
s_add_u32 s64, s32, 270336
buffer_load_dwordx4 v169, s[8:11], s64 offen nt lds
s_add_u32 m0, s68, 3168
s_add_u32 s64, s32, 274432
buffer_load_dwordx4 v169, s[8:11], s64 offen nt lds
s_waitcnt vmcnt(16)
ds_read_b64_tr_b16 a[0:1], v160 offset:0
ds_read_b64_tr_b16 a[2:3], v160 offset:2048
ds_read_b64_tr_b16 a[4:5], v161 offset:0
ds_read_b64_tr_b16 a[6:7], v161 offset:2048
ds_read_b64_tr_b16 a[8:9], v162 offset:0
ds_read_b64_tr_b16 a[10:11], v162 offset:2048
ds_read_b64_tr_b16 a[12:13], v163 offset:0
ds_read_b64_tr_b16 a[14:15], v163 offset:2048
s_add_u32 m0, s68, 4224
s_add_u32 s64, s32, 278528
buffer_load_dwordx4 v169, s[8:11], s64 offen nt lds
s_add_u32 m0, s68, 5280
s_add_u32 s64, s32, 282624
buffer_load_dwordx4 v169, s[8:11], s64 offen nt lds
s_add_u32 m0, s68, 6336
s_add_u32 s64, s32, 286720
buffer_load_dwordx4 v169, s[8:11], s64 offen nt lds
s_add_u32 m0, s68, 7392
s_add_u32 s64, s32, 290816
buffer_load_dwordx4 v169, s[8:11], s64 offen nt lds
s_setprio 1
s_waitcnt vmcnt(16) lgkmcnt(0)
v_mfma_f32_16x16x32_bf16 v[0:3], a[0:3], a[64:67], v[0:3]
ds_read_b64_tr_b16 a[16:17], v160 offset:4096
v_mfma_f32_16x16x32_bf16 v[4:7], a[0:3], a[68:71], v[4:7]
ds_read_b64_tr_b16 a[18:19], v160 offset:6144
v_mfma_f32_16x16x32_bf16 v[20:23], a[4:7], a[68:71], v[20:23]
ds_read_b64_tr_b16 a[20:21], v161 offset:4096
v_mfma_f32_16x16x32_bf16 v[16:19], a[4:7], a[64:67], v[16:19]
ds_read_b64_tr_b16 a[22:23], v161 offset:6144
v_mfma_f32_16x16x32_bf16 v[32:35], a[8:11], a[64:67], v[32:35]
ds_read_b64_tr_b16 a[24:25], v162 offset:4096
v_mfma_f32_16x16x32_bf16 v[36:39], a[8:11], a[68:71], v[36:39]
ds_read_b64_tr_b16 a[26:27], v162 offset:6144
v_mfma_f32_16x16x32_bf16 v[52:55], a[12:15], a[68:71], v[52:55]
ds_read_b64_tr_b16 a[28:29], v163 offset:4096
v_mfma_f32_16x16x32_bf16 v[48:51], a[12:15], a[64:67], v[48:51]
ds_read_b64_tr_b16 a[30:31], v163 offset:6144
v_mfma_f32_16x16x32_bf16 v[56:59], a[12:15], a[72:75], v[56:59]
v_mfma_f32_16x16x32_bf16 v[60:63], a[12:15], a[76:79], v[60:63]
v_mfma_f32_16x16x32_bf16 v[44:47], a[8:11], a[76:79], v[44:47]
v_mfma_f32_16x16x32_bf16 v[40:43], a[8:11], a[72:75], v[40:43]
v_mfma_f32_16x16x32_bf16 v[24:27], a[4:7], a[72:75], v[24:27]
v_mfma_f32_16x16x32_bf16 v[28:31], a[4:7], a[76:79], v[28:31]
v_mfma_f32_16x16x32_bf16 v[12:15], a[0:3], a[76:79], v[12:15]
v_mfma_f32_16x16x32_bf16 v[8:11], a[0:3], a[72:75], v[8:11]
s_waitcnt vmcnt(12) lgkmcnt(0)
v_mfma_f32_16x16x32_bf16 v[64:67], a[16:19], a[64:67], v[64:67]
ds_read_b64_tr_b16 a[0:1], v160 offset:8192
v_mfma_f32_16x16x32_bf16 v[68:71], a[16:19], a[68:71], v[68:71]
ds_read_b64_tr_b16 a[2:3], v160 offset:10240
v_mfma_f32_16x16x32_bf16 v[84:87], a[20:23], a[68:71], v[84:87]
ds_read_b64_tr_b16 a[4:5], v161 offset:8192
v_mfma_f32_16x16x32_bf16 v[80:83], a[20:23], a[64:67], v[80:83]
ds_read_b64_tr_b16 a[6:7], v161 offset:10240
v_mfma_f32_16x16x32_bf16 v[96:99], a[24:27], a[64:67], v[96:99]
ds_read_b64_tr_b16 a[8:9], v162 offset:8192
v_mfma_f32_16x16x32_bf16 v[100:103], a[24:27], a[68:71], v[100:103]
ds_read_b64_tr_b16 a[10:11], v162 offset:10240
v_mfma_f32_16x16x32_bf16 v[116:119], a[28:31], a[68:71], v[116:119]
ds_read_b64_tr_b16 a[12:13], v163 offset:8192
v_mfma_f32_16x16x32_bf16 v[112:115], a[28:31], a[64:67], v[112:115]
ds_read_b64_tr_b16 a[14:15], v163 offset:10240
v_mfma_f32_16x16x32_bf16 v[120:123], a[28:31], a[72:75], v[120:123]
v_mfma_f32_16x16x32_bf16 v[124:127], a[28:31], a[76:79], v[124:127]
v_mfma_f32_16x16x32_bf16 v[108:111], a[24:27], a[76:79], v[108:111]
v_mfma_f32_16x16x32_bf16 v[104:107], a[24:27], a[72:75], v[104:107]
v_mfma_f32_16x16x32_bf16 v[88:91], a[20:23], a[72:75], v[88:91]
v_mfma_f32_16x16x32_bf16 v[92:95], a[20:23], a[76:79], v[92:95]
v_mfma_f32_16x16x32_bf16 v[76:79], a[16:19], a[76:79], v[76:79]
v_mfma_f32_16x16x32_bf16 v[72:75], a[16:19], a[72:75], v[72:75]
s_waitcnt vmcnt(8) lgkmcnt(0)
v_mfma_f32_16x16x32_bf16 v[0:3], a[0:3], v[132:135], v[0:3]
ds_read_b64_tr_b16 a[16:17], v160 offset:12288
v_mfma_f32_16x16x32_bf16 v[4:7], a[0:3], v[136:139], v[4:7]
ds_read_b64_tr_b16 a[18:19], v160 offset:14336
v_mfma_f32_16x16x32_bf16 v[20:23], a[4:7], v[136:139], v[20:23]
ds_read_b64_tr_b16 a[20:21], v161 offset:12288
v_mfma_f32_16x16x32_bf16 v[16:19], a[4:7], v[132:135], v[16:19]
ds_read_b64_tr_b16 a[22:23], v161 offset:14336
v_mfma_f32_16x16x32_bf16 v[32:35], a[8:11], v[132:135], v[32:35]
ds_read_b64_tr_b16 a[24:25], v162 offset:12288
v_mfma_f32_16x16x32_bf16 v[36:39], a[8:11], v[136:139], v[36:39]
ds_read_b64_tr_b16 a[26:27], v162 offset:14336
v_mfma_f32_16x16x32_bf16 v[52:55], a[12:15], v[136:139], v[52:55]
ds_read_b64_tr_b16 a[28:29], v163 offset:12288
v_mfma_f32_16x16x32_bf16 v[48:51], a[12:15], v[132:135], v[48:51]
ds_read_b64_tr_b16 a[30:31], v163 offset:14336
v_mfma_f32_16x16x32_bf16 v[56:59], a[12:15], v[140:143], v[56:59]
v_mfma_f32_16x16x32_bf16 v[60:63], a[12:15], v[144:147], v[60:63]
v_mfma_f32_16x16x32_bf16 v[44:47], a[8:11], v[144:147], v[44:47]
v_mfma_f32_16x16x32_bf16 v[40:43], a[8:11], v[140:143], v[40:43]
v_mfma_f32_16x16x32_bf16 v[24:27], a[4:7], v[140:143], v[24:27]
v_mfma_f32_16x16x32_bf16 v[28:31], a[4:7], v[144:147], v[28:31]
v_mfma_f32_16x16x32_bf16 v[12:15], a[0:3], v[144:147], v[12:15]
v_mfma_f32_16x16x32_bf16 v[8:11], a[0:3], v[140:143], v[8:11]
s_waitcnt lgkmcnt(0)
v_mfma_f32_16x16x32_bf16 v[64:67], a[16:19], v[132:135], v[64:67]
ds_read_b128 a[32:35], v128 offset:0
v_mfma_f32_16x16x32_bf16 v[68:71], a[16:19], v[136:139], v[68:71]
ds_read_b128 a[36:39], v129 offset:0
v_mfma_f32_16x16x32_bf16 v[84:87], a[20:23], v[136:139], v[84:87]
ds_read_b128 a[40:43], v130 offset:0
v_mfma_f32_16x16x32_bf16 v[80:83], a[20:23], v[132:135], v[80:83]
ds_read_b128 a[44:47], v131 offset:0
v_mfma_f32_16x16x32_bf16 v[96:99], a[24:27], v[132:135], v[96:99]
ds_read_b128 a[48:51], v128 offset:4096
v_mfma_f32_16x16x32_bf16 v[100:103], a[24:27], v[136:139], v[100:103]
ds_read_b128 a[52:55], v129 offset:4096
v_mfma_f32_16x16x32_bf16 v[116:119], a[28:31], v[136:139], v[116:119]
ds_read_b128 a[56:59], v130 offset:4096
v_mfma_f32_16x16x32_bf16 v[112:115], a[28:31], v[132:135], v[112:115]
ds_read_b128 a[60:63], v131 offset:4096
v_mfma_f32_16x16x32_bf16 v[120:123], a[28:31], v[140:143], v[120:123]
ds_read_b128 a[64:67], v128 offset:8192
v_mfma_f32_16x16x32_bf16 v[124:127], a[28:31], v[144:147], v[124:127]
ds_read_b128 a[68:71], v129 offset:8192
v_mfma_f32_16x16x32_bf16 v[108:111], a[24:27], v[144:147], v[108:111]
ds_read_b128 a[72:75], v130 offset:8192
v_mfma_f32_16x16x32_bf16 v[104:107], a[24:27], v[140:143], v[104:107]
ds_read_b128 a[76:79], v131 offset:8192
v_mfma_f32_16x16x32_bf16 v[88:91], a[20:23], v[140:143], v[88:91]
v_mfma_f32_16x16x32_bf16 v[92:95], a[20:23], v[144:147], v[92:95]
v_mfma_f32_16x16x32_bf16 v[76:79], a[16:19], v[144:147], v[76:79]
v_mfma_f32_16x16x32_bf16 v[72:75], a[16:19], v[140:143], v[72:75]
ds_read_b128 v[132:135], v128 offset:12288
ds_read_b128 v[136:139], v129 offset:12288
ds_read_b128 v[140:143], v130 offset:12288
ds_read_b128 v[144:147], v131 offset:12288
s_waitcnt lgkmcnt(0)
s_waitcnt vmcnt(0)
s_barrier
s_add_u32 m0, s68, 33792
s_add_u32 s64, s33, 262144
buffer_load_dwordx4 v169, s[8:11], s64 offen nt lds
s_add_u32 m0, s68, 34848
s_add_u32 s64, s33, 266240
buffer_load_dwordx4 v169, s[8:11], s64 offen nt lds
s_add_u32 m0, s68, 35904
s_add_u32 s64, s33, 270336
buffer_load_dwordx4 v169, s[8:11], s64 offen nt lds
s_add_u32 m0, s68, 36960
s_add_u32 s64, s33, 274432
buffer_load_dwordx4 v169, s[8:11], s64 offen nt lds
s_add_u32 m0, s68, 38016
s_add_u32 s64, s33, 278528
buffer_load_dwordx4 v169, s[8:11], s64 offen nt lds
s_add_u32 m0, s68, 39072
s_add_u32 s64, s33, 282624
buffer_load_dwordx4 v169, s[8:11], s64 offen nt lds
s_add_u32 m0, s68, 40128
s_add_u32 s64, s33, 286720
buffer_load_dwordx4 v169, s[8:11], s64 offen nt lds
s_add_u32 m0, s68, 41184
s_add_u32 s64, s33, 290816
buffer_load_dwordx4 v169, s[8:11], s64 offen nt lds
s_add_u32 m0, s66, 0
s_add_u32 s64, s42, 0
buffer_load_dwordx4 v156, s[20:23], s64 offen offset:0 lds
buffer_load_dwordx4 v157, s[20:23], s64 offen offset:1024 lds
buffer_load_dwordx4 v158, s[20:23], s64 offen offset:2048 lds
buffer_load_dwordx4 v159, s[20:23], s64 offen offset:3072 lds
s_add_u32 m0, s66, 4096
s_add_u32 s64, s42, 128
buffer_load_dwordx4 v156, s[20:23], s64 offen offset:0 lds
buffer_load_dwordx4 v157, s[20:23], s64 offen offset:1024 lds
buffer_load_dwordx4 v158, s[20:23], s64 offen offset:2048 lds
buffer_load_dwordx4 v159, s[20:23], s64 offen offset:3072 lds
s_waitcnt vmcnt(8)
s_barrier
s_setprio 3
s_waitcnt vmcnt(4)
ds_read_b64_tr_b16 a[0:1], v160 offset:0
ds_read_b64_tr_b16 a[2:3], v160 offset:2048
ds_read_b64_tr_b16 a[4:5], v161 offset:0
ds_read_b64_tr_b16 a[6:7], v161 offset:2048
ds_read_b64_tr_b16 a[8:9], v162 offset:0
ds_read_b64_tr_b16 a[10:11], v162 offset:2048
ds_read_b64_tr_b16 a[12:13], v163 offset:0
ds_read_b64_tr_b16 a[14:15], v163 offset:2048
s_add_u32 m0, s68, 0
s_add_u32 s64, s34, 262144
buffer_load_dwordx4 v169, s[8:11], s64 offen nt lds
s_add_u32 m0, s68, 1056
s_add_u32 s64, s34, 266240
buffer_load_dwordx4 v169, s[8:11], s64 offen nt lds
s_add_u32 m0, s68, 2112
s_add_u32 s64, s34, 270336
buffer_load_dwordx4 v169, s[8:11], s64 offen nt lds
s_add_u32 m0, s68, 3168
s_add_u32 s64, s34, 274432
buffer_load_dwordx4 v169, s[8:11], s64 offen nt lds
s_add_u32 m0, s68, 4224
s_add_u32 s64, s34, 278528
buffer_load_dwordx4 v169, s[8:11], s64 offen nt lds
s_add_u32 m0, s68, 5280
s_add_u32 s64, s34, 282624
buffer_load_dwordx4 v169, s[8:11], s64 offen nt lds
s_add_u32 m0, s68, 6336
s_add_u32 s64, s34, 286720
buffer_load_dwordx4 v169, s[8:11], s64 offen nt lds
s_add_u32 m0, s68, 7392
s_add_u32 s64, s34, 290816
buffer_load_dwordx4 v169, s[8:11], s64 offen nt lds
s_setprio 1
s_waitcnt vmcnt(8) lgkmcnt(0)
v_mfma_f32_16x16x32_bf16 v[0:3], a[0:3], a[32:35], v[0:3]
ds_read_b64_tr_b16 a[16:17], v160 offset:4096
v_mfma_f32_16x16x32_bf16 v[4:7], a[0:3], a[36:39], v[4:7]
ds_read_b64_tr_b16 a[18:19], v160 offset:6144
v_mfma_f32_16x16x32_bf16 v[20:23], a[4:7], a[36:39], v[20:23]
ds_read_b64_tr_b16 a[20:21], v161 offset:4096
v_mfma_f32_16x16x32_bf16 v[16:19], a[4:7], a[32:35], v[16:19]
ds_read_b64_tr_b16 a[22:23], v161 offset:6144
v_mfma_f32_16x16x32_bf16 v[32:35], a[8:11], a[32:35], v[32:35]
ds_read_b64_tr_b16 a[24:25], v162 offset:4096
v_mfma_f32_16x16x32_bf16 v[36:39], a[8:11], a[36:39], v[36:39]
ds_read_b64_tr_b16 a[26:27], v162 offset:6144
v_mfma_f32_16x16x32_bf16 v[52:55], a[12:15], a[36:39], v[52:55]
ds_read_b64_tr_b16 a[28:29], v163 offset:4096
v_mfma_f32_16x16x32_bf16 v[48:51], a[12:15], a[32:35], v[48:51]
ds_read_b64_tr_b16 a[30:31], v163 offset:6144
v_mfma_f32_16x16x32_bf16 v[56:59], a[12:15], a[40:43], v[56:59]
v_mfma_f32_16x16x32_bf16 v[60:63], a[12:15], a[44:47], v[60:63]
v_mfma_f32_16x16x32_bf16 v[44:47], a[8:11], a[44:47], v[44:47]
v_mfma_f32_16x16x32_bf16 v[40:43], a[8:11], a[40:43], v[40:43]
v_mfma_f32_16x16x32_bf16 v[24:27], a[4:7], a[40:43], v[24:27]
v_mfma_f32_16x16x32_bf16 v[28:31], a[4:7], a[44:47], v[28:31]
v_mfma_f32_16x16x32_bf16 v[12:15], a[0:3], a[44:47], v[12:15]
v_mfma_f32_16x16x32_bf16 v[8:11], a[0:3], a[40:43], v[8:11]
s_waitcnt lgkmcnt(0)
v_mfma_f32_16x16x32_bf16 v[64:67], a[16:19], a[32:35], v[64:67]
s_add_u32 m0, s66, 8192
s_add_u32 s64, s42, 28672
buffer_load_dwordx4 v156, s[20:23], s64 offen offset:0 lds
v_mfma_f32_16x16x32_bf16 v[68:71], a[16:19], a[36:39], v[68:71]
buffer_load_dwordx4 v157, s[20:23], s64 offen offset:1024 lds
v_mfma_f32_16x16x32_bf16 v[84:87], a[20:23], a[36:39], v[84:87]
buffer_load_dwordx4 v158, s[20:23], s64 offen offset:2048 lds
v_mfma_f32_16x16x32_bf16 v[80:83], a[20:23], a[32:35], v[80:83]
buffer_load_dwordx4 v159, s[20:23], s64 offen offset:3072 lds
v_mfma_f32_16x16x32_bf16 v[96:99], a[24:27], a[32:35], v[96:99]
s_add_u32 m0, s66, 12288
s_add_u32 s64, s42, 28800
buffer_load_dwordx4 v156, s[20:23], s64 offen offset:0 lds
v_mfma_f32_16x16x32_bf16 v[100:103], a[24:27], a[36:39], v[100:103]
buffer_load_dwordx4 v157, s[20:23], s64 offen offset:1024 lds
v_mfma_f32_16x16x32_bf16 v[116:119], a[28:31], a[36:39], v[116:119]
buffer_load_dwordx4 v158, s[20:23], s64 offen offset:2048 lds
v_mfma_f32_16x16x32_bf16 v[112:115], a[28:31], a[32:35], v[112:115]
buffer_load_dwordx4 v159, s[20:23], s64 offen offset:3072 lds
v_mfma_f32_16x16x32_bf16 v[120:123], a[28:31], a[40:43], v[120:123]
v_mfma_f32_16x16x32_bf16 v[124:127], a[28:31], a[44:47], v[124:127]
v_mfma_f32_16x16x32_bf16 v[108:111], a[24:27], a[44:47], v[108:111]
v_mfma_f32_16x16x32_bf16 v[104:107], a[24:27], a[40:43], v[104:107]
v_mfma_f32_16x16x32_bf16 v[88:91], a[20:23], a[40:43], v[88:91]
v_mfma_f32_16x16x32_bf16 v[92:95], a[20:23], a[44:47], v[92:95]
v_mfma_f32_16x16x32_bf16 v[76:79], a[16:19], a[44:47], v[76:79]
v_mfma_f32_16x16x32_bf16 v[72:75], a[16:19], a[40:43], v[72:75]
s_waitcnt vmcnt(8)
s_barrier
s_setprio 3
s_waitcnt vmcnt(4)
ds_read_b64_tr_b16 a[0:1], v160 offset:8192
ds_read_b64_tr_b16 a[2:3], v160 offset:10240
ds_read_b64_tr_b16 a[4:5], v161 offset:8192
ds_read_b64_tr_b16 a[6:7], v161 offset:10240
ds_read_b64_tr_b16 a[8:9], v162 offset:8192
ds_read_b64_tr_b16 a[10:11], v162 offset:10240
ds_read_b64_tr_b16 a[12:13], v163 offset:8192
ds_read_b64_tr_b16 a[14:15], v163 offset:10240
s_add_u32 m0, s68, 33792
s_add_u32 s64, s35, 262144
buffer_load_dwordx4 v169, s[8:11], s64 offen nt lds
s_add_u32 m0, s68, 34848
s_add_u32 s64, s35, 266240
buffer_load_dwordx4 v169, s[8:11], s64 offen nt lds
s_add_u32 m0, s68, 35904
s_add_u32 s64, s35, 270336
buffer_load_dwordx4 v169, s[8:11], s64 offen nt lds
s_add_u32 m0, s68, 36960
s_add_u32 s64, s35, 274432
buffer_load_dwordx4 v169, s[8:11], s64 offen nt lds
s_add_u32 m0, s68, 38016
s_add_u32 s64, s35, 278528
buffer_load_dwordx4 v169, s[8:11], s64 offen nt lds
s_add_u32 m0, s68, 39072
s_add_u32 s64, s35, 282624
buffer_load_dwordx4 v169, s[8:11], s64 offen nt lds
s_add_u32 m0, s68, 40128
s_add_u32 s64, s35, 286720
buffer_load_dwordx4 v169, s[8:11], s64 offen nt lds
s_add_u32 m0, s68, 41184
s_add_u32 s64, s35, 290816
buffer_load_dwordx4 v169, s[8:11], s64 offen nt lds
s_setprio 1
s_waitcnt vmcnt(8) lgkmcnt(0)
v_mfma_f32_16x16x32_bf16 v[0:3], a[0:3], a[48:51], v[0:3]
ds_read_b64_tr_b16 a[16:17], v160 offset:12288
v_mfma_f32_16x16x32_bf16 v[4:7], a[0:3], a[52:55], v[4:7]
ds_read_b64_tr_b16 a[18:19], v160 offset:14336
v_mfma_f32_16x16x32_bf16 v[20:23], a[4:7], a[52:55], v[20:23]
ds_read_b64_tr_b16 a[20:21], v161 offset:12288
v_mfma_f32_16x16x32_bf16 v[16:19], a[4:7], a[48:51], v[16:19]
ds_read_b64_tr_b16 a[22:23], v161 offset:14336
v_mfma_f32_16x16x32_bf16 v[32:35], a[8:11], a[48:51], v[32:35]
ds_read_b64_tr_b16 a[24:25], v162 offset:12288
v_mfma_f32_16x16x32_bf16 v[36:39], a[8:11], a[52:55], v[36:39]
ds_read_b64_tr_b16 a[26:27], v162 offset:14336
v_mfma_f32_16x16x32_bf16 v[52:55], a[12:15], a[52:55], v[52:55]
ds_read_b64_tr_b16 a[28:29], v163 offset:12288
v_mfma_f32_16x16x32_bf16 v[48:51], a[12:15], a[48:51], v[48:51]
ds_read_b64_tr_b16 a[30:31], v163 offset:14336
v_mfma_f32_16x16x32_bf16 v[56:59], a[12:15], a[56:59], v[56:59]
v_mfma_f32_16x16x32_bf16 v[60:63], a[12:15], a[60:63], v[60:63]
v_mfma_f32_16x16x32_bf16 v[44:47], a[8:11], a[60:63], v[44:47]
v_mfma_f32_16x16x32_bf16 v[40:43], a[8:11], a[56:59], v[40:43]
v_mfma_f32_16x16x32_bf16 v[24:27], a[4:7], a[56:59], v[24:27]
v_mfma_f32_16x16x32_bf16 v[28:31], a[4:7], a[60:63], v[28:31]
v_mfma_f32_16x16x32_bf16 v[12:15], a[0:3], a[60:63], v[12:15]
v_mfma_f32_16x16x32_bf16 v[8:11], a[0:3], a[56:59], v[8:11]
s_waitcnt lgkmcnt(0)
v_mfma_f32_16x16x32_bf16 v[64:67], a[16:19], a[48:51], v[64:67]
s_add_u32 m0, s66, 0
s_add_u32 s64, s42, 229376
buffer_load_dwordx4 v156, s[20:23], s64 offen offset:0 lds
v_mfma_f32_16x16x32_bf16 v[68:71], a[16:19], a[52:55], v[68:71]
buffer_load_dwordx4 v157, s[20:23], s64 offen offset:1024 lds
v_mfma_f32_16x16x32_bf16 v[84:87], a[20:23], a[52:55], v[84:87]
buffer_load_dwordx4 v158, s[20:23], s64 offen offset:2048 lds
v_mfma_f32_16x16x32_bf16 v[80:83], a[20:23], a[48:51], v[80:83]
buffer_load_dwordx4 v159, s[20:23], s64 offen offset:3072 lds
v_mfma_f32_16x16x32_bf16 v[96:99], a[24:27], a[48:51], v[96:99]
s_add_u32 m0, s66, 4096
s_add_u32 s64, s42, 229504
buffer_load_dwordx4 v156, s[20:23], s64 offen offset:0 lds
v_mfma_f32_16x16x32_bf16 v[100:103], a[24:27], a[52:55], v[100:103]
buffer_load_dwordx4 v157, s[20:23], s64 offen offset:1024 lds
v_mfma_f32_16x16x32_bf16 v[116:119], a[28:31], a[52:55], v[116:119]
buffer_load_dwordx4 v158, s[20:23], s64 offen offset:2048 lds
v_mfma_f32_16x16x32_bf16 v[112:115], a[28:31], a[48:51], v[112:115]
buffer_load_dwordx4 v159, s[20:23], s64 offen offset:3072 lds
v_mfma_f32_16x16x32_bf16 v[120:123], a[28:31], a[56:59], v[120:123]
v_mfma_f32_16x16x32_bf16 v[124:127], a[28:31], a[60:63], v[124:127]
v_mfma_f32_16x16x32_bf16 v[108:111], a[24:27], a[60:63], v[108:111]
v_mfma_f32_16x16x32_bf16 v[104:107], a[24:27], a[56:59], v[104:107]
v_mfma_f32_16x16x32_bf16 v[88:91], a[20:23], a[56:59], v[88:91]
v_mfma_f32_16x16x32_bf16 v[92:95], a[20:23], a[60:63], v[92:95]
v_mfma_f32_16x16x32_bf16 v[76:79], a[16:19], a[60:63], v[76:79]
v_mfma_f32_16x16x32_bf16 v[72:75], a[16:19], a[56:59], v[72:75]
s_waitcnt vmcnt(8)
s_barrier
s_setprio 3
s_waitcnt vmcnt(4)
ds_read_b64_tr_b16 a[0:1], v160 offset:0
ds_read_b64_tr_b16 a[2:3], v160 offset:2048
ds_read_b64_tr_b16 a[4:5], v161 offset:0
ds_read_b64_tr_b16 a[6:7], v161 offset:2048
ds_read_b64_tr_b16 a[8:9], v162 offset:0
ds_read_b64_tr_b16 a[10:11], v162 offset:2048
ds_read_b64_tr_b16 a[12:13], v163 offset:0
ds_read_b64_tr_b16 a[14:15], v163 offset:2048
s_add_u32 m0, s68, 0
s_add_u32 s64, s32, 393216
buffer_load_dwordx4 v169, s[8:11], s64 offen nt lds
s_add_u32 m0, s68, 1056
s_add_u32 s64, s32, 397312
buffer_load_dwordx4 v169, s[8:11], s64 offen nt lds
s_add_u32 m0, s68, 2112
s_add_u32 s64, s32, 401408
buffer_load_dwordx4 v169, s[8:11], s64 offen nt lds
s_add_u32 m0, s68, 3168
s_add_u32 s64, s32, 405504
buffer_load_dwordx4 v169, s[8:11], s64 offen nt lds
s_add_u32 m0, s68, 4224
s_add_u32 s64, s32, 409600
buffer_load_dwordx4 v169, s[8:11], s64 offen nt lds
s_add_u32 m0, s68, 5280
s_add_u32 s64, s32, 413696
buffer_load_dwordx4 v169, s[8:11], s64 offen nt lds
s_add_u32 m0, s68, 6336
s_add_u32 s64, s32, 417792
buffer_load_dwordx4 v169, s[8:11], s64 offen nt lds
s_add_u32 m0, s68, 7392
s_add_u32 s64, s32, 421888
buffer_load_dwordx4 v169, s[8:11], s64 offen nt lds
s_setprio 1
s_waitcnt vmcnt(8) lgkmcnt(0)
v_mfma_f32_16x16x32_bf16 v[0:3], a[0:3], a[64:67], v[0:3]
ds_read_b64_tr_b16 a[16:17], v160 offset:4096
v_mfma_f32_16x16x32_bf16 v[4:7], a[0:3], a[68:71], v[4:7]
ds_read_b64_tr_b16 a[18:19], v160 offset:6144
v_mfma_f32_16x16x32_bf16 v[20:23], a[4:7], a[68:71], v[20:23]
ds_read_b64_tr_b16 a[20:21], v161 offset:4096
v_mfma_f32_16x16x32_bf16 v[16:19], a[4:7], a[64:67], v[16:19]
ds_read_b64_tr_b16 a[22:23], v161 offset:6144
v_mfma_f32_16x16x32_bf16 v[32:35], a[8:11], a[64:67], v[32:35]
ds_read_b64_tr_b16 a[24:25], v162 offset:4096
v_mfma_f32_16x16x32_bf16 v[36:39], a[8:11], a[68:71], v[36:39]
ds_read_b64_tr_b16 a[26:27], v162 offset:6144
v_mfma_f32_16x16x32_bf16 v[52:55], a[12:15], a[68:71], v[52:55]
ds_read_b64_tr_b16 a[28:29], v163 offset:4096
v_mfma_f32_16x16x32_bf16 v[48:51], a[12:15], a[64:67], v[48:51]
ds_read_b64_tr_b16 a[30:31], v163 offset:6144
v_mfma_f32_16x16x32_bf16 v[56:59], a[12:15], a[72:75], v[56:59]
v_mfma_f32_16x16x32_bf16 v[60:63], a[12:15], a[76:79], v[60:63]
v_mfma_f32_16x16x32_bf16 v[44:47], a[8:11], a[76:79], v[44:47]
v_mfma_f32_16x16x32_bf16 v[40:43], a[8:11], a[72:75], v[40:43]
v_mfma_f32_16x16x32_bf16 v[24:27], a[4:7], a[72:75], v[24:27]
v_mfma_f32_16x16x32_bf16 v[28:31], a[4:7], a[76:79], v[28:31]
v_mfma_f32_16x16x32_bf16 v[12:15], a[0:3], a[76:79], v[12:15]
v_mfma_f32_16x16x32_bf16 v[8:11], a[0:3], a[72:75], v[8:11]
s_waitcnt lgkmcnt(0)
v_mfma_f32_16x16x32_bf16 v[64:67], a[16:19], a[64:67], v[64:67]
s_add_u32 m0, s66, 8192
s_add_u32 s64, s42, 258048
buffer_load_dwordx4 v156, s[20:23], s64 offen offset:0 lds
v_mfma_f32_16x16x32_bf16 v[68:71], a[16:19], a[68:71], v[68:71]
buffer_load_dwordx4 v157, s[20:23], s64 offen offset:1024 lds
v_mfma_f32_16x16x32_bf16 v[84:87], a[20:23], a[68:71], v[84:87]
buffer_load_dwordx4 v158, s[20:23], s64 offen offset:2048 lds
v_mfma_f32_16x16x32_bf16 v[80:83], a[20:23], a[64:67], v[80:83]
buffer_load_dwordx4 v159, s[20:23], s64 offen offset:3072 lds
v_mfma_f32_16x16x32_bf16 v[96:99], a[24:27], a[64:67], v[96:99]
s_add_u32 m0, s66, 12288
s_add_u32 s64, s42, 258176
buffer_load_dwordx4 v156, s[20:23], s64 offen offset:0 lds
v_mfma_f32_16x16x32_bf16 v[100:103], a[24:27], a[68:71], v[100:103]
buffer_load_dwordx4 v157, s[20:23], s64 offen offset:1024 lds
v_mfma_f32_16x16x32_bf16 v[116:119], a[28:31], a[68:71], v[116:119]
buffer_load_dwordx4 v158, s[20:23], s64 offen offset:2048 lds
v_mfma_f32_16x16x32_bf16 v[112:115], a[28:31], a[64:67], v[112:115]
buffer_load_dwordx4 v159, s[20:23], s64 offen offset:3072 lds
v_mfma_f32_16x16x32_bf16 v[120:123], a[28:31], a[72:75], v[120:123]
v_mfma_f32_16x16x32_bf16 v[124:127], a[28:31], a[76:79], v[124:127]
v_mfma_f32_16x16x32_bf16 v[108:111], a[24:27], a[76:79], v[108:111]
v_mfma_f32_16x16x32_bf16 v[104:107], a[24:27], a[72:75], v[104:107]
v_mfma_f32_16x16x32_bf16 v[88:91], a[20:23], a[72:75], v[88:91]
v_mfma_f32_16x16x32_bf16 v[92:95], a[20:23], a[76:79], v[92:95]
v_mfma_f32_16x16x32_bf16 v[76:79], a[16:19], a[76:79], v[76:79]
v_mfma_f32_16x16x32_bf16 v[72:75], a[16:19], a[72:75], v[72:75]
s_waitcnt vmcnt(8)
s_barrier
s_setprio 3
s_waitcnt vmcnt(4)
ds_read_b64_tr_b16 a[0:1], v160 offset:8192
ds_read_b64_tr_b16 a[2:3], v160 offset:10240
ds_read_b64_tr_b16 a[4:5], v161 offset:8192
ds_read_b64_tr_b16 a[6:7], v161 offset:10240
ds_read_b64_tr_b16 a[8:9], v162 offset:8192
ds_read_b64_tr_b16 a[10:11], v162 offset:10240
ds_read_b64_tr_b16 a[12:13], v163 offset:8192
ds_read_b64_tr_b16 a[14:15], v163 offset:10240
s_add_u32 m0, s68, 33792
s_add_u32 s64, s33, 393216
buffer_load_dwordx4 v169, s[8:11], s64 offen nt lds
s_add_u32 m0, s68, 34848
s_add_u32 s64, s33, 397312
buffer_load_dwordx4 v169, s[8:11], s64 offen nt lds
s_add_u32 m0, s68, 35904
s_add_u32 s64, s33, 401408
buffer_load_dwordx4 v169, s[8:11], s64 offen nt lds
s_add_u32 m0, s68, 36960
s_add_u32 s64, s33, 405504
buffer_load_dwordx4 v169, s[8:11], s64 offen nt lds
s_add_u32 m0, s68, 38016
s_add_u32 s64, s33, 409600
buffer_load_dwordx4 v169, s[8:11], s64 offen nt lds
s_add_u32 m0, s68, 39072
s_add_u32 s64, s33, 413696
buffer_load_dwordx4 v169, s[8:11], s64 offen nt lds
s_add_u32 m0, s68, 40128
s_add_u32 s64, s33, 417792
buffer_load_dwordx4 v169, s[8:11], s64 offen nt lds
s_add_u32 m0, s68, 41184
s_add_u32 s64, s33, 421888
buffer_load_dwordx4 v169, s[8:11], s64 offen nt lds
s_setprio 1
s_waitcnt vmcnt(8) lgkmcnt(0)
v_mfma_f32_16x16x32_bf16 v[0:3], a[0:3], v[132:135], v[0:3]
ds_read_b64_tr_b16 a[16:17], v160 offset:12288
v_mfma_f32_16x16x32_bf16 v[4:7], a[0:3], v[136:139], v[4:7]
ds_read_b64_tr_b16 a[18:19], v160 offset:14336
v_mfma_f32_16x16x32_bf16 v[20:23], a[4:7], v[136:139], v[20:23]
ds_read_b64_tr_b16 a[20:21], v161 offset:12288
v_mfma_f32_16x16x32_bf16 v[16:19], a[4:7], v[132:135], v[16:19]
ds_read_b64_tr_b16 a[22:23], v161 offset:14336
v_mfma_f32_16x16x32_bf16 v[32:35], a[8:11], v[132:135], v[32:35]
ds_read_b64_tr_b16 a[24:25], v162 offset:12288
v_mfma_f32_16x16x32_bf16 v[36:39], a[8:11], v[136:139], v[36:39]
ds_read_b64_tr_b16 a[26:27], v162 offset:14336
v_mfma_f32_16x16x32_bf16 v[52:55], a[12:15], v[136:139], v[52:55]
ds_read_b64_tr_b16 a[28:29], v163 offset:12288
v_mfma_f32_16x16x32_bf16 v[48:51], a[12:15], v[132:135], v[48:51]
ds_read_b64_tr_b16 a[30:31], v163 offset:14336
v_mfma_f32_16x16x32_bf16 v[56:59], a[12:15], v[140:143], v[56:59]
v_mfma_f32_16x16x32_bf16 v[60:63], a[12:15], v[144:147], v[60:63]
v_mfma_f32_16x16x32_bf16 v[44:47], a[8:11], v[144:147], v[44:47]
v_mfma_f32_16x16x32_bf16 v[40:43], a[8:11], v[140:143], v[40:43]
v_mfma_f32_16x16x32_bf16 v[24:27], a[4:7], v[140:143], v[24:27]
v_mfma_f32_16x16x32_bf16 v[28:31], a[4:7], v[144:147], v[28:31]
v_mfma_f32_16x16x32_bf16 v[12:15], a[0:3], v[144:147], v[12:15]
v_mfma_f32_16x16x32_bf16 v[8:11], a[0:3], v[140:143], v[8:11]
s_waitcnt lgkmcnt(0)
v_mfma_f32_16x16x32_bf16 v[64:67], a[16:19], v[132:135], v[64:67]
s_add_u32 m0, s66, 0
s_add_u32 s64, s43, 0
buffer_load_dwordx4 v156, s[20:23], s64 offen offset:0 lds
v_mfma_f32_16x16x32_bf16 v[68:71], a[16:19], v[136:139], v[68:71]
buffer_load_dwordx4 v157, s[20:23], s64 offen offset:1024 lds
v_mfma_f32_16x16x32_bf16 v[84:87], a[20:23], v[136:139], v[84:87]
buffer_load_dwordx4 v158, s[20:23], s64 offen offset:2048 lds
v_mfma_f32_16x16x32_bf16 v[80:83], a[20:23], v[132:135], v[80:83]
buffer_load_dwordx4 v159, s[20:23], s64 offen offset:3072 lds
v_mfma_f32_16x16x32_bf16 v[96:99], a[24:27], v[132:135], v[96:99]
s_add_u32 m0, s66, 4096
s_add_u32 s64, s43, 128
buffer_load_dwordx4 v156, s[20:23], s64 offen offset:0 lds
v_mfma_f32_16x16x32_bf16 v[100:103], a[24:27], v[136:139], v[100:103]
buffer_load_dwordx4 v157, s[20:23], s64 offen offset:1024 lds
v_mfma_f32_16x16x32_bf16 v[116:119], a[28:31], v[136:139], v[116:119]
buffer_load_dwordx4 v158, s[20:23], s64 offen offset:2048 lds
v_mfma_f32_16x16x32_bf16 v[112:115], a[28:31], v[132:135], v[112:115]
buffer_load_dwordx4 v159, s[20:23], s64 offen offset:3072 lds
v_mfma_f32_16x16x32_bf16 v[120:123], a[28:31], v[140:143], v[120:123]
v_mfma_f32_16x16x32_bf16 v[124:127], a[28:31], v[144:147], v[124:127]
v_mfma_f32_16x16x32_bf16 v[108:111], a[24:27], v[144:147], v[108:111]
v_mfma_f32_16x16x32_bf16 v[104:107], a[24:27], v[140:143], v[104:107]
v_mfma_f32_16x16x32_bf16 v[88:91], a[20:23], v[140:143], v[88:91]
v_mfma_f32_16x16x32_bf16 v[92:95], a[20:23], v[144:147], v[92:95]
v_mfma_f32_16x16x32_bf16 v[76:79], a[16:19], v[144:147], v[76:79]
v_mfma_f32_16x16x32_bf16 v[72:75], a[16:19], v[140:143], v[72:75]
s_waitcnt vmcnt(8)
s_barrier
s_setprio 3
s_waitcnt vmcnt(4)
ds_read_b64_tr_b16 a[0:1], v160 offset:0
ds_read_b64_tr_b16 a[2:3], v160 offset:2048
ds_read_b64_tr_b16 a[4:5], v161 offset:0
ds_read_b64_tr_b16 a[6:7], v161 offset:2048
ds_read_b64_tr_b16 a[8:9], v162 offset:0
ds_read_b64_tr_b16 a[10:11], v162 offset:2048
ds_read_b64_tr_b16 a[12:13], v163 offset:0
ds_read_b64_tr_b16 a[14:15], v163 offset:2048
ds_read_b128 a[32:35], v128 offset:0
ds_read_b128 a[36:39], v129 offset:0
ds_read_b128 a[40:43], v130 offset:0
ds_read_b128 a[44:47], v131 offset:0
s_add_u32 m0, s68, 0
s_add_u32 s64, s34, 393216
buffer_load_dwordx4 v169, s[8:11], s64 offen nt lds
s_add_u32 m0, s68, 1056
s_add_u32 s64, s34, 397312
buffer_load_dwordx4 v169, s[8:11], s64 offen nt lds
s_add_u32 m0, s68, 2112
s_add_u32 s64, s34, 401408
buffer_load_dwordx4 v169, s[8:11], s64 offen nt lds
s_add_u32 m0, s68, 3168
s_add_u32 s64, s34, 405504
buffer_load_dwordx4 v169, s[8:11], s64 offen nt lds
s_add_u32 m0, s68, 4224
s_add_u32 s64, s34, 409600
buffer_load_dwordx4 v169, s[8:11], s64 offen nt lds
s_add_u32 m0, s68, 5280
s_add_u32 s64, s34, 413696
buffer_load_dwordx4 v169, s[8:11], s64 offen nt lds
s_add_u32 m0, s68, 6336
s_add_u32 s64, s34, 417792
buffer_load_dwordx4 v169, s[8:11], s64 offen nt lds
s_add_u32 m0, s68, 7392
s_add_u32 s64, s34, 421888
buffer_load_dwordx4 v169, s[8:11], s64 offen nt lds
s_setprio 1
s_waitcnt vmcnt(8) lgkmcnt(0)
v_mfma_f32_16x16x32_bf16 v[0:3], a[0:3], a[32:35], v[0:3]
ds_read_b64_tr_b16 a[16:17], v160 offset:4096
v_mfma_f32_16x16x32_bf16 v[4:7], a[0:3], a[36:39], v[4:7]
ds_read_b64_tr_b16 a[18:19], v160 offset:6144
v_mfma_f32_16x16x32_bf16 v[20:23], a[4:7], a[36:39], v[20:23]
ds_read_b64_tr_b16 a[20:21], v161 offset:4096
v_mfma_f32_16x16x32_bf16 v[16:19], a[4:7], a[32:35], v[16:19]
ds_read_b64_tr_b16 a[22:23], v161 offset:6144
v_mfma_f32_16x16x32_bf16 v[32:35], a[8:11], a[32:35], v[32:35]
ds_read_b64_tr_b16 a[24:25], v162 offset:4096
v_mfma_f32_16x16x32_bf16 v[36:39], a[8:11], a[36:39], v[36:39]
ds_read_b64_tr_b16 a[26:27], v162 offset:6144
v_mfma_f32_16x16x32_bf16 v[52:55], a[12:15], a[36:39], v[52:55]
ds_read_b64_tr_b16 a[28:29], v163 offset:4096
v_mfma_f32_16x16x32_bf16 v[48:51], a[12:15], a[32:35], v[48:51]
ds_read_b64_tr_b16 a[30:31], v163 offset:6144
v_mfma_f32_16x16x32_bf16 v[56:59], a[12:15], a[40:43], v[56:59]
v_mfma_f32_16x16x32_bf16 v[60:63], a[12:15], a[44:47], v[60:63]
v_mfma_f32_16x16x32_bf16 v[44:47], a[8:11], a[44:47], v[44:47]
v_mfma_f32_16x16x32_bf16 v[40:43], a[8:11], a[40:43], v[40:43]
v_mfma_f32_16x16x32_bf16 v[24:27], a[4:7], a[40:43], v[24:27]
v_mfma_f32_16x16x32_bf16 v[28:31], a[4:7], a[44:47], v[28:31]
v_mfma_f32_16x16x32_bf16 v[12:15], a[0:3], a[44:47], v[12:15]
v_mfma_f32_16x16x32_bf16 v[8:11], a[0:3], a[40:43], v[8:11]
s_waitcnt lgkmcnt(0)
v_mfma_f32_16x16x32_bf16 v[64:67], a[16:19], a[32:35], v[64:67]
s_add_u32 m0, s66, 8192
s_add_u32 s64, s43, 28672
buffer_load_dwordx4 v156, s[20:23], s64 offen offset:0 lds
v_mfma_f32_16x16x32_bf16 v[68:71], a[16:19], a[36:39], v[68:71]
buffer_load_dwordx4 v157, s[20:23], s64 offen offset:1024 lds
v_mfma_f32_16x16x32_bf16 v[84:87], a[20:23], a[36:39], v[84:87]
buffer_load_dwordx4 v158, s[20:23], s64 offen offset:2048 lds
v_mfma_f32_16x16x32_bf16 v[80:83], a[20:23], a[32:35], v[80:83]
buffer_load_dwordx4 v159, s[20:23], s64 offen offset:3072 lds
v_mfma_f32_16x16x32_bf16 v[96:99], a[24:27], a[32:35], v[96:99]
s_add_u32 m0, s66, 12288
s_add_u32 s64, s43, 28800
buffer_load_dwordx4 v156, s[20:23], s64 offen offset:0 lds
v_mfma_f32_16x16x32_bf16 v[100:103], a[24:27], a[36:39], v[100:103]
buffer_load_dwordx4 v157, s[20:23], s64 offen offset:1024 lds
v_mfma_f32_16x16x32_bf16 v[116:119], a[28:31], a[36:39], v[116:119]
buffer_load_dwordx4 v158, s[20:23], s64 offen offset:2048 lds
v_mfma_f32_16x16x32_bf16 v[112:115], a[28:31], a[32:35], v[112:115]
buffer_load_dwordx4 v159, s[20:23], s64 offen offset:3072 lds
v_mfma_f32_16x16x32_bf16 v[120:123], a[28:31], a[40:43], v[120:123]
v_mfma_f32_16x16x32_bf16 v[124:127], a[28:31], a[44:47], v[124:127]
v_mfma_f32_16x16x32_bf16 v[108:111], a[24:27], a[44:47], v[108:111]
v_mfma_f32_16x16x32_bf16 v[104:107], a[24:27], a[40:43], v[104:107]
v_mfma_f32_16x16x32_bf16 v[88:91], a[20:23], a[40:43], v[88:91]
v_mfma_f32_16x16x32_bf16 v[92:95], a[20:23], a[44:47], v[92:95]
v_mfma_f32_16x16x32_bf16 v[76:79], a[16:19], a[44:47], v[76:79]
v_mfma_f32_16x16x32_bf16 v[72:75], a[16:19], a[40:43], v[72:75]
s_waitcnt vmcnt(8)
s_barrier
s_setprio 3
s_waitcnt vmcnt(4)
ds_read_b64_tr_b16 a[0:1], v160 offset:8192
ds_read_b64_tr_b16 a[2:3], v160 offset:10240
ds_read_b64_tr_b16 a[4:5], v161 offset:8192
ds_read_b64_tr_b16 a[6:7], v161 offset:10240
ds_read_b64_tr_b16 a[8:9], v162 offset:8192
ds_read_b64_tr_b16 a[10:11], v162 offset:10240
ds_read_b64_tr_b16 a[12:13], v163 offset:8192
ds_read_b64_tr_b16 a[14:15], v163 offset:10240
ds_read_b128 a[48:51], v128 offset:4096
ds_read_b128 a[52:55], v129 offset:4096
ds_read_b128 a[56:59], v130 offset:4096
ds_read_b128 a[60:63], v131 offset:4096
s_add_u32 m0, s68, 33792
s_add_u32 s64, s35, 393216
buffer_load_dwordx4 v169, s[8:11], s64 offen nt lds
s_add_u32 m0, s68, 34848
s_add_u32 s64, s35, 397312
buffer_load_dwordx4 v169, s[8:11], s64 offen nt lds
s_add_u32 m0, s68, 35904
s_add_u32 s64, s35, 401408
buffer_load_dwordx4 v169, s[8:11], s64 offen nt lds
s_add_u32 m0, s68, 36960
s_add_u32 s64, s35, 405504
buffer_load_dwordx4 v169, s[8:11], s64 offen nt lds
s_add_u32 m0, s68, 38016
s_add_u32 s64, s35, 409600
buffer_load_dwordx4 v169, s[8:11], s64 offen nt lds
s_add_u32 m0, s68, 39072
s_add_u32 s64, s35, 413696
buffer_load_dwordx4 v169, s[8:11], s64 offen nt lds
s_add_u32 m0, s68, 40128
s_add_u32 s64, s35, 417792
buffer_load_dwordx4 v169, s[8:11], s64 offen nt lds
s_add_u32 m0, s68, 41184
s_add_u32 s64, s35, 421888
buffer_load_dwordx4 v169, s[8:11], s64 offen nt lds
s_setprio 1
s_waitcnt vmcnt(8) lgkmcnt(0)
v_mfma_f32_16x16x32_bf16 v[0:3], a[0:3], a[48:51], v[0:3]
ds_read_b64_tr_b16 a[16:17], v160 offset:12288
v_mfma_f32_16x16x32_bf16 v[4:7], a[0:3], a[52:55], v[4:7]
ds_read_b64_tr_b16 a[18:19], v160 offset:14336
v_mfma_f32_16x16x32_bf16 v[20:23], a[4:7], a[52:55], v[20:23]
ds_read_b64_tr_b16 a[20:21], v161 offset:12288
v_mfma_f32_16x16x32_bf16 v[16:19], a[4:7], a[48:51], v[16:19]
ds_read_b64_tr_b16 a[22:23], v161 offset:14336
v_mfma_f32_16x16x32_bf16 v[32:35], a[8:11], a[48:51], v[32:35]
ds_read_b64_tr_b16 a[24:25], v162 offset:12288
v_mfma_f32_16x16x32_bf16 v[36:39], a[8:11], a[52:55], v[36:39]
ds_read_b64_tr_b16 a[26:27], v162 offset:14336
v_mfma_f32_16x16x32_bf16 v[52:55], a[12:15], a[52:55], v[52:55]
ds_read_b64_tr_b16 a[28:29], v163 offset:12288
v_mfma_f32_16x16x32_bf16 v[48:51], a[12:15], a[48:51], v[48:51]
ds_read_b64_tr_b16 a[30:31], v163 offset:14336
v_mfma_f32_16x16x32_bf16 v[56:59], a[12:15], a[56:59], v[56:59]
v_mfma_f32_16x16x32_bf16 v[60:63], a[12:15], a[60:63], v[60:63]
v_mfma_f32_16x16x32_bf16 v[44:47], a[8:11], a[60:63], v[44:47]
v_mfma_f32_16x16x32_bf16 v[40:43], a[8:11], a[56:59], v[40:43]
v_mfma_f32_16x16x32_bf16 v[24:27], a[4:7], a[56:59], v[24:27]
v_mfma_f32_16x16x32_bf16 v[28:31], a[4:7], a[60:63], v[28:31]
v_mfma_f32_16x16x32_bf16 v[12:15], a[0:3], a[60:63], v[12:15]
v_mfma_f32_16x16x32_bf16 v[8:11], a[0:3], a[56:59], v[8:11]
s_waitcnt lgkmcnt(0)
v_mfma_f32_16x16x32_bf16 v[64:67], a[16:19], a[48:51], v[64:67]
s_add_u32 m0, s66, 0
s_add_u32 s64, s43, 229376
buffer_load_dwordx4 v156, s[20:23], s64 offen offset:0 lds
v_mfma_f32_16x16x32_bf16 v[68:71], a[16:19], a[52:55], v[68:71]
buffer_load_dwordx4 v157, s[20:23], s64 offen offset:1024 lds
v_mfma_f32_16x16x32_bf16 v[84:87], a[20:23], a[52:55], v[84:87]
buffer_load_dwordx4 v158, s[20:23], s64 offen offset:2048 lds
v_mfma_f32_16x16x32_bf16 v[80:83], a[20:23], a[48:51], v[80:83]
buffer_load_dwordx4 v159, s[20:23], s64 offen offset:3072 lds
v_mfma_f32_16x16x32_bf16 v[96:99], a[24:27], a[48:51], v[96:99]
s_add_u32 m0, s66, 4096
s_add_u32 s64, s43, 229504
buffer_load_dwordx4 v156, s[20:23], s64 offen offset:0 lds
v_mfma_f32_16x16x32_bf16 v[100:103], a[24:27], a[52:55], v[100:103]
buffer_load_dwordx4 v157, s[20:23], s64 offen offset:1024 lds
v_mfma_f32_16x16x32_bf16 v[116:119], a[28:31], a[52:55], v[116:119]
buffer_load_dwordx4 v158, s[20:23], s64 offen offset:2048 lds
v_mfma_f32_16x16x32_bf16 v[112:115], a[28:31], a[48:51], v[112:115]
buffer_load_dwordx4 v159, s[20:23], s64 offen offset:3072 lds
v_mfma_f32_16x16x32_bf16 v[120:123], a[28:31], a[56:59], v[120:123]
v_mfma_f32_16x16x32_bf16 v[124:127], a[28:31], a[60:63], v[124:127]
v_mfma_f32_16x16x32_bf16 v[108:111], a[24:27], a[60:63], v[108:111]
v_mfma_f32_16x16x32_bf16 v[104:107], a[24:27], a[56:59], v[104:107]
v_mfma_f32_16x16x32_bf16 v[88:91], a[20:23], a[56:59], v[88:91]
v_mfma_f32_16x16x32_bf16 v[92:95], a[20:23], a[60:63], v[92:95]
v_mfma_f32_16x16x32_bf16 v[76:79], a[16:19], a[60:63], v[76:79]
v_mfma_f32_16x16x32_bf16 v[72:75], a[16:19], a[56:59], v[72:75]
s_waitcnt vmcnt(8)
s_barrier
s_setprio 3
s_waitcnt vmcnt(4)
ds_read_b64_tr_b16 a[0:1], v160 offset:0
ds_read_b64_tr_b16 a[2:3], v160 offset:2048
ds_read_b64_tr_b16 a[4:5], v161 offset:0
ds_read_b64_tr_b16 a[6:7], v161 offset:2048
ds_read_b64_tr_b16 a[8:9], v162 offset:0
ds_read_b64_tr_b16 a[10:11], v162 offset:2048
ds_read_b64_tr_b16 a[12:13], v163 offset:0
ds_read_b64_tr_b16 a[14:15], v163 offset:2048
ds_read_b128 a[64:67], v128 offset:8192
ds_read_b128 a[68:71], v129 offset:8192
ds_read_b128 a[72:75], v130 offset:8192
ds_read_b128 a[76:79], v131 offset:8192
s_add_u32 m0, s77, 0
s_add_u32 s64, s36, 262144
buffer_load_dwordx4 v168, s[12:15], s64 offen nt lds
s_add_u32 m0, s77, 1024
s_add_u32 s64, s36, 278528
buffer_load_dwordx4 v168, s[12:15], s64 offen nt lds
s_add_u32 m0, s77, 2048
s_add_u32 s64, s36, 294912
buffer_load_dwordx4 v168, s[12:15], s64 offen nt lds
s_add_u32 m0, s77, 3072
s_add_u32 s64, s36, 311296
buffer_load_dwordx4 v168, s[12:15], s64 offen nt lds
s_add_u32 m0, s77, 4096
s_add_u32 s64, s36, 327680
buffer_load_dwordx4 v168, s[12:15], s64 offen nt lds
s_add_u32 m0, s77, 5120
s_add_u32 s64, s36, 344064
buffer_load_dwordx4 v168, s[12:15], s64 offen nt lds
s_add_u32 m0, s77, 6144
s_add_u32 s64, s36, 360448
buffer_load_dwordx4 v168, s[12:15], s64 offen nt lds
s_add_u32 m0, s77, 7168
s_add_u32 s64, s36, 376832
buffer_load_dwordx4 v168, s[12:15], s64 offen nt lds
s_setprio 1
s_waitcnt vmcnt(8) lgkmcnt(0)
v_mfma_f32_16x16x32_bf16 v[0:3], a[0:3], a[64:67], v[0:3]
ds_read_b64_tr_b16 a[16:17], v160 offset:4096
v_mfma_f32_16x16x32_bf16 v[4:7], a[0:3], a[68:71], v[4:7]
ds_read_b64_tr_b16 a[18:19], v160 offset:6144
v_mfma_f32_16x16x32_bf16 v[20:23], a[4:7], a[68:71], v[20:23]
ds_read_b64_tr_b16 a[20:21], v161 offset:4096
v_mfma_f32_16x16x32_bf16 v[16:19], a[4:7], a[64:67], v[16:19]
ds_read_b64_tr_b16 a[22:23], v161 offset:6144
v_mfma_f32_16x16x32_bf16 v[32:35], a[8:11], a[64:67], v[32:35]
ds_read_b64_tr_b16 a[24:25], v162 offset:4096
v_mfma_f32_16x16x32_bf16 v[36:39], a[8:11], a[68:71], v[36:39]
ds_read_b64_tr_b16 a[26:27], v162 offset:6144
v_mfma_f32_16x16x32_bf16 v[52:55], a[12:15], a[68:71], v[52:55]
ds_read_b64_tr_b16 a[28:29], v163 offset:4096
v_mfma_f32_16x16x32_bf16 v[48:51], a[12:15], a[64:67], v[48:51]
ds_read_b64_tr_b16 a[30:31], v163 offset:6144
v_mfma_f32_16x16x32_bf16 v[56:59], a[12:15], a[72:75], v[56:59]
v_mfma_f32_16x16x32_bf16 v[60:63], a[12:15], a[76:79], v[60:63]
v_mfma_f32_16x16x32_bf16 v[44:47], a[8:11], a[76:79], v[44:47]
v_mfma_f32_16x16x32_bf16 v[40:43], a[8:11], a[72:75], v[40:43]
v_mfma_f32_16x16x32_bf16 v[24:27], a[4:7], a[72:75], v[24:27]
v_mfma_f32_16x16x32_bf16 v[28:31], a[4:7], a[76:79], v[28:31]
v_mfma_f32_16x16x32_bf16 v[12:15], a[0:3], a[76:79], v[12:15]
v_mfma_f32_16x16x32_bf16 v[8:11], a[0:3], a[72:75], v[8:11]
s_waitcnt lgkmcnt(0)
v_mfma_f32_16x16x32_bf16 v[64:67], a[16:19], a[64:67], v[64:67]
s_add_u32 m0, s66, 8192
s_add_u32 s64, s43, 258048
buffer_load_dwordx4 v156, s[20:23], s64 offen offset:0 lds
v_mfma_f32_16x16x32_bf16 v[68:71], a[16:19], a[68:71], v[68:71]
buffer_load_dwordx4 v157, s[20:23], s64 offen offset:1024 lds
v_mfma_f32_16x16x32_bf16 v[84:87], a[20:23], a[68:71], v[84:87]
buffer_load_dwordx4 v158, s[20:23], s64 offen offset:2048 lds
v_mfma_f32_16x16x32_bf16 v[80:83], a[20:23], a[64:67], v[80:83]
buffer_load_dwordx4 v159, s[20:23], s64 offen offset:3072 lds
v_mfma_f32_16x16x32_bf16 v[96:99], a[24:27], a[64:67], v[96:99]
s_add_u32 m0, s66, 12288
s_add_u32 s64, s43, 258176
buffer_load_dwordx4 v156, s[20:23], s64 offen offset:0 lds
v_mfma_f32_16x16x32_bf16 v[100:103], a[24:27], a[68:71], v[100:103]
buffer_load_dwordx4 v157, s[20:23], s64 offen offset:1024 lds
v_mfma_f32_16x16x32_bf16 v[116:119], a[28:31], a[68:71], v[116:119]
buffer_load_dwordx4 v158, s[20:23], s64 offen offset:2048 lds
v_mfma_f32_16x16x32_bf16 v[112:115], a[28:31], a[64:67], v[112:115]
buffer_load_dwordx4 v159, s[20:23], s64 offen offset:3072 lds
v_mfma_f32_16x16x32_bf16 v[120:123], a[28:31], a[72:75], v[120:123]
v_mfma_f32_16x16x32_bf16 v[124:127], a[28:31], a[76:79], v[124:127]
v_mfma_f32_16x16x32_bf16 v[108:111], a[24:27], a[76:79], v[108:111]
v_mfma_f32_16x16x32_bf16 v[104:107], a[24:27], a[72:75], v[104:107]
v_mfma_f32_16x16x32_bf16 v[88:91], a[20:23], a[72:75], v[88:91]
v_mfma_f32_16x16x32_bf16 v[92:95], a[20:23], a[76:79], v[92:95]
v_mfma_f32_16x16x32_bf16 v[76:79], a[16:19], a[76:79], v[76:79]
v_mfma_f32_16x16x32_bf16 v[72:75], a[16:19], a[72:75], v[72:75]
s_waitcnt vmcnt(8)
s_barrier
s_setprio 3
s_waitcnt vmcnt(4)
ds_read_b64_tr_b16 a[0:1], v160 offset:8192
ds_read_b64_tr_b16 a[2:3], v160 offset:10240
ds_read_b64_tr_b16 a[4:5], v161 offset:8192
ds_read_b64_tr_b16 a[6:7], v161 offset:10240
ds_read_b64_tr_b16 a[8:9], v162 offset:8192
ds_read_b64_tr_b16 a[10:11], v162 offset:10240
ds_read_b64_tr_b16 a[12:13], v163 offset:8192
ds_read_b64_tr_b16 a[14:15], v163 offset:10240
ds_read_b128 v[132:135], v128 offset:12288
ds_read_b128 v[136:139], v129 offset:12288
ds_read_b128 v[140:143], v130 offset:12288
ds_read_b128 v[144:147], v131 offset:12288
s_add_u32 m0, s77, 33792
s_add_u32 s64, s36, 393216
buffer_load_dwordx4 v168, s[12:15], s64 offen nt lds
s_add_u32 m0, s77, 34816
s_add_u32 s64, s36, 409600
buffer_load_dwordx4 v168, s[12:15], s64 offen nt lds
s_add_u32 m0, s77, 35840
s_add_u32 s64, s36, 425984
buffer_load_dwordx4 v168, s[12:15], s64 offen nt lds
s_add_u32 m0, s77, 36864
s_add_u32 s64, s36, 442368
buffer_load_dwordx4 v168, s[12:15], s64 offen nt lds
s_add_u32 m0, s77, 37888
s_add_u32 s64, s36, 458752
buffer_load_dwordx4 v168, s[12:15], s64 offen nt lds
s_add_u32 m0, s77, 38912
s_add_u32 s64, s36, 475136
buffer_load_dwordx4 v168, s[12:15], s64 offen nt lds
s_add_u32 m0, s77, 39936
s_add_u32 s64, s36, 491520
buffer_load_dwordx4 v168, s[12:15], s64 offen nt lds
s_add_u32 m0, s77, 40960
s_add_u32 s64, s36, 507904
buffer_load_dwordx4 v168, s[12:15], s64 offen nt lds
s_setprio 1
s_waitcnt vmcnt(8) lgkmcnt(0)
v_mfma_f32_16x16x32_bf16 v[0:3], a[0:3], v[132:135], v[0:3]
ds_read_b64_tr_b16 a[16:17], v160 offset:12288
v_mfma_f32_16x16x32_bf16 v[4:7], a[0:3], v[136:139], v[4:7]
ds_read_b64_tr_b16 a[18:19], v160 offset:14336
v_mfma_f32_16x16x32_bf16 v[20:23], a[4:7], v[136:139], v[20:23]
ds_read_b64_tr_b16 a[20:21], v161 offset:12288
v_mfma_f32_16x16x32_bf16 v[16:19], a[4:7], v[132:135], v[16:19]
ds_read_b64_tr_b16 a[22:23], v161 offset:14336
v_mfma_f32_16x16x32_bf16 v[32:35], a[8:11], v[132:135], v[32:35]
ds_read_b64_tr_b16 a[24:25], v162 offset:12288
v_mfma_f32_16x16x32_bf16 v[36:39], a[8:11], v[136:139], v[36:39]
ds_read_b64_tr_b16 a[26:27], v162 offset:14336
v_mfma_f32_16x16x32_bf16 v[52:55], a[12:15], v[136:139], v[52:55]
ds_read_b64_tr_b16 a[28:29], v163 offset:12288
v_mfma_f32_16x16x32_bf16 v[48:51], a[12:15], v[132:135], v[48:51]
ds_read_b64_tr_b16 a[30:31], v163 offset:14336
v_mfma_f32_16x16x32_bf16 v[56:59], a[12:15], v[140:143], v[56:59]
v_mfma_f32_16x16x32_bf16 v[60:63], a[12:15], v[144:147], v[60:63]
v_mfma_f32_16x16x32_bf16 v[44:47], a[8:11], v[144:147], v[44:47]
v_mfma_f32_16x16x32_bf16 v[40:43], a[8:11], v[140:143], v[40:43]
v_mfma_f32_16x16x32_bf16 v[24:27], a[4:7], v[140:143], v[24:27]
v_mfma_f32_16x16x32_bf16 v[28:31], a[4:7], v[144:147], v[28:31]
v_mfma_f32_16x16x32_bf16 v[12:15], a[0:3], v[144:147], v[12:15]
v_mfma_f32_16x16x32_bf16 v[8:11], a[0:3], v[140:143], v[8:11]
s_waitcnt lgkmcnt(0)
v_mfma_f32_16x16x32_bf16 v[64:67], a[16:19], v[132:135], v[64:67]
v_mfma_f32_16x16x32_bf16 v[68:71], a[16:19], v[136:139], v[68:71]
v_mfma_f32_16x16x32_bf16 v[84:87], a[20:23], v[136:139], v[84:87]
v_mfma_f32_16x16x32_bf16 v[80:83], a[20:23], v[132:135], v[80:83]
v_mfma_f32_16x16x32_bf16 v[96:99], a[24:27], v[132:135], v[96:99]
v_mfma_f32_16x16x32_bf16 v[100:103], a[24:27], v[136:139], v[100:103]
v_mfma_f32_16x16x32_bf16 v[116:119], a[28:31], v[136:139], v[116:119]
v_mfma_f32_16x16x32_bf16 v[112:115], a[28:31], v[132:135], v[112:115]
v_mfma_f32_16x16x32_bf16 v[120:123], a[28:31], v[140:143], v[120:123]
v_mfma_f32_16x16x32_bf16 v[124:127], a[28:31], v[144:147], v[124:127]
v_mfma_f32_16x16x32_bf16 v[108:111], a[24:27], v[144:147], v[108:111]
v_mfma_f32_16x16x32_bf16 v[104:107], a[24:27], v[140:143], v[104:107]
v_mfma_f32_16x16x32_bf16 v[88:91], a[20:23], v[140:143], v[88:91]
v_mfma_f32_16x16x32_bf16 v[92:95], a[20:23], v[144:147], v[92:95]
v_mfma_f32_16x16x32_bf16 v[76:79], a[16:19], v[144:147], v[76:79]
v_mfma_f32_16x16x32_bf16 v[72:75], a[16:19], v[140:143], v[72:75]
s_waitcnt vmcnt(0)
s_barrier
s_add_u32 m0, s77, 0
s_add_u32 s64, s37, 262144
buffer_load_dwordx4 v168, s[12:15], s64 offen nt lds
s_add_u32 m0, s77, 1024
s_add_u32 s64, s37, 278528
buffer_load_dwordx4 v168, s[12:15], s64 offen nt lds
s_add_u32 m0, s77, 2048
s_add_u32 s64, s37, 294912
buffer_load_dwordx4 v168, s[12:15], s64 offen nt lds
s_add_u32 m0, s77, 3072
s_add_u32 s64, s37, 311296
buffer_load_dwordx4 v168, s[12:15], s64 offen nt lds
s_add_u32 m0, s77, 4096
s_add_u32 s64, s37, 327680
buffer_load_dwordx4 v168, s[12:15], s64 offen nt lds
s_add_u32 m0, s77, 5120
s_add_u32 s64, s37, 344064
buffer_load_dwordx4 v168, s[12:15], s64 offen nt lds
s_add_u32 m0, s77, 6144
s_add_u32 s64, s37, 360448
buffer_load_dwordx4 v168, s[12:15], s64 offen nt lds
s_add_u32 m0, s77, 7168
s_add_u32 s64, s37, 376832
buffer_load_dwordx4 v168, s[12:15], s64 offen nt lds
s_barrier
s_add_u32 m0, s66, 0
s_add_u32 s64, s40, 458752
buffer_load_dwordx4 v156, s[20:23], s64 offen offset:0 lds
buffer_load_dwordx4 v157, s[20:23], s64 offen offset:1024 lds
buffer_load_dwordx4 v158, s[20:23], s64 offen offset:2048 lds
buffer_load_dwordx4 v159, s[20:23], s64 offen offset:3072 lds
s_add_u32 m0, s66, 4096
s_add_u32 s64, s40, 458880
buffer_load_dwordx4 v156, s[20:23], s64 offen offset:0 lds
buffer_load_dwordx4 v157, s[20:23], s64 offen offset:1024 lds
buffer_load_dwordx4 v158, s[20:23], s64 offen offset:2048 lds
buffer_load_dwordx4 v159, s[20:23], s64 offen offset:3072 lds
s_waitcnt vmcnt(8)
s_barrier
s_setprio 3
s_add_u32 m0, s77, 33792
s_add_u32 s64, s37, 393216
buffer_load_dwordx4 v168, s[12:15], s64 offen nt lds
s_add_u32 m0, s77, 34816
s_add_u32 s64, s37, 409600
buffer_load_dwordx4 v168, s[12:15], s64 offen nt lds
s_add_u32 m0, s77, 35840
s_add_u32 s64, s37, 425984
buffer_load_dwordx4 v168, s[12:15], s64 offen nt lds
s_add_u32 m0, s77, 36864
s_add_u32 s64, s37, 442368
buffer_load_dwordx4 v168, s[12:15], s64 offen nt lds
s_waitcnt vmcnt(8)
ds_read_b64_tr_b16 a[0:1], v160 offset:0
ds_read_b64_tr_b16 a[2:3], v160 offset:2048
ds_read_b64_tr_b16 a[4:5], v161 offset:0
ds_read_b64_tr_b16 a[6:7], v161 offset:2048
ds_read_b64_tr_b16 a[8:9], v162 offset:0
ds_read_b64_tr_b16 a[10:11], v162 offset:2048
ds_read_b64_tr_b16 a[12:13], v163 offset:0
ds_read_b64_tr_b16 a[14:15], v163 offset:2048
s_add_u32 m0, s77, 37888
s_add_u32 s64, s37, 458752
buffer_load_dwordx4 v168, s[12:15], s64 offen nt lds
s_add_u32 m0, s77, 38912
s_add_u32 s64, s37, 475136
buffer_load_dwordx4 v168, s[12:15], s64 offen nt lds
s_add_u32 m0, s77, 39936
s_add_u32 s64, s37, 491520
buffer_load_dwordx4 v168, s[12:15], s64 offen nt lds
s_add_u32 m0, s77, 40960
s_add_u32 s64, s37, 507904
buffer_load_dwordx4 v168, s[12:15], s64 offen nt lds
s_barrier
ds_read_b128 a[32:35], v128 offset:0
ds_read_b128 a[36:39], v129 offset:0
ds_read_b128 a[40:43], v130 offset:0
ds_read_b128 a[44:47], v131 offset:0
s_setprio 1
s_waitcnt vmcnt(8) lgkmcnt(0)
v_mfma_f32_16x16x32_bf16 v[0:3], a[0:3], a[32:35], v[0:3]
ds_read_b64_tr_b16 a[16:17], v160 offset:4096
v_mfma_f32_16x16x32_bf16 v[4:7], a[0:3], a[36:39], v[4:7]
ds_read_b64_tr_b16 a[18:19], v160 offset:6144
v_mfma_f32_16x16x32_bf16 v[20:23], a[4:7], a[36:39], v[20:23]
ds_read_b64_tr_b16 a[20:21], v161 offset:4096
v_mfma_f32_16x16x32_bf16 v[16:19], a[4:7], a[32:35], v[16:19]
ds_read_b64_tr_b16 a[22:23], v161 offset:6144
v_mfma_f32_16x16x32_bf16 v[32:35], a[8:11], a[32:35], v[32:35]
ds_read_b64_tr_b16 a[24:25], v162 offset:4096
v_mfma_f32_16x16x32_bf16 v[36:39], a[8:11], a[36:39], v[36:39]
ds_read_b64_tr_b16 a[26:27], v162 offset:6144
v_mfma_f32_16x16x32_bf16 v[52:55], a[12:15], a[36:39], v[52:55]
ds_read_b64_tr_b16 a[28:29], v163 offset:4096
v_mfma_f32_16x16x32_bf16 v[48:51], a[12:15], a[32:35], v[48:51]
ds_read_b64_tr_b16 a[30:31], v163 offset:6144
v_mfma_f32_16x16x32_bf16 v[56:59], a[12:15], a[40:43], v[56:59]
v_mfma_f32_16x16x32_bf16 v[60:63], a[12:15], a[44:47], v[60:63]
v_mfma_f32_16x16x32_bf16 v[44:47], a[8:11], a[44:47], v[44:47]
v_mfma_f32_16x16x32_bf16 v[40:43], a[8:11], a[40:43], v[40:43]
v_mfma_f32_16x16x32_bf16 v[24:27], a[4:7], a[40:43], v[24:27]
v_mfma_f32_16x16x32_bf16 v[28:31], a[4:7], a[44:47], v[28:31]
v_mfma_f32_16x16x32_bf16 v[12:15], a[0:3], a[44:47], v[12:15]
v_mfma_f32_16x16x32_bf16 v[8:11], a[0:3], a[40:43], v[8:11]
s_waitcnt lgkmcnt(0)
v_mfma_f32_16x16x32_bf16 v[64:67], a[16:19], a[32:35], v[64:67]
s_add_u32 m0, s66, 8192
s_add_u32 s64, s40, 487424
buffer_load_dwordx4 v156, s[20:23], s64 offen offset:0 lds
v_mfma_f32_16x16x32_bf16 v[68:71], a[16:19], a[36:39], v[68:71]
buffer_load_dwordx4 v157, s[20:23], s64 offen offset:1024 lds
v_mfma_f32_16x16x32_bf16 v[84:87], a[20:23], a[36:39], v[84:87]
buffer_load_dwordx4 v158, s[20:23], s64 offen offset:2048 lds
v_mfma_f32_16x16x32_bf16 v[80:83], a[20:23], a[32:35], v[80:83]
buffer_load_dwordx4 v159, s[20:23], s64 offen offset:3072 lds
v_mfma_f32_16x16x32_bf16 v[96:99], a[24:27], a[32:35], v[96:99]
s_add_u32 m0, s66, 12288
s_add_u32 s64, s40, 487552
buffer_load_dwordx4 v156, s[20:23], s64 offen offset:0 lds
v_mfma_f32_16x16x32_bf16 v[100:103], a[24:27], a[36:39], v[100:103]
buffer_load_dwordx4 v157, s[20:23], s64 offen offset:1024 lds
v_mfma_f32_16x16x32_bf16 v[116:119], a[28:31], a[36:39], v[116:119]
buffer_load_dwordx4 v158, s[20:23], s64 offen offset:2048 lds
v_mfma_f32_16x16x32_bf16 v[112:115], a[28:31], a[32:35], v[112:115]
buffer_load_dwordx4 v159, s[20:23], s64 offen offset:3072 lds
v_mfma_f32_16x16x32_bf16 v[120:123], a[28:31], a[40:43], v[120:123]
v_mfma_f32_16x16x32_bf16 v[124:127], a[28:31], a[44:47], v[124:127]
v_mfma_f32_16x16x32_bf16 v[108:111], a[24:27], a[44:47], v[108:111]
v_mfma_f32_16x16x32_bf16 v[104:107], a[24:27], a[40:43], v[104:107]
v_mfma_f32_16x16x32_bf16 v[88:91], a[20:23], a[40:43], v[88:91]
v_mfma_f32_16x16x32_bf16 v[92:95], a[20:23], a[44:47], v[92:95]
v_mfma_f32_16x16x32_bf16 v[76:79], a[16:19], a[44:47], v[76:79]
v_mfma_f32_16x16x32_bf16 v[72:75], a[16:19], a[40:43], v[72:75]
s_waitcnt vmcnt(8)
s_barrier
s_setprio 3
s_add_u32 m0, s77, 0
s_add_u32 s64, s38, 262144
buffer_load_dwordx4 v168, s[12:15], s64 offen nt lds
s_add_u32 m0, s77, 1024
s_add_u32 s64, s38, 278528
buffer_load_dwordx4 v168, s[12:15], s64 offen nt lds
s_add_u32 m0, s77, 2048
s_add_u32 s64, s38, 294912
buffer_load_dwordx4 v168, s[12:15], s64 offen nt lds
s_add_u32 m0, s77, 3072
s_add_u32 s64, s38, 311296
buffer_load_dwordx4 v168, s[12:15], s64 offen nt lds
s_waitcnt vmcnt(8)
ds_read_b64_tr_b16 a[0:1], v160 offset:8192
ds_read_b64_tr_b16 a[2:3], v160 offset:10240
ds_read_b64_tr_b16 a[4:5], v161 offset:8192
ds_read_b64_tr_b16 a[6:7], v161 offset:10240
ds_read_b64_tr_b16 a[8:9], v162 offset:8192
ds_read_b64_tr_b16 a[10:11], v162 offset:10240
ds_read_b64_tr_b16 a[12:13], v163 offset:8192
ds_read_b64_tr_b16 a[14:15], v163 offset:10240
ds_read_b128 a[48:51], v128 offset:4096
ds_read_b128 a[52:55], v129 offset:4096
ds_read_b128 a[56:59], v130 offset:4096
ds_read_b128 a[60:63], v131 offset:4096
s_add_u32 m0, s77, 4096
s_add_u32 s64, s38, 327680
buffer_load_dwordx4 v168, s[12:15], s64 offen nt lds
s_add_u32 m0, s77, 5120
s_add_u32 s64, s38, 344064
buffer_load_dwordx4 v168, s[12:15], s64 offen nt lds
s_add_u32 m0, s77, 6144
s_add_u32 s64, s38, 360448
buffer_load_dwordx4 v168, s[12:15], s64 offen nt lds
s_add_u32 m0, s77, 7168
s_add_u32 s64, s38, 376832
buffer_load_dwordx4 v168, s[12:15], s64 offen nt lds
s_setprio 1
s_waitcnt vmcnt(8) lgkmcnt(0)
v_mfma_f32_16x16x32_bf16 v[0:3], a[0:3], a[48:51], v[0:3]
ds_read_b64_tr_b16 a[16:17], v160 offset:12288
v_mfma_f32_16x16x32_bf16 v[4:7], a[0:3], a[52:55], v[4:7]
ds_read_b64_tr_b16 a[18:19], v160 offset:14336
v_mfma_f32_16x16x32_bf16 v[20:23], a[4:7], a[52:55], v[20:23]
ds_read_b64_tr_b16 a[20:21], v161 offset:12288
v_mfma_f32_16x16x32_bf16 v[16:19], a[4:7], a[48:51], v[16:19]
ds_read_b64_tr_b16 a[22:23], v161 offset:14336
v_mfma_f32_16x16x32_bf16 v[32:35], a[8:11], a[48:51], v[32:35]
ds_read_b64_tr_b16 a[24:25], v162 offset:12288
v_mfma_f32_16x16x32_bf16 v[36:39], a[8:11], a[52:55], v[36:39]
ds_read_b64_tr_b16 a[26:27], v162 offset:14336
v_mfma_f32_16x16x32_bf16 v[52:55], a[12:15], a[52:55], v[52:55]
ds_read_b64_tr_b16 a[28:29], v163 offset:12288
v_mfma_f32_16x16x32_bf16 v[48:51], a[12:15], a[48:51], v[48:51]
ds_read_b64_tr_b16 a[30:31], v163 offset:14336
v_mfma_f32_16x16x32_bf16 v[56:59], a[12:15], a[56:59], v[56:59]
v_mfma_f32_16x16x32_bf16 v[60:63], a[12:15], a[60:63], v[60:63]
v_mfma_f32_16x16x32_bf16 v[44:47], a[8:11], a[60:63], v[44:47]
v_mfma_f32_16x16x32_bf16 v[40:43], a[8:11], a[56:59], v[40:43]
v_mfma_f32_16x16x32_bf16 v[24:27], a[4:7], a[56:59], v[24:27]
v_mfma_f32_16x16x32_bf16 v[28:31], a[4:7], a[60:63], v[28:31]
v_mfma_f32_16x16x32_bf16 v[12:15], a[0:3], a[60:63], v[12:15]
v_mfma_f32_16x16x32_bf16 v[8:11], a[0:3], a[56:59], v[8:11]
s_waitcnt lgkmcnt(0)
v_mfma_f32_16x16x32_bf16 v[64:67], a[16:19], a[48:51], v[64:67]
ds_read_b128 a[64:67], v128 offset:8192
v_mfma_f32_16x16x32_bf16 v[68:71], a[16:19], a[52:55], v[68:71]
ds_read_b128 a[68:71], v129 offset:8192
v_mfma_f32_16x16x32_bf16 v[84:87], a[20:23], a[52:55], v[84:87]
ds_read_b128 a[72:75], v130 offset:8192
v_mfma_f32_16x16x32_bf16 v[80:83], a[20:23], a[48:51], v[80:83]
ds_read_b128 a[76:79], v131 offset:8192
v_mfma_f32_16x16x32_bf16 v[96:99], a[24:27], a[48:51], v[96:99]
ds_read_b128 a[32:35], v128 offset:12288
v_mfma_f32_16x16x32_bf16 v[100:103], a[24:27], a[52:55], v[100:103]
ds_read_b128 a[36:39], v129 offset:12288
v_mfma_f32_16x16x32_bf16 v[116:119], a[28:31], a[52:55], v[116:119]
ds_read_b128 a[40:43], v130 offset:12288
v_mfma_f32_16x16x32_bf16 v[112:115], a[28:31], a[48:51], v[112:115]
ds_read_b128 a[44:47], v131 offset:12288
v_mfma_f32_16x16x32_bf16 v[120:123], a[28:31], a[56:59], v[120:123]
s_add_u32 m0, s66, 0
s_add_u32 s64, s40, 688128
buffer_load_dwordx4 v156, s[20:23], s64 offen offset:0 lds
v_mfma_f32_16x16x32_bf16 v[124:127], a[28:31], a[60:63], v[124:127]
buffer_load_dwordx4 v157, s[20:23], s64 offen offset:1024 lds
v_mfma_f32_16x16x32_bf16 v[108:111], a[24:27], a[60:63], v[108:111]
buffer_load_dwordx4 v158, s[20:23], s64 offen offset:2048 lds
v_mfma_f32_16x16x32_bf16 v[104:107], a[24:27], a[56:59], v[104:107]
buffer_load_dwordx4 v159, s[20:23], s64 offen offset:3072 lds
v_mfma_f32_16x16x32_bf16 v[88:91], a[20:23], a[56:59], v[88:91]
s_add_u32 m0, s66, 4096
s_add_u32 s64, s40, 688256
buffer_load_dwordx4 v156, s[20:23], s64 offen offset:0 lds
v_mfma_f32_16x16x32_bf16 v[92:95], a[20:23], a[60:63], v[92:95]
buffer_load_dwordx4 v157, s[20:23], s64 offen offset:1024 lds
v_mfma_f32_16x16x32_bf16 v[76:79], a[16:19], a[60:63], v[76:79]
buffer_load_dwordx4 v158, s[20:23], s64 offen offset:2048 lds
v_mfma_f32_16x16x32_bf16 v[72:75], a[16:19], a[56:59], v[72:75]
buffer_load_dwordx4 v159, s[20:23], s64 offen offset:3072 lds
s_add_u32 m0, s66, 8192
s_add_u32 s64, s40, 716800
buffer_load_dwordx4 v156, s[20:23], s64 offen offset:0 lds
buffer_load_dwordx4 v157, s[20:23], s64 offen offset:1024 lds
buffer_load_dwordx4 v158, s[20:23], s64 offen offset:2048 lds
buffer_load_dwordx4 v159, s[20:23], s64 offen offset:3072 lds
s_waitcnt lgkmcnt(0)
s_waitcnt vmcnt(8)
ds_read_b64_tr_b16 a[0:1], v160 offset:0
ds_read_b64_tr_b16 a[2:3], v160 offset:2048
ds_read_b64_tr_b16 a[4:5], v161 offset:0
ds_read_b64_tr_b16 a[6:7], v161 offset:2048
ds_read_b64_tr_b16 a[8:9], v162 offset:0
ds_read_b64_tr_b16 a[10:11], v162 offset:2048
ds_read_b64_tr_b16 a[12:13], v163 offset:0
ds_read_b64_tr_b16 a[14:15], v163 offset:2048
s_barrier
s_setprio 3
s_setprio 1
s_waitcnt vmcnt(4) lgkmcnt(0)
v_mfma_f32_16x16x32_bf16 v[0:3], a[0:3], a[64:67], v[0:3]
ds_read_b64_tr_b16 a[16:17], v160 offset:4096
v_mfma_f32_16x16x32_bf16 v[4:7], a[0:3], a[68:71], v[4:7]
ds_read_b64_tr_b16 a[18:19], v160 offset:6144
v_mfma_f32_16x16x32_bf16 v[20:23], a[4:7], a[68:71], v[20:23]
ds_read_b64_tr_b16 a[20:21], v161 offset:4096
v_mfma_f32_16x16x32_bf16 v[16:19], a[4:7], a[64:67], v[16:19]
ds_read_b64_tr_b16 a[22:23], v161 offset:6144
v_mfma_f32_16x16x32_bf16 v[32:35], a[8:11], a[64:67], v[32:35]
ds_read_b64_tr_b16 a[24:25], v162 offset:4096
v_mfma_f32_16x16x32_bf16 v[36:39], a[8:11], a[68:71], v[36:39]
ds_read_b64_tr_b16 a[26:27], v162 offset:6144
v_mfma_f32_16x16x32_bf16 v[52:55], a[12:15], a[68:71], v[52:55]
ds_read_b64_tr_b16 a[28:29], v163 offset:4096
v_mfma_f32_16x16x32_bf16 v[48:51], a[12:15], a[64:67], v[48:51]
ds_read_b64_tr_b16 a[30:31], v163 offset:6144
v_mfma_f32_16x16x32_bf16 v[56:59], a[12:15], a[72:75], v[56:59]
s_add_u32 m0, s77, 33792
s_add_u32 s64, s38, 393216
buffer_load_dwordx4 v168, s[12:15], s64 offen nt lds
v_mfma_f32_16x16x32_bf16 v[60:63], a[12:15], a[76:79], v[60:63]
s_add_u32 m0, s77, 34816
s_add_u32 s64, s38, 409600
buffer_load_dwordx4 v168, s[12:15], s64 offen nt lds
v_mfma_f32_16x16x32_bf16 v[44:47], a[8:11], a[76:79], v[44:47]
s_add_u32 m0, s77, 35840
s_add_u32 s64, s38, 425984
buffer_load_dwordx4 v168, s[12:15], s64 offen nt lds
v_mfma_f32_16x16x32_bf16 v[40:43], a[8:11], a[72:75], v[40:43]
s_add_u32 m0, s77, 36864
s_add_u32 s64, s38, 442368
buffer_load_dwordx4 v168, s[12:15], s64 offen nt lds
v_mfma_f32_16x16x32_bf16 v[24:27], a[4:7], a[72:75], v[24:27]
v_mfma_f32_16x16x32_bf16 v[28:31], a[4:7], a[76:79], v[28:31]
v_mfma_f32_16x16x32_bf16 v[12:15], a[0:3], a[76:79], v[12:15]
v_mfma_f32_16x16x32_bf16 v[8:11], a[0:3], a[72:75], v[8:11]
s_waitcnt vmcnt(4) lgkmcnt(0)
v_mfma_f32_16x16x32_bf16 v[64:67], a[16:19], a[64:67], v[64:67]
ds_read_b64_tr_b16 a[0:1], v160 offset:8192
v_mfma_f32_16x16x32_bf16 v[68:71], a[16:19], a[68:71], v[68:71]
ds_read_b64_tr_b16 a[2:3], v160 offset:10240
v_mfma_f32_16x16x32_bf16 v[84:87], a[20:23], a[68:71], v[84:87]
ds_read_b64_tr_b16 a[4:5], v161 offset:8192
v_mfma_f32_16x16x32_bf16 v[80:83], a[20:23], a[64:67], v[80:83]
ds_read_b64_tr_b16 a[6:7], v161 offset:10240
v_mfma_f32_16x16x32_bf16 v[96:99], a[24:27], a[64:67], v[96:99]
ds_read_b64_tr_b16 a[8:9], v162 offset:8192
v_mfma_f32_16x16x32_bf16 v[100:103], a[24:27], a[68:71], v[100:103]
ds_read_b64_tr_b16 a[10:11], v162 offset:10240
v_mfma_f32_16x16x32_bf16 v[116:119], a[28:31], a[68:71], v[116:119]
ds_read_b64_tr_b16 a[12:13], v163 offset:8192
v_mfma_f32_16x16x32_bf16 v[112:115], a[28:31], a[64:67], v[112:115]
ds_read_b64_tr_b16 a[14:15], v163 offset:10240
v_mfma_f32_16x16x32_bf16 v[120:123], a[28:31], a[72:75], v[120:123]
s_add_u32 m0, s77, 37888
s_add_u32 s64, s38, 458752
buffer_load_dwordx4 v168, s[12:15], s64 offen nt lds
v_mfma_f32_16x16x32_bf16 v[124:127], a[28:31], a[76:79], v[124:127]
s_add_u32 m0, s77, 38912
s_add_u32 s64, s38, 475136
buffer_load_dwordx4 v168, s[12:15], s64 offen nt lds
v_mfma_f32_16x16x32_bf16 v[108:111], a[24:27], a[76:79], v[108:111]
s_add_u32 m0, s77, 39936
s_add_u32 s64, s38, 491520
buffer_load_dwordx4 v168, s[12:15], s64 offen nt lds
v_mfma_f32_16x16x32_bf16 v[104:107], a[24:27], a[72:75], v[104:107]
s_add_u32 m0, s77, 40960
s_add_u32 s64, s38, 507904
buffer_load_dwordx4 v168, s[12:15], s64 offen nt lds
v_mfma_f32_16x16x32_bf16 v[88:91], a[20:23], a[72:75], v[88:91]
s_add_u32 m0, s66, 12288
s_add_u32 s64, s40, 716928
buffer_load_dwordx4 v156, s[20:23], s64 offen offset:0 lds
v_mfma_f32_16x16x32_bf16 v[92:95], a[20:23], a[76:79], v[92:95]
buffer_load_dwordx4 v157, s[20:23], s64 offen offset:1024 lds
v_mfma_f32_16x16x32_bf16 v[76:79], a[16:19], a[76:79], v[76:79]
buffer_load_dwordx4 v158, s[20:23], s64 offen offset:2048 lds
v_mfma_f32_16x16x32_bf16 v[72:75], a[16:19], a[72:75], v[72:75]
buffer_load_dwordx4 v159, s[20:23], s64 offen offset:3072 lds
s_add_u32 m0, s66, 0
s_add_u32 s64, s41, 458752
buffer_load_dwordx4 v156, s[20:23], s64 offen offset:0 lds
buffer_load_dwordx4 v157, s[20:23], s64 offen offset:1024 lds
buffer_load_dwordx4 v158, s[20:23], s64 offen offset:2048 lds
buffer_load_dwordx4 v159, s[20:23], s64 offen offset:3072 lds
s_waitcnt lgkmcnt(0)
v_mfma_f32_16x16x32_bf16 v[0:3], a[0:3], a[32:35], v[0:3]
s_add_u32 m0, s66, 4096
s_add_u32 s64, s41, 458880
buffer_load_dwordx4 v156, s[20:23], s64 offen offset:0 lds
v_mfma_f32_16x16x32_bf16 v[4:7], a[0:3], a[36:39], v[4:7]
buffer_load_dwordx4 v157, s[20:23], s64 offen offset:1024 lds
v_mfma_f32_16x16x32_bf16 v[20:23], a[4:7], a[36:39], v[20:23]
buffer_load_dwordx4 v158, s[20:23], s64 offen offset:2048 lds
v_mfma_f32_16x16x32_bf16 v[16:19], a[4:7], a[32:35], v[16:19]
buffer_load_dwordx4 v159, s[20:23], s64 offen offset:3072 lds
v_mfma_f32_16x16x32_bf16 v[32:35], a[8:11], a[32:35], v[32:35]
v_mfma_f32_16x16x32_bf16 v[36:39], a[8:11], a[36:39], v[36:39]
v_mfma_f32_16x16x32_bf16 v[52:55], a[12:15], a[36:39], v[52:55]
v_mfma_f32_16x16x32_bf16 v[48:51], a[12:15], a[32:35], v[48:51]
v_mfma_f32_16x16x32_bf16 v[56:59], a[12:15], a[40:43], v[56:59]
v_mfma_f32_16x16x32_bf16 v[60:63], a[12:15], a[44:47], v[60:63]
v_mfma_f32_16x16x32_bf16 v[44:47], a[8:11], a[44:47], v[44:47]
v_mfma_f32_16x16x32_bf16 v[40:43], a[8:11], a[40:43], v[40:43]
v_mfma_f32_16x16x32_bf16 v[24:27], a[4:7], a[40:43], v[24:27]
v_mfma_f32_16x16x32_bf16 v[28:31], a[4:7], a[44:47], v[28:31]
v_mfma_f32_16x16x32_bf16 v[12:15], a[0:3], a[44:47], v[12:15]
v_mfma_f32_16x16x32_bf16 v[8:11], a[0:3], a[40:43], v[8:11]
s_waitcnt vmcnt(12)
s_barrier
s_setprio 3
s_add_u32 m0, s77, 0
s_add_u32 s64, s39, 262144
buffer_load_dwordx4 v168, s[12:15], s64 offen nt lds
s_add_u32 m0, s77, 1024
s_add_u32 s64, s39, 278528
buffer_load_dwordx4 v168, s[12:15], s64 offen nt lds
s_add_u32 m0, s77, 2048
s_add_u32 s64, s39, 294912
buffer_load_dwordx4 v168, s[12:15], s64 offen nt lds
s_add_u32 m0, s77, 3072
s_add_u32 s64, s39, 311296
buffer_load_dwordx4 v168, s[12:15], s64 offen nt lds
s_waitcnt vmcnt(12)
ds_read_b64_tr_b16 a[0:1], v160 offset:12288
ds_read_b64_tr_b16 a[2:3], v160 offset:14336
ds_read_b64_tr_b16 a[4:5], v161 offset:12288
ds_read_b64_tr_b16 a[6:7], v161 offset:14336
ds_read_b64_tr_b16 a[8:9], v162 offset:12288
ds_read_b64_tr_b16 a[10:11], v162 offset:14336
ds_read_b64_tr_b16 a[12:13], v163 offset:12288
ds_read_b64_tr_b16 a[14:15], v163 offset:14336
s_add_u32 m0, s77, 4096
s_add_u32 s64, s39, 327680
buffer_load_dwordx4 v168, s[12:15], s64 offen nt lds
s_add_u32 m0, s77, 5120
s_add_u32 s64, s39, 344064
buffer_load_dwordx4 v168, s[12:15], s64 offen nt lds
s_add_u32 m0, s77, 6144
s_add_u32 s64, s39, 360448
buffer_load_dwordx4 v168, s[12:15], s64 offen nt lds
s_add_u32 m0, s77, 7168
s_add_u32 s64, s39, 376832
buffer_load_dwordx4 v168, s[12:15], s64 offen nt lds
s_setprio 1
s_waitcnt vmcnt(12) lgkmcnt(0)
v_mfma_f32_16x16x32_bf16 v[64:67], a[0:3], a[32:35], v[64:67]
ds_read_b128 a[48:51], v128 offset:0
v_mfma_f32_16x16x32_bf16 v[68:71], a[0:3], a[36:39], v[68:71]
ds_read_b128 a[52:55], v129 offset:0
v_mfma_f32_16x16x32_bf16 v[84:87], a[4:7], a[36:39], v[84:87]
ds_read_b128 a[56:59], v130 offset:0
v_mfma_f32_16x16x32_bf16 v[80:83], a[4:7], a[32:35], v[80:83]
ds_read_b128 a[60:63], v131 offset:0
v_mfma_f32_16x16x32_bf16 v[96:99], a[8:11], a[32:35], v[96:99]
ds_read_b64_tr_b16 a[16:17], v160 offset:0
v_mfma_f32_16x16x32_bf16 v[100:103], a[8:11], a[36:39], v[100:103]
ds_read_b64_tr_b16 a[18:19], v160 offset:2048
v_mfma_f32_16x16x32_bf16 v[116:119], a[12:15], a[36:39], v[116:119]
ds_read_b64_tr_b16 a[20:21], v161 offset:0
v_mfma_f32_16x16x32_bf16 v[112:115], a[12:15], a[32:35], v[112:115]
ds_read_b64_tr_b16 a[22:23], v161 offset:2048
v_mfma_f32_16x16x32_bf16 v[120:123], a[12:15], a[40:43], v[120:123]
ds_read_b64_tr_b16 a[24:25], v162 offset:0
v_mfma_f32_16x16x32_bf16 v[124:127], a[12:15], a[44:47], v[124:127]
ds_read_b64_tr_b16 a[26:27], v162 offset:2048
v_mfma_f32_16x16x32_bf16 v[108:111], a[8:11], a[44:47], v[108:111]
ds_read_b64_tr_b16 a[28:29], v163 offset:0
v_mfma_f32_16x16x32_bf16 v[104:107], a[8:11], a[40:43], v[104:107]
ds_read_b64_tr_b16 a[30:31], v163 offset:2048
v_mfma_f32_16x16x32_bf16 v[88:91], a[4:7], a[40:43], v[88:91]
v_mfma_f32_16x16x32_bf16 v[92:95], a[4:7], a[44:47], v[92:95]
v_mfma_f32_16x16x32_bf16 v[76:79], a[0:3], a[44:47], v[76:79]
v_mfma_f32_16x16x32_bf16 v[72:75], a[0:3], a[40:43], v[72:75]
s_waitcnt vmcnt(8) lgkmcnt(0)
v_mfma_f32_16x16x32_bf16 v[0:3], a[16:19], a[48:51], v[0:3]
ds_read_b64_tr_b16 a[0:1], v160 offset:4096
v_mfma_f32_16x16x32_bf16 v[4:7], a[16:19], a[52:55], v[4:7]
ds_read_b64_tr_b16 a[2:3], v160 offset:6144
v_mfma_f32_16x16x32_bf16 v[20:23], a[20:23], a[52:55], v[20:23]
ds_read_b64_tr_b16 a[4:5], v161 offset:4096
v_mfma_f32_16x16x32_bf16 v[16:19], a[20:23], a[48:51], v[16:19]
ds_read_b64_tr_b16 a[6:7], v161 offset:6144
v_mfma_f32_16x16x32_bf16 v[32:35], a[24:27], a[48:51], v[32:35]
ds_read_b64_tr_b16 a[8:9], v162 offset:4096
v_mfma_f32_16x16x32_bf16 v[36:39], a[24:27], a[52:55], v[36:39]
ds_read_b64_tr_b16 a[10:11], v162 offset:6144
v_mfma_f32_16x16x32_bf16 v[52:55], a[28:31], a[52:55], v[52:55]
ds_read_b64_tr_b16 a[12:13], v163 offset:4096
v_mfma_f32_16x16x32_bf16 v[48:51], a[28:31], a[48:51], v[48:51]
ds_read_b64_tr_b16 a[14:15], v163 offset:6144
v_mfma_f32_16x16x32_bf16 v[56:59], a[28:31], a[56:59], v[56:59]
s_add_u32 m0, s66, 8192
s_add_u32 s64, s41, 487424
buffer_load_dwordx4 v156, s[20:23], s64 offen offset:0 lds
v_mfma_f32_16x16x32_bf16 v[60:63], a[28:31], a[60:63], v[60:63]
buffer_load_dwordx4 v157, s[20:23], s64 offen offset:1024 lds
v_mfma_f32_16x16x32_bf16 v[44:47], a[24:27], a[60:63], v[44:47]
buffer_load_dwordx4 v158, s[20:23], s64 offen offset:2048 lds
v_mfma_f32_16x16x32_bf16 v[40:43], a[24:27], a[56:59], v[40:43]
buffer_load_dwordx4 v159, s[20:23], s64 offen offset:3072 lds
v_mfma_f32_16x16x32_bf16 v[24:27], a[20:23], a[56:59], v[24:27]
s_add_u32 m0, s66, 12288
s_add_u32 s64, s41, 487552
buffer_load_dwordx4 v156, s[20:23], s64 offen offset:0 lds
v_mfma_f32_16x16x32_bf16 v[28:31], a[20:23], a[60:63], v[28:31]
buffer_load_dwordx4 v157, s[20:23], s64 offen offset:1024 lds
v_mfma_f32_16x16x32_bf16 v[12:15], a[16:19], a[60:63], v[12:15]
buffer_load_dwordx4 v158, s[20:23], s64 offen offset:2048 lds
v_mfma_f32_16x16x32_bf16 v[8:11], a[16:19], a[56:59], v[8:11]
buffer_load_dwordx4 v159, s[20:23], s64 offen offset:3072 lds
s_waitcnt lgkmcnt(0)
v_mfma_f32_16x16x32_bf16 v[64:67], a[0:3], a[48:51], v[64:67]
ds_read_b128 a[64:67], v128 offset:4096
v_mfma_f32_16x16x32_bf16 v[68:71], a[0:3], a[52:55], v[68:71]
ds_read_b128 a[68:71], v129 offset:4096
v_mfma_f32_16x16x32_bf16 v[84:87], a[4:7], a[52:55], v[84:87]
ds_read_b128 a[72:75], v130 offset:4096
v_mfma_f32_16x16x32_bf16 v[80:83], a[4:7], a[48:51], v[80:83]
ds_read_b128 a[76:79], v131 offset:4096
v_mfma_f32_16x16x32_bf16 v[96:99], a[8:11], a[48:51], v[96:99]
ds_read_b128 a[32:35], v128 offset:8192
v_mfma_f32_16x16x32_bf16 v[100:103], a[8:11], a[52:55], v[100:103]
ds_read_b128 a[36:39], v129 offset:8192
v_mfma_f32_16x16x32_bf16 v[116:119], a[12:15], a[52:55], v[116:119]
ds_read_b128 a[40:43], v130 offset:8192
v_mfma_f32_16x16x32_bf16 v[112:115], a[12:15], a[48:51], v[112:115]
ds_read_b128 a[44:47], v131 offset:8192
v_mfma_f32_16x16x32_bf16 v[120:123], a[12:15], a[56:59], v[120:123]
s_add_u32 m0, s66, 0
s_add_u32 s64, s41, 688128
buffer_load_dwordx4 v156, s[20:23], s64 offen offset:0 lds
v_mfma_f32_16x16x32_bf16 v[124:127], a[12:15], a[60:63], v[124:127]
buffer_load_dwordx4 v157, s[20:23], s64 offen offset:1024 lds
v_mfma_f32_16x16x32_bf16 v[108:111], a[8:11], a[60:63], v[108:111]
buffer_load_dwordx4 v158, s[20:23], s64 offen offset:2048 lds
v_mfma_f32_16x16x32_bf16 v[104:107], a[8:11], a[56:59], v[104:107]
buffer_load_dwordx4 v159, s[20:23], s64 offen offset:3072 lds
v_mfma_f32_16x16x32_bf16 v[88:91], a[4:7], a[56:59], v[88:91]
v_mfma_f32_16x16x32_bf16 v[92:95], a[4:7], a[60:63], v[92:95]
v_mfma_f32_16x16x32_bf16 v[76:79], a[0:3], a[60:63], v[76:79]
v_mfma_f32_16x16x32_bf16 v[72:75], a[0:3], a[56:59], v[72:75]
ds_read_b128 a[48:51], v128 offset:12288
ds_read_b128 a[52:55], v129 offset:12288
ds_read_b128 a[56:59], v130 offset:12288
ds_read_b128 a[60:63], v131 offset:12288
s_add_u32 m0, s66, 4096
s_add_u32 s64, s41, 688256
buffer_load_dwordx4 v156, s[20:23], s64 offen offset:0 lds
buffer_load_dwordx4 v157, s[20:23], s64 offen offset:1024 lds
buffer_load_dwordx4 v158, s[20:23], s64 offen offset:2048 lds
buffer_load_dwordx4 v159, s[20:23], s64 offen offset:3072 lds
s_waitcnt lgkmcnt(0)
s_waitcnt vmcnt(12)
ds_read_b64_tr_b16 a[0:1], v160 offset:8192
ds_read_b64_tr_b16 a[2:3], v160 offset:10240
ds_read_b64_tr_b16 a[4:5], v161 offset:8192
ds_read_b64_tr_b16 a[6:7], v161 offset:10240
ds_read_b64_tr_b16 a[8:9], v162 offset:8192
ds_read_b64_tr_b16 a[10:11], v162 offset:10240
ds_read_b64_tr_b16 a[12:13], v163 offset:8192
ds_read_b64_tr_b16 a[14:15], v163 offset:10240
s_barrier
s_setprio 3
s_setprio 1
s_waitcnt vmcnt(8) lgkmcnt(0)
v_mfma_f32_16x16x32_bf16 v[0:3], a[0:3], a[64:67], v[0:3]
ds_read_b64_tr_b16 a[16:17], v160 offset:12288
v_mfma_f32_16x16x32_bf16 v[4:7], a[0:3], a[68:71], v[4:7]
ds_read_b64_tr_b16 a[18:19], v160 offset:14336
v_mfma_f32_16x16x32_bf16 v[20:23], a[4:7], a[68:71], v[20:23]
ds_read_b64_tr_b16 a[20:21], v161 offset:12288
v_mfma_f32_16x16x32_bf16 v[16:19], a[4:7], a[64:67], v[16:19]
ds_read_b64_tr_b16 a[22:23], v161 offset:14336
v_mfma_f32_16x16x32_bf16 v[32:35], a[8:11], a[64:67], v[32:35]
ds_read_b64_tr_b16 a[24:25], v162 offset:12288
v_mfma_f32_16x16x32_bf16 v[36:39], a[8:11], a[68:71], v[36:39]
ds_read_b64_tr_b16 a[26:27], v162 offset:14336
v_mfma_f32_16x16x32_bf16 v[52:55], a[12:15], a[68:71], v[52:55]
ds_read_b64_tr_b16 a[28:29], v163 offset:12288
v_mfma_f32_16x16x32_bf16 v[48:51], a[12:15], a[64:67], v[48:51]
ds_read_b64_tr_b16 a[30:31], v163 offset:14336
v_mfma_f32_16x16x32_bf16 v[56:59], a[12:15], a[72:75], v[56:59]
s_add_u32 m0, s77, 33792
s_add_u32 s64, s39, 393216
buffer_load_dwordx4 v168, s[12:15], s64 offen nt lds
v_mfma_f32_16x16x32_bf16 v[60:63], a[12:15], a[76:79], v[60:63]
s_add_u32 m0, s77, 34816
s_add_u32 s64, s39, 409600
buffer_load_dwordx4 v168, s[12:15], s64 offen nt lds
v_mfma_f32_16x16x32_bf16 v[44:47], a[8:11], a[76:79], v[44:47]
s_add_u32 m0, s77, 35840
s_add_u32 s64, s39, 425984
buffer_load_dwordx4 v168, s[12:15], s64 offen nt lds
v_mfma_f32_16x16x32_bf16 v[40:43], a[8:11], a[72:75], v[40:43]
s_add_u32 m0, s77, 36864
s_add_u32 s64, s39, 442368
buffer_load_dwordx4 v168, s[12:15], s64 offen nt lds
v_mfma_f32_16x16x32_bf16 v[24:27], a[4:7], a[72:75], v[24:27]
v_mfma_f32_16x16x32_bf16 v[28:31], a[4:7], a[76:79], v[28:31]
v_mfma_f32_16x16x32_bf16 v[12:15], a[0:3], a[76:79], v[12:15]
v_mfma_f32_16x16x32_bf16 v[8:11], a[0:3], a[72:75], v[8:11]
s_waitcnt vmcnt(8) lgkmcnt(0)
v_mfma_f32_16x16x32_bf16 v[64:67], a[16:19], a[64:67], v[64:67]
ds_read_b64_tr_b16 a[0:1], v160 offset:0
v_mfma_f32_16x16x32_bf16 v[68:71], a[16:19], a[68:71], v[68:71]
ds_read_b64_tr_b16 a[2:3], v160 offset:2048
v_mfma_f32_16x16x32_bf16 v[84:87], a[20:23], a[68:71], v[84:87]
ds_read_b64_tr_b16 a[4:5], v161 offset:0
v_mfma_f32_16x16x32_bf16 v[80:83], a[20:23], a[64:67], v[80:83]
ds_read_b64_tr_b16 a[6:7], v161 offset:2048
v_mfma_f32_16x16x32_bf16 v[96:99], a[24:27], a[64:67], v[96:99]
ds_read_b64_tr_b16 a[8:9], v162 offset:0
v_mfma_f32_16x16x32_bf16 v[100:103], a[24:27], a[68:71], v[100:103]
ds_read_b64_tr_b16 a[10:11], v162 offset:2048
v_mfma_f32_16x16x32_bf16 v[116:119], a[28:31], a[68:71], v[116:119]
ds_read_b64_tr_b16 a[12:13], v163 offset:0
v_mfma_f32_16x16x32_bf16 v[112:115], a[28:31], a[64:67], v[112:115]
ds_read_b64_tr_b16 a[14:15], v163 offset:2048
v_mfma_f32_16x16x32_bf16 v[120:123], a[28:31], a[72:75], v[120:123]
s_add_u32 m0, s77, 37888
s_add_u32 s64, s39, 458752
buffer_load_dwordx4 v168, s[12:15], s64 offen nt lds
v_mfma_f32_16x16x32_bf16 v[124:127], a[28:31], a[76:79], v[124:127]
s_add_u32 m0, s77, 38912
s_add_u32 s64, s39, 475136
buffer_load_dwordx4 v168, s[12:15], s64 offen nt lds
v_mfma_f32_16x16x32_bf16 v[108:111], a[24:27], a[76:79], v[108:111]
s_add_u32 m0, s77, 39936
s_add_u32 s64, s39, 491520
buffer_load_dwordx4 v168, s[12:15], s64 offen nt lds
v_mfma_f32_16x16x32_bf16 v[104:107], a[24:27], a[72:75], v[104:107]
s_add_u32 m0, s77, 40960
s_add_u32 s64, s39, 507904
buffer_load_dwordx4 v168, s[12:15], s64 offen nt lds
v_mfma_f32_16x16x32_bf16 v[88:91], a[20:23], a[72:75], v[88:91]
s_add_u32 m0, s66, 8192
s_add_u32 s64, s41, 716800
buffer_load_dwordx4 v156, s[20:23], s64 offen offset:0 lds
v_mfma_f32_16x16x32_bf16 v[92:95], a[20:23], a[76:79], v[92:95]
buffer_load_dwordx4 v157, s[20:23], s64 offen offset:1024 lds
v_mfma_f32_16x16x32_bf16 v[76:79], a[16:19], a[76:79], v[76:79]
buffer_load_dwordx4 v158, s[20:23], s64 offen offset:2048 lds
v_mfma_f32_16x16x32_bf16 v[72:75], a[16:19], a[72:75], v[72:75]
buffer_load_dwordx4 v159, s[20:23], s64 offen offset:3072 lds
s_waitcnt vmcnt(12) lgkmcnt(0)
v_mfma_f32_16x16x32_bf16 v[0:3], a[0:3], a[32:35], v[0:3]
ds_read_b64_tr_b16 a[16:17], v160 offset:4096
v_mfma_f32_16x16x32_bf16 v[4:7], a[0:3], a[36:39], v[4:7]
ds_read_b64_tr_b16 a[18:19], v160 offset:6144
v_mfma_f32_16x16x32_bf16 v[20:23], a[4:7], a[36:39], v[20:23]
ds_read_b64_tr_b16 a[20:21], v161 offset:4096
v_mfma_f32_16x16x32_bf16 v[16:19], a[4:7], a[32:35], v[16:19]
ds_read_b64_tr_b16 a[22:23], v161 offset:6144
v_mfma_f32_16x16x32_bf16 v[32:35], a[8:11], a[32:35], v[32:35]
ds_read_b64_tr_b16 a[24:25], v162 offset:4096
v_mfma_f32_16x16x32_bf16 v[36:39], a[8:11], a[36:39], v[36:39]
ds_read_b64_tr_b16 a[26:27], v162 offset:6144
v_mfma_f32_16x16x32_bf16 v[52:55], a[12:15], a[36:39], v[52:55]
ds_read_b64_tr_b16 a[28:29], v163 offset:4096
v_mfma_f32_16x16x32_bf16 v[48:51], a[12:15], a[32:35], v[48:51]
ds_read_b64_tr_b16 a[30:31], v163 offset:6144
v_mfma_f32_16x16x32_bf16 v[56:59], a[12:15], a[40:43], v[56:59]
s_add_u32 m0, s66, 12288
s_add_u32 s64, s41, 716928
buffer_load_dwordx4 v156, s[20:23], s64 offen offset:0 lds
v_mfma_f32_16x16x32_bf16 v[60:63], a[12:15], a[44:47], v[60:63]
buffer_load_dwordx4 v157, s[20:23], s64 offen offset:1024 lds
v_mfma_f32_16x16x32_bf16 v[44:47], a[8:11], a[44:47], v[44:47]
buffer_load_dwordx4 v158, s[20:23], s64 offen offset:2048 lds
v_mfma_f32_16x16x32_bf16 v[40:43], a[8:11], a[40:43], v[40:43]
buffer_load_dwordx4 v159, s[20:23], s64 offen offset:3072 lds
v_mfma_f32_16x16x32_bf16 v[24:27], a[4:7], a[40:43], v[24:27]
v_mfma_f32_16x16x32_bf16 v[28:31], a[4:7], a[44:47], v[28:31]
v_mfma_f32_16x16x32_bf16 v[12:15], a[0:3], a[44:47], v[12:15]
v_mfma_f32_16x16x32_bf16 v[8:11], a[0:3], a[40:43], v[8:11]
s_waitcnt lgkmcnt(0)
v_mfma_f32_16x16x32_bf16 v[64:67], a[16:19], a[32:35], v[64:67]
s_add_u32 m0, s66, 0
s_add_u32 s64, s42, 458752
buffer_load_dwordx4 v156, s[20:23], s64 offen offset:0 lds
v_mfma_f32_16x16x32_bf16 v[68:71], a[16:19], a[36:39], v[68:71]
buffer_load_dwordx4 v157, s[20:23], s64 offen offset:1024 lds
v_mfma_f32_16x16x32_bf16 v[84:87], a[20:23], a[36:39], v[84:87]
buffer_load_dwordx4 v158, s[20:23], s64 offen offset:2048 lds
v_mfma_f32_16x16x32_bf16 v[80:83], a[20:23], a[32:35], v[80:83]
buffer_load_dwordx4 v159, s[20:23], s64 offen offset:3072 lds
v_mfma_f32_16x16x32_bf16 v[96:99], a[24:27], a[32:35], v[96:99]
v_mfma_f32_16x16x32_bf16 v[100:103], a[24:27], a[36:39], v[100:103]
v_mfma_f32_16x16x32_bf16 v[116:119], a[28:31], a[36:39], v[116:119]
v_mfma_f32_16x16x32_bf16 v[112:115], a[28:31], a[32:35], v[112:115]
v_mfma_f32_16x16x32_bf16 v[120:123], a[28:31], a[40:43], v[120:123]
v_mfma_f32_16x16x32_bf16 v[124:127], a[28:31], a[44:47], v[124:127]
v_mfma_f32_16x16x32_bf16 v[108:111], a[24:27], a[44:47], v[108:111]
v_mfma_f32_16x16x32_bf16 v[104:107], a[24:27], a[40:43], v[104:107]
v_mfma_f32_16x16x32_bf16 v[88:91], a[20:23], a[40:43], v[88:91]
v_mfma_f32_16x16x32_bf16 v[92:95], a[20:23], a[44:47], v[92:95]
v_mfma_f32_16x16x32_bf16 v[76:79], a[16:19], a[44:47], v[76:79]
v_mfma_f32_16x16x32_bf16 v[72:75], a[16:19], a[40:43], v[72:75]
s_add_u32 m0, s66, 4096
s_add_u32 s64, s42, 458880
buffer_load_dwordx4 v156, s[20:23], s64 offen offset:0 lds
buffer_load_dwordx4 v157, s[20:23], s64 offen offset:1024 lds
buffer_load_dwordx4 v158, s[20:23], s64 offen offset:2048 lds
buffer_load_dwordx4 v159, s[20:23], s64 offen offset:3072 lds
s_waitcnt vmcnt(16)
s_barrier
s_setprio 3
s_waitcnt vmcnt(12)
ds_read_b64_tr_b16 a[0:1], v160 offset:8192
ds_read_b64_tr_b16 a[2:3], v160 offset:10240
ds_read_b64_tr_b16 a[4:5], v161 offset:8192
ds_read_b64_tr_b16 a[6:7], v161 offset:10240
ds_read_b64_tr_b16 a[8:9], v162 offset:8192
ds_read_b64_tr_b16 a[10:11], v162 offset:10240
ds_read_b64_tr_b16 a[12:13], v163 offset:8192
ds_read_b64_tr_b16 a[14:15], v163 offset:10240
s_setprio 1
s_waitcnt vmcnt(8) lgkmcnt(0)
v_mfma_f32_16x16x32_bf16 v[0:3], a[0:3], a[48:51], v[0:3]
ds_read_b64_tr_b16 a[16:17], v160 offset:12288
v_mfma_f32_16x16x32_bf16 v[4:7], a[0:3], a[52:55], v[4:7]
ds_read_b64_tr_b16 a[18:19], v160 offset:14336
v_mfma_f32_16x16x32_bf16 v[20:23], a[4:7], a[52:55], v[20:23]
ds_read_b64_tr_b16 a[20:21], v161 offset:12288
v_mfma_f32_16x16x32_bf16 v[16:19], a[4:7], a[48:51], v[16:19]
ds_read_b64_tr_b16 a[22:23], v161 offset:14336
v_mfma_f32_16x16x32_bf16 v[32:35], a[8:11], a[48:51], v[32:35]
ds_read_b64_tr_b16 a[24:25], v162 offset:12288
v_mfma_f32_16x16x32_bf16 v[36:39], a[8:11], a[52:55], v[36:39]
ds_read_b64_tr_b16 a[26:27], v162 offset:14336
v_mfma_f32_16x16x32_bf16 v[52:55], a[12:15], a[52:55], v[52:55]
ds_read_b64_tr_b16 a[28:29], v163 offset:12288
v_mfma_f32_16x16x32_bf16 v[48:51], a[12:15], a[48:51], v[48:51]
ds_read_b64_tr_b16 a[30:31], v163 offset:14336
v_mfma_f32_16x16x32_bf16 v[56:59], a[12:15], a[56:59], v[56:59]
v_mfma_f32_16x16x32_bf16 v[60:63], a[12:15], a[60:63], v[60:63]
v_mfma_f32_16x16x32_bf16 v[44:47], a[8:11], a[60:63], v[44:47]
v_mfma_f32_16x16x32_bf16 v[40:43], a[8:11], a[56:59], v[40:43]
v_mfma_f32_16x16x32_bf16 v[24:27], a[4:7], a[56:59], v[24:27]
v_mfma_f32_16x16x32_bf16 v[28:31], a[4:7], a[60:63], v[28:31]
v_mfma_f32_16x16x32_bf16 v[12:15], a[0:3], a[60:63], v[12:15]
v_mfma_f32_16x16x32_bf16 v[8:11], a[0:3], a[56:59], v[8:11]
s_waitcnt vmcnt(4) lgkmcnt(0)
v_mfma_f32_16x16x32_bf16 v[64:67], a[16:19], a[48:51], v[64:67]
ds_read_b128 a[64:67], v128 offset:0
v_mfma_f32_16x16x32_bf16 v[68:71], a[16:19], a[52:55], v[68:71]
ds_read_b128 a[68:71], v129 offset:0
v_mfma_f32_16x16x32_bf16 v[84:87], a[20:23], a[52:55], v[84:87]
ds_read_b128 a[72:75], v130 offset:0
v_mfma_f32_16x16x32_bf16 v[80:83], a[20:23], a[48:51], v[80:83]
ds_read_b128 a[76:79], v131 offset:0
v_mfma_f32_16x16x32_bf16 v[96:99], a[24:27], a[48:51], v[96:99]
ds_read_b64_tr_b16 a[0:1], v160 offset:0
v_mfma_f32_16x16x32_bf16 v[100:103], a[24:27], a[52:55], v[100:103]
ds_read_b64_tr_b16 a[2:3], v160 offset:2048
v_mfma_f32_16x16x32_bf16 v[116:119], a[28:31], a[52:55], v[116:119]
ds_read_b64_tr_b16 a[4:5], v161 offset:0
v_mfma_f32_16x16x32_bf16 v[112:115], a[28:31], a[48:51], v[112:115]
ds_read_b64_tr_b16 a[6:7], v161 offset:2048
v_mfma_f32_16x16x32_bf16 v[120:123], a[28:31], a[56:59], v[120:123]
ds_read_b64_tr_b16 a[8:9], v162 offset:0
v_mfma_f32_16x16x32_bf16 v[124:127], a[28:31], a[60:63], v[124:127]
ds_read_b64_tr_b16 a[10:11], v162 offset:2048
v_mfma_f32_16x16x32_bf16 v[108:111], a[24:27], a[60:63], v[108:111]
ds_read_b64_tr_b16 a[12:13], v163 offset:0
v_mfma_f32_16x16x32_bf16 v[104:107], a[24:27], a[56:59], v[104:107]
ds_read_b64_tr_b16 a[14:15], v163 offset:2048
v_mfma_f32_16x16x32_bf16 v[88:91], a[20:23], a[56:59], v[88:91]
s_add_u32 m0, s66, 8192
s_add_u32 s64, s42, 487424
buffer_load_dwordx4 v156, s[20:23], s64 offen offset:0 lds
v_mfma_f32_16x16x32_bf16 v[92:95], a[20:23], a[60:63], v[92:95]
buffer_load_dwordx4 v157, s[20:23], s64 offen offset:1024 lds
v_mfma_f32_16x16x32_bf16 v[76:79], a[16:19], a[60:63], v[76:79]
buffer_load_dwordx4 v158, s[20:23], s64 offen offset:2048 lds
v_mfma_f32_16x16x32_bf16 v[72:75], a[16:19], a[56:59], v[72:75]
buffer_load_dwordx4 v159, s[20:23], s64 offen offset:3072 lds
s_waitcnt vmcnt(4) lgkmcnt(0)
v_mfma_f32_16x16x32_bf16 v[0:3], a[0:3], a[64:67], v[0:3]
ds_read_b64_tr_b16 a[16:17], v160 offset:4096
v_mfma_f32_16x16x32_bf16 v[4:7], a[0:3], a[68:71], v[4:7]
ds_read_b64_tr_b16 a[18:19], v160 offset:6144
v_mfma_f32_16x16x32_bf16 v[20:23], a[4:7], a[68:71], v[20:23]
ds_read_b64_tr_b16 a[20:21], v161 offset:4096
v_mfma_f32_16x16x32_bf16 v[16:19], a[4:7], a[64:67], v[16:19]
ds_read_b64_tr_b16 a[22:23], v161 offset:6144
v_mfma_f32_16x16x32_bf16 v[32:35], a[8:11], a[64:67], v[32:35]
ds_read_b64_tr_b16 a[24:25], v162 offset:4096
v_mfma_f32_16x16x32_bf16 v[36:39], a[8:11], a[68:71], v[36:39]
ds_read_b64_tr_b16 a[26:27], v162 offset:6144
v_mfma_f32_16x16x32_bf16 v[52:55], a[12:15], a[68:71], v[52:55]
ds_read_b64_tr_b16 a[28:29], v163 offset:4096
v_mfma_f32_16x16x32_bf16 v[48:51], a[12:15], a[64:67], v[48:51]
ds_read_b64_tr_b16 a[30:31], v163 offset:6144
v_mfma_f32_16x16x32_bf16 v[56:59], a[12:15], a[72:75], v[56:59]
s_add_u32 m0, s66, 12288
s_add_u32 s64, s42, 487552
buffer_load_dwordx4 v156, s[20:23], s64 offen offset:0 lds
v_mfma_f32_16x16x32_bf16 v[60:63], a[12:15], a[76:79], v[60:63]
buffer_load_dwordx4 v157, s[20:23], s64 offen offset:1024 lds
v_mfma_f32_16x16x32_bf16 v[44:47], a[8:11], a[76:79], v[44:47]
buffer_load_dwordx4 v158, s[20:23], s64 offen offset:2048 lds
v_mfma_f32_16x16x32_bf16 v[40:43], a[8:11], a[72:75], v[40:43]
buffer_load_dwordx4 v159, s[20:23], s64 offen offset:3072 lds
v_mfma_f32_16x16x32_bf16 v[24:27], a[4:7], a[72:75], v[24:27]
v_mfma_f32_16x16x32_bf16 v[28:31], a[4:7], a[76:79], v[28:31]
v_mfma_f32_16x16x32_bf16 v[12:15], a[0:3], a[76:79], v[12:15]
v_mfma_f32_16x16x32_bf16 v[8:11], a[0:3], a[72:75], v[8:11]
s_waitcnt lgkmcnt(0)
v_mfma_f32_16x16x32_bf16 v[64:67], a[16:19], a[64:67], v[64:67]
ds_read_b128 a[32:35], v128 offset:4096
v_mfma_f32_16x16x32_bf16 v[68:71], a[16:19], a[68:71], v[68:71]
ds_read_b128 a[36:39], v129 offset:4096
v_mfma_f32_16x16x32_bf16 v[84:87], a[20:23], a[68:71], v[84:87]
ds_read_b128 a[40:43], v130 offset:4096
v_mfma_f32_16x16x32_bf16 v[80:83], a[20:23], a[64:67], v[80:83]
ds_read_b128 a[44:47], v131 offset:4096
v_mfma_f32_16x16x32_bf16 v[96:99], a[24:27], a[64:67], v[96:99]
ds_read_b128 a[48:51], v128 offset:8192
v_mfma_f32_16x16x32_bf16 v[100:103], a[24:27], a[68:71], v[100:103]
ds_read_b128 a[52:55], v129 offset:8192
v_mfma_f32_16x16x32_bf16 v[116:119], a[28:31], a[68:71], v[116:119]
ds_read_b128 a[56:59], v130 offset:8192
v_mfma_f32_16x16x32_bf16 v[112:115], a[28:31], a[64:67], v[112:115]
ds_read_b128 a[60:63], v131 offset:8192
v_mfma_f32_16x16x32_bf16 v[120:123], a[28:31], a[72:75], v[120:123]
s_add_u32 m0, s66, 0
s_add_u32 s64, s42, 688128
buffer_load_dwordx4 v156, s[20:23], s64 offen offset:0 lds
v_mfma_f32_16x16x32_bf16 v[124:127], a[28:31], a[76:79], v[124:127]
buffer_load_dwordx4 v157, s[20:23], s64 offen offset:1024 lds
v_mfma_f32_16x16x32_bf16 v[108:111], a[24:27], a[76:79], v[108:111]
buffer_load_dwordx4 v158, s[20:23], s64 offen offset:2048 lds
v_mfma_f32_16x16x32_bf16 v[104:107], a[24:27], a[72:75], v[104:107]
buffer_load_dwordx4 v159, s[20:23], s64 offen offset:3072 lds
v_mfma_f32_16x16x32_bf16 v[88:91], a[20:23], a[72:75], v[88:91]
v_mfma_f32_16x16x32_bf16 v[92:95], a[20:23], a[76:79], v[92:95]
v_mfma_f32_16x16x32_bf16 v[76:79], a[16:19], a[76:79], v[76:79]
v_mfma_f32_16x16x32_bf16 v[72:75], a[16:19], a[72:75], v[72:75]
ds_read_b128 a[64:67], v128 offset:12288
ds_read_b128 a[68:71], v129 offset:12288
ds_read_b128 a[72:75], v130 offset:12288
ds_read_b128 a[76:79], v131 offset:12288
s_add_u32 m0, s66, 4096
s_add_u32 s64, s42, 688256
buffer_load_dwordx4 v156, s[20:23], s64 offen offset:0 lds
buffer_load_dwordx4 v157, s[20:23], s64 offen offset:1024 lds
buffer_load_dwordx4 v158, s[20:23], s64 offen offset:2048 lds
buffer_load_dwordx4 v159, s[20:23], s64 offen offset:3072 lds
s_waitcnt lgkmcnt(0)
s_waitcnt vmcnt(12)
ds_read_b64_tr_b16 a[0:1], v160 offset:8192
ds_read_b64_tr_b16 a[2:3], v160 offset:10240
ds_read_b64_tr_b16 a[4:5], v161 offset:8192
ds_read_b64_tr_b16 a[6:7], v161 offset:10240
ds_read_b64_tr_b16 a[8:9], v162 offset:8192
ds_read_b64_tr_b16 a[10:11], v162 offset:10240
ds_read_b64_tr_b16 a[12:13], v163 offset:8192
ds_read_b64_tr_b16 a[14:15], v163 offset:10240
s_barrier
s_setprio 3
s_setprio 1
s_waitcnt vmcnt(8) lgkmcnt(0)
v_mfma_f32_16x16x32_bf16 v[0:3], a[0:3], a[32:35], v[0:3]
ds_read_b64_tr_b16 a[16:17], v160 offset:12288
v_mfma_f32_16x16x32_bf16 v[4:7], a[0:3], a[36:39], v[4:7]
ds_read_b64_tr_b16 a[18:19], v160 offset:14336
v_mfma_f32_16x16x32_bf16 v[20:23], a[4:7], a[36:39], v[20:23]
ds_read_b64_tr_b16 a[20:21], v161 offset:12288
v_mfma_f32_16x16x32_bf16 v[16:19], a[4:7], a[32:35], v[16:19]
ds_read_b64_tr_b16 a[22:23], v161 offset:14336
v_mfma_f32_16x16x32_bf16 v[32:35], a[8:11], a[32:35], v[32:35]
ds_read_b64_tr_b16 a[24:25], v162 offset:12288
v_mfma_f32_16x16x32_bf16 v[36:39], a[8:11], a[36:39], v[36:39]
ds_read_b64_tr_b16 a[26:27], v162 offset:14336
v_mfma_f32_16x16x32_bf16 v[52:55], a[12:15], a[36:39], v[52:55]
ds_read_b64_tr_b16 a[28:29], v163 offset:12288
v_mfma_f32_16x16x32_bf16 v[48:51], a[12:15], a[32:35], v[48:51]
ds_read_b64_tr_b16 a[30:31], v163 offset:14336
v_mfma_f32_16x16x32_bf16 v[56:59], a[12:15], a[40:43], v[56:59]
s_add_u32 m0, s66, 8192
s_add_u32 s64, s42, 716800
buffer_load_dwordx4 v156, s[20:23], s64 offen offset:0 lds
v_mfma_f32_16x16x32_bf16 v[60:63], a[12:15], a[44:47], v[60:63]
buffer_load_dwordx4 v157, s[20:23], s64 offen offset:1024 lds
v_mfma_f32_16x16x32_bf16 v[44:47], a[8:11], a[44:47], v[44:47]
buffer_load_dwordx4 v158, s[20:23], s64 offen offset:2048 lds
v_mfma_f32_16x16x32_bf16 v[40:43], a[8:11], a[40:43], v[40:43]
buffer_load_dwordx4 v159, s[20:23], s64 offen offset:3072 lds
v_mfma_f32_16x16x32_bf16 v[24:27], a[4:7], a[40:43], v[24:27]
v_mfma_f32_16x16x32_bf16 v[28:31], a[4:7], a[44:47], v[28:31]
v_mfma_f32_16x16x32_bf16 v[12:15], a[0:3], a[44:47], v[12:15]
v_mfma_f32_16x16x32_bf16 v[8:11], a[0:3], a[40:43], v[8:11]
s_waitcnt vmcnt(8) lgkmcnt(0)
v_mfma_f32_16x16x32_bf16 v[64:67], a[16:19], a[32:35], v[64:67]
ds_read_b64_tr_b16 a[0:1], v160 offset:0
v_mfma_f32_16x16x32_bf16 v[68:71], a[16:19], a[36:39], v[68:71]
ds_read_b64_tr_b16 a[2:3], v160 offset:2048
v_mfma_f32_16x16x32_bf16 v[84:87], a[20:23], a[36:39], v[84:87]
ds_read_b64_tr_b16 a[4:5], v161 offset:0
v_mfma_f32_16x16x32_bf16 v[80:83], a[20:23], a[32:35], v[80:83]
ds_read_b64_tr_b16 a[6:7], v161 offset:2048
v_mfma_f32_16x16x32_bf16 v[96:99], a[24:27], a[32:35], v[96:99]
ds_read_b64_tr_b16 a[8:9], v162 offset:0
v_mfma_f32_16x16x32_bf16 v[100:103], a[24:27], a[36:39], v[100:103]
ds_read_b64_tr_b16 a[10:11], v162 offset:2048
v_mfma_f32_16x16x32_bf16 v[116:119], a[28:31], a[36:39], v[116:119]
ds_read_b64_tr_b16 a[12:13], v163 offset:0
v_mfma_f32_16x16x32_bf16 v[112:115], a[28:31], a[32:35], v[112:115]
ds_read_b64_tr_b16 a[14:15], v163 offset:2048
v_mfma_f32_16x16x32_bf16 v[120:123], a[28:31], a[40:43], v[120:123]
s_add_u32 m0, s66, 12288
s_add_u32 s64, s42, 716928
buffer_load_dwordx4 v156, s[20:23], s64 offen offset:0 lds
v_mfma_f32_16x16x32_bf16 v[124:127], a[28:31], a[44:47], v[124:127]
buffer_load_dwordx4 v157, s[20:23], s64 offen offset:1024 lds
v_mfma_f32_16x16x32_bf16 v[108:111], a[24:27], a[44:47], v[108:111]
buffer_load_dwordx4 v158, s[20:23], s64 offen offset:2048 lds
v_mfma_f32_16x16x32_bf16 v[104:107], a[24:27], a[40:43], v[104:107]
buffer_load_dwordx4 v159, s[20:23], s64 offen offset:3072 lds
v_mfma_f32_16x16x32_bf16 v[88:91], a[20:23], a[40:43], v[88:91]
v_mfma_f32_16x16x32_bf16 v[92:95], a[20:23], a[44:47], v[92:95]
v_mfma_f32_16x16x32_bf16 v[76:79], a[16:19], a[44:47], v[76:79]
v_mfma_f32_16x16x32_bf16 v[72:75], a[16:19], a[40:43], v[72:75]
s_waitcnt vmcnt(8) lgkmcnt(0)
v_mfma_f32_16x16x32_bf16 v[0:3], a[0:3], a[48:51], v[0:3]
ds_read_b64_tr_b16 a[16:17], v160 offset:4096
v_mfma_f32_16x16x32_bf16 v[4:7], a[0:3], a[52:55], v[4:7]
ds_read_b64_tr_b16 a[18:19], v160 offset:6144
v_mfma_f32_16x16x32_bf16 v[20:23], a[4:7], a[52:55], v[20:23]
ds_read_b64_tr_b16 a[20:21], v161 offset:4096
v_mfma_f32_16x16x32_bf16 v[16:19], a[4:7], a[48:51], v[16:19]
ds_read_b64_tr_b16 a[22:23], v161 offset:6144
v_mfma_f32_16x16x32_bf16 v[32:35], a[8:11], a[48:51], v[32:35]
ds_read_b64_tr_b16 a[24:25], v162 offset:4096
v_mfma_f32_16x16x32_bf16 v[36:39], a[8:11], a[52:55], v[36:39]
ds_read_b64_tr_b16 a[26:27], v162 offset:6144
v_mfma_f32_16x16x32_bf16 v[52:55], a[12:15], a[52:55], v[52:55]
ds_read_b64_tr_b16 a[28:29], v163 offset:4096
v_mfma_f32_16x16x32_bf16 v[48:51], a[12:15], a[48:51], v[48:51]
ds_read_b64_tr_b16 a[30:31], v163 offset:6144
v_mfma_f32_16x16x32_bf16 v[56:59], a[12:15], a[56:59], v[56:59]
s_add_u32 m0, s66, 0
s_add_u32 s64, s43, 458752
buffer_load_dwordx4 v156, s[20:23], s64 offen offset:0 lds
v_mfma_f32_16x16x32_bf16 v[60:63], a[12:15], a[60:63], v[60:63]
buffer_load_dwordx4 v157, s[20:23], s64 offen offset:1024 lds
v_mfma_f32_16x16x32_bf16 v[44:47], a[8:11], a[60:63], v[44:47]
buffer_load_dwordx4 v158, s[20:23], s64 offen offset:2048 lds
v_mfma_f32_16x16x32_bf16 v[40:43], a[8:11], a[56:59], v[40:43]
buffer_load_dwordx4 v159, s[20:23], s64 offen offset:3072 lds
v_mfma_f32_16x16x32_bf16 v[24:27], a[4:7], a[56:59], v[24:27]
v_mfma_f32_16x16x32_bf16 v[28:31], a[4:7], a[60:63], v[28:31]
v_mfma_f32_16x16x32_bf16 v[12:15], a[0:3], a[60:63], v[12:15]
v_mfma_f32_16x16x32_bf16 v[8:11], a[0:3], a[56:59], v[8:11]
s_waitcnt vmcnt(8) lgkmcnt(0)
v_mfma_f32_16x16x32_bf16 v[64:67], a[16:19], a[48:51], v[64:67]
ds_read_b64_tr_b16 a[0:1], v160 offset:8192
v_mfma_f32_16x16x32_bf16 v[68:71], a[16:19], a[52:55], v[68:71]
ds_read_b64_tr_b16 a[2:3], v160 offset:10240
v_mfma_f32_16x16x32_bf16 v[84:87], a[20:23], a[52:55], v[84:87]
ds_read_b64_tr_b16 a[4:5], v161 offset:8192
v_mfma_f32_16x16x32_bf16 v[80:83], a[20:23], a[48:51], v[80:83]
ds_read_b64_tr_b16 a[6:7], v161 offset:10240
v_mfma_f32_16x16x32_bf16 v[96:99], a[24:27], a[48:51], v[96:99]
ds_read_b64_tr_b16 a[8:9], v162 offset:8192
v_mfma_f32_16x16x32_bf16 v[100:103], a[24:27], a[52:55], v[100:103]
ds_read_b64_tr_b16 a[10:11], v162 offset:10240
v_mfma_f32_16x16x32_bf16 v[116:119], a[28:31], a[52:55], v[116:119]
ds_read_b64_tr_b16 a[12:13], v163 offset:8192
v_mfma_f32_16x16x32_bf16 v[112:115], a[28:31], a[48:51], v[112:115]
ds_read_b64_tr_b16 a[14:15], v163 offset:10240
v_mfma_f32_16x16x32_bf16 v[120:123], a[28:31], a[56:59], v[120:123]
s_add_u32 m0, s66, 4096
s_add_u32 s64, s43, 458880
buffer_load_dwordx4 v156, s[20:23], s64 offen offset:0 lds
v_mfma_f32_16x16x32_bf16 v[124:127], a[28:31], a[60:63], v[124:127]
buffer_load_dwordx4 v157, s[20:23], s64 offen offset:1024 lds
v_mfma_f32_16x16x32_bf16 v[108:111], a[24:27], a[60:63], v[108:111]
buffer_load_dwordx4 v158, s[20:23], s64 offen offset:2048 lds
v_mfma_f32_16x16x32_bf16 v[104:107], a[24:27], a[56:59], v[104:107]
buffer_load_dwordx4 v159, s[20:23], s64 offen offset:3072 lds
v_mfma_f32_16x16x32_bf16 v[88:91], a[20:23], a[56:59], v[88:91]
v_mfma_f32_16x16x32_bf16 v[92:95], a[20:23], a[60:63], v[92:95]
v_mfma_f32_16x16x32_bf16 v[76:79], a[16:19], a[60:63], v[76:79]
v_mfma_f32_16x16x32_bf16 v[72:75], a[16:19], a[56:59], v[72:75]
s_waitcnt vmcnt(8) lgkmcnt(0)
v_mfma_f32_16x16x32_bf16 v[0:3], a[0:3], a[64:67], v[0:3]
ds_read_b64_tr_b16 a[16:17], v160 offset:12288
v_mfma_f32_16x16x32_bf16 v[4:7], a[0:3], a[68:71], v[4:7]
ds_read_b64_tr_b16 a[18:19], v160 offset:14336
v_mfma_f32_16x16x32_bf16 v[20:23], a[4:7], a[68:71], v[20:23]
ds_read_b64_tr_b16 a[20:21], v161 offset:12288
v_mfma_f32_16x16x32_bf16 v[16:19], a[4:7], a[64:67], v[16:19]
ds_read_b64_tr_b16 a[22:23], v161 offset:14336
v_mfma_f32_16x16x32_bf16 v[32:35], a[8:11], a[64:67], v[32:35]
ds_read_b64_tr_b16 a[24:25], v162 offset:12288
v_mfma_f32_16x16x32_bf16 v[36:39], a[8:11], a[68:71], v[36:39]
ds_read_b64_tr_b16 a[26:27], v162 offset:14336
v_mfma_f32_16x16x32_bf16 v[52:55], a[12:15], a[68:71], v[52:55]
ds_read_b64_tr_b16 a[28:29], v163 offset:12288
v_mfma_f32_16x16x32_bf16 v[48:51], a[12:15], a[64:67], v[48:51]
ds_read_b64_tr_b16 a[30:31], v163 offset:14336
v_mfma_f32_16x16x32_bf16 v[56:59], a[12:15], a[72:75], v[56:59]
s_add_u32 m0, s66, 8192
s_add_u32 s64, s43, 487424
buffer_load_dwordx4 v156, s[20:23], s64 offen offset:0 lds
v_mfma_f32_16x16x32_bf16 v[60:63], a[12:15], a[76:79], v[60:63]
buffer_load_dwordx4 v157, s[20:23], s64 offen offset:1024 lds
v_mfma_f32_16x16x32_bf16 v[44:47], a[8:11], a[76:79], v[44:47]
buffer_load_dwordx4 v158, s[20:23], s64 offen offset:2048 lds
v_mfma_f32_16x16x32_bf16 v[40:43], a[8:11], a[72:75], v[40:43]
buffer_load_dwordx4 v159, s[20:23], s64 offen offset:3072 lds
v_mfma_f32_16x16x32_bf16 v[24:27], a[4:7], a[72:75], v[24:27]
v_mfma_f32_16x16x32_bf16 v[28:31], a[4:7], a[76:79], v[28:31]
v_mfma_f32_16x16x32_bf16 v[12:15], a[0:3], a[76:79], v[12:15]
v_mfma_f32_16x16x32_bf16 v[8:11], a[0:3], a[72:75], v[8:11]
s_waitcnt vmcnt(8) lgkmcnt(0)
v_mfma_f32_16x16x32_bf16 v[64:67], a[16:19], a[64:67], v[64:67]
ds_read_b64_tr_b16 a[0:1], v160 offset:0
v_mfma_f32_16x16x32_bf16 v[68:71], a[16:19], a[68:71], v[68:71]
ds_read_b64_tr_b16 a[2:3], v160 offset:2048
v_mfma_f32_16x16x32_bf16 v[84:87], a[20:23], a[68:71], v[84:87]
ds_read_b64_tr_b16 a[4:5], v161 offset:0
v_mfma_f32_16x16x32_bf16 v[80:83], a[20:23], a[64:67], v[80:83]
ds_read_b64_tr_b16 a[6:7], v161 offset:2048
v_mfma_f32_16x16x32_bf16 v[96:99], a[24:27], a[64:67], v[96:99]
ds_read_b64_tr_b16 a[8:9], v162 offset:0
v_mfma_f32_16x16x32_bf16 v[100:103], a[24:27], a[68:71], v[100:103]
ds_read_b64_tr_b16 a[10:11], v162 offset:2048
v_mfma_f32_16x16x32_bf16 v[116:119], a[28:31], a[68:71], v[116:119]
ds_read_b64_tr_b16 a[12:13], v163 offset:0
v_mfma_f32_16x16x32_bf16 v[112:115], a[28:31], a[64:67], v[112:115]
ds_read_b64_tr_b16 a[14:15], v163 offset:2048
v_mfma_f32_16x16x32_bf16 v[120:123], a[28:31], a[72:75], v[120:123]
s_add_u32 m0, s66, 12288
s_add_u32 s64, s43, 487552
buffer_load_dwordx4 v156, s[20:23], s64 offen offset:0 lds
v_mfma_f32_16x16x32_bf16 v[124:127], a[28:31], a[76:79], v[124:127]
buffer_load_dwordx4 v157, s[20:23], s64 offen offset:1024 lds
v_mfma_f32_16x16x32_bf16 v[108:111], a[24:27], a[76:79], v[108:111]
buffer_load_dwordx4 v158, s[20:23], s64 offen offset:2048 lds
v_mfma_f32_16x16x32_bf16 v[104:107], a[24:27], a[72:75], v[104:107]
buffer_load_dwordx4 v159, s[20:23], s64 offen offset:3072 lds
v_mfma_f32_16x16x32_bf16 v[88:91], a[20:23], a[72:75], v[88:91]
v_mfma_f32_16x16x32_bf16 v[92:95], a[20:23], a[76:79], v[92:95]
v_mfma_f32_16x16x32_bf16 v[76:79], a[16:19], a[76:79], v[76:79]
v_mfma_f32_16x16x32_bf16 v[72:75], a[16:19], a[72:75], v[72:75]
s_setprio 3
s_barrier
ds_read_b128 a[32:35], v128 offset:0
ds_read_b128 a[36:39], v129 offset:0
ds_read_b128 a[40:43], v130 offset:0
ds_read_b128 a[44:47], v131 offset:0
s_setprio 1
s_waitcnt vmcnt(8) lgkmcnt(0)
v_mfma_f32_16x16x32_bf16 v[0:3], a[0:3], a[32:35], v[0:3]
ds_read_b64_tr_b16 a[16:17], v160 offset:4096
v_mfma_f32_16x16x32_bf16 v[4:7], a[0:3], a[36:39], v[4:7]
ds_read_b64_tr_b16 a[18:19], v160 offset:6144
v_mfma_f32_16x16x32_bf16 v[20:23], a[4:7], a[36:39], v[20:23]
ds_read_b64_tr_b16 a[20:21], v161 offset:4096
v_mfma_f32_16x16x32_bf16 v[16:19], a[4:7], a[32:35], v[16:19]
ds_read_b64_tr_b16 a[22:23], v161 offset:6144
v_mfma_f32_16x16x32_bf16 v[32:35], a[8:11], a[32:35], v[32:35]
ds_read_b64_tr_b16 a[24:25], v162 offset:4096
v_mfma_f32_16x16x32_bf16 v[36:39], a[8:11], a[36:39], v[36:39]
ds_read_b64_tr_b16 a[26:27], v162 offset:6144
v_mfma_f32_16x16x32_bf16 v[52:55], a[12:15], a[36:39], v[52:55]
ds_read_b64_tr_b16 a[28:29], v163 offset:4096
v_mfma_f32_16x16x32_bf16 v[48:51], a[12:15], a[32:35], v[48:51]
ds_read_b64_tr_b16 a[30:31], v163 offset:6144
v_mfma_f32_16x16x32_bf16 v[56:59], a[12:15], a[40:43], v[56:59]
s_add_u32 m0, s66, 0
s_add_u32 s64, s43, 688128
buffer_load_dwordx4 v156, s[20:23], s64 offen offset:0 lds
v_mfma_f32_16x16x32_bf16 v[60:63], a[12:15], a[44:47], v[60:63]
buffer_load_dwordx4 v157, s[20:23], s64 offen offset:1024 lds
v_mfma_f32_16x16x32_bf16 v[44:47], a[8:11], a[44:47], v[44:47]
buffer_load_dwordx4 v158, s[20:23], s64 offen offset:2048 lds
v_mfma_f32_16x16x32_bf16 v[40:43], a[8:11], a[40:43], v[40:43]
buffer_load_dwordx4 v159, s[20:23], s64 offen offset:3072 lds
v_mfma_f32_16x16x32_bf16 v[24:27], a[4:7], a[40:43], v[24:27]
v_mfma_f32_16x16x32_bf16 v[28:31], a[4:7], a[44:47], v[28:31]
v_mfma_f32_16x16x32_bf16 v[12:15], a[0:3], a[44:47], v[12:15]
v_mfma_f32_16x16x32_bf16 v[8:11], a[0:3], a[40:43], v[8:11]
s_waitcnt vmcnt(8) lgkmcnt(0)
v_mfma_f32_16x16x32_bf16 v[64:67], a[16:19], a[32:35], v[64:67]
ds_read_b128 a[48:51], v128 offset:4096
v_mfma_f32_16x16x32_bf16 v[68:71], a[16:19], a[36:39], v[68:71]
ds_read_b128 a[52:55], v129 offset:4096
v_mfma_f32_16x16x32_bf16 v[84:87], a[20:23], a[36:39], v[84:87]
ds_read_b128 a[56:59], v130 offset:4096
v_mfma_f32_16x16x32_bf16 v[80:83], a[20:23], a[32:35], v[80:83]
ds_read_b128 a[60:63], v131 offset:4096
v_mfma_f32_16x16x32_bf16 v[96:99], a[24:27], a[32:35], v[96:99]
ds_read_b64_tr_b16 a[0:1], v160 offset:8192
v_mfma_f32_16x16x32_bf16 v[100:103], a[24:27], a[36:39], v[100:103]
ds_read_b64_tr_b16 a[2:3], v160 offset:10240
v_mfma_f32_16x16x32_bf16 v[116:119], a[28:31], a[36:39], v[116:119]
ds_read_b64_tr_b16 a[4:5], v161 offset:8192
v_mfma_f32_16x16x32_bf16 v[112:115], a[28:31], a[32:35], v[112:115]
ds_read_b64_tr_b16 a[6:7], v161 offset:10240
v_mfma_f32_16x16x32_bf16 v[120:123], a[28:31], a[40:43], v[120:123]
ds_read_b64_tr_b16 a[8:9], v162 offset:8192
v_mfma_f32_16x16x32_bf16 v[124:127], a[28:31], a[44:47], v[124:127]
ds_read_b64_tr_b16 a[10:11], v162 offset:10240
v_mfma_f32_16x16x32_bf16 v[108:111], a[24:27], a[44:47], v[108:111]
ds_read_b64_tr_b16 a[12:13], v163 offset:8192
v_mfma_f32_16x16x32_bf16 v[104:107], a[24:27], a[40:43], v[104:107]
ds_read_b64_tr_b16 a[14:15], v163 offset:10240
v_mfma_f32_16x16x32_bf16 v[88:91], a[20:23], a[40:43], v[88:91]
s_add_u32 m0, s66, 4096
s_add_u32 s64, s43, 688256
buffer_load_dwordx4 v156, s[20:23], s64 offen offset:0 lds
v_mfma_f32_16x16x32_bf16 v[92:95], a[20:23], a[44:47], v[92:95]
buffer_load_dwordx4 v157, s[20:23], s64 offen offset:1024 lds
v_mfma_f32_16x16x32_bf16 v[76:79], a[16:19], a[44:47], v[76:79]
buffer_load_dwordx4 v158, s[20:23], s64 offen offset:2048 lds
v_mfma_f32_16x16x32_bf16 v[72:75], a[16:19], a[40:43], v[72:75]
buffer_load_dwordx4 v159, s[20:23], s64 offen offset:3072 lds
s_waitcnt vmcnt(8) lgkmcnt(0)
v_mfma_f32_16x16x32_bf16 v[0:3], a[0:3], a[48:51], v[0:3]
ds_read_b64_tr_b16 a[16:17], v160 offset:12288
v_mfma_f32_16x16x32_bf16 v[4:7], a[0:3], a[52:55], v[4:7]
ds_read_b64_tr_b16 a[18:19], v160 offset:14336
v_mfma_f32_16x16x32_bf16 v[20:23], a[4:7], a[52:55], v[20:23]
ds_read_b64_tr_b16 a[20:21], v161 offset:12288
v_mfma_f32_16x16x32_bf16 v[16:19], a[4:7], a[48:51], v[16:19]
ds_read_b64_tr_b16 a[22:23], v161 offset:14336
v_mfma_f32_16x16x32_bf16 v[32:35], a[8:11], a[48:51], v[32:35]
ds_read_b64_tr_b16 a[24:25], v162 offset:12288
v_mfma_f32_16x16x32_bf16 v[36:39], a[8:11], a[52:55], v[36:39]
ds_read_b64_tr_b16 a[26:27], v162 offset:14336
v_mfma_f32_16x16x32_bf16 v[52:55], a[12:15], a[52:55], v[52:55]
ds_read_b64_tr_b16 a[28:29], v163 offset:12288
v_mfma_f32_16x16x32_bf16 v[48:51], a[12:15], a[48:51], v[48:51]
ds_read_b64_tr_b16 a[30:31], v163 offset:14336
v_mfma_f32_16x16x32_bf16 v[56:59], a[12:15], a[56:59], v[56:59]
s_add_u32 m0, s66, 8192
s_add_u32 s64, s43, 716800
buffer_load_dwordx4 v156, s[20:23], s64 offen offset:0 lds
v_mfma_f32_16x16x32_bf16 v[60:63], a[12:15], a[60:63], v[60:63]
buffer_load_dwordx4 v157, s[20:23], s64 offen offset:1024 lds
v_mfma_f32_16x16x32_bf16 v[44:47], a[8:11], a[60:63], v[44:47]
buffer_load_dwordx4 v158, s[20:23], s64 offen offset:2048 lds
v_mfma_f32_16x16x32_bf16 v[40:43], a[8:11], a[56:59], v[40:43]
buffer_load_dwordx4 v159, s[20:23], s64 offen offset:3072 lds
v_mfma_f32_16x16x32_bf16 v[24:27], a[4:7], a[56:59], v[24:27]
v_mfma_f32_16x16x32_bf16 v[28:31], a[4:7], a[60:63], v[28:31]
v_mfma_f32_16x16x32_bf16 v[12:15], a[0:3], a[60:63], v[12:15]
v_mfma_f32_16x16x32_bf16 v[8:11], a[0:3], a[56:59], v[8:11]
s_waitcnt vmcnt(8) lgkmcnt(0)
v_mfma_f32_16x16x32_bf16 v[64:67], a[16:19], a[48:51], v[64:67]
ds_read_b128 a[64:67], v128 offset:8192
v_mfma_f32_16x16x32_bf16 v[68:71], a[16:19], a[52:55], v[68:71]
ds_read_b128 a[68:71], v129 offset:8192
v_mfma_f32_16x16x32_bf16 v[84:87], a[20:23], a[52:55], v[84:87]
ds_read_b128 a[72:75], v130 offset:8192
v_mfma_f32_16x16x32_bf16 v[80:83], a[20:23], a[48:51], v[80:83]
ds_read_b128 a[76:79], v131 offset:8192
v_mfma_f32_16x16x32_bf16 v[96:99], a[24:27], a[48:51], v[96:99]
ds_read_b64_tr_b16 a[0:1], v160 offset:0
v_mfma_f32_16x16x32_bf16 v[100:103], a[24:27], a[52:55], v[100:103]
ds_read_b64_tr_b16 a[2:3], v160 offset:2048
v_mfma_f32_16x16x32_bf16 v[116:119], a[28:31], a[52:55], v[116:119]
ds_read_b64_tr_b16 a[4:5], v161 offset:0
v_mfma_f32_16x16x32_bf16 v[112:115], a[28:31], a[48:51], v[112:115]
ds_read_b64_tr_b16 a[6:7], v161 offset:2048
v_mfma_f32_16x16x32_bf16 v[120:123], a[28:31], a[56:59], v[120:123]
ds_read_b64_tr_b16 a[8:9], v162 offset:0
v_mfma_f32_16x16x32_bf16 v[124:127], a[28:31], a[60:63], v[124:127]
ds_read_b64_tr_b16 a[10:11], v162 offset:2048
v_mfma_f32_16x16x32_bf16 v[108:111], a[24:27], a[60:63], v[108:111]
ds_read_b64_tr_b16 a[12:13], v163 offset:0
v_mfma_f32_16x16x32_bf16 v[104:107], a[24:27], a[56:59], v[104:107]
ds_read_b64_tr_b16 a[14:15], v163 offset:2048
v_mfma_f32_16x16x32_bf16 v[88:91], a[20:23], a[56:59], v[88:91]
s_add_u32 m0, s66, 12288
s_add_u32 s64, s43, 716928
buffer_load_dwordx4 v156, s[20:23], s64 offen offset:0 lds
v_mfma_f32_16x16x32_bf16 v[92:95], a[20:23], a[60:63], v[92:95]
buffer_load_dwordx4 v157, s[20:23], s64 offen offset:1024 lds
v_mfma_f32_16x16x32_bf16 v[76:79], a[16:19], a[60:63], v[76:79]
buffer_load_dwordx4 v158, s[20:23], s64 offen offset:2048 lds
v_mfma_f32_16x16x32_bf16 v[72:75], a[16:19], a[56:59], v[72:75]
buffer_load_dwordx4 v159, s[20:23], s64 offen offset:3072 lds
s_waitcnt vmcnt(8) lgkmcnt(0)
v_mfma_f32_16x16x32_bf16 v[0:3], a[0:3], a[64:67], v[0:3]
ds_read_b64_tr_b16 a[16:17], v160 offset:4096
v_mfma_f32_16x16x32_bf16 v[4:7], a[0:3], a[68:71], v[4:7]
ds_read_b64_tr_b16 a[18:19], v160 offset:6144
v_mfma_f32_16x16x32_bf16 v[20:23], a[4:7], a[68:71], v[20:23]
ds_read_b64_tr_b16 a[20:21], v161 offset:4096
v_mfma_f32_16x16x32_bf16 v[16:19], a[4:7], a[64:67], v[16:19]
ds_read_b64_tr_b16 a[22:23], v161 offset:6144
v_mfma_f32_16x16x32_bf16 v[32:35], a[8:11], a[64:67], v[32:35]
ds_read_b64_tr_b16 a[24:25], v162 offset:4096
v_mfma_f32_16x16x32_bf16 v[36:39], a[8:11], a[68:71], v[36:39]
ds_read_b64_tr_b16 a[26:27], v162 offset:6144
v_mfma_f32_16x16x32_bf16 v[52:55], a[12:15], a[68:71], v[52:55]
ds_read_b64_tr_b16 a[28:29], v163 offset:4096
v_mfma_f32_16x16x32_bf16 v[48:51], a[12:15], a[64:67], v[48:51]
ds_read_b64_tr_b16 a[30:31], v163 offset:6144
v_mfma_f32_16x16x32_bf16 v[56:59], a[12:15], a[72:75], v[56:59]
v_mfma_f32_16x16x32_bf16 v[60:63], a[12:15], a[76:79], v[60:63]
v_mfma_f32_16x16x32_bf16 v[44:47], a[8:11], a[76:79], v[44:47]
v_mfma_f32_16x16x32_bf16 v[40:43], a[8:11], a[72:75], v[40:43]
v_mfma_f32_16x16x32_bf16 v[24:27], a[4:7], a[72:75], v[24:27]
v_mfma_f32_16x16x32_bf16 v[28:31], a[4:7], a[76:79], v[28:31]
v_mfma_f32_16x16x32_bf16 v[12:15], a[0:3], a[76:79], v[12:15]
v_mfma_f32_16x16x32_bf16 v[8:11], a[0:3], a[72:75], v[8:11]
s_waitcnt vmcnt(4) lgkmcnt(0)
v_mfma_f32_16x16x32_bf16 v[64:67], a[16:19], a[64:67], v[64:67]
ds_read_b128 a[32:35], v128 offset:12288
v_mfma_f32_16x16x32_bf16 v[68:71], a[16:19], a[68:71], v[68:71]
ds_read_b128 a[36:39], v129 offset:12288
v_mfma_f32_16x16x32_bf16 v[84:87], a[20:23], a[68:71], v[84:87]
ds_read_b128 a[40:43], v130 offset:12288
v_mfma_f32_16x16x32_bf16 v[80:83], a[20:23], a[64:67], v[80:83]
ds_read_b128 a[44:47], v131 offset:12288
v_mfma_f32_16x16x32_bf16 v[96:99], a[24:27], a[64:67], v[96:99]
ds_read_b64_tr_b16 a[0:1], v160 offset:8192
v_mfma_f32_16x16x32_bf16 v[100:103], a[24:27], a[68:71], v[100:103]
ds_read_b64_tr_b16 a[2:3], v160 offset:10240
v_mfma_f32_16x16x32_bf16 v[116:119], a[28:31], a[68:71], v[116:119]
ds_read_b64_tr_b16 a[4:5], v161 offset:8192
v_mfma_f32_16x16x32_bf16 v[112:115], a[28:31], a[64:67], v[112:115]
ds_read_b64_tr_b16 a[6:7], v161 offset:10240
v_mfma_f32_16x16x32_bf16 v[120:123], a[28:31], a[72:75], v[120:123]
ds_read_b64_tr_b16 a[8:9], v162 offset:8192
v_mfma_f32_16x16x32_bf16 v[124:127], a[28:31], a[76:79], v[124:127]
ds_read_b64_tr_b16 a[10:11], v162 offset:10240
v_mfma_f32_16x16x32_bf16 v[108:111], a[24:27], a[76:79], v[108:111]
ds_read_b64_tr_b16 a[12:13], v163 offset:8192
v_mfma_f32_16x16x32_bf16 v[104:107], a[24:27], a[72:75], v[104:107]
ds_read_b64_tr_b16 a[14:15], v163 offset:10240
v_mfma_f32_16x16x32_bf16 v[88:91], a[20:23], a[72:75], v[88:91]
v_mfma_f32_16x16x32_bf16 v[92:95], a[20:23], a[76:79], v[92:95]
v_mfma_f32_16x16x32_bf16 v[76:79], a[16:19], a[76:79], v[76:79]
v_mfma_f32_16x16x32_bf16 v[72:75], a[16:19], a[72:75], v[72:75]
s_waitcnt vmcnt(0) lgkmcnt(0)
v_mfma_f32_16x16x32_bf16 v[0:3], a[0:3], a[32:35], v[0:3]
ds_read_b64_tr_b16 a[16:17], v160 offset:12288
v_mfma_f32_16x16x32_bf16 v[4:7], a[0:3], a[36:39], v[4:7]
ds_read_b64_tr_b16 a[18:19], v160 offset:14336
v_mfma_f32_16x16x32_bf16 v[20:23], a[4:7], a[36:39], v[20:23]
ds_read_b64_tr_b16 a[20:21], v161 offset:12288
v_mfma_f32_16x16x32_bf16 v[16:19], a[4:7], a[32:35], v[16:19]
ds_read_b64_tr_b16 a[22:23], v161 offset:14336
v_mfma_f32_16x16x32_bf16 v[32:35], a[8:11], a[32:35], v[32:35]
ds_read_b64_tr_b16 a[24:25], v162 offset:12288
v_mfma_f32_16x16x32_bf16 v[36:39], a[8:11], a[36:39], v[36:39]
ds_read_b64_tr_b16 a[26:27], v162 offset:14336
v_mfma_f32_16x16x32_bf16 v[52:55], a[12:15], a[36:39], v[52:55]
ds_read_b64_tr_b16 a[28:29], v163 offset:12288
v_mfma_f32_16x16x32_bf16 v[48:51], a[12:15], a[32:35], v[48:51]
ds_read_b64_tr_b16 a[30:31], v163 offset:14336
v_mfma_f32_16x16x32_bf16 v[56:59], a[12:15], a[40:43], v[56:59]
v_lshlrev_b32 v132, 4, v172
s_and_b32 s65, s83, 0xfc
s_mul_i32 s65, s65, 65536
s_mul_i32 s64, s60, 4096
s_add_u32 s65, s65, s64
s_mul_i32 s2, s62, 16384
s_add_u32 s2, s2, s65
s_add_u32 s64, s62, 1
s_and_b32 s64, s64, 3
s_mul_i32 s64, s64, 65536
s_add_u32 s33, s64, s2
s_add_u32 s64, s62, 2
s_and_b32 s64, s64, 3
s_mul_i32 s64, s64, 65536
s_add_u32 s34, s64, s2
s_add_u32 s64, s62, 3
s_and_b32 s64, s64, 3
s_mul_i32 s64, s64, 65536
s_add_u32 s35, s64, s2
v_mfma_f32_16x16x32_bf16 v[60:63], a[12:15], a[44:47], v[60:63]
v_mfma_f32_16x16x32_bf16 v[44:47], a[8:11], a[44:47], v[44:47]
v_mfma_f32_16x16x32_bf16 v[40:43], a[8:11], a[40:43], v[40:43]
v_mfma_f32_16x16x32_bf16 v[24:27], a[4:7], a[40:43], v[24:27]
v_mfma_f32_16x16x32_bf16 v[28:31], a[4:7], a[44:47], v[28:31]
v_mfma_f32_16x16x32_bf16 v[12:15], a[0:3], a[44:47], v[12:15]
v_mfma_f32_16x16x32_bf16 v[8:11], a[0:3], a[40:43], v[8:11]
s_waitcnt lgkmcnt(0)
v_mfma_f32_16x16x32_bf16 v[64:67], a[16:19], a[32:35], v[64:67]
v_mfma_f32_16x16x32_bf16 v[68:71], a[16:19], a[36:39], v[68:71]
v_mfma_f32_16x16x32_bf16 v[84:87], a[20:23], a[36:39], v[84:87]
v_mfma_f32_16x16x32_bf16 v[80:83], a[20:23], a[32:35], v[80:83]
v_cvt_pk_bf16_f32 v136, v4, v5
v_cvt_pk_bf16_f32 v137, v6, v7
v_mfma_f32_16x16x32_bf16 v[96:99], a[24:27], a[32:35], v[96:99]
v_cvt_pk_bf16_f32 v138, v20, v21
v_cvt_pk_bf16_f32 v139, v22, v23
buffer_store_dwordx4 v[136:139], v132, s[28:31], s33 offen offset:0 sc1
v_mfma_f32_16x16x32_bf16 v[100:103], a[24:27], a[36:39], v[100:103]
v_cvt_pk_bf16_f32 v140, v8, v9
v_cvt_pk_bf16_f32 v141, v10, v11
v_mfma_f32_16x16x32_bf16 v[116:119], a[28:31], a[36:39], v[116:119]
v_cvt_pk_bf16_f32 v142, v24, v25
v_cvt_pk_bf16_f32 v143, v26, v27
buffer_store_dwordx4 v[140:143], v132, s[28:31], s34 offen offset:0 sc1
v_mfma_f32_16x16x32_bf16 v[112:115], a[28:31], a[32:35], v[112:115]
v_cvt_pk_bf16_f32 v144, v12, v13
v_cvt_pk_bf16_f32 v145, v14, v15
v_mfma_f32_16x16x32_bf16 v[120:123], a[28:31], a[40:43], v[120:123]
v_cvt_pk_bf16_f32 v146, v28, v29
v_cvt_pk_bf16_f32 v147, v30, v31
buffer_store_dwordx4 v[144:147], v132, s[28:31], s35 offen offset:0 sc1
v_mfma_f32_16x16x32_bf16 v[124:127], a[28:31], a[44:47], v[124:127]
v_cvt_pk_bf16_f32 v136, v36, v37
v_cvt_pk_bf16_f32 v137, v38, v39
v_mfma_f32_16x16x32_bf16 v[108:111], a[24:27], a[44:47], v[108:111]
v_cvt_pk_bf16_f32 v138, v52, v53
v_cvt_pk_bf16_f32 v139, v54, v55
buffer_store_dwordx4 v[136:139], v132, s[28:31], s33 offen offset:1024 sc1
v_mfma_f32_16x16x32_bf16 v[104:107], a[24:27], a[40:43], v[104:107]
v_cvt_pk_bf16_f32 v140, v40, v41
v_cvt_pk_bf16_f32 v141, v42, v43
v_mfma_f32_16x16x32_bf16 v[88:91], a[20:23], a[40:43], v[88:91]
v_cvt_pk_bf16_f32 v142, v56, v57
v_cvt_pk_bf16_f32 v143, v58, v59
buffer_store_dwordx4 v[140:143], v132, s[28:31], s34 offen offset:1024 sc1
v_mfma_f32_16x16x32_bf16 v[92:95], a[20:23], a[44:47], v[92:95]
v_cvt_pk_bf16_f32 v144, v44, v45
v_cvt_pk_bf16_f32 v145, v46, v47
v_mfma_f32_16x16x32_bf16 v[76:79], a[16:19], a[44:47], v[76:79]
v_cvt_pk_bf16_f32 v146, v60, v61
v_cvt_pk_bf16_f32 v147, v62, v63
buffer_store_dwordx4 v[144:147], v132, s[28:31], s35 offen offset:1024 sc1
v_mfma_f32_16x16x32_bf16 v[72:75], a[16:19], a[40:43], v[72:75]
s_nop 7
v_cvt_pk_bf16_f32 v136, v68, v69
v_cvt_pk_bf16_f32 v137, v70, v71
v_cvt_pk_bf16_f32 v138, v84, v85
v_cvt_pk_bf16_f32 v139, v86, v87
buffer_store_dwordx4 v[136:139], v132, s[28:31], s33 offen offset:2048 sc1
v_cvt_pk_bf16_f32 v140, v72, v73
v_cvt_pk_bf16_f32 v141, v74, v75
v_cvt_pk_bf16_f32 v142, v88, v89
v_cvt_pk_bf16_f32 v143, v90, v91
buffer_store_dwordx4 v[140:143], v132, s[28:31], s34 offen offset:2048 sc1
v_cvt_pk_bf16_f32 v144, v76, v77
v_cvt_pk_bf16_f32 v145, v78, v79
v_cvt_pk_bf16_f32 v146, v92, v93
v_cvt_pk_bf16_f32 v147, v94, v95
buffer_store_dwordx4 v[144:147], v132, s[28:31], s35 offen offset:2048 sc1
v_cvt_pk_bf16_f32 v136, v100, v101
v_cvt_pk_bf16_f32 v137, v102, v103
v_cvt_pk_bf16_f32 v138, v116, v117
v_cvt_pk_bf16_f32 v139, v118, v119
buffer_store_dwordx4 v[136:139], v132, s[28:31], s33 offen offset:3072 sc1
v_cvt_pk_bf16_f32 v140, v104, v105
v_cvt_pk_bf16_f32 v141, v106, v107
v_cvt_pk_bf16_f32 v142, v120, v121
v_cvt_pk_bf16_f32 v143, v122, v123
buffer_store_dwordx4 v[140:143], v132, s[28:31], s34 offen offset:3072 sc1
v_cvt_pk_bf16_f32 v144, v108, v109
v_cvt_pk_bf16_f32 v145, v110, v111
v_cvt_pk_bf16_f32 v146, v124, v125
v_cvt_pk_bf16_f32 v147, v126, v127
buffer_store_dwordx4 v[144:147], v132, s[28:31], s35 offen offset:3072 sc1
v_and_b32 v133, 15, v172
v_mul_u32_u24 v133, 1792, v133
v_lshrrev_b32 v134, 4, v172
v_lshl_add_u32 v133, v134, 3, v133
s_waitcnt vmcnt(0)
s_barrier
s_cmp_eq_u32 s60, 0
s_cbranch_scc0 L_nopoll
v_add_u32 v149, 1, v149
s_mov_b64 exec, 15
buffer_store_dword v149, v151, s[28:31], 0 offen sc1
s_mov_b32 s76, 0
L_poll:
buffer_load_dword v134, v150, s[28:31], 0 offen sc1
s_add_u32 s76, s76, 1
s_waitcnt vmcnt(0)
v_cmp_eq_u32 vcc, v134, v148
s_nop 0
s_cbranch_vccz L_polled
s_cmp_lt_u32 s76, 0x20000
s_cbranch_scc1 L_poll
L_polled:
s_mov_b64 exec, -1
L_nopoll:
s_barrier
s_mul_i32 s2, s62, 65536
s_add_u32 s2, s2, s65
s_add_u32 s64, s62, 1
s_and_b32 s64, s64, 3
s_mul_i32 s64, s64, 16384
s_add_u32 s64, s64, s2
buffer_load_dwordx4 v[4:7], v132, s[28:31], s64 offen offset:0 sc1
buffer_load_dwordx4 v[36:39], v132, s[28:31], s64 offen offset:1024 sc1
buffer_load_dwordx4 v[68:71], v132, s[28:31], s64 offen offset:2048 sc1
buffer_load_dwordx4 v[100:103], v132, s[28:31], s64 offen offset:3072 sc1
s_add_u32 s64, s62, 2
s_and_b32 s64, s64, 3
s_mul_i32 s64, s64, 16384
s_add_u32 s64, s64, s2
buffer_load_dwordx4 v[8:11], v132, s[28:31], s64 offen offset:0 sc1
buffer_load_dwordx4 v[40:43], v132, s[28:31], s64 offen offset:1024 sc1
buffer_load_dwordx4 v[72:75], v132, s[28:31], s64 offen offset:2048 sc1
buffer_load_dwordx4 v[104:107], v132, s[28:31], s64 offen offset:3072 sc1
s_add_u32 s64, s62, 3
s_and_b32 s64, s64, 3
s_mul_i32 s64, s64, 16384
s_add_u32 s64, s64, s2
buffer_load_dwordx4 v[12:15], v132, s[28:31], s64 offen offset:0 sc1
buffer_load_dwordx4 v[44:47], v132, s[28:31], s64 offen offset:1024 sc1
buffer_load_dwordx4 v[76:79], v132, s[28:31], s64 offen offset:2048 sc1
buffer_load_dwordx4 v[108:111], v132, s[28:31], s64 offen offset:3072 sc1
s_mul_i32 s2, s61, 114688
s_mul_i32 s3, s62, 28672
s_add_u32 s2, s2, s3
s_mul_i32 s3, s63, 896
s_add_u32 s2, s2, s3
s_add_u32 s2, s2, s67
s_waitcnt vmcnt(0)
v_lshlrev_b32 v136, 16, v4
v_and_b32 v137, 0xffff0000, v4
v_lshlrev_b32 v138, 16, v5
v_and_b32 v139, 0xffff0000, v5
v_pk_add_f32 v[0:1], v[0:1], v[136:137]
v_pk_add_f32 v[2:3], v[2:3], v[138:139]
v_lshlrev_b32 v136, 16, v8
v_and_b32 v137, 0xffff0000, v8
v_lshlrev_b32 v138, 16, v9
v_and_b32 v139, 0xffff0000, v9
v_pk_add_f32 v[0:1], v[0:1], v[136:137]
v_pk_add_f32 v[2:3], v[2:3], v[138:139]
v_lshlrev_b32 v136, 16, v12
v_and_b32 v137, 0xffff0000, v12
v_lshlrev_b32 v138, 16, v13
v_and_b32 v139, 0xffff0000, v13
v_pk_add_f32 v[0:1], v[0:1], v[136:137]
v_pk_add_f32 v[2:3], v[2:3], v[138:139]
v_cvt_pk_bf16_f32 v0, v0, v1
v_cvt_pk_bf16_f32 v1, v2, v3
buffer_store_dwordx2 v[0:1], v133, s[24:27], s2 offen offset:0
v_lshlrev_b32 v136, 16, v6
v_and_b32 v137, 0xffff0000, v6
v_lshlrev_b32 v138, 16, v7
v_and_b32 v139, 0xffff0000, v7
v_pk_add_f32 v[16:17], v[16:17], v[136:137]
v_pk_add_f32 v[18:19], v[18:19], v[138:139]
v_lshlrev_b32 v136, 16, v10
v_and_b32 v137, 0xffff0000, v10
v_lshlrev_b32 v138, 16, v11
v_and_b32 v139, 0xffff0000, v11
v_pk_add_f32 v[16:17], v[16:17], v[136:137]
v_pk_add_f32 v[18:19], v[18:19], v[138:139]
v_lshlrev_b32 v136, 16, v14
v_and_b32 v137, 0xffff0000, v14
v_lshlrev_b32 v138, 16, v15
v_and_b32 v139, 0xffff0000, v15
v_pk_add_f32 v[16:17], v[16:17], v[136:137]
v_pk_add_f32 v[18:19], v[18:19], v[138:139]
v_cvt_pk_bf16_f32 v16, v16, v17
v_cvt_pk_bf16_f32 v17, v18, v19
buffer_store_dwordx2 v[16:17], v133, s[24:27], s2 offen offset:32
v_lshlrev_b32 v136, 16, v36
v_and_b32 v137, 0xffff0000, v36
v_lshlrev_b32 v138, 16, v37
v_and_b32 v139, 0xffff0000, v37
v_pk_add_f32 v[32:33], v[32:33], v[136:137]
v_pk_add_f32 v[34:35], v[34:35], v[138:139]
v_lshlrev_b32 v136, 16, v40
v_and_b32 v137, 0xffff0000, v40
v_lshlrev_b32 v138, 16, v41
v_and_b32 v139, 0xffff0000, v41
v_pk_add_f32 v[32:33], v[32:33], v[136:137]
v_pk_add_f32 v[34:35], v[34:35], v[138:139]
v_lshlrev_b32 v136, 16, v44
v_and_b32 v137, 0xffff0000, v44
v_lshlrev_b32 v138, 16, v45
v_and_b32 v139, 0xffff0000, v45
v_pk_add_f32 v[32:33], v[32:33], v[136:137]
v_pk_add_f32 v[34:35], v[34:35], v[138:139]
v_cvt_pk_bf16_f32 v32, v32, v33
v_cvt_pk_bf16_f32 v33, v34, v35
buffer_store_dwordx2 v[32:33], v133, s[24:27], s2 offen offset:64
v_lshlrev_b32 v136, 16, v38
v_and_b32 v137, 0xffff0000, v38
v_lshlrev_b32 v138, 16, v39
v_and_b32 v139, 0xffff0000, v39
v_pk_add_f32 v[48:49], v[48:49], v[136:137]
v_pk_add_f32 v[50:51], v[50:51], v[138:139]
v_lshlrev_b32 v136, 16, v42
v_and_b32 v137, 0xffff0000, v42
v_lshlrev_b32 v138, 16, v43
v_and_b32 v139, 0xffff0000, v43
v_pk_add_f32 v[48:49], v[48:49], v[136:137]
v_pk_add_f32 v[50:51], v[50:51], v[138:139]
v_lshlrev_b32 v136, 16, v46
v_and_b32 v137, 0xffff0000, v46
v_lshlrev_b32 v138, 16, v47
v_and_b32 v139, 0xffff0000, v47
v_pk_add_f32 v[48:49], v[48:49], v[136:137]
v_pk_add_f32 v[50:51], v[50:51], v[138:139]
v_cvt_pk_bf16_f32 v48, v48, v49
v_cvt_pk_bf16_f32 v49, v50, v51
buffer_store_dwordx2 v[48:49], v133, s[24:27], s2 offen offset:96
v_lshlrev_b32 v136, 16, v68
v_and_b32 v137, 0xffff0000, v68
v_lshlrev_b32 v138, 16, v69
v_and_b32 v139, 0xffff0000, v69
v_pk_add_f32 v[64:65], v[64:65], v[136:137]
v_pk_add_f32 v[66:67], v[66:67], v[138:139]
v_lshlrev_b32 v136, 16, v72
v_and_b32 v137, 0xffff0000, v72
v_lshlrev_b32 v138, 16, v73
v_and_b32 v139, 0xffff0000, v73
v_pk_add_f32 v[64:65], v[64:65], v[136:137]
v_pk_add_f32 v[66:67], v[66:67], v[138:139]
v_lshlrev_b32 v136, 16, v76
v_and_b32 v137, 0xffff0000, v76
v_lshlrev_b32 v138, 16, v77
v_and_b32 v139, 0xffff0000, v77
v_pk_add_f32 v[64:65], v[64:65], v[136:137]
v_pk_add_f32 v[66:67], v[66:67], v[138:139]
v_cvt_pk_bf16_f32 v64, v64, v65
v_cvt_pk_bf16_f32 v65, v66, v67
buffer_store_dwordx2 v[64:65], v133, s[24:27], s2 offen offset:128
v_lshlrev_b32 v136, 16, v70
v_and_b32 v137, 0xffff0000, v70
v_lshlrev_b32 v138, 16, v71
v_and_b32 v139, 0xffff0000, v71
v_pk_add_f32 v[80:81], v[80:81], v[136:137]
v_pk_add_f32 v[82:83], v[82:83], v[138:139]
v_lshlrev_b32 v136, 16, v74
v_and_b32 v137, 0xffff0000, v74
v_lshlrev_b32 v138, 16, v75
v_and_b32 v139, 0xffff0000, v75
v_pk_add_f32 v[80:81], v[80:81], v[136:137]
v_pk_add_f32 v[82:83], v[82:83], v[138:139]
v_lshlrev_b32 v136, 16, v78
v_and_b32 v137, 0xffff0000, v78
v_lshlrev_b32 v138, 16, v79
v_and_b32 v139, 0xffff0000, v79
v_pk_add_f32 v[80:81], v[80:81], v[136:137]
v_pk_add_f32 v[82:83], v[82:83], v[138:139]
v_cvt_pk_bf16_f32 v80, v80, v81
v_cvt_pk_bf16_f32 v81, v82, v83
buffer_store_dwordx2 v[80:81], v133, s[24:27], s2 offen offset:160
v_lshlrev_b32 v136, 16, v100
v_and_b32 v137, 0xffff0000, v100
v_lshlrev_b32 v138, 16, v101
v_and_b32 v139, 0xffff0000, v101
v_pk_add_f32 v[96:97], v[96:97], v[136:137]
v_pk_add_f32 v[98:99], v[98:99], v[138:139]
v_lshlrev_b32 v136, 16, v104
v_and_b32 v137, 0xffff0000, v104
v_lshlrev_b32 v138, 16, v105
v_and_b32 v139, 0xffff0000, v105
v_pk_add_f32 v[96:97], v[96:97], v[136:137]
v_pk_add_f32 v[98:99], v[98:99], v[138:139]
v_lshlrev_b32 v136, 16, v108
v_and_b32 v137, 0xffff0000, v108
v_lshlrev_b32 v138, 16, v109
v_and_b32 v139, 0xffff0000, v109
v_pk_add_f32 v[96:97], v[96:97], v[136:137]
v_pk_add_f32 v[98:99], v[98:99], v[138:139]
v_cvt_pk_bf16_f32 v96, v96, v97
v_cvt_pk_bf16_f32 v97, v98, v99
buffer_store_dwordx2 v[96:97], v133, s[24:27], s2 offen offset:192
v_lshlrev_b32 v136, 16, v102
v_and_b32 v137, 0xffff0000, v102
v_lshlrev_b32 v138, 16, v103
v_and_b32 v139, 0xffff0000, v103
v_pk_add_f32 v[112:113], v[112:113], v[136:137]
v_pk_add_f32 v[114:115], v[114:115], v[138:139]
v_lshlrev_b32 v136, 16, v106
v_and_b32 v137, 0xffff0000, v106
v_lshlrev_b32 v138, 16, v107
v_and_b32 v139, 0xffff0000, v107
v_pk_add_f32 v[112:113], v[112:113], v[136:137]
v_pk_add_f32 v[114:115], v[114:115], v[138:139]
v_lshlrev_b32 v136, 16, v110
v_and_b32 v137, 0xffff0000, v110
v_lshlrev_b32 v138, 16, v111
v_and_b32 v139, 0xffff0000, v111
v_pk_add_f32 v[112:113], v[112:113], v[136:137]
v_pk_add_f32 v[114:115], v[114:115], v[138:139]
v_cvt_pk_bf16_f32 v112, v112, v113
v_cvt_pk_bf16_f32 v113, v114, v115
buffer_store_dwordx2 v[112:113], v133, s[24:27], s2 offen offset:224
s_endpgm
L_B3:
s_waitcnt vmcnt(0)
s_barrier
s_add_u32 m0, s77, 0
s_add_u32 s64, s37, 0
buffer_load_dwordx4 v168, s[12:15], s64 offen nt lds
s_add_u32 m0, s77, 1024
s_add_u32 s64, s37, 16384
buffer_load_dwordx4 v168, s[12:15], s64 offen nt lds
s_add_u32 m0, s77, 2048
s_add_u32 s64, s37, 32768
buffer_load_dwordx4 v168, s[12:15], s64 offen nt lds
s_add_u32 m0, s77, 3072
s_add_u32 s64, s37, 49152
buffer_load_dwordx4 v168, s[12:15], s64 offen nt lds
s_add_u32 m0, s77, 4096
s_add_u32 s64, s37, 65536
buffer_load_dwordx4 v168, s[12:15], s64 offen nt lds
s_add_u32 m0, s77, 5120
s_add_u32 s64, s37, 81920
buffer_load_dwordx4 v168, s[12:15], s64 offen nt lds
s_add_u32 m0, s77, 6144
s_add_u32 s64, s37, 98304
buffer_load_dwordx4 v168, s[12:15], s64 offen nt lds
s_add_u32 m0, s77, 7168
s_add_u32 s64, s37, 114688
buffer_load_dwordx4 v168, s[12:15], s64 offen nt lds
s_barrier
s_add_u32 m0, s66, 0
s_add_u32 s64, s40, 0
buffer_load_dwordx4 v156, s[20:23], s64 offen offset:0 lds
buffer_load_dwordx4 v157, s[20:23], s64 offen offset:1024 lds
buffer_load_dwordx4 v158, s[20:23], s64 offen offset:2048 lds
buffer_load_dwordx4 v159, s[20:23], s64 offen offset:3072 lds
s_waitcnt vmcnt(4)
s_barrier
s_setprio 3
s_add_u32 m0, s77, 33792
s_add_u32 s64, s37, 131072
buffer_load_dwordx4 v168, s[12:15], s64 offen nt lds
s_add_u32 m0, s77, 34816
s_add_u32 s64, s37, 147456
buffer_load_dwordx4 v168, s[12:15], s64 offen nt lds
s_add_u32 m0, s77, 35840
s_add_u32 s64, s37, 163840
buffer_load_dwordx4 v168, s[12:15], s64 offen nt lds
s_add_u32 m0, s77, 36864
s_add_u32 s64, s37, 180224
buffer_load_dwordx4 v168, s[12:15], s64 offen nt lds
s_waitcnt vmcnt(4)
ds_read_b64_tr_b16 a[0:1], v160 offset:0
ds_read_b64_tr_b16 a[2:3], v160 offset:2048
ds_read_b64_tr_b16 a[4:5], v161 offset:0
ds_read_b64_tr_b16 a[6:7], v161 offset:2048
ds_read_b64_tr_b16 a[8:9], v162 offset:0
ds_read_b64_tr_b16 a[10:11], v162 offset:2048
ds_read_b64_tr_b16 a[12:13], v163 offset:0
ds_read_b64_tr_b16 a[14:15], v163 offset:2048
s_add_u32 m0, s77, 37888
s_add_u32 s64, s37, 196608
buffer_load_dwordx4 v168, s[12:15], s64 offen nt lds
s_add_u32 m0, s77, 38912
s_add_u32 s64, s37, 212992
buffer_load_dwordx4 v168, s[12:15], s64 offen nt lds
s_add_u32 m0, s77, 39936
s_add_u32 s64, s37, 229376
buffer_load_dwordx4 v168, s[12:15], s64 offen nt lds
s_add_u32 m0, s77, 40960
s_add_u32 s64, s37, 245760
buffer_load_dwordx4 v168, s[12:15], s64 offen nt lds
s_barrier
ds_read_b128 a[32:35], v128 offset:0
ds_read_b128 a[36:39], v129 offset:0
ds_read_b128 a[40:43], v130 offset:0
ds_read_b128 a[44:47], v131 offset:0
s_setprio 1
s_waitcnt lgkmcnt(0)
v_mfma_f32_16x16x32_bf16 v[0:3], a[0:3], a[32:35], 0
v_mfma_f32_16x16x32_bf16 v[4:7], a[0:3], a[36:39], 0
v_mfma_f32_16x16x32_bf16 v[20:23], a[4:7], a[36:39], 0
v_mfma_f32_16x16x32_bf16 v[16:19], a[4:7], a[32:35], 0
v_mfma_f32_16x16x32_bf16 v[32:35], a[8:11], a[32:35], 0
v_mfma_f32_16x16x32_bf16 v[36:39], a[8:11], a[36:39], 0
v_mfma_f32_16x16x32_bf16 v[52:55], a[12:15], a[36:39], 0
v_mfma_f32_16x16x32_bf16 v[48:51], a[12:15], a[32:35], 0
v_mfma_f32_16x16x32_bf16 v[56:59], a[12:15], a[40:43], 0
v_mfma_f32_16x16x32_bf16 v[60:63], a[12:15], a[44:47], 0
v_mfma_f32_16x16x32_bf16 v[44:47], a[8:11], a[44:47], 0
v_mfma_f32_16x16x32_bf16 v[40:43], a[8:11], a[40:43], 0
v_mfma_f32_16x16x32_bf16 v[24:27], a[4:7], a[40:43], 0
v_mfma_f32_16x16x32_bf16 v[28:31], a[4:7], a[44:47], 0
v_mfma_f32_16x16x32_bf16 v[12:15], a[0:3], a[44:47], 0
v_mfma_f32_16x16x32_bf16 v[8:11], a[0:3], a[40:43], 0
s_add_u32 m0, s66, 8192
s_add_u32 s64, s40, 28672
buffer_load_dwordx4 v156, s[20:23], s64 offen offset:0 lds
buffer_load_dwordx4 v157, s[20:23], s64 offen offset:1024 lds
buffer_load_dwordx4 v158, s[20:23], s64 offen offset:2048 lds
buffer_load_dwordx4 v159, s[20:23], s64 offen offset:3072 lds
s_waitcnt vmcnt(4)
s_barrier
s_setprio 3
s_add_u32 m0, s77, 0
s_add_u32 s64, s38, 0
buffer_load_dwordx4 v168, s[12:15], s64 offen nt lds
s_add_u32 m0, s77, 1024
s_add_u32 s64, s38, 16384
buffer_load_dwordx4 v168, s[12:15], s64 offen nt lds
s_add_u32 m0, s77, 2048
s_add_u32 s64, s38, 32768
buffer_load_dwordx4 v168, s[12:15], s64 offen nt lds
s_add_u32 m0, s77, 3072
s_add_u32 s64, s38, 49152
buffer_load_dwordx4 v168, s[12:15], s64 offen nt lds
s_waitcnt vmcnt(4)
ds_read_b64_tr_b16 a[0:1], v160 offset:8192
ds_read_b64_tr_b16 a[2:3], v160 offset:10240
ds_read_b64_tr_b16 a[4:5], v161 offset:8192
ds_read_b64_tr_b16 a[6:7], v161 offset:10240
ds_read_b64_tr_b16 a[8:9], v162 offset:8192
ds_read_b64_tr_b16 a[10:11], v162 offset:10240
ds_read_b64_tr_b16 a[12:13], v163 offset:8192
ds_read_b64_tr_b16 a[14:15], v163 offset:10240
ds_read_b128 a[48:51], v128 offset:4096
ds_read_b128 a[52:55], v129 offset:4096
ds_read_b128 a[56:59], v130 offset:4096
ds_read_b128 a[60:63], v131 offset:4096
s_add_u32 m0, s77, 4096
s_add_u32 s64, s38, 65536
buffer_load_dwordx4 v168, s[12:15], s64 offen nt lds
s_add_u32 m0, s77, 5120
s_add_u32 s64, s38, 81920
buffer_load_dwordx4 v168, s[12:15], s64 offen nt lds
s_add_u32 m0, s77, 6144
s_add_u32 s64, s38, 98304
buffer_load_dwordx4 v168, s[12:15], s64 offen nt lds
s_add_u32 m0, s77, 7168
s_add_u32 s64, s38, 114688
buffer_load_dwordx4 v168, s[12:15], s64 offen nt lds
s_setprio 1
s_waitcnt lgkmcnt(0)
v_mfma_f32_16x16x32_bf16 v[0:3], a[0:3], a[48:51], v[0:3]
ds_read_b128 a[64:67], v128 offset:8192
v_mfma_f32_16x16x32_bf16 v[4:7], a[0:3], a[52:55], v[4:7]
ds_read_b128 a[68:71], v129 offset:8192
v_mfma_f32_16x16x32_bf16 v[20:23], a[4:7], a[52:55], v[20:23]
ds_read_b128 a[72:75], v130 offset:8192
v_mfma_f32_16x16x32_bf16 v[16:19], a[4:7], a[48:51], v[16:19]
ds_read_b128 a[76:79], v131 offset:8192
v_mfma_f32_16x16x32_bf16 v[32:35], a[8:11], a[48:51], v[32:35]
ds_read_b128 v[132:135], v128 offset:12288
v_mfma_f32_16x16x32_bf16 v[36:39], a[8:11], a[52:55], v[36:39]
ds_read_b128 v[136:139], v129 offset:12288
v_mfma_f32_16x16x32_bf16 v[52:55], a[12:15], a[52:55], v[52:55]
ds_read_b128 v[140:143], v130 offset:12288
v_mfma_f32_16x16x32_bf16 v[48:51], a[12:15], a[48:51], v[48:51]
ds_read_b128 v[144:147], v131 offset:12288
v_mfma_f32_16x16x32_bf16 v[56:59], a[12:15], a[56:59], v[56:59]
v_mfma_f32_16x16x32_bf16 v[60:63], a[12:15], a[60:63], v[60:63]
v_mfma_f32_16x16x32_bf16 v[44:47], a[8:11], a[60:63], v[44:47]
v_mfma_f32_16x16x32_bf16 v[40:43], a[8:11], a[56:59], v[40:43]
v_mfma_f32_16x16x32_bf16 v[24:27], a[4:7], a[56:59], v[24:27]
v_mfma_f32_16x16x32_bf16 v[28:31], a[4:7], a[60:63], v[28:31]
v_mfma_f32_16x16x32_bf16 v[12:15], a[0:3], a[60:63], v[12:15]
v_mfma_f32_16x16x32_bf16 v[8:11], a[0:3], a[56:59], v[8:11]
s_add_u32 m0, s66, 0
s_add_u32 s64, s40, 229376
buffer_load_dwordx4 v156, s[20:23], s64 offen offset:0 lds
buffer_load_dwordx4 v157, s[20:23], s64 offen offset:1024 lds
buffer_load_dwordx4 v158, s[20:23], s64 offen offset:2048 lds
buffer_load_dwordx4 v159, s[20:23], s64 offen offset:3072 lds
s_waitcnt lgkmcnt(0)
s_waitcnt vmcnt(0)
ds_read_b64_tr_b16 a[0:1], v160 offset:0
ds_read_b64_tr_b16 a[2:3], v160 offset:2048
ds_read_b64_tr_b16 a[4:5], v161 offset:0
ds_read_b64_tr_b16 a[6:7], v161 offset:2048
ds_read_b64_tr_b16 a[8:9], v162 offset:0
ds_read_b64_tr_b16 a[10:11], v162 offset:2048
ds_read_b64_tr_b16 a[12:13], v163 offset:0
ds_read_b64_tr_b16 a[14:15], v163 offset:2048
s_barrier
s_setprio 3
s_setprio 1
s_waitcnt lgkmcnt(0)
v_mfma_f32_16x16x32_bf16 v[0:3], a[0:3], a[64:67], v[0:3]
s_add_u32 m0, s77, 33792
s_add_u32 s64, s38, 131072
buffer_load_dwordx4 v168, s[12:15], s64 offen nt lds
v_mfma_f32_16x16x32_bf16 v[4:7], a[0:3], a[68:71], v[4:7]
s_add_u32 m0, s77, 34816
s_add_u32 s64, s38, 147456
buffer_load_dwordx4 v168, s[12:15], s64 offen nt lds
v_mfma_f32_16x16x32_bf16 v[20:23], a[4:7], a[68:71], v[20:23]
s_add_u32 m0, s77, 35840
s_add_u32 s64, s38, 163840
buffer_load_dwordx4 v168, s[12:15], s64 offen nt lds
v_mfma_f32_16x16x32_bf16 v[16:19], a[4:7], a[64:67], v[16:19]
s_add_u32 m0, s77, 36864
s_add_u32 s64, s38, 180224
buffer_load_dwordx4 v168, s[12:15], s64 offen nt lds
v_mfma_f32_16x16x32_bf16 v[32:35], a[8:11], a[64:67], v[32:35]
s_add_u32 m0, s77, 37888
s_add_u32 s64, s38, 196608
buffer_load_dwordx4 v168, s[12:15], s64 offen nt lds
v_mfma_f32_16x16x32_bf16 v[36:39], a[8:11], a[68:71], v[36:39]
s_add_u32 m0, s77, 38912
s_add_u32 s64, s38, 212992
buffer_load_dwordx4 v168, s[12:15], s64 offen nt lds
v_mfma_f32_16x16x32_bf16 v[52:55], a[12:15], a[68:71], v[52:55]
s_add_u32 m0, s77, 39936
s_add_u32 s64, s38, 229376
buffer_load_dwordx4 v168, s[12:15], s64 offen nt lds
v_mfma_f32_16x16x32_bf16 v[48:51], a[12:15], a[64:67], v[48:51]
s_add_u32 m0, s77, 40960
s_add_u32 s64, s38, 245760
buffer_load_dwordx4 v168, s[12:15], s64 offen nt lds
v_mfma_f32_16x16x32_bf16 v[56:59], a[12:15], a[72:75], v[56:59]
v_mfma_f32_16x16x32_bf16 v[60:63], a[12:15], a[76:79], v[60:63]
v_mfma_f32_16x16x32_bf16 v[44:47], a[8:11], a[76:79], v[44:47]
v_mfma_f32_16x16x32_bf16 v[40:43], a[8:11], a[72:75], v[40:43]
v_mfma_f32_16x16x32_bf16 v[24:27], a[4:7], a[72:75], v[24:27]
v_mfma_f32_16x16x32_bf16 v[28:31], a[4:7], a[76:79], v[28:31]
v_mfma_f32_16x16x32_bf16 v[12:15], a[0:3], a[76:79], v[12:15]
v_mfma_f32_16x16x32_bf16 v[8:11], a[0:3], a[72:75], v[8:11]
s_add_u32 m0, s66, 8192
s_add_u32 s64, s40, 258048
buffer_load_dwordx4 v156, s[20:23], s64 offen offset:0 lds
buffer_load_dwordx4 v157, s[20:23], s64 offen offset:1024 lds
buffer_load_dwordx4 v158, s[20:23], s64 offen offset:2048 lds
buffer_load_dwordx4 v159, s[20:23], s64 offen offset:3072 lds
s_waitcnt vmcnt(4)
s_barrier
s_setprio 3
s_add_u32 m0, s77, 0
s_add_u32 s64, s39, 0
buffer_load_dwordx4 v168, s[12:15], s64 offen nt lds
s_add_u32 m0, s77, 1024
s_add_u32 s64, s39, 16384
buffer_load_dwordx4 v168, s[12:15], s64 offen nt lds
s_add_u32 m0, s77, 2048
s_add_u32 s64, s39, 32768
buffer_load_dwordx4 v168, s[12:15], s64 offen nt lds
s_add_u32 m0, s77, 3072
s_add_u32 s64, s39, 49152
buffer_load_dwordx4 v168, s[12:15], s64 offen nt lds
s_waitcnt vmcnt(4)
ds_read_b64_tr_b16 a[0:1], v160 offset:8192
ds_read_b64_tr_b16 a[2:3], v160 offset:10240
ds_read_b64_tr_b16 a[4:5], v161 offset:8192
ds_read_b64_tr_b16 a[6:7], v161 offset:10240
ds_read_b64_tr_b16 a[8:9], v162 offset:8192
ds_read_b64_tr_b16 a[10:11], v162 offset:10240
ds_read_b64_tr_b16 a[12:13], v163 offset:8192
ds_read_b64_tr_b16 a[14:15], v163 offset:10240
s_add_u32 m0, s77, 4096
s_add_u32 s64, s39, 65536
buffer_load_dwordx4 v168, s[12:15], s64 offen nt lds
s_add_u32 m0, s77, 5120
s_add_u32 s64, s39, 81920
buffer_load_dwordx4 v168, s[12:15], s64 offen nt lds
s_add_u32 m0, s77, 6144
s_add_u32 s64, s39, 98304
buffer_load_dwordx4 v168, s[12:15], s64 offen nt lds
s_add_u32 m0, s77, 7168
s_add_u32 s64, s39, 114688
buffer_load_dwordx4 v168, s[12:15], s64 offen nt lds
s_setprio 1
s_waitcnt lgkmcnt(0)
v_mfma_f32_16x16x32_bf16 v[0:3], a[0:3], v[132:135], v[0:3]
ds_read_b128 a[32:35], v128 offset:0
v_mfma_f32_16x16x32_bf16 v[4:7], a[0:3], v[136:139], v[4:7]
ds_read_b128 a[36:39], v129 offset:0
v_mfma_f32_16x16x32_bf16 v[20:23], a[4:7], v[136:139], v[20:23]
ds_read_b128 a[40:43], v130 offset:0
v_mfma_f32_16x16x32_bf16 v[16:19], a[4:7], v[132:135], v[16:19]
ds_read_b128 a[44:47], v131 offset:0
v_mfma_f32_16x16x32_bf16 v[32:35], a[8:11], v[132:135], v[32:35]
ds_read_b128 a[48:51], v128 offset:4096
v_mfma_f32_16x16x32_bf16 v[36:39], a[8:11], v[136:139], v[36:39]
ds_read_b128 a[52:55], v129 offset:4096
v_mfma_f32_16x16x32_bf16 v[52:55], a[12:15], v[136:139], v[52:55]
ds_read_b128 a[56:59], v130 offset:4096
v_mfma_f32_16x16x32_bf16 v[48:51], a[12:15], v[132:135], v[48:51]
ds_read_b128 a[60:63], v131 offset:4096
v_mfma_f32_16x16x32_bf16 v[56:59], a[12:15], v[140:143], v[56:59]
ds_read_b128 a[64:67], v128 offset:8192
v_mfma_f32_16x16x32_bf16 v[60:63], a[12:15], v[144:147], v[60:63]
ds_read_b128 a[68:71], v129 offset:8192
v_mfma_f32_16x16x32_bf16 v[44:47], a[8:11], v[144:147], v[44:47]
ds_read_b128 a[72:75], v130 offset:8192
v_mfma_f32_16x16x32_bf16 v[40:43], a[8:11], v[140:143], v[40:43]
ds_read_b128 a[76:79], v131 offset:8192
v_mfma_f32_16x16x32_bf16 v[24:27], a[4:7], v[140:143], v[24:27]
v_mfma_f32_16x16x32_bf16 v[28:31], a[4:7], v[144:147], v[28:31]
v_mfma_f32_16x16x32_bf16 v[12:15], a[0:3], v[144:147], v[12:15]
v_mfma_f32_16x16x32_bf16 v[8:11], a[0:3], v[140:143], v[8:11]
ds_read_b128 v[132:135], v128 offset:12288
ds_read_b128 v[136:139], v129 offset:12288
ds_read_b128 v[140:143], v130 offset:12288
ds_read_b128 v[144:147], v131 offset:12288
s_add_u32 m0, s66, 0
s_add_u32 s64, s41, 0
buffer_load_dwordx4 v156, s[20:23], s64 offen offset:0 lds
buffer_load_dwordx4 v157, s[20:23], s64 offen offset:1024 lds
buffer_load_dwordx4 v158, s[20:23], s64 offen offset:2048 lds
buffer_load_dwordx4 v159, s[20:23], s64 offen offset:3072 lds
s_add_u32 m0, s66, 8192
s_add_u32 s64, s41, 28672
buffer_load_dwordx4 v156, s[20:23], s64 offen offset:0 lds
buffer_load_dwordx4 v157, s[20:23], s64 offen offset:1024 lds
buffer_load_dwordx4 v158, s[20:23], s64 offen offset:2048 lds
buffer_load_dwordx4 v159, s[20:23], s64 offen offset:3072 lds
s_waitcnt lgkmcnt(0)
s_waitcnt vmcnt(4)
ds_read_b64_tr_b16 a[0:1], v160 offset:0
ds_read_b64_tr_b16 a[2:3], v160 offset:2048
ds_read_b64_tr_b16 a[4:5], v161 offset:0
ds_read_b64_tr_b16 a[6:7], v161 offset:2048
ds_read_b64_tr_b16 a[8:9], v162 offset:0
ds_read_b64_tr_b16 a[10:11], v162 offset:2048
ds_read_b64_tr_b16 a[12:13], v163 offset:0
ds_read_b64_tr_b16 a[14:15], v163 offset:2048
s_barrier
s_setprio 3
s_setprio 1
s_waitcnt vmcnt(0) lgkmcnt(0)
v_mfma_f32_16x16x32_bf16 v[0:3], a[0:3], a[32:35], v[0:3]
ds_read_b64_tr_b16 a[16:17], v160 offset:8192
v_mfma_f32_16x16x32_bf16 v[4:7], a[0:3], a[36:39], v[4:7]
ds_read_b64_tr_b16 a[18:19], v160 offset:10240
v_mfma_f32_16x16x32_bf16 v[20:23], a[4:7], a[36:39], v[20:23]
ds_read_b64_tr_b16 a[20:21], v161 offset:8192
v_mfma_f32_16x16x32_bf16 v[16:19], a[4:7], a[32:35], v[16:19]
ds_read_b64_tr_b16 a[22:23], v161 offset:10240
v_mfma_f32_16x16x32_bf16 v[32:35], a[8:11], a[32:35], v[32:35]
ds_read_b64_tr_b16 a[24:25], v162 offset:8192
v_mfma_f32_16x16x32_bf16 v[36:39], a[8:11], a[36:39], v[36:39]
ds_read_b64_tr_b16 a[26:27], v162 offset:10240
v_mfma_f32_16x16x32_bf16 v[52:55], a[12:15], a[36:39], v[52:55]
ds_read_b64_tr_b16 a[28:29], v163 offset:8192
v_mfma_f32_16x16x32_bf16 v[48:51], a[12:15], a[32:35], v[48:51]
ds_read_b64_tr_b16 a[30:31], v163 offset:10240
v_mfma_f32_16x16x32_bf16 v[56:59], a[12:15], a[40:43], v[56:59]
s_add_u32 m0, s77, 33792
s_add_u32 s64, s39, 131072
buffer_load_dwordx4 v168, s[12:15], s64 offen nt lds
v_mfma_f32_16x16x32_bf16 v[60:63], a[12:15], a[44:47], v[60:63]
s_add_u32 m0, s77, 34816
s_add_u32 s64, s39, 147456
buffer_load_dwordx4 v168, s[12:15], s64 offen nt lds
v_mfma_f32_16x16x32_bf16 v[44:47], a[8:11], a[44:47], v[44:47]
s_add_u32 m0, s77, 35840
s_add_u32 s64, s39, 163840
buffer_load_dwordx4 v168, s[12:15], s64 offen nt lds
v_mfma_f32_16x16x32_bf16 v[40:43], a[8:11], a[40:43], v[40:43]
s_add_u32 m0, s77, 36864
s_add_u32 s64, s39, 180224
buffer_load_dwordx4 v168, s[12:15], s64 offen nt lds
v_mfma_f32_16x16x32_bf16 v[24:27], a[4:7], a[40:43], v[24:27]
s_add_u32 m0, s77, 37888
s_add_u32 s64, s39, 196608
buffer_load_dwordx4 v168, s[12:15], s64 offen nt lds
v_mfma_f32_16x16x32_bf16 v[28:31], a[4:7], a[44:47], v[28:31]
s_add_u32 m0, s77, 38912
s_add_u32 s64, s39, 212992
buffer_load_dwordx4 v168, s[12:15], s64 offen nt lds
v_mfma_f32_16x16x32_bf16 v[12:15], a[0:3], a[44:47], v[12:15]
s_add_u32 m0, s77, 39936
s_add_u32 s64, s39, 229376
buffer_load_dwordx4 v168, s[12:15], s64 offen nt lds
v_mfma_f32_16x16x32_bf16 v[8:11], a[0:3], a[40:43], v[8:11]
s_add_u32 m0, s77, 40960
s_add_u32 s64, s39, 245760
buffer_load_dwordx4 v168, s[12:15], s64 offen nt lds
s_waitcnt lgkmcnt(0)
v_mfma_f32_16x16x32_bf16 v[0:3], a[16:19], a[48:51], v[0:3]
s_add_u32 m0, s66, 0
s_add_u32 s64, s41, 229376
buffer_load_dwordx4 v156, s[20:23], s64 offen offset:0 lds
v_mfma_f32_16x16x32_bf16 v[4:7], a[16:19], a[52:55], v[4:7]
buffer_load_dwordx4 v157, s[20:23], s64 offen offset:1024 lds
v_mfma_f32_16x16x32_bf16 v[20:23], a[20:23], a[52:55], v[20:23]
buffer_load_dwordx4 v158, s[20:23], s64 offen offset:2048 lds
v_mfma_f32_16x16x32_bf16 v[16:19], a[20:23], a[48:51], v[16:19]
buffer_load_dwordx4 v159, s[20:23], s64 offen offset:3072 lds
v_mfma_f32_16x16x32_bf16 v[32:35], a[24:27], a[48:51], v[32:35]
v_mfma_f32_16x16x32_bf16 v[36:39], a[24:27], a[52:55], v[36:39]
v_mfma_f32_16x16x32_bf16 v[52:55], a[28:31], a[52:55], v[52:55]
v_mfma_f32_16x16x32_bf16 v[48:51], a[28:31], a[48:51], v[48:51]
v_mfma_f32_16x16x32_bf16 v[56:59], a[28:31], a[56:59], v[56:59]
v_mfma_f32_16x16x32_bf16 v[60:63], a[28:31], a[60:63], v[60:63]
v_mfma_f32_16x16x32_bf16 v[44:47], a[24:27], a[60:63], v[44:47]
v_mfma_f32_16x16x32_bf16 v[40:43], a[24:27], a[56:59], v[40:43]
v_mfma_f32_16x16x32_bf16 v[24:27], a[20:23], a[56:59], v[24:27]
v_mfma_f32_16x16x32_bf16 v[28:31], a[20:23], a[60:63], v[28:31]
v_mfma_f32_16x16x32_bf16 v[12:15], a[16:19], a[60:63], v[12:15]
v_mfma_f32_16x16x32_bf16 v[8:11], a[16:19], a[56:59], v[8:11]
s_add_u32 m0, s66, 8192
s_add_u32 s64, s41, 258048
buffer_load_dwordx4 v156, s[20:23], s64 offen offset:0 lds
buffer_load_dwordx4 v157, s[20:23], s64 offen offset:1024 lds
buffer_load_dwordx4 v158, s[20:23], s64 offen offset:2048 lds
buffer_load_dwordx4 v159, s[20:23], s64 offen offset:3072 lds
s_waitcnt vmcnt(8)
s_barrier
s_setprio 3
s_add_u32 m0, s68, 0
s_add_u32 s64, s32, 262144
buffer_load_dwordx4 v169, s[8:11], s64 offen nt lds
s_add_u32 m0, s68, 1056
s_add_u32 s64, s32, 266240
buffer_load_dwordx4 v169, s[8:11], s64 offen nt lds
s_add_u32 m0, s68, 2112
s_add_u32 s64, s32, 270336
buffer_load_dwordx4 v169, s[8:11], s64 offen nt lds
s_add_u32 m0, s68, 3168
s_add_u32 s64, s32, 274432
buffer_load_dwordx4 v169, s[8:11], s64 offen nt lds
s_waitcnt vmcnt(8)
ds_read_b64_tr_b16 a[0:1], v160 offset:0
ds_read_b64_tr_b16 a[2:3], v160 offset:2048
ds_read_b64_tr_b16 a[4:5], v161 offset:0
ds_read_b64_tr_b16 a[6:7], v161 offset:2048
ds_read_b64_tr_b16 a[8:9], v162 offset:0
ds_read_b64_tr_b16 a[10:11], v162 offset:2048
ds_read_b64_tr_b16 a[12:13], v163 offset:0
ds_read_b64_tr_b16 a[14:15], v163 offset:2048
s_add_u32 m0, s68, 4224
s_add_u32 s64, s32, 278528
buffer_load_dwordx4 v169, s[8:11], s64 offen nt lds
s_add_u32 m0, s68, 5280
s_add_u32 s64, s32, 282624
buffer_load_dwordx4 v169, s[8:11], s64 offen nt lds
s_add_u32 m0, s68, 6336
s_add_u32 s64, s32, 286720
buffer_load_dwordx4 v169, s[8:11], s64 offen nt lds
s_add_u32 m0, s68, 7392
s_add_u32 s64, s32, 290816
buffer_load_dwordx4 v169, s[8:11], s64 offen nt lds
s_setprio 1
s_waitcnt vmcnt(8) lgkmcnt(0)
v_mfma_f32_16x16x32_bf16 v[0:3], a[0:3], a[64:67], v[0:3]
ds_read_b64_tr_b16 a[16:17], v160 offset:8192
v_mfma_f32_16x16x32_bf16 v[4:7], a[0:3], a[68:71], v[4:7]
ds_read_b64_tr_b16 a[18:19], v160 offset:10240
v_mfma_f32_16x16x32_bf16 v[20:23], a[4:7], a[68:71], v[20:23]
ds_read_b64_tr_b16 a[20:21], v161 offset:8192
v_mfma_f32_16x16x32_bf16 v[16:19], a[4:7], a[64:67], v[16:19]
ds_read_b64_tr_b16 a[22:23], v161 offset:10240
v_mfma_f32_16x16x32_bf16 v[32:35], a[8:11], a[64:67], v[32:35]
ds_read_b64_tr_b16 a[24:25], v162 offset:8192
v_mfma_f32_16x16x32_bf16 v[36:39], a[8:11], a[68:71], v[36:39]
ds_read_b64_tr_b16 a[26:27], v162 offset:10240
v_mfma_f32_16x16x32_bf16 v[52:55], a[12:15], a[68:71], v[52:55]
ds_read_b64_tr_b16 a[28:29], v163 offset:8192
v_mfma_f32_16x16x32_bf16 v[48:51], a[12:15], a[64:67], v[48:51]
ds_read_b64_tr_b16 a[30:31], v163 offset:10240
v_mfma_f32_16x16x32_bf16 v[56:59], a[12:15], a[72:75], v[56:59]
v_mfma_f32_16x16x32_bf16 v[60:63], a[12:15], a[76:79], v[60:63]
v_mfma_f32_16x16x32_bf16 v[44:47], a[8:11], a[76:79], v[44:47]
v_mfma_f32_16x16x32_bf16 v[40:43], a[8:11], a[72:75], v[40:43]
v_mfma_f32_16x16x32_bf16 v[24:27], a[4:7], a[72:75], v[24:27]
v_mfma_f32_16x16x32_bf16 v[28:31], a[4:7], a[76:79], v[28:31]
v_mfma_f32_16x16x32_bf16 v[12:15], a[0:3], a[76:79], v[12:15]
v_mfma_f32_16x16x32_bf16 v[8:11], a[0:3], a[72:75], v[8:11]
s_waitcnt lgkmcnt(0)
v_mfma_f32_16x16x32_bf16 v[0:3], a[16:19], v[132:135], v[0:3]
ds_read_b128 a[32:35], v128 offset:0
v_mfma_f32_16x16x32_bf16 v[4:7], a[16:19], v[136:139], v[4:7]
ds_read_b128 a[36:39], v129 offset:0
v_mfma_f32_16x16x32_bf16 v[20:23], a[20:23], v[136:139], v[20:23]
ds_read_b128 a[40:43], v130 offset:0
v_mfma_f32_16x16x32_bf16 v[16:19], a[20:23], v[132:135], v[16:19]
ds_read_b128 a[44:47], v131 offset:0
v_mfma_f32_16x16x32_bf16 v[32:35], a[24:27], v[132:135], v[32:35]
ds_read_b128 a[48:51], v128 offset:4096
v_mfma_f32_16x16x32_bf16 v[36:39], a[24:27], v[136:139], v[36:39]
ds_read_b128 a[52:55], v129 offset:4096
v_mfma_f32_16x16x32_bf16 v[52:55], a[28:31], v[136:139], v[52:55]
ds_read_b128 a[56:59], v130 offset:4096
v_mfma_f32_16x16x32_bf16 v[48:51], a[28:31], v[132:135], v[48:51]
ds_read_b128 a[60:63], v131 offset:4096
v_mfma_f32_16x16x32_bf16 v[56:59], a[28:31], v[140:143], v[56:59]
ds_read_b128 a[64:67], v128 offset:8192
v_mfma_f32_16x16x32_bf16 v[60:63], a[28:31], v[144:147], v[60:63]
ds_read_b128 a[68:71], v129 offset:8192
v_mfma_f32_16x16x32_bf16 v[44:47], a[24:27], v[144:147], v[44:47]
ds_read_b128 a[72:75], v130 offset:8192
v_mfma_f32_16x16x32_bf16 v[40:43], a[24:27], v[140:143], v[40:43]
ds_read_b128 a[76:79], v131 offset:8192
v_mfma_f32_16x16x32_bf16 v[24:27], a[20:23], v[140:143], v[24:27]
v_mfma_f32_16x16x32_bf16 v[28:31], a[20:23], v[144:147], v[28:31]
v_mfma_f32_16x16x32_bf16 v[12:15], a[16:19], v[144:147], v[12:15]
v_mfma_f32_16x16x32_bf16 v[8:11], a[16:19], v[140:143], v[8:11]
ds_read_b128 v[132:135], v128 offset:12288
ds_read_b128 v[136:139], v129 offset:12288
ds_read_b128 v[140:143], v130 offset:12288
ds_read_b128 v[144:147], v131 offset:12288
s_waitcnt lgkmcnt(0)
s_waitcnt vmcnt(0)
s_barrier
s_add_u32 m0, s68, 33792
s_add_u32 s64, s33, 262144
buffer_load_dwordx4 v169, s[8:11], s64 offen nt lds
s_add_u32 m0, s68, 34848
s_add_u32 s64, s33, 266240
buffer_load_dwordx4 v169, s[8:11], s64 offen nt lds
s_add_u32 m0, s68, 35904
s_add_u32 s64, s33, 270336
buffer_load_dwordx4 v169, s[8:11], s64 offen nt lds
s_add_u32 m0, s68, 36960
s_add_u32 s64, s33, 274432
buffer_load_dwordx4 v169, s[8:11], s64 offen nt lds
s_add_u32 m0, s68, 38016
s_add_u32 s64, s33, 278528
buffer_load_dwordx4 v169, s[8:11], s64 offen nt lds
s_add_u32 m0, s68, 39072
s_add_u32 s64, s33, 282624
buffer_load_dwordx4 v169, s[8:11], s64 offen nt lds
s_add_u32 m0, s68, 40128
s_add_u32 s64, s33, 286720
buffer_load_dwordx4 v169, s[8:11], s64 offen nt lds
s_add_u32 m0, s68, 41184
s_add_u32 s64, s33, 290816
buffer_load_dwordx4 v169, s[8:11], s64 offen nt lds
s_add_u32 m0, s66, 0
s_add_u32 s64, s42, 0
buffer_load_dwordx4 v156, s[20:23], s64 offen offset:0 lds
buffer_load_dwordx4 v157, s[20:23], s64 offen offset:1024 lds
buffer_load_dwordx4 v158, s[20:23], s64 offen offset:2048 lds
buffer_load_dwordx4 v159, s[20:23], s64 offen offset:3072 lds
s_waitcnt vmcnt(4)
s_barrier
s_setprio 3
s_waitcnt vmcnt(0)
ds_read_b64_tr_b16 a[0:1], v160 offset:0
ds_read_b64_tr_b16 a[2:3], v160 offset:2048
ds_read_b64_tr_b16 a[4:5], v161 offset:0
ds_read_b64_tr_b16 a[6:7], v161 offset:2048
ds_read_b64_tr_b16 a[8:9], v162 offset:0
ds_read_b64_tr_b16 a[10:11], v162 offset:2048
ds_read_b64_tr_b16 a[12:13], v163 offset:0
ds_read_b64_tr_b16 a[14:15], v163 offset:2048
s_add_u32 m0, s68, 0
s_add_u32 s64, s34, 262144
buffer_load_dwordx4 v169, s[8:11], s64 offen nt lds
s_add_u32 m0, s68, 1056
s_add_u32 s64, s34, 266240
buffer_load_dwordx4 v169, s[8:11], s64 offen nt lds
s_add_u32 m0, s68, 2112
s_add_u32 s64, s34, 270336
buffer_load_dwordx4 v169, s[8:11], s64 offen nt lds
s_add_u32 m0, s68, 3168
s_add_u32 s64, s34, 274432
buffer_load_dwordx4 v169, s[8:11], s64 offen nt lds
s_add_u32 m0, s68, 4224
s_add_u32 s64, s34, 278528
buffer_load_dwordx4 v169, s[8:11], s64 offen nt lds
s_add_u32 m0, s68, 5280
s_add_u32 s64, s34, 282624
buffer_load_dwordx4 v169, s[8:11], s64 offen nt lds
s_add_u32 m0, s68, 6336
s_add_u32 s64, s34, 286720
buffer_load_dwordx4 v169, s[8:11], s64 offen nt lds
s_add_u32 m0, s68, 7392
s_add_u32 s64, s34, 290816
buffer_load_dwordx4 v169, s[8:11], s64 offen nt lds
s_setprio 1
s_waitcnt lgkmcnt(0)
v_mfma_f32_16x16x32_bf16 v[0:3], a[0:3], a[32:35], v[0:3]
v_mfma_f32_16x16x32_bf16 v[4:7], a[0:3], a[36:39], v[4:7]
v_mfma_f32_16x16x32_bf16 v[20:23], a[4:7], a[36:39], v[20:23]
v_mfma_f32_16x16x32_bf16 v[16:19], a[4:7], a[32:35], v[16:19]
v_mfma_f32_16x16x32_bf16 v[32:35], a[8:11], a[32:35], v[32:35]
v_mfma_f32_16x16x32_bf16 v[36:39], a[8:11], a[36:39], v[36:39]
v_mfma_f32_16x16x32_bf16 v[52:55], a[12:15], a[36:39], v[52:55]
v_mfma_f32_16x16x32_bf16 v[48:51], a[12:15], a[32:35], v[48:51]
v_mfma_f32_16x16x32_bf16 v[56:59], a[12:15], a[40:43], v[56:59]
v_mfma_f32_16x16x32_bf16 v[60:63], a[12:15], a[44:47], v[60:63]
v_mfma_f32_16x16x32_bf16 v[44:47], a[8:11], a[44:47], v[44:47]
v_mfma_f32_16x16x32_bf16 v[40:43], a[8:11], a[40:43], v[40:43]
v_mfma_f32_16x16x32_bf16 v[24:27], a[4:7], a[40:43], v[24:27]
v_mfma_f32_16x16x32_bf16 v[28:31], a[4:7], a[44:47], v[28:31]
v_mfma_f32_16x16x32_bf16 v[12:15], a[0:3], a[44:47], v[12:15]
v_mfma_f32_16x16x32_bf16 v[8:11], a[0:3], a[40:43], v[8:11]
s_add_u32 m0, s66, 8192
s_add_u32 s64, s42, 28672
buffer_load_dwordx4 v156, s[20:23], s64 offen offset:0 lds
buffer_load_dwordx4 v157, s[20:23], s64 offen offset:1024 lds
buffer_load_dwordx4 v158, s[20:23], s64 offen offset:2048 lds
buffer_load_dwordx4 v159, s[20:23], s64 offen offset:3072 lds
s_waitcnt vmcnt(4)
s_barrier
s_setprio 3
s_waitcnt vmcnt(0)
ds_read_b64_tr_b16 a[0:1], v160 offset:8192
ds_read_b64_tr_b16 a[2:3], v160 offset:10240
ds_read_b64_tr_b16 a[4:5], v161 offset:8192
ds_read_b64_tr_b16 a[6:7], v161 offset:10240
ds_read_b64_tr_b16 a[8:9], v162 offset:8192
ds_read_b64_tr_b16 a[10:11], v162 offset:10240
ds_read_b64_tr_b16 a[12:13], v163 offset:8192
ds_read_b64_tr_b16 a[14:15], v163 offset:10240
s_add_u32 m0, s68, 33792
s_add_u32 s64, s35, 262144
buffer_load_dwordx4 v169, s[8:11], s64 offen nt lds
s_add_u32 m0, s68, 34848
s_add_u32 s64, s35, 266240
buffer_load_dwordx4 v169, s[8:11], s64 offen nt lds
s_add_u32 m0, s68, 35904
s_add_u32 s64, s35, 270336
buffer_load_dwordx4 v169, s[8:11], s64 offen nt lds
s_add_u32 m0, s68, 36960
s_add_u32 s64, s35, 274432
buffer_load_dwordx4 v169, s[8:11], s64 offen nt lds
s_add_u32 m0, s68, 38016
s_add_u32 s64, s35, 278528
buffer_load_dwordx4 v169, s[8:11], s64 offen nt lds
s_add_u32 m0, s68, 39072
s_add_u32 s64, s35, 282624
buffer_load_dwordx4 v169, s[8:11], s64 offen nt lds
s_add_u32 m0, s68, 40128
s_add_u32 s64, s35, 286720
buffer_load_dwordx4 v169, s[8:11], s64 offen nt lds
s_add_u32 m0, s68, 41184
s_add_u32 s64, s35, 290816
buffer_load_dwordx4 v169, s[8:11], s64 offen nt lds
s_setprio 1
s_waitcnt lgkmcnt(0)
v_mfma_f32_16x16x32_bf16 v[0:3], a[0:3], a[48:51], v[0:3]
v_mfma_f32_16x16x32_bf16 v[4:7], a[0:3], a[52:55], v[4:7]
v_mfma_f32_16x16x32_bf16 v[20:23], a[4:7], a[52:55], v[20:23]
v_mfma_f32_16x16x32_bf16 v[16:19], a[4:7], a[48:51], v[16:19]
v_mfma_f32_16x16x32_bf16 v[32:35], a[8:11], a[48:51], v[32:35]
v_mfma_f32_16x16x32_bf16 v[36:39], a[8:11], a[52:55], v[36:39]
v_mfma_f32_16x16x32_bf16 v[52:55], a[12:15], a[52:55], v[52:55]
v_mfma_f32_16x16x32_bf16 v[48:51], a[12:15], a[48:51], v[48:51]
v_mfma_f32_16x16x32_bf16 v[56:59], a[12:15], a[56:59], v[56:59]
v_mfma_f32_16x16x32_bf16 v[60:63], a[12:15], a[60:63], v[60:63]
v_mfma_f32_16x16x32_bf16 v[44:47], a[8:11], a[60:63], v[44:47]
v_mfma_f32_16x16x32_bf16 v[40:43], a[8:11], a[56:59], v[40:43]
v_mfma_f32_16x16x32_bf16 v[24:27], a[4:7], a[56:59], v[24:27]
v_mfma_f32_16x16x32_bf16 v[28:31], a[4:7], a[60:63], v[28:31]
v_mfma_f32_16x16x32_bf16 v[12:15], a[0:3], a[60:63], v[12:15]
v_mfma_f32_16x16x32_bf16 v[8:11], a[0:3], a[56:59], v[8:11]
s_add_u32 m0, s66, 0
s_add_u32 s64, s42, 229376
buffer_load_dwordx4 v156, s[20:23], s64 offen offset:0 lds
buffer_load_dwordx4 v157, s[20:23], s64 offen offset:1024 lds
buffer_load_dwordx4 v158, s[20:23], s64 offen offset:2048 lds
buffer_load_dwordx4 v159, s[20:23], s64 offen offset:3072 lds
s_waitcnt vmcnt(4)
s_barrier
s_setprio 3
s_waitcnt vmcnt(0)
ds_read_b64_tr_b16 a[0:1], v160 offset:0
ds_read_b64_tr_b16 a[2:3], v160 offset:2048
ds_read_b64_tr_b16 a[4:5], v161 offset:0
ds_read_b64_tr_b16 a[6:7], v161 offset:2048
ds_read_b64_tr_b16 a[8:9], v162 offset:0
ds_read_b64_tr_b16 a[10:11], v162 offset:2048
ds_read_b64_tr_b16 a[12:13], v163 offset:0
ds_read_b64_tr_b16 a[14:15], v163 offset:2048
s_add_u32 m0, s68, 0
s_add_u32 s64, s32, 393216
buffer_load_dwordx4 v169, s[8:11], s64 offen nt lds
s_add_u32 m0, s68, 1056
s_add_u32 s64, s32, 397312
buffer_load_dwordx4 v169, s[8:11], s64 offen nt lds
s_add_u32 m0, s68, 2112
s_add_u32 s64, s32, 401408
buffer_load_dwordx4 v169, s[8:11], s64 offen nt lds
s_add_u32 m0, s68, 3168
s_add_u32 s64, s32, 405504
buffer_load_dwordx4 v169, s[8:11], s64 offen nt lds
s_add_u32 m0, s68, 4224
s_add_u32 s64, s32, 409600
buffer_load_dwordx4 v169, s[8:11], s64 offen nt lds
s_add_u32 m0, s68, 5280
s_add_u32 s64, s32, 413696
buffer_load_dwordx4 v169, s[8:11], s64 offen nt lds
s_add_u32 m0, s68, 6336
s_add_u32 s64, s32, 417792
buffer_load_dwordx4 v169, s[8:11], s64 offen nt lds
s_add_u32 m0, s68, 7392
s_add_u32 s64, s32, 421888
buffer_load_dwordx4 v169, s[8:11], s64 offen nt lds
s_setprio 1
s_waitcnt lgkmcnt(0)
v_mfma_f32_16x16x32_bf16 v[0:3], a[0:3], a[64:67], v[0:3]
v_mfma_f32_16x16x32_bf16 v[4:7], a[0:3], a[68:71], v[4:7]
v_mfma_f32_16x16x32_bf16 v[20:23], a[4:7], a[68:71], v[20:23]
v_mfma_f32_16x16x32_bf16 v[16:19], a[4:7], a[64:67], v[16:19]
v_mfma_f32_16x16x32_bf16 v[32:35], a[8:11], a[64:67], v[32:35]
v_mfma_f32_16x16x32_bf16 v[36:39], a[8:11], a[68:71], v[36:39]
v_mfma_f32_16x16x32_bf16 v[52:55], a[12:15], a[68:71], v[52:55]
v_mfma_f32_16x16x32_bf16 v[48:51], a[12:15], a[64:67], v[48:51]
v_mfma_f32_16x16x32_bf16 v[56:59], a[12:15], a[72:75], v[56:59]
v_mfma_f32_16x16x32_bf16 v[60:63], a[12:15], a[76:79], v[60:63]
v_mfma_f32_16x16x32_bf16 v[44:47], a[8:11], a[76:79], v[44:47]
v_mfma_f32_16x16x32_bf16 v[40:43], a[8:11], a[72:75], v[40:43]
v_mfma_f32_16x16x32_bf16 v[24:27], a[4:7], a[72:75], v[24:27]
v_mfma_f32_16x16x32_bf16 v[28:31], a[4:7], a[76:79], v[28:31]
v_mfma_f32_16x16x32_bf16 v[12:15], a[0:3], a[76:79], v[12:15]
v_mfma_f32_16x16x32_bf16 v[8:11], a[0:3], a[72:75], v[8:11]
s_add_u32 m0, s66, 8192
s_add_u32 s64, s42, 258048
buffer_load_dwordx4 v156, s[20:23], s64 offen offset:0 lds
buffer_load_dwordx4 v157, s[20:23], s64 offen offset:1024 lds
buffer_load_dwordx4 v158, s[20:23], s64 offen offset:2048 lds
buffer_load_dwordx4 v159, s[20:23], s64 offen offset:3072 lds
s_waitcnt vmcnt(4)
s_barrier
s_setprio 3
s_waitcnt vmcnt(0)
ds_read_b64_tr_b16 a[0:1], v160 offset:8192
ds_read_b64_tr_b16 a[2:3], v160 offset:10240
ds_read_b64_tr_b16 a[4:5], v161 offset:8192
ds_read_b64_tr_b16 a[6:7], v161 offset:10240
ds_read_b64_tr_b16 a[8:9], v162 offset:8192
ds_read_b64_tr_b16 a[10:11], v162 offset:10240
ds_read_b64_tr_b16 a[12:13], v163 offset:8192
ds_read_b64_tr_b16 a[14:15], v163 offset:10240
s_add_u32 m0, s68, 33792
s_add_u32 s64, s33, 393216
buffer_load_dwordx4 v169, s[8:11], s64 offen nt lds
s_add_u32 m0, s68, 34848
s_add_u32 s64, s33, 397312
buffer_load_dwordx4 v169, s[8:11], s64 offen nt lds
s_add_u32 m0, s68, 35904
s_add_u32 s64, s33, 401408
buffer_load_dwordx4 v169, s[8:11], s64 offen nt lds
s_add_u32 m0, s68, 36960
s_add_u32 s64, s33, 405504
buffer_load_dwordx4 v169, s[8:11], s64 offen nt lds
s_add_u32 m0, s68, 38016
s_add_u32 s64, s33, 409600
buffer_load_dwordx4 v169, s[8:11], s64 offen nt lds
s_add_u32 m0, s68, 39072
s_add_u32 s64, s33, 413696
buffer_load_dwordx4 v169, s[8:11], s64 offen nt lds
s_add_u32 m0, s68, 40128
s_add_u32 s64, s33, 417792
buffer_load_dwordx4 v169, s[8:11], s64 offen nt lds
s_add_u32 m0, s68, 41184
s_add_u32 s64, s33, 421888
buffer_load_dwordx4 v169, s[8:11], s64 offen nt lds
s_setprio 1
s_waitcnt lgkmcnt(0)
v_mfma_f32_16x16x32_bf16 v[0:3], a[0:3], v[132:135], v[0:3]
v_mfma_f32_16x16x32_bf16 v[4:7], a[0:3], v[136:139], v[4:7]
v_mfma_f32_16x16x32_bf16 v[20:23], a[4:7], v[136:139], v[20:23]
v_mfma_f32_16x16x32_bf16 v[16:19], a[4:7], v[132:135], v[16:19]
v_mfma_f32_16x16x32_bf16 v[32:35], a[8:11], v[132:135], v[32:35]
v_mfma_f32_16x16x32_bf16 v[36:39], a[8:11], v[136:139], v[36:39]
v_mfma_f32_16x16x32_bf16 v[52:55], a[12:15], v[136:139], v[52:55]
v_mfma_f32_16x16x32_bf16 v[48:51], a[12:15], v[132:135], v[48:51]
v_mfma_f32_16x16x32_bf16 v[56:59], a[12:15], v[140:143], v[56:59]
v_mfma_f32_16x16x32_bf16 v[60:63], a[12:15], v[144:147], v[60:63]
v_mfma_f32_16x16x32_bf16 v[44:47], a[8:11], v[144:147], v[44:47]
v_mfma_f32_16x16x32_bf16 v[40:43], a[8:11], v[140:143], v[40:43]
v_mfma_f32_16x16x32_bf16 v[24:27], a[4:7], v[140:143], v[24:27]
v_mfma_f32_16x16x32_bf16 v[28:31], a[4:7], v[144:147], v[28:31]
v_mfma_f32_16x16x32_bf16 v[12:15], a[0:3], v[144:147], v[12:15]
v_mfma_f32_16x16x32_bf16 v[8:11], a[0:3], v[140:143], v[8:11]
s_add_u32 m0, s66, 0
s_add_u32 s64, s43, 0
buffer_load_dwordx4 v156, s[20:23], s64 offen offset:0 lds
buffer_load_dwordx4 v157, s[20:23], s64 offen offset:1024 lds
buffer_load_dwordx4 v158, s[20:23], s64 offen offset:2048 lds
buffer_load_dwordx4 v159, s[20:23], s64 offen offset:3072 lds
s_waitcnt vmcnt(4)
s_barrier
s_setprio 3
s_waitcnt vmcnt(0)
ds_read_b64_tr_b16 a[0:1], v160 offset:0
ds_read_b64_tr_b16 a[2:3], v160 offset:2048
ds_read_b64_tr_b16 a[4:5], v161 offset:0
ds_read_b64_tr_b16 a[6:7], v161 offset:2048
ds_read_b64_tr_b16 a[8:9], v162 offset:0
ds_read_b64_tr_b16 a[10:11], v162 offset:2048
ds_read_b64_tr_b16 a[12:13], v163 offset:0
ds_read_b64_tr_b16 a[14:15], v163 offset:2048
ds_read_b128 a[32:35], v128 offset:0
ds_read_b128 a[36:39], v129 offset:0
ds_read_b128 a[40:43], v130 offset:0
ds_read_b128 a[44:47], v131 offset:0
s_add_u32 m0, s68, 0
s_add_u32 s64, s34, 393216
buffer_load_dwordx4 v169, s[8:11], s64 offen nt lds
s_add_u32 m0, s68, 1056
s_add_u32 s64, s34, 397312
buffer_load_dwordx4 v169, s[8:11], s64 offen nt lds
s_add_u32 m0, s68, 2112
s_add_u32 s64, s34, 401408
buffer_load_dwordx4 v169, s[8:11], s64 offen nt lds
s_add_u32 m0, s68, 3168
s_add_u32 s64, s34, 405504
buffer_load_dwordx4 v169, s[8:11], s64 offen nt lds
s_add_u32 m0, s68, 4224
s_add_u32 s64, s34, 409600
buffer_load_dwordx4 v169, s[8:11], s64 offen nt lds
s_add_u32 m0, s68, 5280
s_add_u32 s64, s34, 413696
buffer_load_dwordx4 v169, s[8:11], s64 offen nt lds
s_add_u32 m0, s68, 6336
s_add_u32 s64, s34, 417792
buffer_load_dwordx4 v169, s[8:11], s64 offen nt lds
s_add_u32 m0, s68, 7392
s_add_u32 s64, s34, 421888
buffer_load_dwordx4 v169, s[8:11], s64 offen nt lds
s_setprio 1
s_waitcnt lgkmcnt(0)
v_mfma_f32_16x16x32_bf16 v[0:3], a[0:3], a[32:35], v[0:3]
v_mfma_f32_16x16x32_bf16 v[4:7], a[0:3], a[36:39], v[4:7]
v_mfma_f32_16x16x32_bf16 v[20:23], a[4:7], a[36:39], v[20:23]
v_mfma_f32_16x16x32_bf16 v[16:19], a[4:7], a[32:35], v[16:19]
v_mfma_f32_16x16x32_bf16 v[32:35], a[8:11], a[32:35], v[32:35]
v_mfma_f32_16x16x32_bf16 v[36:39], a[8:11], a[36:39], v[36:39]
v_mfma_f32_16x16x32_bf16 v[52:55], a[12:15], a[36:39], v[52:55]
v_mfma_f32_16x16x32_bf16 v[48:51], a[12:15], a[32:35], v[48:51]
v_mfma_f32_16x16x32_bf16 v[56:59], a[12:15], a[40:43], v[56:59]
v_mfma_f32_16x16x32_bf16 v[60:63], a[12:15], a[44:47], v[60:63]
v_mfma_f32_16x16x32_bf16 v[44:47], a[8:11], a[44:47], v[44:47]
v_mfma_f32_16x16x32_bf16 v[40:43], a[8:11], a[40:43], v[40:43]
v_mfma_f32_16x16x32_bf16 v[24:27], a[4:7], a[40:43], v[24:27]
v_mfma_f32_16x16x32_bf16 v[28:31], a[4:7], a[44:47], v[28:31]
v_mfma_f32_16x16x32_bf16 v[12:15], a[0:3], a[44:47], v[12:15]
v_mfma_f32_16x16x32_bf16 v[8:11], a[0:3], a[40:43], v[8:11]
s_add_u32 m0, s66, 8192
s_add_u32 s64, s43, 28672
buffer_load_dwordx4 v156, s[20:23], s64 offen offset:0 lds
buffer_load_dwordx4 v157, s[20:23], s64 offen offset:1024 lds
buffer_load_dwordx4 v158, s[20:23], s64 offen offset:2048 lds
buffer_load_dwordx4 v159, s[20:23], s64 offen offset:3072 lds
s_waitcnt vmcnt(4)
s_barrier
s_setprio 3
s_waitcnt vmcnt(0)
ds_read_b64_tr_b16 a[0:1], v160 offset:8192
ds_read_b64_tr_b16 a[2:3], v160 offset:10240
ds_read_b64_tr_b16 a[4:5], v161 offset:8192
ds_read_b64_tr_b16 a[6:7], v161 offset:10240
ds_read_b64_tr_b16 a[8:9], v162 offset:8192
ds_read_b64_tr_b16 a[10:11], v162 offset:10240
ds_read_b64_tr_b16 a[12:13], v163 offset:8192
ds_read_b64_tr_b16 a[14:15], v163 offset:10240
ds_read_b128 a[48:51], v128 offset:4096
ds_read_b128 a[52:55], v129 offset:4096
ds_read_b128 a[56:59], v130 offset:4096
ds_read_b128 a[60:63], v131 offset:4096
s_add_u32 m0, s68, 33792
s_add_u32 s64, s35, 393216
buffer_load_dwordx4 v169, s[8:11], s64 offen nt lds
s_add_u32 m0, s68, 34848
s_add_u32 s64, s35, 397312
buffer_load_dwordx4 v169, s[8:11], s64 offen nt lds
s_add_u32 m0, s68, 35904
s_add_u32 s64, s35, 401408
buffer_load_dwordx4 v169, s[8:11], s64 offen nt lds
s_add_u32 m0, s68, 36960
s_add_u32 s64, s35, 405504
buffer_load_dwordx4 v169, s[8:11], s64 offen nt lds
s_add_u32 m0, s68, 38016
s_add_u32 s64, s35, 409600
buffer_load_dwordx4 v169, s[8:11], s64 offen nt lds
s_add_u32 m0, s68, 39072
s_add_u32 s64, s35, 413696
buffer_load_dwordx4 v169, s[8:11], s64 offen nt lds
s_add_u32 m0, s68, 40128
s_add_u32 s64, s35, 417792
buffer_load_dwordx4 v169, s[8:11], s64 offen nt lds
s_add_u32 m0, s68, 41184
s_add_u32 s64, s35, 421888
buffer_load_dwordx4 v169, s[8:11], s64 offen nt lds
s_setprio 1
s_waitcnt lgkmcnt(0)
v_mfma_f32_16x16x32_bf16 v[0:3], a[0:3], a[48:51], v[0:3]
v_mfma_f32_16x16x32_bf16 v[4:7], a[0:3], a[52:55], v[4:7]
v_mfma_f32_16x16x32_bf16 v[20:23], a[4:7], a[52:55], v[20:23]
v_mfma_f32_16x16x32_bf16 v[16:19], a[4:7], a[48:51], v[16:19]
v_mfma_f32_16x16x32_bf16 v[32:35], a[8:11], a[48:51], v[32:35]
v_mfma_f32_16x16x32_bf16 v[36:39], a[8:11], a[52:55], v[36:39]
v_mfma_f32_16x16x32_bf16 v[52:55], a[12:15], a[52:55], v[52:55]
v_mfma_f32_16x16x32_bf16 v[48:51], a[12:15], a[48:51], v[48:51]
v_mfma_f32_16x16x32_bf16 v[56:59], a[12:15], a[56:59], v[56:59]
v_mfma_f32_16x16x32_bf16 v[60:63], a[12:15], a[60:63], v[60:63]
v_mfma_f32_16x16x32_bf16 v[44:47], a[8:11], a[60:63], v[44:47]
v_mfma_f32_16x16x32_bf16 v[40:43], a[8:11], a[56:59], v[40:43]
v_mfma_f32_16x16x32_bf16 v[24:27], a[4:7], a[56:59], v[24:27]
v_mfma_f32_16x16x32_bf16 v[28:31], a[4:7], a[60:63], v[28:31]
v_mfma_f32_16x16x32_bf16 v[12:15], a[0:3], a[60:63], v[12:15]
v_mfma_f32_16x16x32_bf16 v[8:11], a[0:3], a[56:59], v[8:11]
s_add_u32 m0, s66, 0
s_add_u32 s64, s43, 229376
buffer_load_dwordx4 v156, s[20:23], s64 offen offset:0 lds
buffer_load_dwordx4 v157, s[20:23], s64 offen offset:1024 lds
buffer_load_dwordx4 v158, s[20:23], s64 offen offset:2048 lds
buffer_load_dwordx4 v159, s[20:23], s64 offen offset:3072 lds
s_waitcnt vmcnt(4)
s_barrier
s_setprio 3
s_waitcnt vmcnt(0)
ds_read_b64_tr_b16 a[0:1], v160 offset:0
ds_read_b64_tr_b16 a[2:3], v160 offset:2048
ds_read_b64_tr_b16 a[4:5], v161 offset:0
ds_read_b64_tr_b16 a[6:7], v161 offset:2048
ds_read_b64_tr_b16 a[8:9], v162 offset:0
ds_read_b64_tr_b16 a[10:11], v162 offset:2048
ds_read_b64_tr_b16 a[12:13], v163 offset:0
ds_read_b64_tr_b16 a[14:15], v163 offset:2048
ds_read_b128 a[64:67], v128 offset:8192
ds_read_b128 a[68:71], v129 offset:8192
ds_read_b128 a[72:75], v130 offset:8192
ds_read_b128 a[76:79], v131 offset:8192
s_add_u32 m0, s77, 0
s_add_u32 s64, s36, 262144
buffer_load_dwordx4 v168, s[12:15], s64 offen nt lds
s_add_u32 m0, s77, 1024
s_add_u32 s64, s36, 278528
buffer_load_dwordx4 v168, s[12:15], s64 offen nt lds
s_add_u32 m0, s77, 2048
s_add_u32 s64, s36, 294912
buffer_load_dwordx4 v168, s[12:15], s64 offen nt lds
s_add_u32 m0, s77, 3072
s_add_u32 s64, s36, 311296
buffer_load_dwordx4 v168, s[12:15], s64 offen nt lds
s_add_u32 m0, s77, 4096
s_add_u32 s64, s36, 327680
buffer_load_dwordx4 v168, s[12:15], s64 offen nt lds
s_add_u32 m0, s77, 5120
s_add_u32 s64, s36, 344064
buffer_load_dwordx4 v168, s[12:15], s64 offen nt lds
s_add_u32 m0, s77, 6144
s_add_u32 s64, s36, 360448
buffer_load_dwordx4 v168, s[12:15], s64 offen nt lds
s_add_u32 m0, s77, 7168
s_add_u32 s64, s36, 376832
buffer_load_dwordx4 v168, s[12:15], s64 offen nt lds
s_setprio 1
s_waitcnt lgkmcnt(0)
v_mfma_f32_16x16x32_bf16 v[0:3], a[0:3], a[64:67], v[0:3]
v_mfma_f32_16x16x32_bf16 v[4:7], a[0:3], a[68:71], v[4:7]
v_mfma_f32_16x16x32_bf16 v[20:23], a[4:7], a[68:71], v[20:23]
v_mfma_f32_16x16x32_bf16 v[16:19], a[4:7], a[64:67], v[16:19]
v_mfma_f32_16x16x32_bf16 v[32:35], a[8:11], a[64:67], v[32:35]
v_mfma_f32_16x16x32_bf16 v[36:39], a[8:11], a[68:71], v[36:39]
v_mfma_f32_16x16x32_bf16 v[52:55], a[12:15], a[68:71], v[52:55]
v_mfma_f32_16x16x32_bf16 v[48:51], a[12:15], a[64:67], v[48:51]
v_mfma_f32_16x16x32_bf16 v[56:59], a[12:15], a[72:75], v[56:59]
v_mfma_f32_16x16x32_bf16 v[60:63], a[12:15], a[76:79], v[60:63]
v_mfma_f32_16x16x32_bf16 v[44:47], a[8:11], a[76:79], v[44:47]
v_mfma_f32_16x16x32_bf16 v[40:43], a[8:11], a[72:75], v[40:43]
v_mfma_f32_16x16x32_bf16 v[24:27], a[4:7], a[72:75], v[24:27]
v_mfma_f32_16x16x32_bf16 v[28:31], a[4:7], a[76:79], v[28:31]
v_mfma_f32_16x16x32_bf16 v[12:15], a[0:3], a[76:79], v[12:15]
v_mfma_f32_16x16x32_bf16 v[8:11], a[0:3], a[72:75], v[8:11]
s_add_u32 m0, s66, 8192
s_add_u32 s64, s43, 258048
buffer_load_dwordx4 v156, s[20:23], s64 offen offset:0 lds
buffer_load_dwordx4 v157, s[20:23], s64 offen offset:1024 lds
buffer_load_dwordx4 v158, s[20:23], s64 offen offset:2048 lds
buffer_load_dwordx4 v159, s[20:23], s64 offen offset:3072 lds
s_waitcnt vmcnt(4)
s_barrier
s_setprio 3
s_waitcnt vmcnt(0)
ds_read_b64_tr_b16 a[0:1], v160 offset:8192
ds_read_b64_tr_b16 a[2:3], v160 offset:10240
ds_read_b64_tr_b16 a[4:5], v161 offset:8192
ds_read_b64_tr_b16 a[6:7], v161 offset:10240
ds_read_b64_tr_b16 a[8:9], v162 offset:8192
ds_read_b64_tr_b16 a[10:11], v162 offset:10240
ds_read_b64_tr_b16 a[12:13], v163 offset:8192
ds_read_b64_tr_b16 a[14:15], v163 offset:10240
ds_read_b128 v[132:135], v128 offset:12288
ds_read_b128 v[136:139], v129 offset:12288
ds_read_b128 v[140:143], v130 offset:12288
ds_read_b128 v[144:147], v131 offset:12288
s_add_u32 m0, s77, 33792
s_add_u32 s64, s36, 393216
buffer_load_dwordx4 v168, s[12:15], s64 offen nt lds
s_add_u32 m0, s77, 34816
s_add_u32 s64, s36, 409600
buffer_load_dwordx4 v168, s[12:15], s64 offen nt lds
s_add_u32 m0, s77, 35840
s_add_u32 s64, s36, 425984
buffer_load_dwordx4 v168, s[12:15], s64 offen nt lds
s_add_u32 m0, s77, 36864
s_add_u32 s64, s36, 442368
buffer_load_dwordx4 v168, s[12:15], s64 offen nt lds
s_add_u32 m0, s77, 37888
s_add_u32 s64, s36, 458752
buffer_load_dwordx4 v168, s[12:15], s64 offen nt lds
s_add_u32 m0, s77, 38912
s_add_u32 s64, s36, 475136
buffer_load_dwordx4 v168, s[12:15], s64 offen nt lds
s_add_u32 m0, s77, 39936
s_add_u32 s64, s36, 491520
buffer_load_dwordx4 v168, s[12:15], s64 offen nt lds
s_add_u32 m0, s77, 40960
s_add_u32 s64, s36, 507904
buffer_load_dwordx4 v168, s[12:15], s64 offen nt lds
s_setprio 1
s_waitcnt lgkmcnt(0)
v_mfma_f32_16x16x32_bf16 v[0:3], a[0:3], v[132:135], v[0:3]
v_mfma_f32_16x16x32_bf16 v[4:7], a[0:3], v[136:139], v[4:7]
v_mfma_f32_16x16x32_bf16 v[20:23], a[4:7], v[136:139], v[20:23]
v_mfma_f32_16x16x32_bf16 v[16:19], a[4:7], v[132:135], v[16:19]
v_mfma_f32_16x16x32_bf16 v[32:35], a[8:11], v[132:135], v[32:35]
v_mfma_f32_16x16x32_bf16 v[36:39], a[8:11], v[136:139], v[36:39]
v_mfma_f32_16x16x32_bf16 v[52:55], a[12:15], v[136:139], v[52:55]
v_mfma_f32_16x16x32_bf16 v[48:51], a[12:15], v[132:135], v[48:51]
v_mfma_f32_16x16x32_bf16 v[56:59], a[12:15], v[140:143], v[56:59]
v_mfma_f32_16x16x32_bf16 v[60:63], a[12:15], v[144:147], v[60:63]
v_mfma_f32_16x16x32_bf16 v[44:47], a[8:11], v[144:147], v[44:47]
v_mfma_f32_16x16x32_bf16 v[40:43], a[8:11], v[140:143], v[40:43]
v_mfma_f32_16x16x32_bf16 v[24:27], a[4:7], v[140:143], v[24:27]
v_mfma_f32_16x16x32_bf16 v[28:31], a[4:7], v[144:147], v[28:31]
v_mfma_f32_16x16x32_bf16 v[12:15], a[0:3], v[144:147], v[12:15]
v_mfma_f32_16x16x32_bf16 v[8:11], a[0:3], v[140:143], v[8:11]
s_waitcnt vmcnt(0)
s_barrier
s_add_u32 m0, s77, 0
s_add_u32 s64, s37, 262144
buffer_load_dwordx4 v168, s[12:15], s64 offen nt lds
s_add_u32 m0, s77, 1024
s_add_u32 s64, s37, 278528
buffer_load_dwordx4 v168, s[12:15], s64 offen nt lds
s_add_u32 m0, s77, 2048
s_add_u32 s64, s37, 294912
buffer_load_dwordx4 v168, s[12:15], s64 offen nt lds
s_add_u32 m0, s77, 3072
s_add_u32 s64, s37, 311296
buffer_load_dwordx4 v168, s[12:15], s64 offen nt lds
s_add_u32 m0, s77, 4096
s_add_u32 s64, s37, 327680
buffer_load_dwordx4 v168, s[12:15], s64 offen nt lds
s_add_u32 m0, s77, 5120
s_add_u32 s64, s37, 344064
buffer_load_dwordx4 v168, s[12:15], s64 offen nt lds
s_add_u32 m0, s77, 6144
s_add_u32 s64, s37, 360448
buffer_load_dwordx4 v168, s[12:15], s64 offen nt lds
s_add_u32 m0, s77, 7168
s_add_u32 s64, s37, 376832
buffer_load_dwordx4 v168, s[12:15], s64 offen nt lds
s_barrier
s_add_u32 m0, s66, 0
s_add_u32 s64, s40, 458752
buffer_load_dwordx4 v156, s[20:23], s64 offen offset:0 lds
buffer_load_dwordx4 v157, s[20:23], s64 offen offset:1024 lds
buffer_load_dwordx4 v158, s[20:23], s64 offen offset:2048 lds
buffer_load_dwordx4 v159, s[20:23], s64 offen offset:3072 lds
s_waitcnt vmcnt(4)
s_barrier
s_setprio 3
s_add_u32 m0, s77, 33792
s_add_u32 s64, s37, 393216
buffer_load_dwordx4 v168, s[12:15], s64 offen nt lds
s_add_u32 m0, s77, 34816
s_add_u32 s64, s37, 409600
buffer_load_dwordx4 v168, s[12:15], s64 offen nt lds
s_add_u32 m0, s77, 35840
s_add_u32 s64, s37, 425984
buffer_load_dwordx4 v168, s[12:15], s64 offen nt lds
s_add_u32 m0, s77, 36864
s_add_u32 s64, s37, 442368
buffer_load_dwordx4 v168, s[12:15], s64 offen nt lds
s_waitcnt vmcnt(4)
ds_read_b64_tr_b16 a[0:1], v160 offset:0
ds_read_b64_tr_b16 a[2:3], v160 offset:2048
ds_read_b64_tr_b16 a[4:5], v161 offset:0
ds_read_b64_tr_b16 a[6:7], v161 offset:2048
ds_read_b64_tr_b16 a[8:9], v162 offset:0
ds_read_b64_tr_b16 a[10:11], v162 offset:2048
ds_read_b64_tr_b16 a[12:13], v163 offset:0
ds_read_b64_tr_b16 a[14:15], v163 offset:2048
s_add_u32 m0, s77, 37888
s_add_u32 s64, s37, 458752
buffer_load_dwordx4 v168, s[12:15], s64 offen nt lds
s_add_u32 m0, s77, 38912
s_add_u32 s64, s37, 475136
buffer_load_dwordx4 v168, s[12:15], s64 offen nt lds
s_add_u32 m0, s77, 39936
s_add_u32 s64, s37, 491520
buffer_load_dwordx4 v168, s[12:15], s64 offen nt lds
s_add_u32 m0, s77, 40960
s_add_u32 s64, s37, 507904
buffer_load_dwordx4 v168, s[12:15], s64 offen nt lds
s_barrier
ds_read_b128 a[32:35], v128 offset:0
ds_read_b128 a[36:39], v129 offset:0
ds_read_b128 a[40:43], v130 offset:0
ds_read_b128 a[44:47], v131 offset:0
s_setprio 1
s_waitcnt lgkmcnt(0)
v_mfma_f32_16x16x32_bf16 v[0:3], a[0:3], a[32:35], v[0:3]
v_mfma_f32_16x16x32_bf16 v[4:7], a[0:3], a[36:39], v[4:7]
v_mfma_f32_16x16x32_bf16 v[20:23], a[4:7], a[36:39], v[20:23]
v_mfma_f32_16x16x32_bf16 v[16:19], a[4:7], a[32:35], v[16:19]
v_mfma_f32_16x16x32_bf16 v[32:35], a[8:11], a[32:35], v[32:35]
v_mfma_f32_16x16x32_bf16 v[36:39], a[8:11], a[36:39], v[36:39]
v_mfma_f32_16x16x32_bf16 v[52:55], a[12:15], a[36:39], v[52:55]
v_mfma_f32_16x16x32_bf16 v[48:51], a[12:15], a[32:35], v[48:51]
v_mfma_f32_16x16x32_bf16 v[56:59], a[12:15], a[40:43], v[56:59]
v_mfma_f32_16x16x32_bf16 v[60:63], a[12:15], a[44:47], v[60:63]
v_mfma_f32_16x16x32_bf16 v[44:47], a[8:11], a[44:47], v[44:47]
v_mfma_f32_16x16x32_bf16 v[40:43], a[8:11], a[40:43], v[40:43]
v_mfma_f32_16x16x32_bf16 v[24:27], a[4:7], a[40:43], v[24:27]
v_mfma_f32_16x16x32_bf16 v[28:31], a[4:7], a[44:47], v[28:31]
v_mfma_f32_16x16x32_bf16 v[12:15], a[0:3], a[44:47], v[12:15]
v_mfma_f32_16x16x32_bf16 v[8:11], a[0:3], a[40:43], v[8:11]
s_add_u32 m0, s66, 8192
s_add_u32 s64, s40, 487424
buffer_load_dwordx4 v156, s[20:23], s64 offen offset:0 lds
buffer_load_dwordx4 v157, s[20:23], s64 offen offset:1024 lds
buffer_load_dwordx4 v158, s[20:23], s64 offen offset:2048 lds
buffer_load_dwordx4 v159, s[20:23], s64 offen offset:3072 lds
s_waitcnt vmcnt(4)
s_barrier
s_setprio 3
s_add_u32 m0, s77, 0
s_add_u32 s64, s38, 262144
buffer_load_dwordx4 v168, s[12:15], s64 offen nt lds
s_add_u32 m0, s77, 1024
s_add_u32 s64, s38, 278528
buffer_load_dwordx4 v168, s[12:15], s64 offen nt lds
s_add_u32 m0, s77, 2048
s_add_u32 s64, s38, 294912
buffer_load_dwordx4 v168, s[12:15], s64 offen nt lds
s_add_u32 m0, s77, 3072
s_add_u32 s64, s38, 311296
buffer_load_dwordx4 v168, s[12:15], s64 offen nt lds
s_waitcnt vmcnt(4)
ds_read_b64_tr_b16 a[0:1], v160 offset:8192
ds_read_b64_tr_b16 a[2:3], v160 offset:10240
ds_read_b64_tr_b16 a[4:5], v161 offset:8192
ds_read_b64_tr_b16 a[6:7], v161 offset:10240
ds_read_b64_tr_b16 a[8:9], v162 offset:8192
ds_read_b64_tr_b16 a[10:11], v162 offset:10240
ds_read_b64_tr_b16 a[12:13], v163 offset:8192
ds_read_b64_tr_b16 a[14:15], v163 offset:10240
ds_read_b128 a[48:51], v128 offset:4096
ds_read_b128 a[52:55], v129 offset:4096
ds_read_b128 a[56:59], v130 offset:4096
ds_read_b128 a[60:63], v131 offset:4096
s_add_u32 m0, s77, 4096
s_add_u32 s64, s38, 327680
buffer_load_dwordx4 v168, s[12:15], s64 offen nt lds
s_add_u32 m0, s77, 5120
s_add_u32 s64, s38, 344064
buffer_load_dwordx4 v168, s[12:15], s64 offen nt lds
s_add_u32 m0, s77, 6144
s_add_u32 s64, s38, 360448
buffer_load_dwordx4 v168, s[12:15], s64 offen nt lds
s_add_u32 m0, s77, 7168
s_add_u32 s64, s38, 376832
buffer_load_dwordx4 v168, s[12:15], s64 offen nt lds
s_setprio 1
s_waitcnt lgkmcnt(0)
v_mfma_f32_16x16x32_bf16 v[0:3], a[0:3], a[48:51], v[0:3]
ds_read_b128 a[64:67], v128 offset:8192
v_mfma_f32_16x16x32_bf16 v[4:7], a[0:3], a[52:55], v[4:7]
ds_read_b128 a[68:71], v129 offset:8192
v_mfma_f32_16x16x32_bf16 v[20:23], a[4:7], a[52:55], v[20:23]
ds_read_b128 a[72:75], v130 offset:8192
v_mfma_f32_16x16x32_bf16 v[16:19], a[4:7], a[48:51], v[16:19]
ds_read_b128 a[76:79], v131 offset:8192
v_mfma_f32_16x16x32_bf16 v[32:35], a[8:11], a[48:51], v[32:35]
ds_read_b128 a[32:35], v128 offset:12288
v_mfma_f32_16x16x32_bf16 v[36:39], a[8:11], a[52:55], v[36:39]
ds_read_b128 a[36:39], v129 offset:12288
v_mfma_f32_16x16x32_bf16 v[52:55], a[12:15], a[52:55], v[52:55]
ds_read_b128 a[40:43], v130 offset:12288
v_mfma_f32_16x16x32_bf16 v[48:51], a[12:15], a[48:51], v[48:51]
ds_read_b128 a[44:47], v131 offset:12288
v_mfma_f32_16x16x32_bf16 v[56:59], a[12:15], a[56:59], v[56:59]
v_mfma_f32_16x16x32_bf16 v[60:63], a[12:15], a[60:63], v[60:63]
v_mfma_f32_16x16x32_bf16 v[44:47], a[8:11], a[60:63], v[44:47]
v_mfma_f32_16x16x32_bf16 v[40:43], a[8:11], a[56:59], v[40:43]
v_mfma_f32_16x16x32_bf16 v[24:27], a[4:7], a[56:59], v[24:27]
v_mfma_f32_16x16x32_bf16 v[28:31], a[4:7], a[60:63], v[28:31]
v_mfma_f32_16x16x32_bf16 v[12:15], a[0:3], a[60:63], v[12:15]
v_mfma_f32_16x16x32_bf16 v[8:11], a[0:3], a[56:59], v[8:11]
s_add_u32 m0, s66, 0
s_add_u32 s64, s40, 688128
buffer_load_dwordx4 v156, s[20:23], s64 offen offset:0 lds
buffer_load_dwordx4 v157, s[20:23], s64 offen offset:1024 lds
buffer_load_dwordx4 v158, s[20:23], s64 offen offset:2048 lds
buffer_load_dwordx4 v159, s[20:23], s64 offen offset:3072 lds
s_add_u32 m0, s66, 8192
s_add_u32 s64, s40, 716800
buffer_load_dwordx4 v156, s[20:23], s64 offen offset:0 lds
buffer_load_dwordx4 v157, s[20:23], s64 offen offset:1024 lds
buffer_load_dwordx4 v158, s[20:23], s64 offen offset:2048 lds
buffer_load_dwordx4 v159, s[20:23], s64 offen offset:3072 lds
s_waitcnt lgkmcnt(0)
s_waitcnt vmcnt(4)
ds_read_b64_tr_b16 a[0:1], v160 offset:0
ds_read_b64_tr_b16 a[2:3], v160 offset:2048
ds_read_b64_tr_b16 a[4:5], v161 offset:0
ds_read_b64_tr_b16 a[6:7], v161 offset:2048
ds_read_b64_tr_b16 a[8:9], v162 offset:0
ds_read_b64_tr_b16 a[10:11], v162 offset:2048
ds_read_b64_tr_b16 a[12:13], v163 offset:0
ds_read_b64_tr_b16 a[14:15], v163 offset:2048
s_barrier
s_setprio 3
s_setprio 1
s_waitcnt vmcnt(0) lgkmcnt(0)
v_mfma_f32_16x16x32_bf16 v[0:3], a[0:3], a[64:67], v[0:3]
ds_read_b64_tr_b16 a[16:17], v160 offset:8192
v_mfma_f32_16x16x32_bf16 v[4:7], a[0:3], a[68:71], v[4:7]
ds_read_b64_tr_b16 a[18:19], v160 offset:10240
v_mfma_f32_16x16x32_bf16 v[20:23], a[4:7], a[68:71], v[20:23]
ds_read_b64_tr_b16 a[20:21], v161 offset:8192
v_mfma_f32_16x16x32_bf16 v[16:19], a[4:7], a[64:67], v[16:19]
ds_read_b64_tr_b16 a[22:23], v161 offset:10240
v_mfma_f32_16x16x32_bf16 v[32:35], a[8:11], a[64:67], v[32:35]
ds_read_b64_tr_b16 a[24:25], v162 offset:8192
v_mfma_f32_16x16x32_bf16 v[36:39], a[8:11], a[68:71], v[36:39]
ds_read_b64_tr_b16 a[26:27], v162 offset:10240
v_mfma_f32_16x16x32_bf16 v[52:55], a[12:15], a[68:71], v[52:55]
ds_read_b64_tr_b16 a[28:29], v163 offset:8192
v_mfma_f32_16x16x32_bf16 v[48:51], a[12:15], a[64:67], v[48:51]
ds_read_b64_tr_b16 a[30:31], v163 offset:10240
v_mfma_f32_16x16x32_bf16 v[56:59], a[12:15], a[72:75], v[56:59]
s_add_u32 m0, s77, 33792
s_add_u32 s64, s38, 393216
buffer_load_dwordx4 v168, s[12:15], s64 offen nt lds
v_mfma_f32_16x16x32_bf16 v[60:63], a[12:15], a[76:79], v[60:63]
s_add_u32 m0, s77, 34816
s_add_u32 s64, s38, 409600
buffer_load_dwordx4 v168, s[12:15], s64 offen nt lds
v_mfma_f32_16x16x32_bf16 v[44:47], a[8:11], a[76:79], v[44:47]
s_add_u32 m0, s77, 35840
s_add_u32 s64, s38, 425984
buffer_load_dwordx4 v168, s[12:15], s64 offen nt lds
v_mfma_f32_16x16x32_bf16 v[40:43], a[8:11], a[72:75], v[40:43]
s_add_u32 m0, s77, 36864
s_add_u32 s64, s38, 442368
buffer_load_dwordx4 v168, s[12:15], s64 offen nt lds
v_mfma_f32_16x16x32_bf16 v[24:27], a[4:7], a[72:75], v[24:27]
s_add_u32 m0, s77, 37888
s_add_u32 s64, s38, 458752
buffer_load_dwordx4 v168, s[12:15], s64 offen nt lds
v_mfma_f32_16x16x32_bf16 v[28:31], a[4:7], a[76:79], v[28:31]
s_add_u32 m0, s77, 38912
s_add_u32 s64, s38, 475136
buffer_load_dwordx4 v168, s[12:15], s64 offen nt lds
v_mfma_f32_16x16x32_bf16 v[12:15], a[0:3], a[76:79], v[12:15]
s_add_u32 m0, s77, 39936
s_add_u32 s64, s38, 491520
buffer_load_dwordx4 v168, s[12:15], s64 offen nt lds
v_mfma_f32_16x16x32_bf16 v[8:11], a[0:3], a[72:75], v[8:11]
s_add_u32 m0, s77, 40960
s_add_u32 s64, s38, 507904
buffer_load_dwordx4 v168, s[12:15], s64 offen nt lds
s_waitcnt lgkmcnt(0)
v_mfma_f32_16x16x32_bf16 v[0:3], a[16:19], a[32:35], v[0:3]
s_add_u32 m0, s66, 0
s_add_u32 s64, s41, 458752
buffer_load_dwordx4 v156, s[20:23], s64 offen offset:0 lds
v_mfma_f32_16x16x32_bf16 v[4:7], a[16:19], a[36:39], v[4:7]
buffer_load_dwordx4 v157, s[20:23], s64 offen offset:1024 lds
v_mfma_f32_16x16x32_bf16 v[20:23], a[20:23], a[36:39], v[20:23]
buffer_load_dwordx4 v158, s[20:23], s64 offen offset:2048 lds
v_mfma_f32_16x16x32_bf16 v[16:19], a[20:23], a[32:35], v[16:19]
buffer_load_dwordx4 v159, s[20:23], s64 offen offset:3072 lds
v_mfma_f32_16x16x32_bf16 v[32:35], a[24:27], a[32:35], v[32:35]
v_mfma_f32_16x16x32_bf16 v[36:39], a[24:27], a[36:39], v[36:39]
v_mfma_f32_16x16x32_bf16 v[52:55], a[28:31], a[36:39], v[52:55]
v_mfma_f32_16x16x32_bf16 v[48:51], a[28:31], a[32:35], v[48:51]
v_mfma_f32_16x16x32_bf16 v[56:59], a[28:31], a[40:43], v[56:59]
v_mfma_f32_16x16x32_bf16 v[60:63], a[28:31], a[44:47], v[60:63]
v_mfma_f32_16x16x32_bf16 v[44:47], a[24:27], a[44:47], v[44:47]
v_mfma_f32_16x16x32_bf16 v[40:43], a[24:27], a[40:43], v[40:43]
v_mfma_f32_16x16x32_bf16 v[24:27], a[20:23], a[40:43], v[24:27]
v_mfma_f32_16x16x32_bf16 v[28:31], a[20:23], a[44:47], v[28:31]
v_mfma_f32_16x16x32_bf16 v[12:15], a[16:19], a[44:47], v[12:15]
v_mfma_f32_16x16x32_bf16 v[8:11], a[16:19], a[40:43], v[8:11]
s_waitcnt vmcnt(4)
s_barrier
s_setprio 3
s_add_u32 m0, s77, 0
s_add_u32 s64, s39, 262144
buffer_load_dwordx4 v168, s[12:15], s64 offen nt lds
s_add_u32 m0, s77, 1024
s_add_u32 s64, s39, 278528
buffer_load_dwordx4 v168, s[12:15], s64 offen nt lds
s_add_u32 m0, s77, 2048
s_add_u32 s64, s39, 294912
buffer_load_dwordx4 v168, s[12:15], s64 offen nt lds
s_add_u32 m0, s77, 3072
s_add_u32 s64, s39, 311296
buffer_load_dwordx4 v168, s[12:15], s64 offen nt lds
s_waitcnt vmcnt(4)
ds_read_b64_tr_b16 a[0:1], v160 offset:0
ds_read_b64_tr_b16 a[2:3], v160 offset:2048
ds_read_b64_tr_b16 a[4:5], v161 offset:0
ds_read_b64_tr_b16 a[6:7], v161 offset:2048
ds_read_b64_tr_b16 a[8:9], v162 offset:0
ds_read_b64_tr_b16 a[10:11], v162 offset:2048
ds_read_b64_tr_b16 a[12:13], v163 offset:0
ds_read_b64_tr_b16 a[14:15], v163 offset:2048
ds_read_b128 a[48:51], v128 offset:0
ds_read_b128 a[52:55], v129 offset:0
ds_read_b128 a[56:59], v130 offset:0
ds_read_b128 a[60:63], v131 offset:0
s_add_u32 m0, s77, 4096
s_add_u32 s64, s39, 327680
buffer_load_dwordx4 v168, s[12:15], s64 offen nt lds
s_add_u32 m0, s77, 5120
s_add_u32 s64, s39, 344064
buffer_load_dwordx4 v168, s[12:15], s64 offen nt lds
s_add_u32 m0, s77, 6144
s_add_u32 s64, s39, 360448
buffer_load_dwordx4 v168, s[12:15], s64 offen nt lds
s_add_u32 m0, s77, 7168
s_add_u32 s64, s39, 376832
buffer_load_dwordx4 v168, s[12:15], s64 offen nt lds
s_setprio 1
s_waitcnt lgkmcnt(0)
v_mfma_f32_16x16x32_bf16 v[0:3], a[0:3], a[48:51], v[0:3]
ds_read_b128 a[64:67], v128 offset:4096
v_mfma_f32_16x16x32_bf16 v[4:7], a[0:3], a[52:55], v[4:7]
ds_read_b128 a[68:71], v129 offset:4096
v_mfma_f32_16x16x32_bf16 v[20:23], a[4:7], a[52:55], v[20:23]
ds_read_b128 a[72:75], v130 offset:4096
v_mfma_f32_16x16x32_bf16 v[16:19], a[4:7], a[48:51], v[16:19]
ds_read_b128 a[76:79], v131 offset:4096
v_mfma_f32_16x16x32_bf16 v[32:35], a[8:11], a[48:51], v[32:35]
ds_read_b128 a[32:35], v128 offset:8192
v_mfma_f32_16x16x32_bf16 v[36:39], a[8:11], a[52:55], v[36:39]
ds_read_b128 a[36:39], v129 offset:8192
v_mfma_f32_16x16x32_bf16 v[52:55], a[12:15], a[52:55], v[52:55]
ds_read_b128 a[40:43], v130 offset:8192
v_mfma_f32_16x16x32_bf16 v[48:51], a[12:15], a[48:51], v[48:51]
ds_read_b128 a[44:47], v131 offset:8192
v_mfma_f32_16x16x32_bf16 v[56:59], a[12:15], a[56:59], v[56:59]
v_mfma_f32_16x16x32_bf16 v[60:63], a[12:15], a[60:63], v[60:63]
v_mfma_f32_16x16x32_bf16 v[44:47], a[8:11], a[60:63], v[44:47]
v_mfma_f32_16x16x32_bf16 v[40:43], a[8:11], a[56:59], v[40:43]
v_mfma_f32_16x16x32_bf16 v[24:27], a[4:7], a[56:59], v[24:27]
v_mfma_f32_16x16x32_bf16 v[28:31], a[4:7], a[60:63], v[28:31]
v_mfma_f32_16x16x32_bf16 v[12:15], a[0:3], a[60:63], v[12:15]
v_mfma_f32_16x16x32_bf16 v[8:11], a[0:3], a[56:59], v[8:11]
ds_read_b128 a[48:51], v128 offset:12288
ds_read_b128 a[52:55], v129 offset:12288
ds_read_b128 a[56:59], v130 offset:12288
ds_read_b128 a[60:63], v131 offset:12288
s_add_u32 m0, s66, 8192
s_add_u32 s64, s41, 487424
buffer_load_dwordx4 v156, s[20:23], s64 offen offset:0 lds
buffer_load_dwordx4 v157, s[20:23], s64 offen offset:1024 lds
buffer_load_dwordx4 v158, s[20:23], s64 offen offset:2048 lds
buffer_load_dwordx4 v159, s[20:23], s64 offen offset:3072 lds
s_add_u32 m0, s66, 0
s_add_u32 s64, s41, 688128
buffer_load_dwordx4 v156, s[20:23], s64 offen offset:0 lds
buffer_load_dwordx4 v157, s[20:23], s64 offen offset:1024 lds
buffer_load_dwordx4 v158, s[20:23], s64 offen offset:2048 lds
buffer_load_dwordx4 v159, s[20:23], s64 offen offset:3072 lds
s_waitcnt lgkmcnt(0)
s_waitcnt vmcnt(4)
ds_read_b64_tr_b16 a[0:1], v160 offset:8192
ds_read_b64_tr_b16 a[2:3], v160 offset:10240
ds_read_b64_tr_b16 a[4:5], v161 offset:8192
ds_read_b64_tr_b16 a[6:7], v161 offset:10240
ds_read_b64_tr_b16 a[8:9], v162 offset:8192
ds_read_b64_tr_b16 a[10:11], v162 offset:10240
ds_read_b64_tr_b16 a[12:13], v163 offset:8192
ds_read_b64_tr_b16 a[14:15], v163 offset:10240
s_barrier
s_setprio 3
s_setprio 1
s_waitcnt vmcnt(0) lgkmcnt(0)
v_mfma_f32_16x16x32_bf16 v[0:3], a[0:3], a[64:67], v[0:3]
ds_read_b64_tr_b16 a[16:17], v160 offset:0
v_mfma_f32_16x16x32_bf16 v[4:7], a[0:3], a[68:71], v[4:7]
ds_read_b64_tr_b16 a[18:19], v160 offset:2048
v_mfma_f32_16x16x32_bf16 v[20:23], a[4:7], a[68:71], v[20:23]
ds_read_b64_tr_b16 a[20:21], v161 offset:0
v_mfma_f32_16x16x32_bf16 v[16:19], a[4:7], a[64:67], v[16:19]
ds_read_b64_tr_b16 a[22:23], v161 offset:2048
v_mfma_f32_16x16x32_bf16 v[32:35], a[8:11], a[64:67], v[32:35]
ds_read_b64_tr_b16 a[24:25], v162 offset:0
v_mfma_f32_16x16x32_bf16 v[36:39], a[8:11], a[68:71], v[36:39]
ds_read_b64_tr_b16 a[26:27], v162 offset:2048
v_mfma_f32_16x16x32_bf16 v[52:55], a[12:15], a[68:71], v[52:55]
ds_read_b64_tr_b16 a[28:29], v163 offset:0
v_mfma_f32_16x16x32_bf16 v[48:51], a[12:15], a[64:67], v[48:51]
ds_read_b64_tr_b16 a[30:31], v163 offset:2048
v_mfma_f32_16x16x32_bf16 v[56:59], a[12:15], a[72:75], v[56:59]
s_add_u32 m0, s77, 33792
s_add_u32 s64, s39, 393216
buffer_load_dwordx4 v168, s[12:15], s64 offen nt lds
v_mfma_f32_16x16x32_bf16 v[60:63], a[12:15], a[76:79], v[60:63]
s_add_u32 m0, s77, 34816
s_add_u32 s64, s39, 409600
buffer_load_dwordx4 v168, s[12:15], s64 offen nt lds
v_mfma_f32_16x16x32_bf16 v[44:47], a[8:11], a[76:79], v[44:47]
s_add_u32 m0, s77, 35840
s_add_u32 s64, s39, 425984
buffer_load_dwordx4 v168, s[12:15], s64 offen nt lds
v_mfma_f32_16x16x32_bf16 v[40:43], a[8:11], a[72:75], v[40:43]
s_add_u32 m0, s77, 36864
s_add_u32 s64, s39, 442368
buffer_load_dwordx4 v168, s[12:15], s64 offen nt lds
v_mfma_f32_16x16x32_bf16 v[24:27], a[4:7], a[72:75], v[24:27]
s_add_u32 m0, s77, 37888
s_add_u32 s64, s39, 458752
buffer_load_dwordx4 v168, s[12:15], s64 offen nt lds
v_mfma_f32_16x16x32_bf16 v[28:31], a[4:7], a[76:79], v[28:31]
s_add_u32 m0, s77, 38912
s_add_u32 s64, s39, 475136
buffer_load_dwordx4 v168, s[12:15], s64 offen nt lds
v_mfma_f32_16x16x32_bf16 v[12:15], a[0:3], a[76:79], v[12:15]
s_add_u32 m0, s77, 39936
s_add_u32 s64, s39, 491520
buffer_load_dwordx4 v168, s[12:15], s64 offen nt lds
v_mfma_f32_16x16x32_bf16 v[8:11], a[0:3], a[72:75], v[8:11]
s_add_u32 m0, s77, 40960
s_add_u32 s64, s39, 507904
buffer_load_dwordx4 v168, s[12:15], s64 offen nt lds
s_waitcnt lgkmcnt(0)
v_mfma_f32_16x16x32_bf16 v[0:3], a[16:19], a[32:35], v[0:3]
s_add_u32 m0, s66, 8192
s_add_u32 s64, s41, 716800
buffer_load_dwordx4 v156, s[20:23], s64 offen offset:0 lds
v_mfma_f32_16x16x32_bf16 v[4:7], a[16:19], a[36:39], v[4:7]
buffer_load_dwordx4 v157, s[20:23], s64 offen offset:1024 lds
v_mfma_f32_16x16x32_bf16 v[20:23], a[20:23], a[36:39], v[20:23]
buffer_load_dwordx4 v158, s[20:23], s64 offen offset:2048 lds
v_mfma_f32_16x16x32_bf16 v[16:19], a[20:23], a[32:35], v[16:19]
buffer_load_dwordx4 v159, s[20:23], s64 offen offset:3072 lds
v_mfma_f32_16x16x32_bf16 v[32:35], a[24:27], a[32:35], v[32:35]
v_mfma_f32_16x16x32_bf16 v[36:39], a[24:27], a[36:39], v[36:39]
v_mfma_f32_16x16x32_bf16 v[52:55], a[28:31], a[36:39], v[52:55]
v_mfma_f32_16x16x32_bf16 v[48:51], a[28:31], a[32:35], v[48:51]
v_mfma_f32_16x16x32_bf16 v[56:59], a[28:31], a[40:43], v[56:59]
v_mfma_f32_16x16x32_bf16 v[60:63], a[28:31], a[44:47], v[60:63]
v_mfma_f32_16x16x32_bf16 v[44:47], a[24:27], a[44:47], v[44:47]
v_mfma_f32_16x16x32_bf16 v[40:43], a[24:27], a[40:43], v[40:43]
v_mfma_f32_16x16x32_bf16 v[24:27], a[20:23], a[40:43], v[24:27]
v_mfma_f32_16x16x32_bf16 v[28:31], a[20:23], a[44:47], v[28:31]
v_mfma_f32_16x16x32_bf16 v[12:15], a[16:19], a[44:47], v[12:15]
v_mfma_f32_16x16x32_bf16 v[8:11], a[16:19], a[40:43], v[8:11]
s_add_u32 m0, s66, 0
s_add_u32 s64, s42, 458752
buffer_load_dwordx4 v156, s[20:23], s64 offen offset:0 lds
buffer_load_dwordx4 v157, s[20:23], s64 offen offset:1024 lds
buffer_load_dwordx4 v158, s[20:23], s64 offen offset:2048 lds
buffer_load_dwordx4 v159, s[20:23], s64 offen offset:3072 lds
s_waitcnt vmcnt(8)
s_barrier
s_setprio 3
s_waitcnt vmcnt(4)
ds_read_b64_tr_b16 a[0:1], v160 offset:8192
ds_read_b64_tr_b16 a[2:3], v160 offset:10240
ds_read_b64_tr_b16 a[4:5], v161 offset:8192
ds_read_b64_tr_b16 a[6:7], v161 offset:10240
ds_read_b64_tr_b16 a[8:9], v162 offset:8192
ds_read_b64_tr_b16 a[10:11], v162 offset:10240
ds_read_b64_tr_b16 a[12:13], v163 offset:8192
ds_read_b64_tr_b16 a[14:15], v163 offset:10240
s_setprio 1
s_waitcnt vmcnt(0) lgkmcnt(0)
v_mfma_f32_16x16x32_bf16 v[0:3], a[0:3], a[48:51], v[0:3]
ds_read_b128 a[64:67], v128 offset:0
v_mfma_f32_16x16x32_bf16 v[4:7], a[0:3], a[52:55], v[4:7]
ds_read_b128 a[68:71], v129 offset:0
v_mfma_f32_16x16x32_bf16 v[20:23], a[4:7], a[52:55], v[20:23]
ds_read_b128 a[72:75], v130 offset:0
v_mfma_f32_16x16x32_bf16 v[16:19], a[4:7], a[48:51], v[16:19]
ds_read_b128 a[76:79], v131 offset:0
v_mfma_f32_16x16x32_bf16 v[32:35], a[8:11], a[48:51], v[32:35]
ds_read_b64_tr_b16 a[16:17], v160 offset:0
v_mfma_f32_16x16x32_bf16 v[36:39], a[8:11], a[52:55], v[36:39]
ds_read_b64_tr_b16 a[18:19], v160 offset:2048
v_mfma_f32_16x16x32_bf16 v[52:55], a[12:15], a[52:55], v[52:55]
ds_read_b64_tr_b16 a[20:21], v161 offset:0
v_mfma_f32_16x16x32_bf16 v[48:51], a[12:15], a[48:51], v[48:51]
ds_read_b64_tr_b16 a[22:23], v161 offset:2048
v_mfma_f32_16x16x32_bf16 v[56:59], a[12:15], a[56:59], v[56:59]
ds_read_b64_tr_b16 a[24:25], v162 offset:0
v_mfma_f32_16x16x32_bf16 v[60:63], a[12:15], a[60:63], v[60:63]
ds_read_b64_tr_b16 a[26:27], v162 offset:2048
v_mfma_f32_16x16x32_bf16 v[44:47], a[8:11], a[60:63], v[44:47]
ds_read_b64_tr_b16 a[28:29], v163 offset:0
v_mfma_f32_16x16x32_bf16 v[40:43], a[8:11], a[56:59], v[40:43]
ds_read_b64_tr_b16 a[30:31], v163 offset:2048
v_mfma_f32_16x16x32_bf16 v[24:27], a[4:7], a[56:59], v[24:27]
v_mfma_f32_16x16x32_bf16 v[28:31], a[4:7], a[60:63], v[28:31]
v_mfma_f32_16x16x32_bf16 v[12:15], a[0:3], a[60:63], v[12:15]
v_mfma_f32_16x16x32_bf16 v[8:11], a[0:3], a[56:59], v[8:11]
s_waitcnt lgkmcnt(0)
v_mfma_f32_16x16x32_bf16 v[0:3], a[16:19], a[64:67], v[0:3]
ds_read_b128 a[32:35], v128 offset:4096
v_mfma_f32_16x16x32_bf16 v[4:7], a[16:19], a[68:71], v[4:7]
ds_read_b128 a[36:39], v129 offset:4096
v_mfma_f32_16x16x32_bf16 v[20:23], a[20:23], a[68:71], v[20:23]
ds_read_b128 a[40:43], v130 offset:4096
v_mfma_f32_16x16x32_bf16 v[16:19], a[20:23], a[64:67], v[16:19]
ds_read_b128 a[44:47], v131 offset:4096
v_mfma_f32_16x16x32_bf16 v[32:35], a[24:27], a[64:67], v[32:35]
ds_read_b128 a[48:51], v128 offset:8192
v_mfma_f32_16x16x32_bf16 v[36:39], a[24:27], a[68:71], v[36:39]
ds_read_b128 a[52:55], v129 offset:8192
v_mfma_f32_16x16x32_bf16 v[52:55], a[28:31], a[68:71], v[52:55]
ds_read_b128 a[56:59], v130 offset:8192
v_mfma_f32_16x16x32_bf16 v[48:51], a[28:31], a[64:67], v[48:51]
ds_read_b128 a[60:63], v131 offset:8192
v_mfma_f32_16x16x32_bf16 v[56:59], a[28:31], a[72:75], v[56:59]
s_add_u32 m0, s66, 8192
s_add_u32 s64, s42, 487424
buffer_load_dwordx4 v156, s[20:23], s64 offen offset:0 lds
v_mfma_f32_16x16x32_bf16 v[60:63], a[28:31], a[76:79], v[60:63]
buffer_load_dwordx4 v157, s[20:23], s64 offen offset:1024 lds
v_mfma_f32_16x16x32_bf16 v[44:47], a[24:27], a[76:79], v[44:47]
buffer_load_dwordx4 v158, s[20:23], s64 offen offset:2048 lds
v_mfma_f32_16x16x32_bf16 v[40:43], a[24:27], a[72:75], v[40:43]
buffer_load_dwordx4 v159, s[20:23], s64 offen offset:3072 lds
v_mfma_f32_16x16x32_bf16 v[24:27], a[20:23], a[72:75], v[24:27]
v_mfma_f32_16x16x32_bf16 v[28:31], a[20:23], a[76:79], v[28:31]
v_mfma_f32_16x16x32_bf16 v[12:15], a[16:19], a[76:79], v[12:15]
v_mfma_f32_16x16x32_bf16 v[8:11], a[16:19], a[72:75], v[8:11]
ds_read_b128 a[64:67], v128 offset:12288
ds_read_b128 a[68:71], v129 offset:12288
ds_read_b128 a[72:75], v130 offset:12288
ds_read_b128 a[76:79], v131 offset:12288
s_add_u32 m0, s66, 0
s_add_u32 s64, s42, 688128
buffer_load_dwordx4 v156, s[20:23], s64 offen offset:0 lds
buffer_load_dwordx4 v157, s[20:23], s64 offen offset:1024 lds
buffer_load_dwordx4 v158, s[20:23], s64 offen offset:2048 lds
buffer_load_dwordx4 v159, s[20:23], s64 offen offset:3072 lds
s_waitcnt lgkmcnt(0)
s_waitcnt vmcnt(4)
ds_read_b64_tr_b16 a[0:1], v160 offset:8192
ds_read_b64_tr_b16 a[2:3], v160 offset:10240
ds_read_b64_tr_b16 a[4:5], v161 offset:8192
ds_read_b64_tr_b16 a[6:7], v161 offset:10240
ds_read_b64_tr_b16 a[8:9], v162 offset:8192
ds_read_b64_tr_b16 a[10:11], v162 offset:10240
ds_read_b64_tr_b16 a[12:13], v163 offset:8192
ds_read_b64_tr_b16 a[14:15], v163 offset:10240
s_barrier
s_setprio 3
s_setprio 1
s_waitcnt vmcnt(0) lgkmcnt(0)
v_mfma_f32_16x16x32_bf16 v[0:3], a[0:3], a[32:35], v[0:3]
ds_read_b64_tr_b16 a[16:17], v160 offset:0
v_mfma_f32_16x16x32_bf16 v[4:7], a[0:3], a[36:39], v[4:7]
ds_read_b64_tr_b16 a[18:19], v160 offset:2048
v_mfma_f32_16x16x32_bf16 v[20:23], a[4:7], a[36:39], v[20:23]
ds_read_b64_tr_b16 a[20:21], v161 offset:0
v_mfma_f32_16x16x32_bf16 v[16:19], a[4:7], a[32:35], v[16:19]
ds_read_b64_tr_b16 a[22:23], v161 offset:2048
v_mfma_f32_16x16x32_bf16 v[32:35], a[8:11], a[32:35], v[32:35]
ds_read_b64_tr_b16 a[24:25], v162 offset:0
v_mfma_f32_16x16x32_bf16 v[36:39], a[8:11], a[36:39], v[36:39]
ds_read_b64_tr_b16 a[26:27], v162 offset:2048
v_mfma_f32_16x16x32_bf16 v[52:55], a[12:15], a[36:39], v[52:55]
ds_read_b64_tr_b16 a[28:29], v163 offset:0
v_mfma_f32_16x16x32_bf16 v[48:51], a[12:15], a[32:35], v[48:51]
ds_read_b64_tr_b16 a[30:31], v163 offset:2048
v_mfma_f32_16x16x32_bf16 v[56:59], a[12:15], a[40:43], v[56:59]
s_add_u32 m0, s66, 8192
s_add_u32 s64, s42, 716800
buffer_load_dwordx4 v156, s[20:23], s64 offen offset:0 lds
v_mfma_f32_16x16x32_bf16 v[60:63], a[12:15], a[44:47], v[60:63]
buffer_load_dwordx4 v157, s[20:23], s64 offen offset:1024 lds
v_mfma_f32_16x16x32_bf16 v[44:47], a[8:11], a[44:47], v[44:47]
buffer_load_dwordx4 v158, s[20:23], s64 offen offset:2048 lds
v_mfma_f32_16x16x32_bf16 v[40:43], a[8:11], a[40:43], v[40:43]
buffer_load_dwordx4 v159, s[20:23], s64 offen offset:3072 lds
v_mfma_f32_16x16x32_bf16 v[24:27], a[4:7], a[40:43], v[24:27]
v_mfma_f32_16x16x32_bf16 v[28:31], a[4:7], a[44:47], v[28:31]
v_mfma_f32_16x16x32_bf16 v[12:15], a[0:3], a[44:47], v[12:15]
v_mfma_f32_16x16x32_bf16 v[8:11], a[0:3], a[40:43], v[8:11]
s_waitcnt vmcnt(0) lgkmcnt(0)
v_mfma_f32_16x16x32_bf16 v[0:3], a[16:19], a[48:51], v[0:3]
ds_read_b64_tr_b16 a[0:1], v160 offset:8192
v_mfma_f32_16x16x32_bf16 v[4:7], a[16:19], a[52:55], v[4:7]
ds_read_b64_tr_b16 a[2:3], v160 offset:10240
v_mfma_f32_16x16x32_bf16 v[20:23], a[20:23], a[52:55], v[20:23]
ds_read_b64_tr_b16 a[4:5], v161 offset:8192
v_mfma_f32_16x16x32_bf16 v[16:19], a[20:23], a[48:51], v[16:19]
ds_read_b64_tr_b16 a[6:7], v161 offset:10240
v_mfma_f32_16x16x32_bf16 v[32:35], a[24:27], a[48:51], v[32:35]
ds_read_b64_tr_b16 a[8:9], v162 offset:8192
v_mfma_f32_16x16x32_bf16 v[36:39], a[24:27], a[52:55], v[36:39]
ds_read_b64_tr_b16 a[10:11], v162 offset:10240
v_mfma_f32_16x16x32_bf16 v[52:55], a[28:31], a[52:55], v[52:55]
ds_read_b64_tr_b16 a[12:13], v163 offset:8192
v_mfma_f32_16x16x32_bf16 v[48:51], a[28:31], a[48:51], v[48:51]
ds_read_b64_tr_b16 a[14:15], v163 offset:10240
v_mfma_f32_16x16x32_bf16 v[56:59], a[28:31], a[56:59], v[56:59]
s_add_u32 m0, s66, 0
s_add_u32 s64, s43, 458752
buffer_load_dwordx4 v156, s[20:23], s64 offen offset:0 lds
v_mfma_f32_16x16x32_bf16 v[60:63], a[28:31], a[60:63], v[60:63]
buffer_load_dwordx4 v157, s[20:23], s64 offen offset:1024 lds
v_mfma_f32_16x16x32_bf16 v[44:47], a[24:27], a[60:63], v[44:47]
buffer_load_dwordx4 v158, s[20:23], s64 offen offset:2048 lds
v_mfma_f32_16x16x32_bf16 v[40:43], a[24:27], a[56:59], v[40:43]
buffer_load_dwordx4 v159, s[20:23], s64 offen offset:3072 lds
v_mfma_f32_16x16x32_bf16 v[24:27], a[20:23], a[56:59], v[24:27]
v_mfma_f32_16x16x32_bf16 v[28:31], a[20:23], a[60:63], v[28:31]
v_mfma_f32_16x16x32_bf16 v[12:15], a[16:19], a[60:63], v[12:15]
v_mfma_f32_16x16x32_bf16 v[8:11], a[16:19], a[56:59], v[8:11]
s_waitcnt vmcnt(0) lgkmcnt(0)
v_mfma_f32_16x16x32_bf16 v[0:3], a[0:3], a[64:67], v[0:3]
ds_read_b64_tr_b16 a[16:17], v160 offset:0
v_mfma_f32_16x16x32_bf16 v[4:7], a[0:3], a[68:71], v[4:7]
ds_read_b64_tr_b16 a[18:19], v160 offset:2048
v_mfma_f32_16x16x32_bf16 v[20:23], a[4:7], a[68:71], v[20:23]
ds_read_b64_tr_b16 a[20:21], v161 offset:0
v_mfma_f32_16x16x32_bf16 v[16:19], a[4:7], a[64:67], v[16:19]
ds_read_b64_tr_b16 a[22:23], v161 offset:2048
v_mfma_f32_16x16x32_bf16 v[32:35], a[8:11], a[64:67], v[32:35]
ds_read_b64_tr_b16 a[24:25], v162 offset:0
v_mfma_f32_16x16x32_bf16 v[36:39], a[8:11], a[68:71], v[36:39]
ds_read_b64_tr_b16 a[26:27], v162 offset:2048
v_mfma_f32_16x16x32_bf16 v[52:55], a[12:15], a[68:71], v[52:55]
ds_read_b64_tr_b16 a[28:29], v163 offset:0
v_mfma_f32_16x16x32_bf16 v[48:51], a[12:15], a[64:67], v[48:51]
ds_read_b64_tr_b16 a[30:31], v163 offset:2048
v_mfma_f32_16x16x32_bf16 v[56:59], a[12:15], a[72:75], v[56:59]
s_add_u32 m0, s66, 8192
s_add_u32 s64, s43, 487424
buffer_load_dwordx4 v156, s[20:23], s64 offen offset:0 lds
v_mfma_f32_16x16x32_bf16 v[60:63], a[12:15], a[76:79], v[60:63]
buffer_load_dwordx4 v157, s[20:23], s64 offen offset:1024 lds
v_mfma_f32_16x16x32_bf16 v[44:47], a[8:11], a[76:79], v[44:47]
buffer_load_dwordx4 v158, s[20:23], s64 offen offset:2048 lds
v_mfma_f32_16x16x32_bf16 v[40:43], a[8:11], a[72:75], v[40:43]
buffer_load_dwordx4 v159, s[20:23], s64 offen offset:3072 lds
v_mfma_f32_16x16x32_bf16 v[24:27], a[4:7], a[72:75], v[24:27]
v_mfma_f32_16x16x32_bf16 v[28:31], a[4:7], a[76:79], v[28:31]
v_mfma_f32_16x16x32_bf16 v[12:15], a[0:3], a[76:79], v[12:15]
v_mfma_f32_16x16x32_bf16 v[8:11], a[0:3], a[72:75], v[8:11]
s_setprio 3
s_barrier
ds_read_b128 a[32:35], v128 offset:0
ds_read_b128 a[36:39], v129 offset:0
ds_read_b128 a[40:43], v130 offset:0
ds_read_b128 a[44:47], v131 offset:0
s_setprio 1
s_waitcnt vmcnt(0) lgkmcnt(0)
v_mfma_f32_16x16x32_bf16 v[0:3], a[16:19], a[32:35], v[0:3]
ds_read_b128 a[48:51], v128 offset:4096
v_mfma_f32_16x16x32_bf16 v[4:7], a[16:19], a[36:39], v[4:7]
ds_read_b128 a[52:55], v129 offset:4096
v_mfma_f32_16x16x32_bf16 v[20:23], a[20:23], a[36:39], v[20:23]
ds_read_b128 a[56:59], v130 offset:4096
v_mfma_f32_16x16x32_bf16 v[16:19], a[20:23], a[32:35], v[16:19]
ds_read_b128 a[60:63], v131 offset:4096
v_mfma_f32_16x16x32_bf16 v[32:35], a[24:27], a[32:35], v[32:35]
ds_read_b64_tr_b16 a[0:1], v160 offset:8192
v_mfma_f32_16x16x32_bf16 v[36:39], a[24:27], a[36:39], v[36:39]
ds_read_b64_tr_b16 a[2:3], v160 offset:10240
v_mfma_f32_16x16x32_bf16 v[52:55], a[28:31], a[36:39], v[52:55]
ds_read_b64_tr_b16 a[4:5], v161 offset:8192
v_mfma_f32_16x16x32_bf16 v[48:51], a[28:31], a[32:35], v[48:51]
ds_read_b64_tr_b16 a[6:7], v161 offset:10240
v_mfma_f32_16x16x32_bf16 v[56:59], a[28:31], a[40:43], v[56:59]
ds_read_b64_tr_b16 a[8:9], v162 offset:8192
v_mfma_f32_16x16x32_bf16 v[60:63], a[28:31], a[44:47], v[60:63]
ds_read_b64_tr_b16 a[10:11], v162 offset:10240
v_mfma_f32_16x16x32_bf16 v[44:47], a[24:27], a[44:47], v[44:47]
ds_read_b64_tr_b16 a[12:13], v163 offset:8192
v_mfma_f32_16x16x32_bf16 v[40:43], a[24:27], a[40:43], v[40:43]
ds_read_b64_tr_b16 a[14:15], v163 offset:10240
v_mfma_f32_16x16x32_bf16 v[24:27], a[20:23], a[40:43], v[24:27]
s_add_u32 m0, s66, 0
s_add_u32 s64, s43, 688128
buffer_load_dwordx4 v156, s[20:23], s64 offen offset:0 lds
v_mfma_f32_16x16x32_bf16 v[28:31], a[20:23], a[44:47], v[28:31]
buffer_load_dwordx4 v157, s[20:23], s64 offen offset:1024 lds
v_mfma_f32_16x16x32_bf16 v[12:15], a[16:19], a[44:47], v[12:15]
buffer_load_dwordx4 v158, s[20:23], s64 offen offset:2048 lds
v_mfma_f32_16x16x32_bf16 v[8:11], a[16:19], a[40:43], v[8:11]
buffer_load_dwordx4 v159, s[20:23], s64 offen offset:3072 lds
s_waitcnt vmcnt(0) lgkmcnt(0)
v_mfma_f32_16x16x32_bf16 v[0:3], a[0:3], a[48:51], v[0:3]
ds_read_b128 a[64:67], v128 offset:8192
v_mfma_f32_16x16x32_bf16 v[4:7], a[0:3], a[52:55], v[4:7]
ds_read_b128 a[68:71], v129 offset:8192
v_mfma_f32_16x16x32_bf16 v[20:23], a[4:7], a[52:55], v[20:23]
ds_read_b128 a[72:75], v130 offset:8192
v_mfma_f32_16x16x32_bf16 v[16:19], a[4:7], a[48:51], v[16:19]
ds_read_b128 a[76:79], v131 offset:8192
v_mfma_f32_16x16x32_bf16 v[32:35], a[8:11], a[48:51], v[32:35]
ds_read_b64_tr_b16 a[16:17], v160 offset:0
v_mfma_f32_16x16x32_bf16 v[36:39], a[8:11], a[52:55], v[36:39]
ds_read_b64_tr_b16 a[18:19], v160 offset:2048
v_mfma_f32_16x16x32_bf16 v[52:55], a[12:15], a[52:55], v[52:55]
ds_read_b64_tr_b16 a[20:21], v161 offset:0
v_mfma_f32_16x16x32_bf16 v[48:51], a[12:15], a[48:51], v[48:51]
ds_read_b64_tr_b16 a[22:23], v161 offset:2048
v_mfma_f32_16x16x32_bf16 v[56:59], a[12:15], a[56:59], v[56:59]
ds_read_b64_tr_b16 a[24:25], v162 offset:0
v_mfma_f32_16x16x32_bf16 v[60:63], a[12:15], a[60:63], v[60:63]
ds_read_b64_tr_b16 a[26:27], v162 offset:2048
v_mfma_f32_16x16x32_bf16 v[44:47], a[8:11], a[60:63], v[44:47]
ds_read_b64_tr_b16 a[28:29], v163 offset:0
v_mfma_f32_16x16x32_bf16 v[40:43], a[8:11], a[56:59], v[40:43]
ds_read_b64_tr_b16 a[30:31], v163 offset:2048
v_mfma_f32_16x16x32_bf16 v[24:27], a[4:7], a[56:59], v[24:27]
s_add_u32 m0, s66, 8192
s_add_u32 s64, s43, 716800
buffer_load_dwordx4 v156, s[20:23], s64 offen offset:0 lds
v_mfma_f32_16x16x32_bf16 v[28:31], a[4:7], a[60:63], v[28:31]
buffer_load_dwordx4 v157, s[20:23], s64 offen offset:1024 lds
v_mfma_f32_16x16x32_bf16 v[12:15], a[0:3], a[60:63], v[12:15]
buffer_load_dwordx4 v158, s[20:23], s64 offen offset:2048 lds
v_mfma_f32_16x16x32_bf16 v[8:11], a[0:3], a[56:59], v[8:11]
buffer_load_dwordx4 v159, s[20:23], s64 offen offset:3072 lds
s_waitcnt vmcnt(0) lgkmcnt(0)
v_mfma_f32_16x16x32_bf16 v[0:3], a[16:19], a[64:67], v[0:3]
ds_read_b128 a[32:35], v128 offset:12288
v_mfma_f32_16x16x32_bf16 v[4:7], a[16:19], a[68:71], v[4:7]
ds_read_b128 a[36:39], v129 offset:12288
v_mfma_f32_16x16x32_bf16 v[20:23], a[20:23], a[68:71], v[20:23]
ds_read_b128 a[40:43], v130 offset:12288
v_mfma_f32_16x16x32_bf16 v[16:19], a[20:23], a[64:67], v[16:19]
ds_read_b128 a[44:47], v131 offset:12288
v_mfma_f32_16x16x32_bf16 v[32:35], a[24:27], a[64:67], v[32:35]
ds_read_b64_tr_b16 a[0:1], v160 offset:8192
v_mfma_f32_16x16x32_bf16 v[36:39], a[24:27], a[68:71], v[36:39]
ds_read_b64_tr_b16 a[2:3], v160 offset:10240
v_mfma_f32_16x16x32_bf16 v[52:55], a[28:31], a[68:71], v[52:55]
ds_read_b64_tr_b16 a[4:5], v161 offset:8192
v_mfma_f32_16x16x32_bf16 v[48:51], a[28:31], a[64:67], v[48:51]
ds_read_b64_tr_b16 a[6:7], v161 offset:10240
v_mfma_f32_16x16x32_bf16 v[56:59], a[28:31], a[72:75], v[56:59]
ds_read_b64_tr_b16 a[8:9], v162 offset:8192
v_mfma_f32_16x16x32_bf16 v[60:63], a[28:31], a[76:79], v[60:63]
ds_read_b64_tr_b16 a[10:11], v162 offset:10240
v_mfma_f32_16x16x32_bf16 v[44:47], a[24:27], a[76:79], v[44:47]
ds_read_b64_tr_b16 a[12:13], v163 offset:8192
v_mfma_f32_16x16x32_bf16 v[40:43], a[24:27], a[72:75], v[40:43]
ds_read_b64_tr_b16 a[14:15], v163 offset:10240
v_mfma_f32_16x16x32_bf16 v[24:27], a[20:23], a[72:75], v[24:27]
v_mfma_f32_16x16x32_bf16 v[28:31], a[20:23], a[76:79], v[28:31]
v_mfma_f32_16x16x32_bf16 v[12:15], a[16:19], a[76:79], v[12:15]
v_mfma_f32_16x16x32_bf16 v[8:11], a[16:19], a[72:75], v[8:11]
s_waitcnt lgkmcnt(0)
v_mfma_f32_16x16x32_bf16 v[0:3], a[0:3], a[32:35], v[0:3]
v_mfma_f32_16x16x32_bf16 v[4:7], a[0:3], a[36:39], v[4:7]
v_mfma_f32_16x16x32_bf16 v[20:23], a[4:7], a[36:39], v[20:23]
v_mfma_f32_16x16x32_bf16 v[16:19], a[4:7], a[32:35], v[16:19]
v_mfma_f32_16x16x32_bf16 v[32:35], a[8:11], a[32:35], v[32:35]
v_mfma_f32_16x16x32_bf16 v[36:39], a[8:11], a[36:39], v[36:39]
v_mfma_f32_16x16x32_bf16 v[52:55], a[12:15], a[36:39], v[52:55]
v_mfma_f32_16x16x32_bf16 v[48:51], a[12:15], a[32:35], v[48:51]
v_mfma_f32_16x16x32_bf16 v[56:59], a[12:15], a[40:43], v[56:59]
v_mfma_f32_16x16x32_bf16 v[60:63], a[12:15], a[44:47], v[60:63]
v_mfma_f32_16x16x32_bf16 v[44:47], a[8:11], a[44:47], v[44:47]
v_mfma_f32_16x16x32_bf16 v[40:43], a[8:11], a[40:43], v[40:43]
v_mfma_f32_16x16x32_bf16 v[24:27], a[4:7], a[40:43], v[24:27]
v_mfma_f32_16x16x32_bf16 v[28:31], a[4:7], a[44:47], v[28:31]
v_mfma_f32_16x16x32_bf16 v[12:15], a[0:3], a[44:47], v[12:15]
v_mfma_f32_16x16x32_bf16 v[8:11], a[0:3], a[40:43], v[8:11]
v_lshlrev_b32 v132, 4, v172
s_and_b32 s65, s83, 0xfc
s_mul_i32 s65, s65, 65536
s_mul_i32 s64, s60, 4096
s_add_u32 s65, s65, s64
s_mul_i32 s2, s62, 16384
s_add_u32 s2, s2, s65
s_add_u32 s64, s62, 1
s_and_b32 s64, s64, 3
s_mul_i32 s64, s64, 65536
s_add_u32 s33, s64, s2
s_add_u32 s64, s62, 2
s_and_b32 s64, s64, 3
s_mul_i32 s64, s64, 65536
s_add_u32 s34, s64, s2
s_add_u32 s64, s62, 3
s_and_b32 s64, s64, 3
s_mul_i32 s64, s64, 65536
s_add_u32 s35, s64, s2
s_nop 7
v_cvt_pk_bf16_f32 v136, v4, v5
v_cvt_pk_bf16_f32 v137, v6, v7
v_cvt_pk_bf16_f32 v138, v20, v21
v_cvt_pk_bf16_f32 v139, v22, v23
buffer_store_dwordx4 v[136:139], v132, s[28:31], s33 offen offset:0 sc1
v_cvt_pk_bf16_f32 v140, v8, v9
v_cvt_pk_bf16_f32 v141, v10, v11
v_cvt_pk_bf16_f32 v142, v24, v25
v_cvt_pk_bf16_f32 v143, v26, v27
buffer_store_dwordx4 v[140:143], v132, s[28:31], s34 offen offset:0 sc1
v_cvt_pk_bf16_f32 v144, v12, v13
v_cvt_pk_bf16_f32 v145, v14, v15
v_cvt_pk_bf16_f32 v146, v28, v29
v_cvt_pk_bf16_f32 v147, v30, v31
buffer_store_dwordx4 v[144:147], v132, s[28:31], s35 offen offset:0 sc1
v_cvt_pk_bf16_f32 v136, v36, v37
v_cvt_pk_bf16_f32 v137, v38, v39
v_cvt_pk_bf16_f32 v138, v52, v53
v_cvt_pk_bf16_f32 v139, v54, v55
buffer_store_dwordx4 v[136:139], v132, s[28:31], s33 offen offset:1024 sc1
v_cvt_pk_bf16_f32 v140, v40, v41
v_cvt_pk_bf16_f32 v141, v42, v43
v_cvt_pk_bf16_f32 v142, v56, v57
v_cvt_pk_bf16_f32 v143, v58, v59
buffer_store_dwordx4 v[140:143], v132, s[28:31], s34 offen offset:1024 sc1
v_cvt_pk_bf16_f32 v144, v44, v45
v_cvt_pk_bf16_f32 v145, v46, v47
v_cvt_pk_bf16_f32 v146, v60, v61
v_cvt_pk_bf16_f32 v147, v62, v63
buffer_store_dwordx4 v[144:147], v132, s[28:31], s35 offen offset:1024 sc1
v_and_b32 v133, 15, v172
v_mul_u32_u24 v133, 1792, v133
v_lshrrev_b32 v134, 4, v172
v_lshl_add_u32 v133, v134, 3, v133
s_waitcnt vmcnt(0)
s_barrier
s_barrier
s_mul_i32 s2, s62, 65536
s_add_u32 s2, s2, s65
s_add_u32 s64, s62, 1
s_and_b32 s64, s64, 3
s_mul_i32 s64, s64, 16384
s_add_u32 s64, s64, s2
buffer_load_dwordx4 v[4:7], v132, s[28:31], s64 offen offset:0 sc1
buffer_load_dwordx4 v[36:39], v132, s[28:31], s64 offen offset:1024 sc1
s_add_u32 s64, s62, 2
s_and_b32 s64, s64, 3
s_mul_i32 s64, s64, 16384
s_add_u32 s64, s64, s2
buffer_load_dwordx4 v[8:11], v132, s[28:31], s64 offen offset:0 sc1
buffer_load_dwordx4 v[40:43], v132, s[28:31], s64 offen offset:1024 sc1
s_add_u32 s64, s62, 3
s_and_b32 s64, s64, 3
s_mul_i32 s64, s64, 16384
s_add_u32 s64, s64, s2
buffer_load_dwordx4 v[12:15], v132, s[28:31], s64 offen offset:0 sc1
buffer_load_dwordx4 v[44:47], v132, s[28:31], s64 offen offset:1024 sc1
s_mul_i32 s2, s61, 114688
s_mul_i32 s3, s62, 28672
s_add_u32 s2, s2, s3
s_mul_i32 s3, s63, 896
s_add_u32 s2, s2, s3
s_add_u32 s2, s2, s67
s_waitcnt vmcnt(0)
v_lshlrev_b32 v136, 16, v4
v_and_b32 v137, 0xffff0000, v4
v_lshlrev_b32 v138, 16, v5
v_and_b32 v139, 0xffff0000, v5
v_pk_add_f32 v[0:1], v[0:1], v[136:137]
v_pk_add_f32 v[2:3], v[2:3], v[138:139]
v_lshlrev_b32 v136, 16, v8
v_and_b32 v137, 0xffff0000, v8
v_lshlrev_b32 v138, 16, v9
v_and_b32 v139, 0xffff0000, v9
v_pk_add_f32 v[0:1], v[0:1], v[136:137]
v_pk_add_f32 v[2:3], v[2:3], v[138:139]
v_lshlrev_b32 v136, 16, v12
v_and_b32 v137, 0xffff0000, v12
v_lshlrev_b32 v138, 16, v13
v_and_b32 v139, 0xffff0000, v13
v_pk_add_f32 v[0:1], v[0:1], v[136:137]
v_pk_add_f32 v[2:3], v[2:3], v[138:139]
v_cvt_pk_bf16_f32 v0, v0, v1
v_cvt_pk_bf16_f32 v1, v2, v3
buffer_store_dwordx2 v[0:1], v133, s[24:27], s2 offen offset:0
v_lshlrev_b32 v136, 16, v6
v_and_b32 v137, 0xffff0000, v6
v_lshlrev_b32 v138, 16, v7
v_and_b32 v139, 0xffff0000, v7
v_pk_add_f32 v[16:17], v[16:17], v[136:137]
v_pk_add_f32 v[18:19], v[18:19], v[138:139]
v_lshlrev_b32 v136, 16, v10
v_and_b32 v137, 0xffff0000, v10
v_lshlrev_b32 v138, 16, v11
v_and_b32 v139, 0xffff0000, v11
v_pk_add_f32 v[16:17], v[16:17], v[136:137]
v_pk_add_f32 v[18:19], v[18:19], v[138:139]
v_lshlrev_b32 v136, 16, v14
v_and_b32 v137, 0xffff0000, v14
v_lshlrev_b32 v138, 16, v15
v_and_b32 v139, 0xffff0000, v15
v_pk_add_f32 v[16:17], v[16:17], v[136:137]
v_pk_add_f32 v[18:19], v[18:19], v[138:139]
v_cvt_pk_bf16_f32 v16, v16, v17
v_cvt_pk_bf16_f32 v17, v18, v19
buffer_store_dwordx2 v[16:17], v133, s[24:27], s2 offen offset:32
v_lshlrev_b32 v136, 16, v36
v_and_b32 v137, 0xffff0000, v36
v_lshlrev_b32 v138, 16, v37
v_and_b32 v139, 0xffff0000, v37
v_pk_add_f32 v[32:33], v[32:33], v[136:137]
v_pk_add_f32 v[34:35], v[34:35], v[138:139]
v_lshlrev_b32 v136, 16, v40
v_and_b32 v137, 0xffff0000, v40
v_lshlrev_b32 v138, 16, v41
v_and_b32 v139, 0xffff0000, v41
v_pk_add_f32 v[32:33], v[32:33], v[136:137]
v_pk_add_f32 v[34:35], v[34:35], v[138:139]
v_lshlrev_b32 v136, 16, v44
v_and_b32 v137, 0xffff0000, v44
v_lshlrev_b32 v138, 16, v45
v_and_b32 v139, 0xffff0000, v45
v_pk_add_f32 v[32:33], v[32:33], v[136:137]
v_pk_add_f32 v[34:35], v[34:35], v[138:139]
v_cvt_pk_bf16_f32 v32, v32, v33
v_cvt_pk_bf16_f32 v33, v34, v35
buffer_store_dwordx2 v[32:33], v133, s[24:27], s2 offen offset:64
v_lshlrev_b32 v136, 16, v38
v_and_b32 v137, 0xffff0000, v38
v_lshlrev_b32 v138, 16, v39
v_and_b32 v139, 0xffff0000, v39
v_pk_add_f32 v[48:49], v[48:49], v[136:137]
v_pk_add_f32 v[50:51], v[50:51], v[138:139]
v_lshlrev_b32 v136, 16, v42
v_and_b32 v137, 0xffff0000, v42
v_lshlrev_b32 v138, 16, v43
v_and_b32 v139, 0xffff0000, v43
v_pk_add_f32 v[48:49], v[48:49], v[136:137]
v_pk_add_f32 v[50:51], v[50:51], v[138:139]
v_lshlrev_b32 v136, 16, v46
v_and_b32 v137, 0xffff0000, v46
v_lshlrev_b32 v138, 16, v47
v_and_b32 v139, 0xffff0000, v47
v_pk_add_f32 v[48:49], v[48:49], v[136:137]
v_pk_add_f32 v[50:51], v[50:51], v[138:139]
v_cvt_pk_bf16_f32 v48, v48, v49
v_cvt_pk_bf16_f32 v49, v50, v51
buffer_store_dwordx2 v[48:49], v133, s[24:27], s2 offen offset:96
s_endpgm
L_A:
s_setprio 2
v_and_b32 v156, 31, v0
v_min_u32 v156, 27, v156
s_mul_i32 s64, s60, 28
v_add_u32 v156, s64, v156
v_lshlrev_b32 v157, 15, v156
s_lshr_b32 s64, s61, 3
s_lshl_b32 s64, s64, 13
s_and_b32 s65, s61, 7
s_lshl_b32 s65, s65, 7
s_add_u32 s64, s64, s65
buffer_load_dword v158, v157, s[16:19], s64 offen
v_bfe_u32 v148, v0, 1, 3
v_mul_u32_u24 v160, 1056, v148
v_and_b32 v148, 1, v0
v_lshl_add_u32 v160, v148, 9, v160
v_lshrrev_b32 v149, 4, v0
v_xor_b32 v149, v149, v148
v_lshl_add_u32 v160, v149, 4, v160
v_bfe_u32 v148, v0, 2, 3
v_lshrrev_b32 v149, 5, v0
v_lshlrev_b32 v149, 10, v149
v_lshl_add_u32 v149, v148, 7, v149
v_and_b32 v150, 3, v0
v_lshl_add_u32 v149, v150, 3, v149
v_lshrrev_b32 v148, 1, v148
v_xor_b32 v150, 0, v148
v_lshl_add_u32 v161, v150, 5, v149
v_xor_b32 v150, 1, v148
v_lshl_add_u32 v162, v150, 5, v149
v_xor_b32 v150, 2, v148
v_lshl_add_u32 v163, v150, 5, v149
v_xor_b32 v150, 3, v148
v_lshl_add_u32 v164, v150, 5, v149
v_mbcnt_lo_u32_b32 v165, -1, 0
v_mbcnt_hi_u32_b32 v165, -1, v165
s_lshr_b32 s64, s60, 1
s_and_b32 s65, s60, 1
s_lshl_b32 s64, s64, 13
s_lshl_b32 s65, s65, 11
s_add_u32 s64, s64, s65
s_add_u32 s64, s64, 142848
v_lshl_add_u32 v165, v165, 4, s64
s_lshr_b32 s64, s60, 1
s_mul_i32 s64, s64, 24576
s_and_b32 s65, s60, 1
s_mul_i32 s65, s65, 6144
s_add_u32 s67, s64, s65
s_sub_u32 s67, s67, 65536
s_mov_b32 s73, 0x3db8aa3b
s_mov_b32 s74, 0x47800000
s_mov_b32 s75, 0
s_lshl_b32 s64, s60, 14
s_lshr_b32 s65, s61, 4
s_lshl_b32 s65, s65, 13
s_add_u32 s64, s64, s65
s_and_b32 s65, s61, 15
s_lshl_b32 s65, s65, 6
s_add_u32 s64, s64, s65
s_buffer_load_dword s92, s[16:19], s64 offset:1024
s_buffer_load_dword s93, s[16:19], s64 offset:66560
s_buffer_load_dword s94, s[16:19], s64 offset:132096
s_buffer_load_dword s95, s[16:19], s64 offset:197632
s_buffer_load_dword s92, s[16:19], s64 offset:263168
s_buffer_load_dword s93, s[16:19], s64 offset:328704
s_buffer_load_dword s94, s[16:19], s64 offset:394240
s_buffer_load_dword s95, s[16:19], s64 offset:459776
s_add_u32 s64, s64, 524288
s_buffer_load_dword s92, s[16:19], s64 offset:1024
s_buffer_load_dword s93, s[16:19], s64 offset:66560
s_buffer_load_dword s94, s[16:19], s64 offset:132096
s_buffer_load_dword s95, s[16:19], s64 offset:197632
s_buffer_load_dword s92, s[16:19], s64 offset:263168
s_buffer_load_dword s93, s[16:19], s64 offset:328704
s_buffer_load_dword s94, s[16:19], s64 offset:394240
s_buffer_load_dword s95, s[16:19], s64 offset:459776
s_add_u32 s64, s64, 524288
s_buffer_load_dword s92, s[16:19], s64 offset:1024
s_buffer_load_dword s93, s[16:19], s64 offset:66560
s_buffer_load_dword s94, s[16:19], s64 offset:132096
s_buffer_load_dword s95, s[16:19], s64 offset:197632
s_buffer_load_dword s92, s[16:19], s64 offset:263168
s_buffer_load_dword s93, s[16:19], s64 offset:328704
s_buffer_load_dword s94, s[16:19], s64 offset:394240
s_buffer_load_dword s95, s[16:19], s64 offset:459776
s_add_u32 s64, s64, 524288
s_buffer_load_dword s92, s[16:19], s64 offset:1024
s_buffer_load_dword s93, s[16:19], s64 offset:66560
s_buffer_load_dword s94, s[16:19], s64 offset:132096
s_buffer_load_dword s95, s[16:19], s64 offset:197632
s_buffer_load_dword s92, s[16:19], s64 offset:263168
s_buffer_load_dword s93, s[16:19], s64 offset:328704
s_buffer_load_dword s94, s[16:19], s64 offset:394240
s_buffer_load_dword s95, s[16:19], s64 offset:459776
s_add_u32 s64, s64, 524288
s_buffer_load_dword s92, s[16:19], s64 offset:1024
s_buffer_load_dword s93, s[16:19], s64 offset:66560
s_buffer_load_dword s94, s[16:19], s64 offset:132096
s_buffer_load_dword s95, s[16:19], s64 offset:197632
s_barrier
s_lshl_b32 s64, s60, 14
s_lshr_b32 s65, s61, 4
s_lshl_b32 s65, s65, 13
s_add_u32 s64, s64, s65
s_and_b32 s65, s61, 15
s_lshl_b32 s65, s65, 6
s_add_u32 s64, s64, s65
s_add_u32 s64, s64, 2097152
s_buffer_load_dword s92, s[16:19], s64 offset:263168
s_buffer_load_dword s93, s[16:19], s64 offset:328704
s_buffer_load_dword s94, s[16:19], s64 offset:394240
s_buffer_load_dword s95, s[16:19], s64 offset:459776
s_add_u32 s64, s64, 524288
s_buffer_load_dword s92, s[16:19], s64 offset:1024
s_buffer_load_dword s93, s[16:19], s64 offset:66560
s_buffer_load_dword s94, s[16:19], s64 offset:132096
s_buffer_load_dword s95, s[16:19], s64 offset:197632
s_buffer_load_dword s92, s[16:19], s64 offset:263168
s_buffer_load_dword s93, s[16:19], s64 offset:328704
s_buffer_load_dword s94, s[16:19], s64 offset:394240
s_buffer_load_dword s95, s[16:19], s64 offset:459776
s_add_u32 s64, s64, 524288
s_buffer_load_dword s92, s[16:19], s64 offset:1024
s_buffer_load_dword s93, s[16:19], s64 offset:66560
s_buffer_load_dword s94, s[16:19], s64 offset:132096
s_buffer_load_dword s95, s[16:19], s64 offset:197632
s_buffer_load_dword s92, s[16:19], s64 offset:263168
s_buffer_load_dword s93, s[16:19], s64 offset:328704
s_buffer_load_dword s94, s[16:19], s64 offset:394240
s_buffer_load_dword s95, s[16:19], s64 offset:459776
s_lshl_b32 s64, s60, 11
s_lshl_b32 s65, s61, 6
s_add_u32 s64, s64, s65
s_buffer_load_dword s92, s[20:23], s64 offset:0
s_buffer_load_dword s93, s[20:23], s64 offset:8192
s_buffer_load_dword s94, s[20:23], s64 offset:16384
s_buffer_load_dword s95, s[20:23], s64 offset:24576
s_buffer_load_dword s92, s[20:23], s64 offset:32768
s_buffer_load_dword s93, s[20:23], s64 offset:40960
s_buffer_load_dword s94, s[20:23], s64 offset:49152
s_buffer_load_dword s95, s[20:23], s64 offset:57344
s_buffer_load_dword s92, s[20:23], s64 offset:65536
s_buffer_load_dword s93, s[20:23], s64 offset:73728
s_buffer_load_dword s94, s[20:23], s64 offset:81920
s_buffer_load_dword s95, s[20:23], s64 offset:90112
s_buffer_load_dword s92, s[20:23], s64 offset:98304
s_buffer_load_dword s93, s[20:23], s64 offset:106496
s_buffer_load_dword s94, s[20:23], s64 offset:114688
s_buffer_load_dword s95, s[20:23], s64 offset:122880
s_buffer_load_dword s92, s[20:23], s64 offset:131072
s_buffer_load_dword s93, s[20:23], s64 offset:139264
s_buffer_load_dword s94, s[20:23], s64 offset:147456
s_buffer_load_dword s95, s[20:23], s64 offset:155648
s_barrier
s_mul_i32 s64, s60, 2176
v_lshl_add_u32 v152, v0, 4, s64
v_add_u32 v166, 68608, v152
v_add_u32 v167, 142848, v152
v_add_u32 v152, 33792, v152
ds_read_b128 v[32:35], v152 offset:0
ds_read_b128 v[36:39], v152 offset:1088
ds_read_b128 v[48:51], v152 offset:8704
ds_read_b128 v[52:55], v152 offset:9792
ds_read_b128 v[64:67], v152 offset:17408
ds_read_b128 v[68:71], v152 offset:18496
ds_read_b128 v[80:83], v152 offset:26112
ds_read_b128 v[84:87], v152 offset:27200
ds_read_b128 v[96:99], v167 offset:0
ds_read_b128 v[100:103], v167 offset:1088
ds_read_b128 v[112:115], v167 offset:8704
ds_read_b128 v[116:119], v167 offset:9792
s_lshl_b32 s64, s60, 11
s_lshl_b32 s65, s61, 6
s_add_u32 s64, s64, s65
s_buffer_load_dword s92, s[20:23], s64 offset:163840
s_buffer_load_dword s93, s[20:23], s64 offset:172032
s_buffer_load_dword s94, s[20:23], s64 offset:180224
s_buffer_load_dword s95, s[20:23], s64 offset:188416
s_buffer_load_dword s92, s[20:23], s64 offset:196608
s_buffer_load_dword s93, s[20:23], s64 offset:204800
s_buffer_load_dword s94, s[20:23], s64 offset:212992
s_buffer_load_dword s95, s[20:23], s64 offset:221184
s_buffer_load_dword s92, s[20:23], s64 offset:229376
s_buffer_load_dword s93, s[20:23], s64 offset:237568
s_buffer_load_dword s94, s[20:23], s64 offset:245760
s_buffer_load_dword s95, s[20:23], s64 offset:253952
s_buffer_load_dword s92, s[20:23], s64 offset:262144
s_buffer_load_dword s93, s[20:23], s64 offset:270336
s_buffer_load_dword s94, s[20:23], s64 offset:278528
s_buffer_load_dword s95, s[20:23], s64 offset:286720
s_buffer_load_dword s92, s[20:23], s64 offset:294912
s_buffer_load_dword s93, s[20:23], s64 offset:303104
s_buffer_load_dword s94, s[20:23], s64 offset:311296
s_buffer_load_dword s95, s[20:23], s64 offset:319488
s_buffer_load_dword s92, s[20:23], s64 offset:327680
s_buffer_load_dword s93, s[20:23], s64 offset:335872
s_buffer_load_dword s94, s[20:23], s64 offset:344064
s_buffer_load_dword s95, s[20:23], s64 offset:352256
s_buffer_load_dword s92, s[20:23], s64 offset:360448
s_buffer_load_dword s93, s[20:23], s64 offset:368640
s_buffer_load_dword s94, s[20:23], s64 offset:376832
s_buffer_load_dword s95, s[20:23], s64 offset:385024
s_buffer_load_dword s92, s[20:23], s64 offset:393216
s_buffer_load_dword s93, s[20:23], s64 offset:401408
s_buffer_load_dword s94, s[20:23], s64 offset:409600
s_buffer_load_dword s95, s[20:23], s64 offset:417792
s_buffer_load_dword s92, s[20:23], s64 offset:425984
s_buffer_load_dword s93, s[20:23], s64 offset:434176
s_buffer_load_dword s94, s[20:23], s64 offset:442368
s_buffer_load_dword s95, s[20:23], s64 offset:450560
s_lshl_b32 s64, s60, 11
s_lshl_b32 s65, s61, 6
s_add_u32 s64, s64, s65
s_buffer_load_dword s92, s[20:23], s64 offset:458752
s_buffer_load_dword s93, s[20:23], s64 offset:466944
s_buffer_load_dword s94, s[20:23], s64 offset:475136
s_buffer_load_dword s95, s[20:23], s64 offset:483328
s_buffer_load_dword s92, s[20:23], s64 offset:491520
s_buffer_load_dword s93, s[20:23], s64 offset:499712
s_buffer_load_dword s94, s[20:23], s64 offset:507904
s_buffer_load_dword s95, s[20:23], s64 offset:516096
s_buffer_load_dword s92, s[20:23], s64 offset:524288
s_buffer_load_dword s93, s[20:23], s64 offset:532480
s_buffer_load_dword s94, s[20:23], s64 offset:540672
s_buffer_load_dword s95, s[20:23], s64 offset:548864
s_buffer_load_dword s92, s[20:23], s64 offset:557056
s_buffer_load_dword s93, s[20:23], s64 offset:565248
s_buffer_load_dword s94, s[20:23], s64 offset:573440
s_buffer_load_dword s95, s[20:23], s64 offset:581632
s_buffer_load_dword s92, s[20:23], s64 offset:589824
s_buffer_load_dword s93, s[20:23], s64 offset:598016
s_buffer_load_dword s94, s[20:23], s64 offset:606208
s_buffer_load_dword s95, s[20:23], s64 offset:614400
s_buffer_load_dword s92, s[20:23], s64 offset:622592
s_buffer_load_dword s93, s[20:23], s64 offset:630784
s_buffer_load_dword s94, s[20:23], s64 offset:638976
s_buffer_load_dword s95, s[20:23], s64 offset:647168
s_buffer_load_dword s92, s[20:23], s64 offset:655360
s_buffer_load_dword s93, s[20:23], s64 offset:663552
s_buffer_load_dword s94, s[20:23], s64 offset:671744
s_buffer_load_dword s95, s[20:23], s64 offset:679936
s_buffer_load_dword s92, s[20:23], s64 offset:688128
s_buffer_load_dword s93, s[20:23], s64 offset:696320
s_buffer_load_dword s94, s[20:23], s64 offset:704512
s_buffer_load_dword s95, s[20:23], s64 offset:712704
s_buffer_load_dword s92, s[20:23], s64 offset:720896
s_buffer_load_dword s93, s[20:23], s64 offset:729088
s_buffer_load_dword s94, s[20:23], s64 offset:737280
s_buffer_load_dword s95, s[20:23], s64 offset:745472
s_buffer_load_dword s92, s[20:23], s64 offset:753664
s_buffer_load_dword s93, s[20:23], s64 offset:761856
s_buffer_load_dword s94, s[20:23], s64 offset:770048
s_buffer_load_dword s95, s[20:23], s64 offset:778240
s_buffer_load_dword s92, s[20:23], s64 offset:786432
s_buffer_load_dword s93, s[20:23], s64 offset:794624
s_buffer_load_dword s94, s[20:23], s64 offset:802816
s_buffer_load_dword s95, s[20:23], s64 offset:811008
s_buffer_load_dword s92, s[20:23], s64 offset:819200
s_buffer_load_dword s93, s[20:23], s64 offset:827392
s_buffer_load_dword s94, s[20:23], s64 offset:835584
s_buffer_load_dword s95, s[20:23], s64 offset:843776
s_buffer_load_dword s92, s[20:23], s64 offset:851968
s_buffer_load_dword s93, s[20:23], s64 offset:860160
s_buffer_load_dword s94, s[20:23], s64 offset:868352
s_buffer_load_dword s95, s[20:23], s64 offset:876544
s_buffer_load_dword s92, s[20:23], s64 offset:884736
s_buffer_load_dword s93, s[20:23], s64 offset:892928
s_buffer_load_dword s94, s[20:23], s64 offset:901120
s_buffer_load_dword s95, s[20:23], s64 offset:909312
s_waitcnt vmcnt(0)
s_barrier
v_add_u32 v165, s67, v165
ds_read_b128 a[0:3], v165 offset:0
ds_read_b128 a[4:7], v165 offset:4096
ds_read_b128 a[8:11], v165 offset:1024
ds_read_b128 a[12:15], v165 offset:5120
ds_read_b128 a[16:19], v165 offset:2048
ds_read_b128 a[20:23], v165 offset:6144
ds_read_b128 a[24:27], v165 offset:3072
ds_read_b128 a[28:31], v165 offset:7168
ds_read_b128 a[32:35], v165 offset:16384
ds_read_b128 a[36:39], v165 offset:20480
ds_read_b128 a[40:43], v165 offset:17408
ds_read_b128 a[44:47], v165 offset:21504
ds_read_b128 a[48:51], v165 offset:18432
ds_read_b128 a[52:55], v165 offset:22528
ds_read_b128 a[56:59], v165 offset:19456
ds_read_b128 a[60:63], v165 offset:23552
v_subrev_u32 v165, s67, v165
s_waitcnt lgkmcnt(0)
s_barrier
ds_read_b128 a[64:67], v160 offset:0
ds_read_b128 a[68:71], v160 offset:64
ds_read_b128 a[72:75], v160 offset:128
ds_read_b128 a[76:79], v160 offset:192
L_item:
s_setprio 2
s_waitcnt lgkmcnt(2)
v_mfma_f32_16x16x32_bf16 v[128:131], a[64:67], a[0:3], 0
ds_read_b128 v[144:147], v160 offset:256
v_mfma_f32_16x16x32_bf16 v[128:131], a[68:71], a[8:11], v[128:131]
ds_read_b128 v[148:151], v160 offset:320
v_mfma_f32_16x16x32_bf16 v[132:135], a[68:71], a[12:15], 0
v_mfma_f32_16x16x32_bf16 v[132:135], a[64:67], a[4:7], v[132:135]
s_waitcnt lgkmcnt(2)
v_mfma_f32_16x16x32_bf16 v[132:135], a[72:75], a[20:23], v[132:135]
ds_read_b128 v[152:155], v160 offset:384
v_mfma_f32_16x16x32_bf16 v[132:135], a[76:79], a[28:31], v[132:135]
ds_read_b128 v[156:159], v160 offset:448
v_mfma_f32_16x16x32_bf16 v[128:131], a[76:79], a[24:27], v[128:131]
v_mfma_f32_16x16x32_bf16 v[128:131], a[72:75], a[16:19], v[128:131]
s_waitcnt lgkmcnt(2)
v_mfma_f32_16x16x32_bf16 v[128:131], v[144:147], a[32:35], v[128:131]
ds_read_b128 a[64:67], v160 offset:8448
v_mfma_f32_16x16x32_bf16 v[128:131], v[148:151], a[40:43], v[128:131]
ds_read_b128 a[68:71], v160 offset:8512
v_mfma_f32_16x16x32_bf16 v[132:135], v[148:151], a[44:47], v[132:135]
v_mfma_f32_16x16x32_bf16 v[132:135], v[144:147], a[36:39], v[132:135]
s_waitcnt lgkmcnt(2)
v_mfma_f32_16x16x32_bf16 v[132:135], v[152:155], a[52:55], v[132:135]
ds_read_b128 a[72:75], v160 offset:8576
v_mfma_f32_16x16x32_bf16 v[132:135], v[156:159], a[60:63], v[132:135]
ds_read_b128 a[76:79], v160 offset:8640
v_mfma_f32_16x16x32_bf16 v[128:131], v[156:159], a[56:59], v[128:131]
v_mfma_f32_16x16x32_bf16 v[128:131], v[152:155], a[48:51], v[128:131]
s_waitcnt lgkmcnt(2)
v_mfma_f32_16x16x32_bf16 v[136:139], a[64:67], a[0:3], 0
ds_read_b128 v[144:147], v160 offset:8704
v_mfma_f32_16x16x32_bf16 v[136:139], a[68:71], a[8:11], v[136:139]
ds_read_b128 v[148:151], v160 offset:8768
v_mfma_f32_16x16x32_bf16 v[140:143], a[68:71], a[12:15], 0
v_mfma_f32_16x16x32_bf16 v[140:143], a[64:67], a[4:7], v[140:143]
s_waitcnt lgkmcnt(2)
v_mfma_f32_16x16x32_bf16 v[140:143], a[72:75], a[20:23], v[140:143]
ds_read_b128 v[152:155], v160 offset:8832
v_mfma_f32_16x16x32_bf16 v[140:143], a[76:79], a[28:31], v[140:143]
ds_read_b128 v[156:159], v160 offset:8896
v_mfma_f32_16x16x32_bf16 v[136:139], a[76:79], a[24:27], v[136:139]
v_mfma_f32_16x16x32_bf16 v[136:139], a[72:75], a[16:19], v[136:139]
s_waitcnt lgkmcnt(2)
v_mfma_f32_16x16x32_bf16 v[136:139], v[144:147], a[32:35], v[136:139]
ds_read_b128 a[64:67], v160 offset:16896
v_mfma_f32_16x16x32_bf16 v[136:139], v[148:151], a[40:43], v[136:139]
ds_read_b128 a[68:71], v160 offset:16960
v_mfma_f32_16x16x32_bf16 v[140:143], v[148:151], a[44:47], v[140:143]
v_mfma_f32_16x16x32_bf16 v[140:143], v[144:147], a[36:39], v[140:143]
s_waitcnt lgkmcnt(2)
v_mfma_f32_16x16x32_bf16 v[140:143], v[152:155], a[52:55], v[140:143]
ds_read_b128 a[72:75], v160 offset:17024
v_mfma_f32_16x16x32_bf16 v[140:143], v[156:159], a[60:63], v[140:143]
ds_read_b128 a[76:79], v160 offset:17088
v_mfma_f32_16x16x32_bf16 v[136:139], v[156:159], a[56:59], v[136:139]
v_mfma_f32_16x16x32_bf16 v[136:139], v[152:155], a[48:51], v[136:139]
s_setprio 0
s_nop 7
v_max3_f32 v144, v128, v129, v130
v_max3_f32 v144, v144, v131, v136
v_max3_f32 v144, v144, v137, v138
v_max_f32 v144, v144, v139
v_mov_b32 v146, v144
s_nop 1
v_permlane32_swap_b32 v146, v144
s_nop 1
v_max_f32 v144, v144, v146
v_mov_b32 v146, v144
s_nop 1
v_permlane16_swap_b32 v146, v144
s_nop 1
v_max_f32 v144, v144, v146
v_mul_f32 v168, s73, v144
v_sub_f32 v168, 0, v168
v_mov_b32 v174, 0
v_max3_f32 v145, v132, v133, v134
v_max3_f32 v145, v145, v135, v140
v_max3_f32 v145, v145, v141, v142
v_max_f32 v145, v145, v143
v_mov_b32 v146, v145
s_nop 1
v_permlane32_swap_b32 v146, v145
s_nop 1
v_max_f32 v145, v145, v146
v_mov_b32 v146, v145
s_nop 1
v_permlane16_swap_b32 v146, v145
s_nop 1
v_max_f32 v145, v145, v146
v_mul_f32 v169, s73, v145
v_sub_f32 v169, 0, v169
v_mov_b32 v175, 0
L_sm0:
v_fma_f32 v144, v128, s73, v168
v_fma_f32 v145, v129, s73, v168
v_fma_f32 v146, v130, s73, v168
v_fma_f32 v147, v131, s73, v168
v_fma_f32 v148, v132, s73, v169
v_fma_f32 v149, v133, s73, v169
v_fma_f32 v150, v134, s73, v169
v_fma_f32 v151, v135, s73, v169
v_exp_f32 v144, v144
v_exp_f32 v145, v145
v_exp_f32 v146, v146
v_exp_f32 v147, v147
v_fma_f32 v152, v136, s73, v168
v_fma_f32 v153, v137, s73, v168
v_fma_f32 v154, v138, s73, v168
v_fma_f32 v155, v139, s73, v168
v_exp_f32 v148, v148
v_exp_f32 v149, v149
v_exp_f32 v150, v150
v_exp_f32 v151, v151
v_fma_f32 v156, v140, s73, v169
v_fma_f32 v157, v141, s73, v169
v_fma_f32 v158, v142, s73, v169
v_fma_f32 v159, v143, s73, v169
v_add_f32 v170, v144, v145
v_cvt_pk_bf16_f32 v0, v144, v145
v_add_f32 v170, v170, v146
v_cvt_pk_bf16_f32 v1, v146, v147
v_add_f32 v170, v170, v147
v_exp_f32 v152, v152
v_exp_f32 v153, v153
v_exp_f32 v154, v154
v_exp_f32 v155, v155
v_add_f32 v171, v148, v149
v_cvt_pk_bf16_f32 v4, v148, v149
v_add_f32 v171, v171, v150
v_cvt_pk_bf16_f32 v5, v150, v151
v_add_f32 v171, v171, v151
v_exp_f32 v156, v156
v_exp_f32 v157, v157
v_exp_f32 v158, v158
v_exp_f32 v159, v159
v_add_f32 v170, v170, v152
v_add_f32 v170, v170, v153
v_cvt_pk_bf16_f32 v2, v152, v153
v_add_f32 v170, v170, v154
v_cvt_pk_bf16_f32 v3, v154, v155
v_add_f32 v170, v170, v155
v_add_f32 v171, v171, v156
v_add_f32 v171, v171, v157
v_cvt_pk_bf16_f32 v6, v156, v157
v_add_f32 v171, v171, v158
v_cvt_pk_bf16_f32 v7, v158, v159
v_add_f32 v171, v171, v159
v_add_f32 v174, v174, v170
v_add_f32 v175, v175, v171
s_setprio 2
s_waitcnt lgkmcnt(2)
v_mfma_f32_16x16x32_bf16 v[128:131], a[64:67], a[0:3], 0
ds_read_b128 v[144:147], v160 offset:17152
v_mfma_f32_16x16x32_bf16 v[128:131], a[68:71], a[8:11], v[128:131]
ds_read_b128 v[148:151], v160 offset:17216
v_mfma_f32_16x16x32_bf16 v[132:135], a[68:71], a[12:15], 0
v_mfma_f32_16x16x32_bf16 v[132:135], a[64:67], a[4:7], v[132:135]
s_waitcnt lgkmcnt(2)
v_mfma_f32_16x16x32_bf16 v[132:135], a[72:75], a[20:23], v[132:135]
ds_read_b128 v[152:155], v160 offset:17280
v_mfma_f32_16x16x32_bf16 v[132:135], a[76:79], a[28:31], v[132:135]
ds_read_b128 v[156:159], v160 offset:17344
v_mfma_f32_16x16x32_bf16 v[128:131], a[76:79], a[24:27], v[128:131]
v_mfma_f32_16x16x32_bf16 v[128:131], a[72:75], a[16:19], v[128:131]
s_waitcnt lgkmcnt(2)
v_mfma_f32_16x16x32_bf16 v[128:131], v[144:147], a[32:35], v[128:131]
ds_read_b128 a[64:67], v160 offset:25344
v_mfma_f32_16x16x32_bf16 v[128:131], v[148:151], a[40:43], v[128:131]
ds_read_b128 a[68:71], v160 offset:25408
v_mfma_f32_16x16x32_bf16 v[132:135], v[148:151], a[44:47], v[132:135]
v_mfma_f32_16x16x32_bf16 v[132:135], v[144:147], a[36:39], v[132:135]
s_waitcnt lgkmcnt(2)
v_mfma_f32_16x16x32_bf16 v[132:135], v[152:155], a[52:55], v[132:135]
ds_read_b128 a[72:75], v160 offset:25472
v_mfma_f32_16x16x32_bf16 v[132:135], v[156:159], a[60:63], v[132:135]
ds_read_b128 a[76:79], v160 offset:25536
v_mfma_f32_16x16x32_bf16 v[128:131], v[156:159], a[56:59], v[128:131]
v_mfma_f32_16x16x32_bf16 v[128:131], v[152:155], a[48:51], v[128:131]
s_waitcnt lgkmcnt(2)
v_mfma_f32_16x16x32_bf16 v[136:139], a[64:67], a[0:3], 0
ds_read_b128 v[144:147], v160 offset:25600
v_mfma_f32_16x16x32_bf16 v[136:139], a[68:71], a[8:11], v[136:139]
ds_read_b128 v[148:151], v160 offset:25664
v_mfma_f32_16x16x32_bf16 v[140:143], a[68:71], a[12:15], 0
v_mfma_f32_16x16x32_bf16 v[140:143], a[64:67], a[4:7], v[140:143]
s_waitcnt lgkmcnt(2)
v_mfma_f32_16x16x32_bf16 v[140:143], a[72:75], a[20:23], v[140:143]
ds_read_b128 v[152:155], v160 offset:25728
v_mfma_f32_16x16x32_bf16 v[140:143], a[76:79], a[28:31], v[140:143]
ds_read_b128 v[156:159], v160 offset:25792
v_mfma_f32_16x16x32_bf16 v[136:139], a[76:79], a[24:27], v[136:139]
v_mfma_f32_16x16x32_bf16 v[136:139], a[72:75], a[16:19], v[136:139]
s_waitcnt lgkmcnt(2)
v_mfma_f32_16x16x32_bf16 v[136:139], v[144:147], a[32:35], v[136:139]
v_mfma_f32_16x16x32_bf16 v[136:139], v[148:151], a[40:43], v[136:139]
v_mfma_f32_16x16x32_bf16 v[140:143], v[148:151], a[44:47], v[140:143]
v_mfma_f32_16x16x32_bf16 v[140:143], v[144:147], a[36:39], v[140:143]
s_waitcnt lgkmcnt(0)
s_barrier
ds_read_b128 a[64:67], v160 offset:33792
ds_read_b128 a[68:71], v160 offset:33856
ds_read_b128 a[72:75], v160 offset:33920
ds_read_b128 a[76:79], v160 offset:33984
v_mfma_f32_16x16x32_bf16 v[140:143], v[152:155], a[52:55], v[140:143]
v_mfma_f32_16x16x32_bf16 v[140:143], v[156:159], a[60:63], v[140:143]
v_mfma_f32_16x16x32_bf16 v[136:139], v[156:159], a[56:59], v[136:139]
v_mfma_f32_16x16x32_bf16 v[136:139], v[152:155], a[48:51], v[136:139]
s_setprio 0
s_nop 1
L_sm1:
v_fma_f32 v144, v128, s73, v168
v_fma_f32 v145, v129, s73, v168
v_fma_f32 v146, v130, s73, v168
v_fma_f32 v147, v131, s73, v168
v_fma_f32 v148, v132, s73, v169
v_fma_f32 v149, v133, s73, v169
v_fma_f32 v150, v134, s73, v169
v_fma_f32 v151, v135, s73, v169
v_exp_f32 v144, v144
v_exp_f32 v145, v145
v_exp_f32 v146, v146
v_exp_f32 v147, v147
v_fma_f32 v152, v136, s73, v168
v_fma_f32 v153, v137, s73, v168
v_fma_f32 v154, v138, s73, v168
v_fma_f32 v155, v139, s73, v168
v_exp_f32 v148, v148
v_exp_f32 v149, v149
v_exp_f32 v150, v150
v_exp_f32 v151, v151
v_fma_f32 v156, v140, s73, v169
v_fma_f32 v157, v141, s73, v169
v_fma_f32 v158, v142, s73, v169
v_fma_f32 v159, v143, s73, v169
v_add_f32 v170, v144, v145
v_cvt_pk_bf16_f32 v8, v144, v145
v_add_f32 v170, v170, v146
v_cvt_pk_bf16_f32 v9, v146, v147
v_add_f32 v170, v170, v147
v_exp_f32 v152, v152
v_exp_f32 v153, v153
v_exp_f32 v154, v154
v_exp_f32 v155, v155
v_add_f32 v171, v148, v149
v_cvt_pk_bf16_f32 v12, v148, v149
v_add_f32 v171, v171, v150
v_cvt_pk_bf16_f32 v13, v150, v151
v_add_f32 v171, v171, v151
v_exp_f32 v156, v156
v_exp_f32 v157, v157
v_exp_f32 v158, v158
v_exp_f32 v159, v159
v_add_f32 v170, v170, v152
v_add_f32 v170, v170, v153
v_cvt_pk_bf16_f32 v10, v152, v153
v_add_f32 v170, v170, v154
v_cvt_pk_bf16_f32 v11, v154, v155
v_add_f32 v170, v170, v155
v_add_f32 v171, v171, v156
v_add_f32 v171, v171, v157
v_cvt_pk_bf16_f32 v14, v156, v157
v_add_f32 v171, v171, v158
v_cvt_pk_bf16_f32 v15, v158, v159
v_add_f32 v171, v171, v159
v_max_f32 v144, v170, v171
v_cmp_lt_f32 vcc, s74, v144
s_nop 0
s_cbranch_vccz L_ok1
s_mov_b32 s65, 1
s_call_b64 s[78:79], L_rescale
s_branch L_sm1
L_ok1:
s_mov_b32 s74, 0x47800000
v_add_f32 v174, v174, v170
v_add_f32 v175, v175, v171
s_setprio 2
s_waitcnt lgkmcnt(2)
v_mfma_f32_16x16x32_bf16 v[128:131], a[64:67], a[0:3], 0
ds_read_b128 v[144:147], v160 offset:34048
v_mfma_f32_16x16x32_bf16 v[128:131], a[68:71], a[8:11], v[128:131]
ds_read_b128 v[148:151], v160 offset:34112
v_mfma_f32_16x16x32_bf16 v[132:135], a[68:71], a[12:15], 0
v_mfma_f32_16x16x32_bf16 v[132:135], a[64:67], a[4:7], v[132:135]
s_cmp_eq_u32 s75, 0
s_cbranch_scc0 L_nxw1
ds_write_b128 v167, v[32:35] offset:0
ds_write_b128 v167, v[36:39] offset:1088
L_nxw1:
s_waitcnt lgkmcnt(2)
v_mfma_f32_16x16x32_bf16 v[132:135], a[72:75], a[20:23], v[132:135]
ds_read_b128 v[152:155], v160 offset:34176
v_mfma_f32_16x16x32_bf16 v[132:135], a[76:79], a[28:31], v[132:135]
ds_read_b128 v[156:159], v160 offset:34240
v_mfma_f32_16x16x32_bf16 v[128:131], a[76:79], a[24:27], v[128:131]
v_mfma_f32_16x16x32_bf16 v[128:131], a[72:75], a[16:19], v[128:131]
s_waitcnt lgkmcnt(2)
v_mfma_f32_16x16x32_bf16 v[128:131], v[144:147], a[32:35], v[128:131]
ds_read_b128 a[64:67], v160 offset:42240
v_mfma_f32_16x16x32_bf16 v[128:131], v[148:151], a[40:43], v[128:131]
ds_read_b128 a[68:71], v160 offset:42304
v_mfma_f32_16x16x32_bf16 v[132:135], v[148:151], a[44:47], v[132:135]
v_mfma_f32_16x16x32_bf16 v[132:135], v[144:147], a[36:39], v[132:135]
s_waitcnt lgkmcnt(2)
v_mfma_f32_16x16x32_bf16 v[132:135], v[152:155], a[52:55], v[132:135]
ds_read_b128 a[72:75], v160 offset:42368
v_mfma_f32_16x16x32_bf16 v[132:135], v[156:159], a[60:63], v[132:135]
ds_read_b128 a[76:79], v160 offset:42432
v_mfma_f32_16x16x32_bf16 v[128:131], v[156:159], a[56:59], v[128:131]
v_mfma_f32_16x16x32_bf16 v[128:131], v[152:155], a[48:51], v[128:131]
s_waitcnt lgkmcnt(2)
v_mfma_f32_16x16x32_bf16 v[136:139], a[64:67], a[0:3], 0
ds_read_b128 v[144:147], v160 offset:42496
v_mfma_f32_16x16x32_bf16 v[136:139], a[68:71], a[8:11], v[136:139]
ds_read_b128 v[148:151], v160 offset:42560
v_mfma_f32_16x16x32_bf16 v[140:143], a[68:71], a[12:15], 0
v_mfma_f32_16x16x32_bf16 v[140:143], a[64:67], a[4:7], v[140:143]
s_waitcnt lgkmcnt(2)
v_mfma_f32_16x16x32_bf16 v[140:143], a[72:75], a[20:23], v[140:143]
ds_read_b128 v[152:155], v160 offset:42624
v_mfma_f32_16x16x32_bf16 v[140:143], a[76:79], a[28:31], v[140:143]
ds_read_b128 v[156:159], v160 offset:42688
v_mfma_f32_16x16x32_bf16 v[136:139], a[76:79], a[24:27], v[136:139]
v_mfma_f32_16x16x32_bf16 v[136:139], a[72:75], a[16:19], v[136:139]
s_waitcnt lgkmcnt(2)
v_mfma_f32_16x16x32_bf16 v[136:139], v[144:147], a[32:35], v[136:139]
ds_read_b128 a[64:67], v160 offset:50688
v_mfma_f32_16x16x32_bf16 v[136:139], v[148:151], a[40:43], v[136:139]
ds_read_b128 a[68:71], v160 offset:50752
v_mfma_f32_16x16x32_bf16 v[140:143], v[148:151], a[44:47], v[140:143]
v_mfma_f32_16x16x32_bf16 v[140:143], v[144:147], a[36:39], v[140:143]
s_waitcnt lgkmcnt(2)
v_mfma_f32_16x16x32_bf16 v[140:143], v[152:155], a[52:55], v[140:143]
ds_read_b128 a[72:75], v160 offset:50816
v_mfma_f32_16x16x32_bf16 v[140:143], v[156:159], a[60:63], v[140:143]
ds_read_b128 a[76:79], v160 offset:50880
v_mfma_f32_16x16x32_bf16 v[136:139], v[156:159], a[56:59], v[136:139]
v_mfma_f32_16x16x32_bf16 v[136:139], v[152:155], a[48:51], v[136:139]
s_setprio 0
s_nop 1
L_sm2:
v_fma_f32 v144, v128, s73, v168
v_fma_f32 v145, v129, s73, v168
v_fma_f32 v146, v130, s73, v168
v_fma_f32 v147, v131, s73, v168
v_fma_f32 v148, v132, s73, v169
v_fma_f32 v149, v133, s73, v169
v_fma_f32 v150, v134, s73, v169
v_fma_f32 v151, v135, s73, v169
v_exp_f32 v144, v144
v_exp_f32 v145, v145
v_exp_f32 v146, v146
v_exp_f32 v147, v147
v_fma_f32 v152, v136, s73, v168
v_fma_f32 v153, v137, s73, v168
v_fma_f32 v154, v138, s73, v168
v_fma_f32 v155, v139, s73, v168
v_exp_f32 v148, v148
v_exp_f32 v149, v149
v_exp_f32 v150, v150
v_exp_f32 v151, v151
v_fma_f32 v156, v140, s73, v169
v_fma_f32 v157, v141, s73, v169
v_fma_f32 v158, v142, s73, v169
v_fma_f32 v159, v143, s73, v169
v_add_f32 v170, v144, v145
v_cvt_pk_bf16_f32 v16, v144, v145
v_add_f32 v170, v170, v146
v_cvt_pk_bf16_f32 v17, v146, v147
v_add_f32 v170, v170, v147
v_exp_f32 v152, v152
v_exp_f32 v153, v153
v_exp_f32 v154, v154
v_exp_f32 v155, v155
v_add_f32 v171, v148, v149
v_cvt_pk_bf16_f32 v20, v148, v149
v_add_f32 v171, v171, v150
v_cvt_pk_bf16_f32 v21, v150, v151
v_add_f32 v171, v171, v151
v_exp_f32 v156, v156
v_exp_f32 v157, v157
v_exp_f32 v158, v158
v_exp_f32 v159, v159
v_add_f32 v170, v170, v152
v_add_f32 v170, v170, v153
v_cvt_pk_bf16_f32 v18, v152, v153
v_add_f32 v170, v170, v154
v_cvt_pk_bf16_f32 v19, v154, v155
v_add_f32 v170, v170, v155
v_add_f32 v171, v171, v156
v_add_f32 v171, v171, v157
v_cvt_pk_bf16_f32 v22, v156, v157
v_add_f32 v171, v171, v158
v_cvt_pk_bf16_f32 v23, v158, v159
v_add_f32 v171, v171, v159
v_max_f32 v144, v170, v171
v_cmp_lt_f32 vcc, s74, v144
s_nop 0
s_cbranch_vccz L_ok2
s_mov_b32 s65, 2
s_call_b64 s[78:79], L_rescale
s_branch L_sm2
L_ok2:
s_mov_b32 s74, 0x47800000
v_add_f32 v174, v174, v170
v_add_f32 v175, v175, v171
s_setprio 2
s_waitcnt lgkmcnt(2)
v_mfma_f32_16x16x32_bf16 v[128:131], a[64:67], a[0:3], 0
ds_read_b128 v[144:147], v160 offset:50944
v_mfma_f32_16x16x32_bf16 v[128:131], a[68:71], a[8:11], v[128:131]
ds_read_b128 v[148:151], v160 offset:51008
v_mfma_f32_16x16x32_bf16 v[132:135], a[68:71], a[12:15], 0
v_mfma_f32_16x16x32_bf16 v[132:135], a[64:67], a[4:7], v[132:135]
s_waitcnt lgkmcnt(2)
v_mfma_f32_16x16x32_bf16 v[132:135], a[72:75], a[20:23], v[132:135]
ds_read_b128 v[152:155], v160 offset:51072
v_mfma_f32_16x16x32_bf16 v[132:135], a[76:79], a[28:31], v[132:135]
ds_read_b128 v[156:159], v160 offset:51136
v_mfma_f32_16x16x32_bf16 v[128:131], a[76:79], a[24:27], v[128:131]
v_mfma_f32_16x16x32_bf16 v[128:131], a[72:75], a[16:19], v[128:131]
s_waitcnt lgkmcnt(2)
v_mfma_f32_16x16x32_bf16 v[128:131], v[144:147], a[32:35], v[128:131]
ds_read_b128 a[64:67], v160 offset:59136
v_mfma_f32_16x16x32_bf16 v[128:131], v[148:151], a[40:43], v[128:131]
ds_read_b128 a[68:71], v160 offset:59200
v_mfma_f32_16x16x32_bf16 v[132:135], v[148:151], a[44:47], v[132:135]
v_mfma_f32_16x16x32_bf16 v[132:135], v[144:147], a[36:39], v[132:135]
s_waitcnt lgkmcnt(2)
v_mfma_f32_16x16x32_bf16 v[132:135], v[152:155], a[52:55], v[132:135]
ds_read_b128 a[72:75], v160 offset:59264
v_mfma_f32_16x16x32_bf16 v[132:135], v[156:159], a[60:63], v[132:135]
ds_read_b128 a[76:79], v160 offset:59328
v_mfma_f32_16x16x32_bf16 v[128:131], v[156:159], a[56:59], v[128:131]
v_mfma_f32_16x16x32_bf16 v[128:131], v[152:155], a[48:51], v[128:131]
s_waitcnt lgkmcnt(2)
v_mfma_f32_16x16x32_bf16 v[136:139], a[64:67], a[0:3], 0
ds_read_b128 v[144:147], v160 offset:59392
v_mfma_f32_16x16x32_bf16 v[136:139], a[68:71], a[8:11], v[136:139]
ds_read_b128 v[148:151], v160 offset:59456
v_mfma_f32_16x16x32_bf16 v[140:143], a[68:71], a[12:15], 0
v_mfma_f32_16x16x32_bf16 v[140:143], a[64:67], a[4:7], v[140:143]
s_waitcnt lgkmcnt(2)
v_mfma_f32_16x16x32_bf16 v[140:143], a[72:75], a[20:23], v[140:143]
ds_read_b128 v[152:155], v160 offset:59520
v_mfma_f32_16x16x32_bf16 v[140:143], a[76:79], a[28:31], v[140:143]
ds_read_b128 v[156:159], v160 offset:59584
v_mfma_f32_16x16x32_bf16 v[136:139], a[76:79], a[24:27], v[136:139]
v_mfma_f32_16x16x32_bf16 v[136:139], a[72:75], a[16:19], v[136:139]
s_waitcnt lgkmcnt(2)
v_mfma_f32_16x16x32_bf16 v[136:139], v[144:147], a[32:35], v[136:139]
v_mfma_f32_16x16x32_bf16 v[136:139], v[148:151], a[40:43], v[136:139]
v_mfma_f32_16x16x32_bf16 v[140:143], v[148:151], a[44:47], v[140:143]
v_mfma_f32_16x16x32_bf16 v[140:143], v[144:147], a[36:39], v[140:143]
s_waitcnt lgkmcnt(0)
s_barrier
ds_read_b128 a[64:67], v160 offset:0
ds_read_b128 a[68:71], v160 offset:64
ds_read_b128 a[72:75], v160 offset:128
ds_read_b128 a[76:79], v160 offset:192
v_mfma_f32_16x16x32_bf16 v[140:143], v[152:155], a[52:55], v[140:143]
v_mfma_f32_16x16x32_bf16 v[140:143], v[156:159], a[60:63], v[140:143]
v_mfma_f32_16x16x32_bf16 v[136:139], v[156:159], a[56:59], v[136:139]
v_mfma_f32_16x16x32_bf16 v[136:139], v[152:155], a[48:51], v[136:139]
s_setprio 0
s_nop 1
L_sm3:
v_fma_f32 v144, v128, s73, v168
v_fma_f32 v145, v129, s73, v168
v_fma_f32 v146, v130, s73, v168
v_fma_f32 v147, v131, s73, v168
v_fma_f32 v148, v132, s73, v169
v_fma_f32 v149, v133, s73, v169
v_fma_f32 v150, v134, s73, v169
v_fma_f32 v151, v135, s73, v169
v_exp_f32 v144, v144
v_exp_f32 v145, v145
v_exp_f32 v146, v146
v_exp_f32 v147, v147
v_fma_f32 v152, v136, s73, v168
v_fma_f32 v153, v137, s73, v168
v_fma_f32 v154, v138, s73, v168
v_fma_f32 v155, v139, s73, v168
v_exp_f32 v148, v148
v_exp_f32 v149, v149
v_exp_f32 v150, v150
v_exp_f32 v151, v151
v_fma_f32 v156, v140, s73, v169
v_fma_f32 v157, v141, s73, v169
v_fma_f32 v158, v142, s73, v169
v_fma_f32 v159, v143, s73, v169
v_add_f32 v170, v144, v145
v_cvt_pk_bf16_f32 v24, v144, v145
v_add_f32 v170, v170, v146
v_cvt_pk_bf16_f32 v25, v146, v147
v_add_f32 v170, v170, v147
v_exp_f32 v152, v152
v_exp_f32 v153, v153
v_exp_f32 v154, v154
v_exp_f32 v155, v155
v_add_f32 v171, v148, v149
v_cvt_pk_bf16_f32 v28, v148, v149
v_add_f32 v171, v171, v150
v_cvt_pk_bf16_f32 v29, v150, v151
v_add_f32 v171, v171, v151
v_exp_f32 v156, v156
v_exp_f32 v157, v157
v_exp_f32 v158, v158
v_exp_f32 v159, v159
v_add_f32 v170, v170, v152
v_add_f32 v170, v170, v153
v_cvt_pk_bf16_f32 v26, v152, v153
v_add_f32 v170, v170, v154
v_cvt_pk_bf16_f32 v27, v154, v155
v_add_f32 v170, v170, v155
v_add_f32 v171, v171, v156
v_add_f32 v171, v171, v157
v_cvt_pk_bf16_f32 v30, v156, v157
v_add_f32 v171, v171, v158
v_cvt_pk_bf16_f32 v31, v158, v159
v_add_f32 v171, v171, v159
v_max_f32 v144, v170, v171
v_cmp_lt_f32 vcc, s74, v144
s_nop 0
s_cbranch_vccz L_ok3
s_mov_b32 s65, 3
s_call_b64 s[78:79], L_rescale
s_branch L_sm3
L_ok3:
s_mov_b32 s74, 0x47800000
v_add_f32 v174, v174, v170
v_add_f32 v175, v175, v171
s_setprio 2
s_waitcnt lgkmcnt(2)
v_mfma_f32_16x16x32_bf16 v[128:131], a[64:67], a[0:3], 0
ds_read_b128 v[144:147], v160 offset:256
v_mfma_f32_16x16x32_bf16 v[128:131], a[68:71], a[8:11], v[128:131]
ds_read_b128 v[148:151], v160 offset:320
v_mfma_f32_16x16x32_bf16 v[132:135], a[68:71], a[12:15], 0
v_mfma_f32_16x16x32_bf16 v[132:135], a[64:67], a[4:7], v[132:135]
s_cmp_eq_u32 s75, 0
s_cbranch_scc0 L_nxw2
ds_write_b128 v167, v[48:51] offset:8704
ds_write_b128 v167, v[52:55] offset:9792
L_nxw2:
s_waitcnt lgkmcnt(2)
v_mfma_f32_16x16x32_bf16 v[132:135], a[72:75], a[20:23], v[132:135]
ds_read_b128 v[152:155], v160 offset:384
v_mfma_f32_16x16x32_bf16 v[132:135], a[76:79], a[28:31], v[132:135]
ds_read_b128 v[156:159], v160 offset:448
v_mfma_f32_16x16x32_bf16 v[128:131], a[76:79], a[24:27], v[128:131]
v_mfma_f32_16x16x32_bf16 v[128:131], a[72:75], a[16:19], v[128:131]
s_waitcnt lgkmcnt(2)
v_mfma_f32_16x16x32_bf16 v[128:131], v[144:147], a[32:35], v[128:131]
ds_read_b128 a[64:67], v160 offset:8448
v_mfma_f32_16x16x32_bf16 v[128:131], v[148:151], a[40:43], v[128:131]
ds_read_b128 a[68:71], v160 offset:8512
v_mfma_f32_16x16x32_bf16 v[132:135], v[148:151], a[44:47], v[132:135]
v_mfma_f32_16x16x32_bf16 v[132:135], v[144:147], a[36:39], v[132:135]
s_waitcnt lgkmcnt(2)
v_mfma_f32_16x16x32_bf16 v[132:135], v[152:155], a[52:55], v[132:135]
ds_read_b128 a[72:75], v160 offset:8576
v_mfma_f32_16x16x32_bf16 v[132:135], v[156:159], a[60:63], v[132:135]
ds_read_b128 a[76:79], v160 offset:8640
v_mfma_f32_16x16x32_bf16 v[128:131], v[156:159], a[56:59], v[128:131]
v_mfma_f32_16x16x32_bf16 v[128:131], v[152:155], a[48:51], v[128:131]
s_waitcnt lgkmcnt(2)
v_mfma_f32_16x16x32_bf16 v[136:139], a[64:67], a[0:3], 0
ds_read_b128 v[144:147], v160 offset:8704
v_mfma_f32_16x16x32_bf16 v[136:139], a[68:71], a[8:11], v[136:139]
ds_read_b128 v[148:151], v160 offset:8768
v_mfma_f32_16x16x32_bf16 v[140:143], a[68:71], a[12:15], 0
v_mfma_f32_16x16x32_bf16 v[140:143], a[64:67], a[4:7], v[140:143]
s_waitcnt lgkmcnt(2)
v_mfma_f32_16x16x32_bf16 v[140:143], a[72:75], a[20:23], v[140:143]
ds_read_b128 v[152:155], v160 offset:8832
v_mfma_f32_16x16x32_bf16 v[140:143], a[76:79], a[28:31], v[140:143]
ds_read_b128 v[156:159], v160 offset:8896
v_mfma_f32_16x16x32_bf16 v[136:139], a[76:79], a[24:27], v[136:139]
v_mfma_f32_16x16x32_bf16 v[136:139], a[72:75], a[16:19], v[136:139]
s_waitcnt lgkmcnt(2)
v_mfma_f32_16x16x32_bf16 v[136:139], v[144:147], a[32:35], v[136:139]
ds_read_b128 a[64:67], v160 offset:16896
v_mfma_f32_16x16x32_bf16 v[136:139], v[148:151], a[40:43], v[136:139]
ds_read_b128 a[68:71], v160 offset:16960
v_mfma_f32_16x16x32_bf16 v[140:143], v[148:151], a[44:47], v[140:143]
v_mfma_f32_16x16x32_bf16 v[140:143], v[144:147], a[36:39], v[140:143]
s_waitcnt lgkmcnt(2)
v_mfma_f32_16x16x32_bf16 v[140:143], v[152:155], a[52:55], v[140:143]
ds_read_b128 a[72:75], v160 offset:17024
v_mfma_f32_16x16x32_bf16 v[140:143], v[156:159], a[60:63], v[140:143]
ds_read_b128 a[76:79], v160 offset:17088
v_mfma_f32_16x16x32_bf16 v[136:139], v[156:159], a[56:59], v[136:139]
v_mfma_f32_16x16x32_bf16 v[136:139], v[152:155], a[48:51], v[136:139]
s_setprio 0
s_nop 1
L_sm4:
v_fma_f32 v144, v128, s73, v168
v_fma_f32 v145, v129, s73, v168
v_fma_f32 v146, v130, s73, v168
v_fma_f32 v147, v131, s73, v168
v_fma_f32 v148, v132, s73, v169
v_fma_f32 v149, v133, s73, v169
v_fma_f32 v150, v134, s73, v169
v_fma_f32 v151, v135, s73, v169
v_exp_f32 v144, v144
v_exp_f32 v145, v145
v_exp_f32 v146, v146
v_exp_f32 v147, v147
v_fma_f32 v152, v136, s73, v168
v_fma_f32 v153, v137, s73, v168
v_fma_f32 v154, v138, s73, v168
v_fma_f32 v155, v139, s73, v168
v_exp_f32 v148, v148
v_exp_f32 v149, v149
v_exp_f32 v150, v150
v_exp_f32 v151, v151
v_fma_f32 v156, v140, s73, v169
v_fma_f32 v157, v141, s73, v169
v_fma_f32 v158, v142, s73, v169
v_fma_f32 v159, v143, s73, v169
v_add_f32 v170, v144, v145
v_cvt_pk_bf16_f32 v32, v144, v145
v_add_f32 v170, v170, v146
v_cvt_pk_bf16_f32 v33, v146, v147
v_add_f32 v170, v170, v147
v_exp_f32 v152, v152
v_exp_f32 v153, v153
v_exp_f32 v154, v154
v_exp_f32 v155, v155
v_add_f32 v171, v148, v149
v_cvt_pk_bf16_f32 v36, v148, v149
v_add_f32 v171, v171, v150
v_cvt_pk_bf16_f32 v37, v150, v151
v_add_f32 v171, v171, v151
v_exp_f32 v156, v156
v_exp_f32 v157, v157
v_exp_f32 v158, v158
v_exp_f32 v159, v159
v_add_f32 v170, v170, v152
v_add_f32 v170, v170, v153
v_cvt_pk_bf16_f32 v34, v152, v153
v_add_f32 v170, v170, v154
v_cvt_pk_bf16_f32 v35, v154, v155
v_add_f32 v170, v170, v155
v_add_f32 v171, v171, v156
v_add_f32 v171, v171, v157
v_cvt_pk_bf16_f32 v38, v156, v157
v_add_f32 v171, v171, v158
v_cvt_pk_bf16_f32 v39, v158, v159
v_add_f32 v171, v171, v159
v_max_f32 v144, v170, v171
v_cmp_lt_f32 vcc, s74, v144
s_nop 0
s_cbranch_vccz L_ok4
s_mov_b32 s65, 4
s_call_b64 s[78:79], L_rescale
s_branch L_sm4
L_ok4:
s_mov_b32 s74, 0x47800000
v_add_f32 v174, v174, v170
v_add_f32 v175, v175, v171
s_setprio 2
s_waitcnt lgkmcnt(2)
v_mfma_f32_16x16x32_bf16 v[128:131], a[64:67], a[0:3], 0
ds_read_b128 v[144:147], v160 offset:17152
v_mfma_f32_16x16x32_bf16 v[128:131], a[68:71], a[8:11], v[128:131]
ds_read_b128 v[148:151], v160 offset:17216
v_mfma_f32_16x16x32_bf16 v[132:135], a[68:71], a[12:15], 0
v_mfma_f32_16x16x32_bf16 v[132:135], a[64:67], a[4:7], v[132:135]
s_waitcnt lgkmcnt(2)
v_mfma_f32_16x16x32_bf16 v[132:135], a[72:75], a[20:23], v[132:135]
ds_read_b128 v[152:155], v160 offset:17280
v_mfma_f32_16x16x32_bf16 v[132:135], a[76:79], a[28:31], v[132:135]
ds_read_b128 v[156:159], v160 offset:17344
v_mfma_f32_16x16x32_bf16 v[128:131], a[76:79], a[24:27], v[128:131]
v_mfma_f32_16x16x32_bf16 v[128:131], a[72:75], a[16:19], v[128:131]
s_waitcnt lgkmcnt(2)
v_mfma_f32_16x16x32_bf16 v[128:131], v[144:147], a[32:35], v[128:131]
ds_read_b128 a[64:67], v160 offset:25344
v_mfma_f32_16x16x32_bf16 v[128:131], v[148:151], a[40:43], v[128:131]
ds_read_b128 a[68:71], v160 offset:25408
v_mfma_f32_16x16x32_bf16 v[132:135], v[148:151], a[44:47], v[132:135]
v_mfma_f32_16x16x32_bf16 v[132:135], v[144:147], a[36:39], v[132:135]
s_waitcnt lgkmcnt(2)
v_mfma_f32_16x16x32_bf16 v[132:135], v[152:155], a[52:55], v[132:135]
ds_read_b128 a[72:75], v160 offset:25472
v_mfma_f32_16x16x32_bf16 v[132:135], v[156:159], a[60:63], v[132:135]
ds_read_b128 a[76:79], v160 offset:25536
v_mfma_f32_16x16x32_bf16 v[128:131], v[156:159], a[56:59], v[128:131]
v_mfma_f32_16x16x32_bf16 v[128:131], v[152:155], a[48:51], v[128:131]
s_waitcnt lgkmcnt(2)
v_mfma_f32_16x16x32_bf16 v[136:139], a[64:67], a[0:3], 0
ds_read_b128 v[144:147], v160 offset:25600
v_mfma_f32_16x16x32_bf16 v[136:139], a[68:71], a[8:11], v[136:139]
ds_read_b128 v[148:151], v160 offset:25664
v_mfma_f32_16x16x32_bf16 v[140:143], a[68:71], a[12:15], 0
v_mfma_f32_16x16x32_bf16 v[140:143], a[64:67], a[4:7], v[140:143]
s_waitcnt lgkmcnt(2)
v_mfma_f32_16x16x32_bf16 v[140:143], a[72:75], a[20:23], v[140:143]
ds_read_b128 v[152:155], v160 offset:25728
v_mfma_f32_16x16x32_bf16 v[140:143], a[76:79], a[28:31], v[140:143]
ds_read_b128 v[156:159], v160 offset:25792
v_mfma_f32_16x16x32_bf16 v[136:139], a[76:79], a[24:27], v[136:139]
v_mfma_f32_16x16x32_bf16 v[136:139], a[72:75], a[16:19], v[136:139]
s_waitcnt lgkmcnt(2)
v_mfma_f32_16x16x32_bf16 v[136:139], v[144:147], a[32:35], v[136:139]
v_mfma_f32_16x16x32_bf16 v[136:139], v[148:151], a[40:43], v[136:139]
v_mfma_f32_16x16x32_bf16 v[140:143], v[148:151], a[44:47], v[140:143]
v_mfma_f32_16x16x32_bf16 v[140:143], v[144:147], a[36:39], v[140:143]
s_waitcnt lgkmcnt(0)
s_barrier
ds_read_b128 a[64:67], v160 offset:33792
ds_read_b128 a[68:71], v160 offset:33856
ds_read_b128 a[72:75], v160 offset:33920
ds_read_b128 a[76:79], v160 offset:33984
v_mfma_f32_16x16x32_bf16 v[140:143], v[152:155], a[52:55], v[140:143]
v_mfma_f32_16x16x32_bf16 v[140:143], v[156:159], a[60:63], v[140:143]
v_mfma_f32_16x16x32_bf16 v[136:139], v[156:159], a[56:59], v[136:139]
v_mfma_f32_16x16x32_bf16 v[136:139], v[152:155], a[48:51], v[136:139]
s_setprio 0
s_nop 1
L_sm5:
v_fma_f32 v144, v128, s73, v168
v_fma_f32 v145, v129, s73, v168
v_fma_f32 v146, v130, s73, v168
v_fma_f32 v147, v131, s73, v168
v_fma_f32 v148, v132, s73, v169
v_fma_f32 v149, v133, s73, v169
v_fma_f32 v150, v134, s73, v169
v_fma_f32 v151, v135, s73, v169
v_exp_f32 v144, v144
v_exp_f32 v145, v145
v_exp_f32 v146, v146
v_exp_f32 v147, v147
v_fma_f32 v152, v136, s73, v168
v_fma_f32 v153, v137, s73, v168
v_fma_f32 v154, v138, s73, v168
v_fma_f32 v155, v139, s73, v168
v_exp_f32 v148, v148
v_exp_f32 v149, v149
v_exp_f32 v150, v150
v_exp_f32 v151, v151
v_fma_f32 v156, v140, s73, v169
v_fma_f32 v157, v141, s73, v169
v_fma_f32 v158, v142, s73, v169
v_fma_f32 v159, v143, s73, v169
v_add_f32 v170, v144, v145
v_cvt_pk_bf16_f32 v40, v144, v145
v_add_f32 v170, v170, v146
v_cvt_pk_bf16_f32 v41, v146, v147
v_add_f32 v170, v170, v147
v_exp_f32 v152, v152
v_exp_f32 v153, v153
v_exp_f32 v154, v154
v_exp_f32 v155, v155
v_add_f32 v171, v148, v149
v_cvt_pk_bf16_f32 v44, v148, v149
v_add_f32 v171, v171, v150
v_cvt_pk_bf16_f32 v45, v150, v151
v_add_f32 v171, v171, v151
v_exp_f32 v156, v156
v_exp_f32 v157, v157
v_exp_f32 v158, v158
v_exp_f32 v159, v159
v_add_f32 v170, v170, v152
v_add_f32 v170, v170, v153
v_cvt_pk_bf16_f32 v42, v152, v153
v_add_f32 v170, v170, v154
v_cvt_pk_bf16_f32 v43, v154, v155
v_add_f32 v170, v170, v155
v_add_f32 v171, v171, v156
v_add_f32 v171, v171, v157
v_cvt_pk_bf16_f32 v46, v156, v157
v_add_f32 v171, v171, v158
v_cvt_pk_bf16_f32 v47, v158, v159
v_add_f32 v171, v171, v159
v_max_f32 v144, v170, v171
v_cmp_lt_f32 vcc, s74, v144
s_nop 0
s_cbranch_vccz L_ok5
s_mov_b32 s65, 5
s_call_b64 s[78:79], L_rescale
s_branch L_sm5
L_ok5:
s_mov_b32 s74, 0x47800000
v_add_f32 v174, v174, v170
v_add_f32 v175, v175, v171
s_setprio 2
s_waitcnt lgkmcnt(2)
v_mfma_f32_16x16x32_bf16 v[128:131], a[64:67], a[0:3], 0
ds_read_b128 v[144:147], v160 offset:34048
v_mfma_f32_16x16x32_bf16 v[128:131], a[68:71], a[8:11], v[128:131]
ds_read_b128 v[148:151], v160 offset:34112
v_mfma_f32_16x16x32_bf16 v[132:135], a[68:71], a[12:15], 0
v_mfma_f32_16x16x32_bf16 v[132:135], a[64:67], a[4:7], v[132:135]
s_cmp_eq_u32 s75, 0
s_cbranch_scc0 L_nxw3
ds_write_b128 v166, v[64:67] offset:0
ds_write_b128 v166, v[68:71] offset:1088
L_nxw3:
s_waitcnt lgkmcnt(2)
v_mfma_f32_16x16x32_bf16 v[132:135], a[72:75], a[20:23], v[132:135]
ds_read_b128 v[152:155], v160 offset:34176
v_mfma_f32_16x16x32_bf16 v[132:135], a[76:79], a[28:31], v[132:135]
ds_read_b128 v[156:159], v160 offset:34240
v_mfma_f32_16x16x32_bf16 v[128:131], a[76:79], a[24:27], v[128:131]
v_mfma_f32_16x16x32_bf16 v[128:131], a[72:75], a[16:19], v[128:131]
s_waitcnt lgkmcnt(2)
v_mfma_f32_16x16x32_bf16 v[128:131], v[144:147], a[32:35], v[128:131]
ds_read_b128 a[64:67], v160 offset:42240
v_mfma_f32_16x16x32_bf16 v[128:131], v[148:151], a[40:43], v[128:131]
ds_read_b128 a[68:71], v160 offset:42304
v_mfma_f32_16x16x32_bf16 v[132:135], v[148:151], a[44:47], v[132:135]
v_mfma_f32_16x16x32_bf16 v[132:135], v[144:147], a[36:39], v[132:135]
s_waitcnt lgkmcnt(2)
v_mfma_f32_16x16x32_bf16 v[132:135], v[152:155], a[52:55], v[132:135]
ds_read_b128 a[72:75], v160 offset:42368
v_mfma_f32_16x16x32_bf16 v[132:135], v[156:159], a[60:63], v[132:135]
ds_read_b128 a[76:79], v160 offset:42432
v_mfma_f32_16x16x32_bf16 v[128:131], v[156:159], a[56:59], v[128:131]
v_mfma_f32_16x16x32_bf16 v[128:131], v[152:155], a[48:51], v[128:131]
s_waitcnt lgkmcnt(2)
v_mfma_f32_16x16x32_bf16 v[136:139], a[64:67], a[0:3], 0
ds_read_b128 v[144:147], v160 offset:42496
v_mfma_f32_16x16x32_bf16 v[136:139], a[68:71], a[8:11], v[136:139]
ds_read_b128 v[148:151], v160 offset:42560
v_mfma_f32_16x16x32_bf16 v[140:143], a[68:71], a[12:15], 0
v_mfma_f32_16x16x32_bf16 v[140:143], a[64:67], a[4:7], v[140:143]
s_waitcnt lgkmcnt(2)
v_mfma_f32_16x16x32_bf16 v[140:143], a[72:75], a[20:23], v[140:143]
ds_read_b128 v[152:155], v160 offset:42624
v_mfma_f32_16x16x32_bf16 v[140:143], a[76:79], a[28:31], v[140:143]
ds_read_b128 v[156:159], v160 offset:42688
v_mfma_f32_16x16x32_bf16 v[136:139], a[76:79], a[24:27], v[136:139]
v_mfma_f32_16x16x32_bf16 v[136:139], a[72:75], a[16:19], v[136:139]
s_waitcnt lgkmcnt(2)
v_mfma_f32_16x16x32_bf16 v[136:139], v[144:147], a[32:35], v[136:139]
ds_read_b128 a[64:67], v160 offset:50688
v_mfma_f32_16x16x32_bf16 v[136:139], v[148:151], a[40:43], v[136:139]
ds_read_b128 a[68:71], v160 offset:50752
v_mfma_f32_16x16x32_bf16 v[140:143], v[148:151], a[44:47], v[140:143]
v_mfma_f32_16x16x32_bf16 v[140:143], v[144:147], a[36:39], v[140:143]
s_waitcnt lgkmcnt(2)
v_mfma_f32_16x16x32_bf16 v[140:143], v[152:155], a[52:55], v[140:143]
ds_read_b128 a[72:75], v160 offset:50816
v_mfma_f32_16x16x32_bf16 v[140:143], v[156:159], a[60:63], v[140:143]
ds_read_b128 a[76:79], v160 offset:50880
v_mfma_f32_16x16x32_bf16 v[136:139], v[156:159], a[56:59], v[136:139]
v_mfma_f32_16x16x32_bf16 v[136:139], v[152:155], a[48:51], v[136:139]
s_setprio 0
s_nop 1
L_sm6:
v_fma_f32 v144, v128, s73, v168
v_fma_f32 v145, v129, s73, v168
v_fma_f32 v146, v130, s73, v168
v_fma_f32 v147, v131, s73, v168
v_fma_f32 v148, v132, s73, v169
v_fma_f32 v149, v133, s73, v169
v_fma_f32 v150, v134, s73, v169
v_fma_f32 v151, v135, s73, v169
v_exp_f32 v144, v144
v_exp_f32 v145, v145
v_exp_f32 v146, v146
v_exp_f32 v147, v147
v_fma_f32 v152, v136, s73, v168
v_fma_f32 v153, v137, s73, v168
v_fma_f32 v154, v138, s73, v168
v_fma_f32 v155, v139, s73, v168
v_exp_f32 v148, v148
v_exp_f32 v149, v149
v_exp_f32 v150, v150
v_exp_f32 v151, v151
v_fma_f32 v156, v140, s73, v169
v_fma_f32 v157, v141, s73, v169
v_fma_f32 v158, v142, s73, v169
v_fma_f32 v159, v143, s73, v169
v_add_f32 v170, v144, v145
v_cvt_pk_bf16_f32 v48, v144, v145
v_add_f32 v170, v170, v146
v_cvt_pk_bf16_f32 v49, v146, v147
v_add_f32 v170, v170, v147
v_exp_f32 v152, v152
v_exp_f32 v153, v153
v_exp_f32 v154, v154
v_exp_f32 v155, v155
v_add_f32 v171, v148, v149
v_cvt_pk_bf16_f32 v52, v148, v149
v_add_f32 v171, v171, v150
v_cvt_pk_bf16_f32 v53, v150, v151
v_add_f32 v171, v171, v151
v_exp_f32 v156, v156
v_exp_f32 v157, v157
v_exp_f32 v158, v158
v_exp_f32 v159, v159
v_add_f32 v170, v170, v152
v_add_f32 v170, v170, v153
v_cvt_pk_bf16_f32 v50, v152, v153
v_add_f32 v170, v170, v154
v_cvt_pk_bf16_f32 v51, v154, v155
v_add_f32 v170, v170, v155
v_add_f32 v171, v171, v156
v_add_f32 v171, v171, v157
v_cvt_pk_bf16_f32 v54, v156, v157
v_add_f32 v171, v171, v158
v_cvt_pk_bf16_f32 v55, v158, v159
v_add_f32 v171, v171, v159
v_max_f32 v144, v170, v171
v_cmp_lt_f32 vcc, s74, v144
s_nop 0
s_cbranch_vccz L_ok6
s_mov_b32 s65, 6
s_call_b64 s[78:79], L_rescale
s_branch L_sm6
L_ok6:
s_mov_b32 s74, 0x47800000
v_add_f32 v174, v174, v170
v_add_f32 v175, v175, v171
s_setprio 2
s_waitcnt lgkmcnt(2)
v_mfma_f32_16x16x32_bf16 v[128:131], a[64:67], a[0:3], 0
ds_read_b128 v[144:147], v160 offset:50944
v_mfma_f32_16x16x32_bf16 v[128:131], a[68:71], a[8:11], v[128:131]
ds_read_b128 v[148:151], v160 offset:51008
v_mfma_f32_16x16x32_bf16 v[132:135], a[68:71], a[12:15], 0
v_mfma_f32_16x16x32_bf16 v[132:135], a[64:67], a[4:7], v[132:135]
s_waitcnt lgkmcnt(2)
v_mfma_f32_16x16x32_bf16 v[132:135], a[72:75], a[20:23], v[132:135]
ds_read_b128 v[152:155], v160 offset:51072
v_mfma_f32_16x16x32_bf16 v[132:135], a[76:79], a[28:31], v[132:135]
ds_read_b128 v[156:159], v160 offset:51136
v_mfma_f32_16x16x32_bf16 v[128:131], a[76:79], a[24:27], v[128:131]
v_mfma_f32_16x16x32_bf16 v[128:131], a[72:75], a[16:19], v[128:131]
s_waitcnt lgkmcnt(2)
v_mfma_f32_16x16x32_bf16 v[128:131], v[144:147], a[32:35], v[128:131]
ds_read_b128 a[64:67], v160 offset:59136
v_mfma_f32_16x16x32_bf16 v[128:131], v[148:151], a[40:43], v[128:131]
ds_read_b128 a[68:71], v160 offset:59200
v_mfma_f32_16x16x32_bf16 v[132:135], v[148:151], a[44:47], v[132:135]
v_mfma_f32_16x16x32_bf16 v[132:135], v[144:147], a[36:39], v[132:135]
s_waitcnt lgkmcnt(2)
v_mfma_f32_16x16x32_bf16 v[132:135], v[152:155], a[52:55], v[132:135]
ds_read_b128 a[72:75], v160 offset:59264
v_mfma_f32_16x16x32_bf16 v[132:135], v[156:159], a[60:63], v[132:135]
ds_read_b128 a[76:79], v160 offset:59328
v_mfma_f32_16x16x32_bf16 v[128:131], v[156:159], a[56:59], v[128:131]
v_mfma_f32_16x16x32_bf16 v[128:131], v[152:155], a[48:51], v[128:131]
s_waitcnt lgkmcnt(2)
v_mfma_f32_16x16x32_bf16 v[136:139], a[64:67], a[0:3], 0
ds_read_b128 v[144:147], v160 offset:59392
v_mfma_f32_16x16x32_bf16 v[136:139], a[68:71], a[8:11], v[136:139]
ds_read_b128 v[148:151], v160 offset:59456
v_mfma_f32_16x16x32_bf16 v[140:143], a[68:71], a[12:15], 0
v_mfma_f32_16x16x32_bf16 v[140:143], a[64:67], a[4:7], v[140:143]
s_waitcnt lgkmcnt(2)
v_mfma_f32_16x16x32_bf16 v[140:143], a[72:75], a[20:23], v[140:143]
ds_read_b128 v[152:155], v160 offset:59520
v_mfma_f32_16x16x32_bf16 v[140:143], a[76:79], a[28:31], v[140:143]
ds_read_b128 v[156:159], v160 offset:59584
v_mfma_f32_16x16x32_bf16 v[136:139], a[76:79], a[24:27], v[136:139]
v_mfma_f32_16x16x32_bf16 v[136:139], a[72:75], a[16:19], v[136:139]
s_waitcnt lgkmcnt(2)
v_mfma_f32_16x16x32_bf16 v[136:139], v[144:147], a[32:35], v[136:139]
v_mfma_f32_16x16x32_bf16 v[136:139], v[148:151], a[40:43], v[136:139]
v_mfma_f32_16x16x32_bf16 v[140:143], v[148:151], a[44:47], v[140:143]
v_mfma_f32_16x16x32_bf16 v[140:143], v[144:147], a[36:39], v[140:143]
s_waitcnt lgkmcnt(0)
s_barrier
ds_read_b128 a[64:67], v160 offset:0
ds_read_b128 a[68:71], v160 offset:64
ds_read_b128 a[72:75], v160 offset:128
ds_read_b128 a[76:79], v160 offset:192
v_mfma_f32_16x16x32_bf16 v[140:143], v[152:155], a[52:55], v[140:143]
v_mfma_f32_16x16x32_bf16 v[140:143], v[156:159], a[60:63], v[140:143]
v_mfma_f32_16x16x32_bf16 v[136:139], v[156:159], a[56:59], v[136:139]
v_mfma_f32_16x16x32_bf16 v[136:139], v[152:155], a[48:51], v[136:139]
s_setprio 0
s_nop 1
L_sm7:
v_fma_f32 v144, v128, s73, v168
v_fma_f32 v145, v129, s73, v168
v_fma_f32 v146, v130, s73, v168
v_fma_f32 v147, v131, s73, v168
v_fma_f32 v148, v132, s73, v169
v_fma_f32 v149, v133, s73, v169
v_fma_f32 v150, v134, s73, v169
v_fma_f32 v151, v135, s73, v169
v_exp_f32 v144, v144
v_exp_f32 v145, v145
v_exp_f32 v146, v146
v_exp_f32 v147, v147
v_fma_f32 v152, v136, s73, v168
v_fma_f32 v153, v137, s73, v168
v_fma_f32 v154, v138, s73, v168
v_fma_f32 v155, v139, s73, v168
v_exp_f32 v148, v148
v_exp_f32 v149, v149
v_exp_f32 v150, v150
v_exp_f32 v151, v151
v_fma_f32 v156, v140, s73, v169
v_fma_f32 v157, v141, s73, v169
v_fma_f32 v158, v142, s73, v169
v_fma_f32 v159, v143, s73, v169
v_add_f32 v170, v144, v145
v_cvt_pk_bf16_f32 v56, v144, v145
v_add_f32 v170, v170, v146
v_cvt_pk_bf16_f32 v57, v146, v147
v_add_f32 v170, v170, v147
v_exp_f32 v152, v152
v_exp_f32 v153, v153
v_exp_f32 v154, v154
v_exp_f32 v155, v155
v_add_f32 v171, v148, v149
v_cvt_pk_bf16_f32 v60, v148, v149
v_add_f32 v171, v171, v150
v_cvt_pk_bf16_f32 v61, v150, v151
v_add_f32 v171, v171, v151
v_exp_f32 v156, v156
v_exp_f32 v157, v157
v_exp_f32 v158, v158
v_exp_f32 v159, v159
v_add_f32 v170, v170, v152
v_add_f32 v170, v170, v153
v_cvt_pk_bf16_f32 v58, v152, v153
v_add_f32 v170, v170, v154
v_cvt_pk_bf16_f32 v59, v154, v155
v_add_f32 v170, v170, v155
v_add_f32 v171, v171, v156
v_add_f32 v171, v171, v157
v_cvt_pk_bf16_f32 v62, v156, v157
v_add_f32 v171, v171, v158
v_cvt_pk_bf16_f32 v63, v158, v159
v_add_f32 v171, v171, v159
v_max_f32 v144, v170, v171
v_cmp_lt_f32 vcc, s74, v144
s_nop 0
s_cbranch_vccz L_ok7
s_mov_b32 s65, 7
s_call_b64 s[78:79], L_rescale
s_branch L_sm7
L_ok7:
s_mov_b32 s74, 0x47800000
v_add_f32 v174, v174, v170
v_add_f32 v175, v175, v171
s_setprio 2
s_waitcnt lgkmcnt(2)
v_mfma_f32_16x16x32_bf16 v[128:131], a[64:67], a[0:3], 0
ds_read_b128 v[144:147], v160 offset:256
v_mfma_f32_16x16x32_bf16 v[128:131], a[68:71], a[8:11], v[128:131]
ds_read_b128 v[148:151], v160 offset:320
v_mfma_f32_16x16x32_bf16 v[132:135], a[68:71], a[12:15], 0
v_mfma_f32_16x16x32_bf16 v[132:135], a[64:67], a[4:7], v[132:135]
s_cmp_eq_u32 s75, 0
s_cbranch_scc0 L_nxw4
ds_write_b128 v167, v[80:83] offset:0
ds_write_b128 v167, v[84:87] offset:1088
L_nxw4:
s_waitcnt lgkmcnt(2)
v_mfma_f32_16x16x32_bf16 v[132:135], a[72:75], a[20:23], v[132:135]
ds_read_b128 v[152:155], v160 offset:384
v_mfma_f32_16x16x32_bf16 v[132:135], a[76:79], a[28:31], v[132:135]
ds_read_b128 v[156:159], v160 offset:448
v_mfma_f32_16x16x32_bf16 v[128:131], a[76:79], a[24:27], v[128:131]
v_mfma_f32_16x16x32_bf16 v[128:131], a[72:75], a[16:19], v[128:131]
s_waitcnt lgkmcnt(2)
v_mfma_f32_16x16x32_bf16 v[128:131], v[144:147], a[32:35], v[128:131]
ds_read_b128 a[64:67], v160 offset:8448
v_mfma_f32_16x16x32_bf16 v[128:131], v[148:151], a[40:43], v[128:131]
ds_read_b128 a[68:71], v160 offset:8512
v_mfma_f32_16x16x32_bf16 v[132:135], v[148:151], a[44:47], v[132:135]
v_mfma_f32_16x16x32_bf16 v[132:135], v[144:147], a[36:39], v[132:135]
s_waitcnt lgkmcnt(2)
v_mfma_f32_16x16x32_bf16 v[132:135], v[152:155], a[52:55], v[132:135]
ds_read_b128 a[72:75], v160 offset:8576
v_mfma_f32_16x16x32_bf16 v[132:135], v[156:159], a[60:63], v[132:135]
ds_read_b128 a[76:79], v160 offset:8640
v_mfma_f32_16x16x32_bf16 v[128:131], v[156:159], a[56:59], v[128:131]
v_mfma_f32_16x16x32_bf16 v[128:131], v[152:155], a[48:51], v[128:131]
s_waitcnt lgkmcnt(2)
v_mfma_f32_16x16x32_bf16 v[136:139], a[64:67], a[0:3], 0
ds_read_b128 v[144:147], v160 offset:8704
v_mfma_f32_16x16x32_bf16 v[136:139], a[68:71], a[8:11], v[136:139]
ds_read_b128 v[148:151], v160 offset:8768
v_mfma_f32_16x16x32_bf16 v[140:143], a[68:71], a[12:15], 0
v_mfma_f32_16x16x32_bf16 v[140:143], a[64:67], a[4:7], v[140:143]
s_waitcnt lgkmcnt(2)
v_mfma_f32_16x16x32_bf16 v[140:143], a[72:75], a[20:23], v[140:143]
ds_read_b128 v[152:155], v160 offset:8832
v_mfma_f32_16x16x32_bf16 v[140:143], a[76:79], a[28:31], v[140:143]
ds_read_b128 v[156:159], v160 offset:8896
v_mfma_f32_16x16x32_bf16 v[136:139], a[76:79], a[24:27], v[136:139]
v_mfma_f32_16x16x32_bf16 v[136:139], a[72:75], a[16:19], v[136:139]
s_waitcnt lgkmcnt(2)
v_mfma_f32_16x16x32_bf16 v[136:139], v[144:147], a[32:35], v[136:139]
ds_read_b128 a[64:67], v160 offset:16896
v_mfma_f32_16x16x32_bf16 v[136:139], v[148:151], a[40:43], v[136:139]
ds_read_b128 a[68:71], v160 offset:16960
v_mfma_f32_16x16x32_bf16 v[140:143], v[148:151], a[44:47], v[140:143]
v_mfma_f32_16x16x32_bf16 v[140:143], v[144:147], a[36:39], v[140:143]
s_waitcnt lgkmcnt(2)
v_mfma_f32_16x16x32_bf16 v[140:143], v[152:155], a[52:55], v[140:143]
ds_read_b128 a[72:75], v160 offset:17024
v_mfma_f32_16x16x32_bf16 v[140:143], v[156:159], a[60:63], v[140:143]
ds_read_b128 a[76:79], v160 offset:17088
v_mfma_f32_16x16x32_bf16 v[136:139], v[156:159], a[56:59], v[136:139]
v_mfma_f32_16x16x32_bf16 v[136:139], v[152:155], a[48:51], v[136:139]
s_setprio 0
s_nop 1
L_sm8:
v_fma_f32 v144, v128, s73, v168
v_fma_f32 v145, v129, s73, v168
v_fma_f32 v146, v130, s73, v168
v_fma_f32 v147, v131, s73, v168
v_fma_f32 v148, v132, s73, v169
v_fma_f32 v149, v133, s73, v169
v_fma_f32 v150, v134, s73, v169
v_fma_f32 v151, v135, s73, v169
v_exp_f32 v144, v144
v_exp_f32 v145, v145
v_exp_f32 v146, v146
v_exp_f32 v147, v147
v_fma_f32 v152, v136, s73, v168
v_fma_f32 v153, v137, s73, v168
v_fma_f32 v154, v138, s73, v168
v_fma_f32 v155, v139, s73, v168
v_exp_f32 v148, v148
v_exp_f32 v149, v149
v_exp_f32 v150, v150
v_exp_f32 v151, v151
v_fma_f32 v156, v140, s73, v169
v_fma_f32 v157, v141, s73, v169
v_fma_f32 v158, v142, s73, v169
v_fma_f32 v159, v143, s73, v169
v_add_f32 v170, v144, v145
v_cvt_pk_bf16_f32 v64, v144, v145
v_add_f32 v170, v170, v146
v_cvt_pk_bf16_f32 v65, v146, v147
v_add_f32 v170, v170, v147
v_exp_f32 v152, v152
v_exp_f32 v153, v153
v_exp_f32 v154, v154
v_exp_f32 v155, v155
v_add_f32 v171, v148, v149
v_cvt_pk_bf16_f32 v68, v148, v149
v_add_f32 v171, v171, v150
v_cvt_pk_bf16_f32 v69, v150, v151
v_add_f32 v171, v171, v151
v_exp_f32 v156, v156
v_exp_f32 v157, v157
v_exp_f32 v158, v158
v_exp_f32 v159, v159
v_add_f32 v170, v170, v152
v_add_f32 v170, v170, v153
v_cvt_pk_bf16_f32 v66, v152, v153
v_add_f32 v170, v170, v154
v_cvt_pk_bf16_f32 v67, v154, v155
v_add_f32 v170, v170, v155
v_add_f32 v171, v171, v156
v_add_f32 v171, v171, v157
v_cvt_pk_bf16_f32 v70, v156, v157
v_add_f32 v171, v171, v158
v_cvt_pk_bf16_f32 v71, v158, v159
v_add_f32 v171, v171, v159
v_max_f32 v144, v170, v171
v_cmp_lt_f32 vcc, s74, v144
s_nop 0
s_cbranch_vccz L_ok8
s_mov_b32 s65, 8
s_call_b64 s[78:79], L_rescale
s_branch L_sm8
L_ok8:
s_mov_b32 s74, 0x47800000
v_add_f32 v174, v174, v170
v_add_f32 v175, v175, v171
s_setprio 2
s_waitcnt lgkmcnt(2)
v_mfma_f32_16x16x32_bf16 v[128:131], a[64:67], a[0:3], 0
ds_read_b128 v[144:147], v160 offset:17152
v_mfma_f32_16x16x32_bf16 v[128:131], a[68:71], a[8:11], v[128:131]
ds_read_b128 v[148:151], v160 offset:17216
v_mfma_f32_16x16x32_bf16 v[132:135], a[68:71], a[12:15], 0
v_mfma_f32_16x16x32_bf16 v[132:135], a[64:67], a[4:7], v[132:135]
s_waitcnt lgkmcnt(2)
v_mfma_f32_16x16x32_bf16 v[132:135], a[72:75], a[20:23], v[132:135]
ds_read_b128 v[152:155], v160 offset:17280
v_mfma_f32_16x16x32_bf16 v[132:135], a[76:79], a[28:31], v[132:135]
ds_read_b128 v[156:159], v160 offset:17344
v_mfma_f32_16x16x32_bf16 v[128:131], a[76:79], a[24:27], v[128:131]
v_mfma_f32_16x16x32_bf16 v[128:131], a[72:75], a[16:19], v[128:131]
s_waitcnt lgkmcnt(2)
v_mfma_f32_16x16x32_bf16 v[128:131], v[144:147], a[32:35], v[128:131]
ds_read_b128 a[64:67], v160 offset:25344
v_mfma_f32_16x16x32_bf16 v[128:131], v[148:151], a[40:43], v[128:131]
ds_read_b128 a[68:71], v160 offset:25408
v_mfma_f32_16x16x32_bf16 v[132:135], v[148:151], a[44:47], v[132:135]
v_mfma_f32_16x16x32_bf16 v[132:135], v[144:147], a[36:39], v[132:135]
s_waitcnt lgkmcnt(2)
v_mfma_f32_16x16x32_bf16 v[132:135], v[152:155], a[52:55], v[132:135]
ds_read_b128 a[72:75], v160 offset:25472
v_mfma_f32_16x16x32_bf16 v[132:135], v[156:159], a[60:63], v[132:135]
ds_read_b128 a[76:79], v160 offset:25536
v_mfma_f32_16x16x32_bf16 v[128:131], v[156:159], a[56:59], v[128:131]
v_mfma_f32_16x16x32_bf16 v[128:131], v[152:155], a[48:51], v[128:131]
s_waitcnt lgkmcnt(2)
v_mfma_f32_16x16x32_bf16 v[136:139], a[64:67], a[0:3], 0
ds_read_b128 v[144:147], v160 offset:25600
v_mfma_f32_16x16x32_bf16 v[136:139], a[68:71], a[8:11], v[136:139]
ds_read_b128 v[148:151], v160 offset:25664
v_mfma_f32_16x16x32_bf16 v[140:143], a[68:71], a[12:15], 0
v_mfma_f32_16x16x32_bf16 v[140:143], a[64:67], a[4:7], v[140:143]
s_waitcnt lgkmcnt(2)
v_mfma_f32_16x16x32_bf16 v[140:143], a[72:75], a[20:23], v[140:143]
ds_read_b128 v[152:155], v160 offset:25728
v_mfma_f32_16x16x32_bf16 v[140:143], a[76:79], a[28:31], v[140:143]
ds_read_b128 v[156:159], v160 offset:25792
v_mfma_f32_16x16x32_bf16 v[136:139], a[76:79], a[24:27], v[136:139]
v_mfma_f32_16x16x32_bf16 v[136:139], a[72:75], a[16:19], v[136:139]
s_waitcnt lgkmcnt(2)
v_mfma_f32_16x16x32_bf16 v[136:139], v[144:147], a[32:35], v[136:139]
v_mfma_f32_16x16x32_bf16 v[136:139], v[148:151], a[40:43], v[136:139]
v_mfma_f32_16x16x32_bf16 v[140:143], v[148:151], a[44:47], v[140:143]
v_mfma_f32_16x16x32_bf16 v[140:143], v[144:147], a[36:39], v[140:143]
s_waitcnt lgkmcnt(0)
s_barrier
ds_read_b128 a[64:67], v160 offset:33792
ds_read_b128 a[68:71], v160 offset:33856
ds_read_b128 a[72:75], v160 offset:33920
ds_read_b128 a[76:79], v160 offset:33984
v_mfma_f32_16x16x32_bf16 v[140:143], v[152:155], a[52:55], v[140:143]
v_mfma_f32_16x16x32_bf16 v[140:143], v[156:159], a[60:63], v[140:143]
v_mfma_f32_16x16x32_bf16 v[136:139], v[156:159], a[56:59], v[136:139]
v_mfma_f32_16x16x32_bf16 v[136:139], v[152:155], a[48:51], v[136:139]
s_setprio 0
s_nop 1
L_sm9:
v_fma_f32 v144, v128, s73, v168
v_fma_f32 v145, v129, s73, v168
v_fma_f32 v146, v130, s73, v168
v_fma_f32 v147, v131, s73, v168
v_fma_f32 v148, v132, s73, v169
v_fma_f32 v149, v133, s73, v169
v_fma_f32 v150, v134, s73, v169
v_fma_f32 v151, v135, s73, v169
v_exp_f32 v144, v144
v_exp_f32 v145, v145
v_exp_f32 v146, v146
v_exp_f32 v147, v147
v_fma_f32 v152, v136, s73, v168
v_fma_f32 v153, v137, s73, v168
v_fma_f32 v154, v138, s73, v168
v_fma_f32 v155, v139, s73, v168
v_exp_f32 v148, v148
v_exp_f32 v149, v149
v_exp_f32 v150, v150
v_exp_f32 v151, v151
v_fma_f32 v156, v140, s73, v169
v_fma_f32 v157, v141, s73, v169
v_fma_f32 v158, v142, s73, v169
v_fma_f32 v159, v143, s73, v169
v_add_f32 v170, v144, v145
v_cvt_pk_bf16_f32 v72, v144, v145
v_add_f32 v170, v170, v146
v_cvt_pk_bf16_f32 v73, v146, v147
v_add_f32 v170, v170, v147
v_exp_f32 v152, v152
v_exp_f32 v153, v153
v_exp_f32 v154, v154
v_exp_f32 v155, v155
v_add_f32 v171, v148, v149
v_cvt_pk_bf16_f32 v76, v148, v149
v_add_f32 v171, v171, v150
v_cvt_pk_bf16_f32 v77, v150, v151
v_add_f32 v171, v171, v151
v_exp_f32 v156, v156
v_exp_f32 v157, v157
v_exp_f32 v158, v158
v_exp_f32 v159, v159
v_add_f32 v170, v170, v152
v_add_f32 v170, v170, v153
v_cvt_pk_bf16_f32 v74, v152, v153
v_add_f32 v170, v170, v154
v_cvt_pk_bf16_f32 v75, v154, v155
v_add_f32 v170, v170, v155
v_add_f32 v171, v171, v156
v_add_f32 v171, v171, v157
v_cvt_pk_bf16_f32 v78, v156, v157
v_add_f32 v171, v171, v158
v_cvt_pk_bf16_f32 v79, v158, v159
v_add_f32 v171, v171, v159
v_max_f32 v144, v170, v171
v_cmp_lt_f32 vcc, s74, v144
s_nop 0
s_cbranch_vccz L_ok9
s_mov_b32 s65, 9
s_call_b64 s[78:79], L_rescale
s_branch L_sm9
L_ok9:
s_mov_b32 s74, 0x47800000
v_add_f32 v174, v174, v170
v_add_f32 v175, v175, v171
s_setprio 2
s_waitcnt lgkmcnt(2)
v_mfma_f32_16x16x32_bf16 v[128:131], a[64:67], a[0:3], 0
ds_read_b128 v[144:147], v160 offset:34048
v_mfma_f32_16x16x32_bf16 v[128:131], a[68:71], a[8:11], v[128:131]
ds_read_b128 v[148:151], v160 offset:34112
v_mfma_f32_16x16x32_bf16 v[132:135], a[68:71], a[12:15], 0
v_mfma_f32_16x16x32_bf16 v[132:135], a[64:67], a[4:7], v[132:135]
s_cmp_eq_u32 s75, 0
s_cbranch_scc0 L_nxw5
ds_write_b128 v167, v[96:99] offset:8704
ds_write_b128 v167, v[100:103] offset:9792
L_nxw5:
s_waitcnt lgkmcnt(2)
v_mfma_f32_16x16x32_bf16 v[132:135], a[72:75], a[20:23], v[132:135]
ds_read_b128 v[152:155], v160 offset:34176
v_mfma_f32_16x16x32_bf16 v[132:135], a[76:79], a[28:31], v[132:135]
ds_read_b128 v[156:159], v160 offset:34240
v_mfma_f32_16x16x32_bf16 v[128:131], a[76:79], a[24:27], v[128:131]
v_mfma_f32_16x16x32_bf16 v[128:131], a[72:75], a[16:19], v[128:131]
s_waitcnt lgkmcnt(2)
v_mfma_f32_16x16x32_bf16 v[128:131], v[144:147], a[32:35], v[128:131]
ds_read_b128 a[64:67], v160 offset:42240
v_mfma_f32_16x16x32_bf16 v[128:131], v[148:151], a[40:43], v[128:131]
ds_read_b128 a[68:71], v160 offset:42304
v_mfma_f32_16x16x32_bf16 v[132:135], v[148:151], a[44:47], v[132:135]
v_mfma_f32_16x16x32_bf16 v[132:135], v[144:147], a[36:39], v[132:135]
s_waitcnt lgkmcnt(2)
v_mfma_f32_16x16x32_bf16 v[132:135], v[152:155], a[52:55], v[132:135]
ds_read_b128 a[72:75], v160 offset:42368
v_mfma_f32_16x16x32_bf16 v[132:135], v[156:159], a[60:63], v[132:135]
ds_read_b128 a[76:79], v160 offset:42432
v_mfma_f32_16x16x32_bf16 v[128:131], v[156:159], a[56:59], v[128:131]
v_mfma_f32_16x16x32_bf16 v[128:131], v[152:155], a[48:51], v[128:131]
s_waitcnt lgkmcnt(2)
v_mfma_f32_16x16x32_bf16 v[136:139], a[64:67], a[0:3], 0
ds_read_b128 v[144:147], v160 offset:42496
v_mfma_f32_16x16x32_bf16 v[136:139], a[68:71], a[8:11], v[136:139]
ds_read_b128 v[148:151], v160 offset:42560
v_mfma_f32_16x16x32_bf16 v[140:143], a[68:71], a[12:15], 0
v_mfma_f32_16x16x32_bf16 v[140:143], a[64:67], a[4:7], v[140:143]
s_waitcnt lgkmcnt(2)
v_mfma_f32_16x16x32_bf16 v[140:143], a[72:75], a[20:23], v[140:143]
ds_read_b128 v[152:155], v160 offset:42624
v_mfma_f32_16x16x32_bf16 v[140:143], a[76:79], a[28:31], v[140:143]
ds_read_b128 v[156:159], v160 offset:42688
v_mfma_f32_16x16x32_bf16 v[136:139], a[76:79], a[24:27], v[136:139]
v_mfma_f32_16x16x32_bf16 v[136:139], a[72:75], a[16:19], v[136:139]
s_waitcnt lgkmcnt(2)
v_mfma_f32_16x16x32_bf16 v[136:139], v[144:147], a[32:35], v[136:139]
ds_read_b128 a[64:67], v160 offset:50688
v_mfma_f32_16x16x32_bf16 v[136:139], v[148:151], a[40:43], v[136:139]
ds_read_b128 a[68:71], v160 offset:50752
v_mfma_f32_16x16x32_bf16 v[140:143], v[148:151], a[44:47], v[140:143]
v_mfma_f32_16x16x32_bf16 v[140:143], v[144:147], a[36:39], v[140:143]
s_waitcnt lgkmcnt(2)
v_mfma_f32_16x16x32_bf16 v[140:143], v[152:155], a[52:55], v[140:143]
ds_read_b128 a[72:75], v160 offset:50816
v_mfma_f32_16x16x32_bf16 v[140:143], v[156:159], a[60:63], v[140:143]
ds_read_b128 a[76:79], v160 offset:50880
v_mfma_f32_16x16x32_bf16 v[136:139], v[156:159], a[56:59], v[136:139]
v_mfma_f32_16x16x32_bf16 v[136:139], v[152:155], a[48:51], v[136:139]
s_setprio 0
s_nop 1
L_sm10:
v_fma_f32 v144, v128, s73, v168
v_fma_f32 v145, v129, s73, v168
v_fma_f32 v146, v130, s73, v168
v_fma_f32 v147, v131, s73, v168
v_fma_f32 v148, v132, s73, v169
v_fma_f32 v149, v133, s73, v169
v_fma_f32 v150, v134, s73, v169
v_fma_f32 v151, v135, s73, v169
v_exp_f32 v144, v144
v_exp_f32 v145, v145
v_exp_f32 v146, v146
v_exp_f32 v147, v147
v_fma_f32 v152, v136, s73, v168
v_fma_f32 v153, v137, s73, v168
v_fma_f32 v154, v138, s73, v168
v_fma_f32 v155, v139, s73, v168
v_exp_f32 v148, v148
v_exp_f32 v149, v149
v_exp_f32 v150, v150
v_exp_f32 v151, v151
v_fma_f32 v156, v140, s73, v169
v_fma_f32 v157, v141, s73, v169
v_fma_f32 v158, v142, s73, v169
v_fma_f32 v159, v143, s73, v169
v_add_f32 v170, v144, v145
v_cvt_pk_bf16_f32 v80, v144, v145
v_add_f32 v170, v170, v146
v_cvt_pk_bf16_f32 v81, v146, v147
v_add_f32 v170, v170, v147
v_exp_f32 v152, v152
v_exp_f32 v153, v153
v_exp_f32 v154, v154
v_exp_f32 v155, v155
v_add_f32 v171, v148, v149
v_cvt_pk_bf16_f32 v84, v148, v149
v_add_f32 v171, v171, v150
v_cvt_pk_bf16_f32 v85, v150, v151
v_add_f32 v171, v171, v151
v_exp_f32 v156, v156
v_exp_f32 v157, v157
v_exp_f32 v158, v158
v_exp_f32 v159, v159
v_add_f32 v170, v170, v152
v_add_f32 v170, v170, v153
v_cvt_pk_bf16_f32 v82, v152, v153
v_add_f32 v170, v170, v154
v_cvt_pk_bf16_f32 v83, v154, v155
v_add_f32 v170, v170, v155
v_add_f32 v171, v171, v156
v_add_f32 v171, v171, v157
v_cvt_pk_bf16_f32 v86, v156, v157
v_add_f32 v171, v171, v158
v_cvt_pk_bf16_f32 v87, v158, v159
v_add_f32 v171, v171, v159
v_max_f32 v144, v170, v171
v_cmp_lt_f32 vcc, s74, v144
s_nop 0
s_cbranch_vccz L_ok10
s_mov_b32 s65, 10
s_call_b64 s[78:79], L_rescale
s_branch L_sm10
L_ok10:
s_mov_b32 s74, 0x47800000
v_add_f32 v174, v174, v170
v_add_f32 v175, v175, v171
s_setprio 2
s_waitcnt lgkmcnt(2)
v_mfma_f32_16x16x32_bf16 v[128:131], a[64:67], a[0:3], 0
ds_read_b128 v[144:147], v160 offset:50944
v_mfma_f32_16x16x32_bf16 v[128:131], a[68:71], a[8:11], v[128:131]
ds_read_b128 v[148:151], v160 offset:51008
v_mfma_f32_16x16x32_bf16 v[132:135], a[68:71], a[12:15], 0
v_mfma_f32_16x16x32_bf16 v[132:135], a[64:67], a[4:7], v[132:135]
s_waitcnt lgkmcnt(2)
v_mfma_f32_16x16x32_bf16 v[132:135], a[72:75], a[20:23], v[132:135]
ds_read_b128 v[152:155], v160 offset:51072
v_mfma_f32_16x16x32_bf16 v[132:135], a[76:79], a[28:31], v[132:135]
ds_read_b128 v[156:159], v160 offset:51136
v_mfma_f32_16x16x32_bf16 v[128:131], a[76:79], a[24:27], v[128:131]
v_mfma_f32_16x16x32_bf16 v[128:131], a[72:75], a[16:19], v[128:131]
s_waitcnt lgkmcnt(2)
v_mfma_f32_16x16x32_bf16 v[128:131], v[144:147], a[32:35], v[128:131]
ds_read_b128 a[64:67], v160 offset:59136
v_mfma_f32_16x16x32_bf16 v[128:131], v[148:151], a[40:43], v[128:131]
ds_read_b128 a[68:71], v160 offset:59200
v_mfma_f32_16x16x32_bf16 v[132:135], v[148:151], a[44:47], v[132:135]
v_mfma_f32_16x16x32_bf16 v[132:135], v[144:147], a[36:39], v[132:135]
s_waitcnt lgkmcnt(2)
v_mfma_f32_16x16x32_bf16 v[132:135], v[152:155], a[52:55], v[132:135]
ds_read_b128 a[72:75], v160 offset:59264
v_mfma_f32_16x16x32_bf16 v[132:135], v[156:159], a[60:63], v[132:135]
ds_read_b128 a[76:79], v160 offset:59328
v_mfma_f32_16x16x32_bf16 v[128:131], v[156:159], a[56:59], v[128:131]
v_mfma_f32_16x16x32_bf16 v[128:131], v[152:155], a[48:51], v[128:131]
s_waitcnt lgkmcnt(2)
v_mfma_f32_16x16x32_bf16 v[136:139], a[64:67], a[0:3], 0
ds_read_b128 v[144:147], v160 offset:59392
v_mfma_f32_16x16x32_bf16 v[136:139], a[68:71], a[8:11], v[136:139]
ds_read_b128 v[148:151], v160 offset:59456
v_mfma_f32_16x16x32_bf16 v[140:143], a[68:71], a[12:15], 0
v_mfma_f32_16x16x32_bf16 v[140:143], a[64:67], a[4:7], v[140:143]
s_waitcnt lgkmcnt(2)
v_mfma_f32_16x16x32_bf16 v[140:143], a[72:75], a[20:23], v[140:143]
ds_read_b128 v[152:155], v160 offset:59520
v_mfma_f32_16x16x32_bf16 v[140:143], a[76:79], a[28:31], v[140:143]
ds_read_b128 v[156:159], v160 offset:59584
v_mfma_f32_16x16x32_bf16 v[136:139], a[76:79], a[24:27], v[136:139]
v_mfma_f32_16x16x32_bf16 v[136:139], a[72:75], a[16:19], v[136:139]
s_waitcnt lgkmcnt(2)
v_mfma_f32_16x16x32_bf16 v[136:139], v[144:147], a[32:35], v[136:139]
v_mfma_f32_16x16x32_bf16 v[136:139], v[148:151], a[40:43], v[136:139]
v_mfma_f32_16x16x32_bf16 v[140:143], v[148:151], a[44:47], v[140:143]
v_mfma_f32_16x16x32_bf16 v[140:143], v[144:147], a[36:39], v[140:143]
s_waitcnt lgkmcnt(0)
s_barrier
ds_read_b128 a[64:67], v160 offset:0
ds_read_b128 a[68:71], v160 offset:64
ds_read_b128 a[72:75], v160 offset:128
ds_read_b128 a[76:79], v160 offset:192
v_mfma_f32_16x16x32_bf16 v[140:143], v[152:155], a[52:55], v[140:143]
v_mfma_f32_16x16x32_bf16 v[140:143], v[156:159], a[60:63], v[140:143]
v_mfma_f32_16x16x32_bf16 v[136:139], v[156:159], a[56:59], v[136:139]
v_mfma_f32_16x16x32_bf16 v[136:139], v[152:155], a[48:51], v[136:139]
s_setprio 0
s_nop 1
L_sm11:
v_fma_f32 v144, v128, s73, v168
v_fma_f32 v145, v129, s73, v168
v_fma_f32 v146, v130, s73, v168
v_fma_f32 v147, v131, s73, v168
v_fma_f32 v148, v132, s73, v169
v_fma_f32 v149, v133, s73, v169
v_fma_f32 v150, v134, s73, v169
v_fma_f32 v151, v135, s73, v169
v_exp_f32 v144, v144
v_exp_f32 v145, v145
v_exp_f32 v146, v146
v_exp_f32 v147, v147
v_fma_f32 v152, v136, s73, v168
v_fma_f32 v153, v137, s73, v168
v_fma_f32 v154, v138, s73, v168
v_fma_f32 v155, v139, s73, v168
v_exp_f32 v148, v148
v_exp_f32 v149, v149
v_exp_f32 v150, v150
v_exp_f32 v151, v151
v_fma_f32 v156, v140, s73, v169
v_fma_f32 v157, v141, s73, v169
v_fma_f32 v158, v142, s73, v169
v_fma_f32 v159, v143, s73, v169
v_add_f32 v170, v144, v145
v_cvt_pk_bf16_f32 v88, v144, v145
v_add_f32 v170, v170, v146
v_cvt_pk_bf16_f32 v89, v146, v147
v_add_f32 v170, v170, v147
v_exp_f32 v152, v152
v_exp_f32 v153, v153
v_exp_f32 v154, v154
v_exp_f32 v155, v155
v_add_f32 v171, v148, v149
v_cvt_pk_bf16_f32 v92, v148, v149
v_add_f32 v171, v171, v150
v_cvt_pk_bf16_f32 v93, v150, v151
v_add_f32 v171, v171, v151
v_exp_f32 v156, v156
v_exp_f32 v157, v157
v_exp_f32 v158, v158
v_exp_f32 v159, v159
v_add_f32 v170, v170, v152
v_add_f32 v170, v170, v153
v_cvt_pk_bf16_f32 v90, v152, v153
v_add_f32 v170, v170, v154
v_cvt_pk_bf16_f32 v91, v154, v155
v_add_f32 v170, v170, v155
v_add_f32 v171, v171, v156
v_add_f32 v171, v171, v157
v_cvt_pk_bf16_f32 v94, v156, v157
v_add_f32 v171, v171, v158
v_cvt_pk_bf16_f32 v95, v158, v159
v_add_f32 v171, v171, v159
v_max_f32 v144, v170, v171
v_cmp_lt_f32 vcc, s74, v144
s_nop 0
s_cbranch_vccz L_ok11
s_mov_b32 s65, 11
s_call_b64 s[78:79], L_rescale
s_branch L_sm11
L_ok11:
s_mov_b32 s74, 0x47800000
v_add_f32 v174, v174, v170
v_add_f32 v175, v175, v171
s_setprio 2
s_waitcnt lgkmcnt(2)
v_mfma_f32_16x16x32_bf16 v[128:131], a[64:67], a[0:3], 0
ds_read_b128 v[144:147], v160 offset:256
v_mfma_f32_16x16x32_bf16 v[128:131], a[68:71], a[8:11], v[128:131]
ds_read_b128 v[148:151], v160 offset:320
v_mfma_f32_16x16x32_bf16 v[132:135], a[68:71], a[12:15], 0
v_mfma_f32_16x16x32_bf16 v[132:135], a[64:67], a[4:7], v[132:135]
s_cmp_eq_u32 s75, 0
s_cbranch_scc0 L_nxw6
ds_write_b128 v166, v[112:115] offset:0
ds_write_b128 v166, v[116:119] offset:1088
L_nxw6:
s_waitcnt lgkmcnt(2)
v_mfma_f32_16x16x32_bf16 v[132:135], a[72:75], a[20:23], v[132:135]
ds_read_b128 v[152:155], v160 offset:384
v_mfma_f32_16x16x32_bf16 v[132:135], a[76:79], a[28:31], v[132:135]
ds_read_b128 v[156:159], v160 offset:448
v_mfma_f32_16x16x32_bf16 v[128:131], a[76:79], a[24:27], v[128:131]
v_mfma_f32_16x16x32_bf16 v[128:131], a[72:75], a[16:19], v[128:131]
s_waitcnt lgkmcnt(2)
v_mfma_f32_16x16x32_bf16 v[128:131], v[144:147], a[32:35], v[128:131]
ds_read_b128 a[64:67], v160 offset:8448
v_mfma_f32_16x16x32_bf16 v[128:131], v[148:151], a[40:43], v[128:131]
ds_read_b128 a[68:71], v160 offset:8512
v_mfma_f32_16x16x32_bf16 v[132:135], v[148:151], a[44:47], v[132:135]
v_mfma_f32_16x16x32_bf16 v[132:135], v[144:147], a[36:39], v[132:135]
s_waitcnt lgkmcnt(2)
v_mfma_f32_16x16x32_bf16 v[132:135], v[152:155], a[52:55], v[132:135]
ds_read_b128 a[72:75], v160 offset:8576
v_mfma_f32_16x16x32_bf16 v[132:135], v[156:159], a[60:63], v[132:135]
ds_read_b128 a[76:79], v160 offset:8640
v_mfma_f32_16x16x32_bf16 v[128:131], v[156:159], a[56:59], v[128:131]
v_mfma_f32_16x16x32_bf16 v[128:131], v[152:155], a[48:51], v[128:131]
s_waitcnt lgkmcnt(2)
v_mfma_f32_16x16x32_bf16 v[136:139], a[64:67], a[0:3], 0
ds_read_b128 v[144:147], v160 offset:8704
v_mfma_f32_16x16x32_bf16 v[136:139], a[68:71], a[8:11], v[136:139]
ds_read_b128 v[148:151], v160 offset:8768
v_mfma_f32_16x16x32_bf16 v[140:143], a[68:71], a[12:15], 0
v_mfma_f32_16x16x32_bf16 v[140:143], a[64:67], a[4:7], v[140:143]
s_waitcnt lgkmcnt(2)
v_mfma_f32_16x16x32_bf16 v[140:143], a[72:75], a[20:23], v[140:143]
ds_read_b128 v[152:155], v160 offset:8832
v_mfma_f32_16x16x32_bf16 v[140:143], a[76:79], a[28:31], v[140:143]
ds_read_b128 v[156:159], v160 offset:8896
v_mfma_f32_16x16x32_bf16 v[136:139], a[76:79], a[24:27], v[136:139]
v_mfma_f32_16x16x32_bf16 v[136:139], a[72:75], a[16:19], v[136:139]
s_waitcnt lgkmcnt(2)
v_mfma_f32_16x16x32_bf16 v[136:139], v[144:147], a[32:35], v[136:139]
ds_read_b128 a[64:67], v160 offset:16896
v_mfma_f32_16x16x32_bf16 v[136:139], v[148:151], a[40:43], v[136:139]
ds_read_b128 a[68:71], v160 offset:16960
v_mfma_f32_16x16x32_bf16 v[140:143], v[148:151], a[44:47], v[140:143]
v_mfma_f32_16x16x32_bf16 v[140:143], v[144:147], a[36:39], v[140:143]
s_waitcnt lgkmcnt(2)
v_mfma_f32_16x16x32_bf16 v[140:143], v[152:155], a[52:55], v[140:143]
ds_read_b128 a[72:75], v160 offset:17024
v_mfma_f32_16x16x32_bf16 v[140:143], v[156:159], a[60:63], v[140:143]
ds_read_b128 a[76:79], v160 offset:17088
v_mfma_f32_16x16x32_bf16 v[136:139], v[156:159], a[56:59], v[136:139]
v_mfma_f32_16x16x32_bf16 v[136:139], v[152:155], a[48:51], v[136:139]
s_setprio 0
s_nop 1
L_sm12:
v_fma_f32 v144, v128, s73, v168
v_fma_f32 v145, v129, s73, v168
v_fma_f32 v146, v130, s73, v168
v_fma_f32 v147, v131, s73, v168
v_fma_f32 v148, v132, s73, v169
v_fma_f32 v149, v133, s73, v169
v_fma_f32 v150, v134, s73, v169
v_fma_f32 v151, v135, s73, v169
v_exp_f32 v144, v144
v_exp_f32 v145, v145
v_exp_f32 v146, v146
v_exp_f32 v147, v147
v_fma_f32 v152, v136, s73, v168
v_fma_f32 v153, v137, s73, v168
v_fma_f32 v154, v138, s73, v168
v_fma_f32 v155, v139, s73, v168
v_exp_f32 v148, v148
v_exp_f32 v149, v149
v_exp_f32 v150, v150
v_exp_f32 v151, v151
v_fma_f32 v156, v140, s73, v169
v_fma_f32 v157, v141, s73, v169
v_fma_f32 v158, v142, s73, v169
v_fma_f32 v159, v143, s73, v169
v_add_f32 v170, v144, v145
v_cvt_pk_bf16_f32 v96, v144, v145
v_add_f32 v170, v170, v146
v_cvt_pk_bf16_f32 v97, v146, v147
v_add_f32 v170, v170, v147
v_exp_f32 v152, v152
v_exp_f32 v153, v153
v_exp_f32 v154, v154
v_exp_f32 v155, v155
v_add_f32 v171, v148, v149
v_cvt_pk_bf16_f32 v100, v148, v149
v_add_f32 v171, v171, v150
v_cvt_pk_bf16_f32 v101, v150, v151
v_add_f32 v171, v171, v151
v_exp_f32 v156, v156
v_exp_f32 v157, v157
v_exp_f32 v158, v158
v_exp_f32 v159, v159
v_add_f32 v170, v170, v152
v_add_f32 v170, v170, v153
v_cvt_pk_bf16_f32 v98, v152, v153
v_add_f32 v170, v170, v154
v_cvt_pk_bf16_f32 v99, v154, v155
v_add_f32 v170, v170, v155
v_add_f32 v171, v171, v156
v_add_f32 v171, v171, v157
v_cvt_pk_bf16_f32 v102, v156, v157
v_add_f32 v171, v171, v158
v_cvt_pk_bf16_f32 v103, v158, v159
v_add_f32 v171, v171, v159
v_max_f32 v144, v170, v171
v_cmp_lt_f32 vcc, s74, v144
s_nop 0
s_cbranch_vccz L_ok12
s_mov_b32 s65, 12
s_call_b64 s[78:79], L_rescale
s_branch L_sm12
L_ok12:
s_mov_b32 s74, 0x47800000
v_add_f32 v174, v174, v170
v_add_f32 v175, v175, v171
s_setprio 2
s_waitcnt lgkmcnt(2)
v_mfma_f32_16x16x32_bf16 v[128:131], a[64:67], a[0:3], 0
ds_read_b128 v[144:147], v160 offset:17152
v_mfma_f32_16x16x32_bf16 v[128:131], a[68:71], a[8:11], v[128:131]
ds_read_b128 v[148:151], v160 offset:17216
v_mfma_f32_16x16x32_bf16 v[132:135], a[68:71], a[12:15], 0
v_mfma_f32_16x16x32_bf16 v[132:135], a[64:67], a[4:7], v[132:135]
s_waitcnt lgkmcnt(2)
v_mfma_f32_16x16x32_bf16 v[132:135], a[72:75], a[20:23], v[132:135]
ds_read_b128 v[152:155], v160 offset:17280
v_mfma_f32_16x16x32_bf16 v[132:135], a[76:79], a[28:31], v[132:135]
ds_read_b128 v[156:159], v160 offset:17344
v_mfma_f32_16x16x32_bf16 v[128:131], a[76:79], a[24:27], v[128:131]
v_mfma_f32_16x16x32_bf16 v[128:131], a[72:75], a[16:19], v[128:131]
s_waitcnt lgkmcnt(2)
v_mfma_f32_16x16x32_bf16 v[128:131], v[144:147], a[32:35], v[128:131]
ds_read_b128 a[64:67], v160 offset:25344
v_mfma_f32_16x16x32_bf16 v[128:131], v[148:151], a[40:43], v[128:131]
ds_read_b128 a[68:71], v160 offset:25408
v_mfma_f32_16x16x32_bf16 v[132:135], v[148:151], a[44:47], v[132:135]
v_mfma_f32_16x16x32_bf16 v[132:135], v[144:147], a[36:39], v[132:135]
s_waitcnt lgkmcnt(2)
v_mfma_f32_16x16x32_bf16 v[132:135], v[152:155], a[52:55], v[132:135]
ds_read_b128 a[72:75], v160 offset:25472
v_mfma_f32_16x16x32_bf16 v[132:135], v[156:159], a[60:63], v[132:135]
ds_read_b128 a[76:79], v160 offset:25536
v_mfma_f32_16x16x32_bf16 v[128:131], v[156:159], a[56:59], v[128:131]
v_mfma_f32_16x16x32_bf16 v[128:131], v[152:155], a[48:51], v[128:131]
s_waitcnt lgkmcnt(2)
v_mfma_f32_16x16x32_bf16 v[136:139], a[64:67], a[0:3], 0
ds_read_b128 v[144:147], v160 offset:25600
v_mfma_f32_16x16x32_bf16 v[136:139], a[68:71], a[8:11], v[136:139]
ds_read_b128 v[148:151], v160 offset:25664
v_mfma_f32_16x16x32_bf16 v[140:143], a[68:71], a[12:15], 0
v_mfma_f32_16x16x32_bf16 v[140:143], a[64:67], a[4:7], v[140:143]
s_waitcnt lgkmcnt(2)
v_mfma_f32_16x16x32_bf16 v[140:143], a[72:75], a[20:23], v[140:143]
ds_read_b128 v[152:155], v160 offset:25728
v_mfma_f32_16x16x32_bf16 v[140:143], a[76:79], a[28:31], v[140:143]
ds_read_b128 v[156:159], v160 offset:25792
v_mfma_f32_16x16x32_bf16 v[136:139], a[76:79], a[24:27], v[136:139]
v_mfma_f32_16x16x32_bf16 v[136:139], a[72:75], a[16:19], v[136:139]
s_waitcnt lgkmcnt(2)
v_mfma_f32_16x16x32_bf16 v[136:139], v[144:147], a[32:35], v[136:139]
v_mfma_f32_16x16x32_bf16 v[136:139], v[148:151], a[40:43], v[136:139]
v_mfma_f32_16x16x32_bf16 v[140:143], v[148:151], a[44:47], v[140:143]
v_mfma_f32_16x16x32_bf16 v[140:143], v[144:147], a[36:39], v[140:143]
s_waitcnt lgkmcnt(0)
s_barrier
ds_read_b128 a[64:67], v160 offset:33792
ds_read_b128 a[68:71], v160 offset:33856
ds_read_b128 a[72:75], v160 offset:33920
ds_read_b128 a[76:79], v160 offset:33984
v_mfma_f32_16x16x32_bf16 v[140:143], v[152:155], a[52:55], v[140:143]
v_mfma_f32_16x16x32_bf16 v[140:143], v[156:159], a[60:63], v[140:143]
v_mfma_f32_16x16x32_bf16 v[136:139], v[156:159], a[56:59], v[136:139]
v_mfma_f32_16x16x32_bf16 v[136:139], v[152:155], a[48:51], v[136:139]
s_setprio 0
s_nop 1
L_sm13:
v_fma_f32 v144, v128, s73, v168
v_fma_f32 v145, v129, s73, v168
v_fma_f32 v146, v130, s73, v168
v_fma_f32 v147, v131, s73, v168
v_fma_f32 v148, v132, s73, v169
v_fma_f32 v149, v133, s73, v169
v_fma_f32 v150, v134, s73, v169
v_fma_f32 v151, v135, s73, v169
v_exp_f32 v144, v144
v_exp_f32 v145, v145
v_exp_f32 v146, v146
v_exp_f32 v147, v147
v_fma_f32 v152, v136, s73, v168
v_fma_f32 v153, v137, s73, v168
v_fma_f32 v154, v138, s73, v168
v_fma_f32 v155, v139, s73, v168
v_exp_f32 v148, v148
v_exp_f32 v149, v149
v_exp_f32 v150, v150
v_exp_f32 v151, v151
v_fma_f32 v156, v140, s73, v169
v_fma_f32 v157, v141, s73, v169
v_fma_f32 v158, v142, s73, v169
v_fma_f32 v159, v143, s73, v169
v_add_f32 v170, v144, v145
v_cvt_pk_bf16_f32 v104, v144, v145
v_add_f32 v170, v170, v146
v_cvt_pk_bf16_f32 v105, v146, v147
v_add_f32 v170, v170, v147
v_exp_f32 v152, v152
v_exp_f32 v153, v153
v_exp_f32 v154, v154
v_exp_f32 v155, v155
v_add_f32 v171, v148, v149
v_cvt_pk_bf16_f32 v108, v148, v149
v_add_f32 v171, v171, v150
v_cvt_pk_bf16_f32 v109, v150, v151
v_add_f32 v171, v171, v151
v_exp_f32 v156, v156
v_exp_f32 v157, v157
v_exp_f32 v158, v158
v_exp_f32 v159, v159
v_add_f32 v170, v170, v152
v_add_f32 v170, v170, v153
v_cvt_pk_bf16_f32 v106, v152, v153
v_add_f32 v170, v170, v154
v_cvt_pk_bf16_f32 v107, v154, v155
v_add_f32 v170, v170, v155
v_add_f32 v171, v171, v156
v_add_f32 v171, v171, v157
v_cvt_pk_bf16_f32 v110, v156, v157
v_add_f32 v171, v171, v158
v_cvt_pk_bf16_f32 v111, v158, v159
v_add_f32 v171, v171, v159
v_max_f32 v144, v170, v171
v_cmp_lt_f32 vcc, s74, v144
s_nop 0
s_cbranch_vccz L_ok13
s_mov_b32 s65, 13
s_call_b64 s[78:79], L_rescale
s_branch L_sm13
L_ok13:
s_mov_b32 s74, 0x47800000
v_add_f32 v174, v174, v170
v_add_f32 v175, v175, v171
s_setprio 2
s_waitcnt lgkmcnt(2)
v_mfma_f32_16x16x32_bf16 v[128:131], a[64:67], a[0:3], 0
ds_read_b128 v[144:147], v160 offset:34048
v_mfma_f32_16x16x32_bf16 v[128:131], a[68:71], a[8:11], v[128:131]
ds_read_b128 v[148:151], v160 offset:34112
v_mfma_f32_16x16x32_bf16 v[132:135], a[68:71], a[12:15], 0
v_mfma_f32_16x16x32_bf16 v[132:135], a[64:67], a[4:7], v[132:135]
s_waitcnt lgkmcnt(2)
v_mfma_f32_16x16x32_bf16 v[132:135], a[72:75], a[20:23], v[132:135]
ds_read_b128 v[152:155], v160 offset:34176
v_mfma_f32_16x16x32_bf16 v[132:135], a[76:79], a[28:31], v[132:135]
ds_read_b128 v[156:159], v160 offset:34240
v_mfma_f32_16x16x32_bf16 v[128:131], a[76:79], a[24:27], v[128:131]
v_mfma_f32_16x16x32_bf16 v[128:131], a[72:75], a[16:19], v[128:131]
s_waitcnt lgkmcnt(2)
v_mfma_f32_16x16x32_bf16 v[128:131], v[144:147], a[32:35], v[128:131]
ds_read_b128 a[64:67], v160 offset:42240
v_mfma_f32_16x16x32_bf16 v[128:131], v[148:151], a[40:43], v[128:131]
ds_read_b128 a[68:71], v160 offset:42304
v_mfma_f32_16x16x32_bf16 v[132:135], v[148:151], a[44:47], v[132:135]
v_mfma_f32_16x16x32_bf16 v[132:135], v[144:147], a[36:39], v[132:135]
s_waitcnt lgkmcnt(2)
v_mfma_f32_16x16x32_bf16 v[132:135], v[152:155], a[52:55], v[132:135]
ds_read_b128 a[72:75], v160 offset:42368
v_mfma_f32_16x16x32_bf16 v[132:135], v[156:159], a[60:63], v[132:135]
ds_read_b128 a[76:79], v160 offset:42432
v_mfma_f32_16x16x32_bf16 v[128:131], v[156:159], a[56:59], v[128:131]
v_mfma_f32_16x16x32_bf16 v[128:131], v[152:155], a[48:51], v[128:131]
s_waitcnt lgkmcnt(2)
v_mfma_f32_16x16x32_bf16 v[136:139], a[64:67], a[0:3], 0
ds_read_b128 v[144:147], v160 offset:42496
v_mfma_f32_16x16x32_bf16 v[136:139], a[68:71], a[8:11], v[136:139]
ds_read_b128 v[148:151], v160 offset:42560
v_mfma_f32_16x16x32_bf16 v[140:143], a[68:71], a[12:15], 0
v_mfma_f32_16x16x32_bf16 v[140:143], a[64:67], a[4:7], v[140:143]
s_waitcnt lgkmcnt(2)
v_mfma_f32_16x16x32_bf16 v[140:143], a[72:75], a[20:23], v[140:143]
ds_read_b128 v[152:155], v160 offset:42624
v_mfma_f32_16x16x32_bf16 v[140:143], a[76:79], a[28:31], v[140:143]
ds_read_b128 v[156:159], v160 offset:42688
v_mfma_f32_16x16x32_bf16 v[136:139], a[76:79], a[24:27], v[136:139]
v_mfma_f32_16x16x32_bf16 v[136:139], a[72:75], a[16:19], v[136:139]
s_waitcnt lgkmcnt(2)
v_mfma_f32_16x16x32_bf16 v[136:139], v[144:147], a[32:35], v[136:139]
ds_read_b128 a[64:67], v160 offset:50688
v_mfma_f32_16x16x32_bf16 v[136:139], v[148:151], a[40:43], v[136:139]
ds_read_b128 a[68:71], v160 offset:50752
v_mfma_f32_16x16x32_bf16 v[140:143], v[148:151], a[44:47], v[140:143]
v_mfma_f32_16x16x32_bf16 v[140:143], v[144:147], a[36:39], v[140:143]
s_waitcnt lgkmcnt(2)
v_mfma_f32_16x16x32_bf16 v[140:143], v[152:155], a[52:55], v[140:143]
ds_read_b128 a[72:75], v160 offset:50816
v_mfma_f32_16x16x32_bf16 v[140:143], v[156:159], a[60:63], v[140:143]
ds_read_b128 a[76:79], v160 offset:50880
v_mfma_f32_16x16x32_bf16 v[136:139], v[156:159], a[56:59], v[136:139]
v_mfma_f32_16x16x32_bf16 v[136:139], v[152:155], a[48:51], v[136:139]
s_setprio 0
s_nop 1
L_sm14:
v_fma_f32 v144, v128, s73, v168
v_fma_f32 v145, v129, s73, v168
v_fma_f32 v146, v130, s73, v168
v_fma_f32 v147, v131, s73, v168
v_fma_f32 v148, v132, s73, v169
v_fma_f32 v149, v133, s73, v169
v_fma_f32 v150, v134, s73, v169
v_fma_f32 v151, v135, s73, v169
v_exp_f32 v144, v144
v_exp_f32 v145, v145
v_exp_f32 v146, v146
v_exp_f32 v147, v147
v_fma_f32 v152, v136, s73, v168
v_fma_f32 v153, v137, s73, v168
v_fma_f32 v154, v138, s73, v168
v_fma_f32 v155, v139, s73, v168
v_exp_f32 v148, v148
v_exp_f32 v149, v149
v_exp_f32 v150, v150
v_exp_f32 v151, v151
v_fma_f32 v156, v140, s73, v169
v_fma_f32 v157, v141, s73, v169
v_fma_f32 v158, v142, s73, v169
v_fma_f32 v159, v143, s73, v169
v_add_f32 v170, v144, v145
v_cvt_pk_bf16_f32 v112, v144, v145
v_add_f32 v170, v170, v146
v_cvt_pk_bf16_f32 v113, v146, v147
v_add_f32 v170, v170, v147
v_exp_f32 v152, v152
v_exp_f32 v153, v153
v_exp_f32 v154, v154
v_exp_f32 v155, v155
v_add_f32 v171, v148, v149
v_cvt_pk_bf16_f32 v116, v148, v149
v_add_f32 v171, v171, v150
v_cvt_pk_bf16_f32 v117, v150, v151
v_add_f32 v171, v171, v151
v_exp_f32 v156, v156
v_exp_f32 v157, v157
v_exp_f32 v158, v158
v_exp_f32 v159, v159
v_add_f32 v170, v170, v152
v_add_f32 v170, v170, v153
v_cvt_pk_bf16_f32 v114, v152, v153
v_add_f32 v170, v170, v154
v_cvt_pk_bf16_f32 v115, v154, v155
v_add_f32 v170, v170, v155
v_add_f32 v171, v171, v156
v_add_f32 v171, v171, v157
v_cvt_pk_bf16_f32 v118, v156, v157
v_add_f32 v171, v171, v158
v_cvt_pk_bf16_f32 v119, v158, v159
v_add_f32 v171, v171, v159
v_max_f32 v144, v170, v171
v_cmp_lt_f32 vcc, s74, v144
s_nop 0
s_cbranch_vccz L_ok14
s_mov_b32 s65, 14
s_call_b64 s[78:79], L_rescale
s_branch L_sm14
L_ok14:
s_mov_b32 s74, 0x47800000
v_add_f32 v174, v174, v170
v_add_f32 v175, v175, v171
s_setprio 2
s_waitcnt lgkmcnt(2)
v_mfma_f32_16x16x32_bf16 v[128:131], a[64:67], a[0:3], 0
ds_read_b128 v[144:147], v160 offset:50944
v_mfma_f32_16x16x32_bf16 v[128:131], a[68:71], a[8:11], v[128:131]
ds_read_b128 v[148:151], v160 offset:51008
v_mfma_f32_16x16x32_bf16 v[132:135], a[68:71], a[12:15], 0
v_mfma_f32_16x16x32_bf16 v[132:135], a[64:67], a[4:7], v[132:135]
s_waitcnt lgkmcnt(2)
v_mfma_f32_16x16x32_bf16 v[132:135], a[72:75], a[20:23], v[132:135]
ds_read_b128 v[152:155], v160 offset:51072
v_mfma_f32_16x16x32_bf16 v[132:135], a[76:79], a[28:31], v[132:135]
ds_read_b128 v[156:159], v160 offset:51136
v_mfma_f32_16x16x32_bf16 v[128:131], a[76:79], a[24:27], v[128:131]
v_mfma_f32_16x16x32_bf16 v[128:131], a[72:75], a[16:19], v[128:131]
s_waitcnt lgkmcnt(2)
v_mfma_f32_16x16x32_bf16 v[128:131], v[144:147], a[32:35], v[128:131]
ds_read_b128 a[64:67], v160 offset:59136
v_mfma_f32_16x16x32_bf16 v[128:131], v[148:151], a[40:43], v[128:131]
ds_read_b128 a[68:71], v160 offset:59200
v_mfma_f32_16x16x32_bf16 v[132:135], v[148:151], a[44:47], v[132:135]
v_mfma_f32_16x16x32_bf16 v[132:135], v[144:147], a[36:39], v[132:135]
s_waitcnt lgkmcnt(2)
v_mfma_f32_16x16x32_bf16 v[132:135], v[152:155], a[52:55], v[132:135]
ds_read_b128 a[72:75], v160 offset:59264
v_mfma_f32_16x16x32_bf16 v[132:135], v[156:159], a[60:63], v[132:135]
ds_read_b128 a[76:79], v160 offset:59328
v_mfma_f32_16x16x32_bf16 v[128:131], v[156:159], a[56:59], v[128:131]
v_mfma_f32_16x16x32_bf16 v[128:131], v[152:155], a[48:51], v[128:131]
s_waitcnt lgkmcnt(2)
v_mfma_f32_16x16x32_bf16 v[136:139], a[64:67], a[0:3], 0
ds_read_b128 v[144:147], v160 offset:59392
v_mfma_f32_16x16x32_bf16 v[136:139], a[68:71], a[8:11], v[136:139]
ds_read_b128 v[148:151], v160 offset:59456
v_mfma_f32_16x16x32_bf16 v[140:143], a[68:71], a[12:15], 0
v_mfma_f32_16x16x32_bf16 v[140:143], a[64:67], a[4:7], v[140:143]
s_waitcnt lgkmcnt(2)
v_mfma_f32_16x16x32_bf16 v[140:143], a[72:75], a[20:23], v[140:143]
ds_read_b128 v[152:155], v160 offset:59520
v_mfma_f32_16x16x32_bf16 v[140:143], a[76:79], a[28:31], v[140:143]
ds_read_b128 v[156:159], v160 offset:59584
v_mfma_f32_16x16x32_bf16 v[136:139], a[76:79], a[24:27], v[136:139]
v_mfma_f32_16x16x32_bf16 v[136:139], a[72:75], a[16:19], v[136:139]
s_waitcnt lgkmcnt(2)
v_mfma_f32_16x16x32_bf16 v[136:139], v[144:147], a[32:35], v[136:139]
v_mfma_f32_16x16x32_bf16 v[136:139], v[148:151], a[40:43], v[136:139]
v_mfma_f32_16x16x32_bf16 v[140:143], v[148:151], a[44:47], v[140:143]
v_mfma_f32_16x16x32_bf16 v[140:143], v[144:147], a[36:39], v[140:143]
s_waitcnt lgkmcnt(0)
s_barrier
ds_read_b64_tr_b16 a[64:65], v161 offset:0
ds_read_b64_tr_b16 a[66:67], v161 offset:2048
ds_read_b64_tr_b16 a[68:69], v161 offset:4096
ds_read_b64_tr_b16 a[70:71], v161 offset:6144
ds_read_b64_tr_b16 a[72:73], v161 offset:8192
ds_read_b64_tr_b16 a[74:75], v161 offset:10240
ds_read_b64_tr_b16 a[76:77], v161 offset:12288
ds_read_b64_tr_b16 a[78:79], v161 offset:14336
v_mfma_f32_16x16x32_bf16 v[140:143], v[152:155], a[52:55], v[140:143]
v_mfma_f32_16x16x32_bf16 v[140:143], v[156:159], a[60:63], v[140:143]
v_mfma_f32_16x16x32_bf16 v[136:139], v[156:159], a[56:59], v[136:139]
v_mfma_f32_16x16x32_bf16 v[136:139], v[152:155], a[48:51], v[136:139]
s_setprio 0
s_nop 1
L_sm15:
v_fma_f32 v144, v128, s73, v168
v_fma_f32 v145, v129, s73, v168
v_fma_f32 v146, v130, s73, v168
v_fma_f32 v147, v131, s73, v168
v_fma_f32 v148, v132, s73, v169
v_fma_f32 v149, v133, s73, v169
v_fma_f32 v150, v134, s73, v169
v_fma_f32 v151, v135, s73, v169
v_exp_f32 v144, v144
v_exp_f32 v145, v145
v_exp_f32 v146, v146
v_exp_f32 v147, v147
v_fma_f32 v152, v136, s73, v168
v_fma_f32 v153, v137, s73, v168
v_fma_f32 v154, v138, s73, v168
v_fma_f32 v155, v139, s73, v168
v_exp_f32 v148, v148
v_exp_f32 v149, v149
v_exp_f32 v150, v150
v_exp_f32 v151, v151
v_fma_f32 v156, v140, s73, v169
v_fma_f32 v157, v141, s73, v169
v_fma_f32 v158, v142, s73, v169
v_fma_f32 v159, v143, s73, v169
v_add_f32 v170, v144, v145
v_cvt_pk_bf16_f32 v120, v144, v145
v_add_f32 v170, v170, v146
v_cvt_pk_bf16_f32 v121, v146, v147
v_add_f32 v170, v170, v147
v_exp_f32 v152, v152
v_exp_f32 v153, v153
v_exp_f32 v154, v154
v_exp_f32 v155, v155
v_add_f32 v171, v148, v149
v_cvt_pk_bf16_f32 v124, v148, v149
v_add_f32 v171, v171, v150
v_cvt_pk_bf16_f32 v125, v150, v151
v_add_f32 v171, v171, v151
v_exp_f32 v156, v156
v_exp_f32 v157, v157
v_exp_f32 v158, v158
v_exp_f32 v159, v159
v_add_f32 v170, v170, v152
v_add_f32 v170, v170, v153
v_cvt_pk_bf16_f32 v122, v152, v153
v_add_f32 v170, v170, v154
v_cvt_pk_bf16_f32 v123, v154, v155
v_add_f32 v170, v170, v155
v_add_f32 v171, v171, v156
v_add_f32 v171, v171, v157
v_cvt_pk_bf16_f32 v126, v156, v157
v_add_f32 v171, v171, v158
v_cvt_pk_bf16_f32 v127, v158, v159
v_add_f32 v171, v171, v159
v_max_f32 v144, v170, v171
v_cmp_lt_f32 vcc, s74, v144
s_nop 0
s_cbranch_vccz L_ok15
s_mov_b32 s65, 15
s_call_b64 s[78:79], L_rescale
s_branch L_sm15
L_ok15:
s_mov_b32 s74, 0x47800000
v_add_f32 v174, v174, v170
v_add_f32 v175, v175, v171
v_mov_b32 v144, v174
s_nop 1
v_permlane32_swap_b32 v144, v174
s_nop 1
v_add_f32 v174, v174, v144
v_mov_b32 v144, v174
s_nop 1
v_permlane16_swap_b32 v144, v174
s_nop 1
v_add_f32 v174, v174, v144
v_rcp_f32 v174, v174
v_mov_b32 v144, v175
s_nop 1
v_permlane32_swap_b32 v144, v175
s_nop 1
v_add_f32 v175, v175, v144
v_mov_b32 v144, v175
s_nop 1
v_permlane16_swap_b32 v144, v175
s_nop 1
v_add_f32 v175, v175, v144
v_rcp_f32 v175, v175
s_mov_b32 s76, 0
L_chunk:
s_setprio 2
s_waitcnt lgkmcnt(4)
v_mfma_f32_16x16x32_bf16 v[128:131], a[64:67], v[0:3], 0
ds_read_b64_tr_b16 v[166:167], v161 offset:16384
v_mfma_f32_16x16x32_bf16 v[128:131], a[68:71], v[8:11], v[128:131]
ds_read_b64_tr_b16 v[168:169], v161 offset:18432
v_mfma_f32_16x16x32_bf16 v[132:135], a[68:71], v[12:15], 0
ds_read_b64_tr_b16 v[170:171], v161 offset:20480
v_mfma_f32_16x16x32_bf16 v[132:135], a[64:67], v[4:7], v[132:135]
ds_read_b64_tr_b16 v[172:173], v161 offset:22528
s_waitcnt lgkmcnt(4)
v_mfma_f32_16x16x32_bf16 v[132:135], a[72:75], v[20:23], v[132:135]
ds_read_b64_tr_b16 a[64:65], v161 offset:24576
v_mfma_f32_16x16x32_bf16 v[132:135], a[76:79], v[28:31], v[132:135]
ds_read_b64_tr_b16 a[66:67], v161 offset:26624
v_mfma_f32_16x16x32_bf16 v[128:131], a[76:79], v[24:27], v[128:131]
ds_read_b64_tr_b16 a[68:69], v161 offset:28672
v_mfma_f32_16x16x32_bf16 v[128:131], a[72:75], v[16:19], v[128:131]
ds_read_b64_tr_b16 a[70:71], v161 offset:30720
s_waitcnt lgkmcnt(4)
v_mfma_f32_16x16x32_bf16 v[128:131], v[166:169], v[32:35], v[128:131]
ds_read_b64_tr_b16 a[72:73], v162 offset:0
v_mfma_f32_16x16x32_bf16 v[128:131], v[170:173], v[40:43], v[128:131]
ds_read_b64_tr_b16 a[74:75], v162 offset:2048
v_mfma_f32_16x16x32_bf16 v[132:135], v[170:173], v[44:47], v[132:135]
ds_read_b64_tr_b16 a[76:77], v162 offset:4096
v_mfma_f32_16x16x32_bf16 v[132:135], v[166:169], v[36:39], v[132:135]
ds_read_b64_tr_b16 a[78:79], v162 offset:6144
s_lshl2_add_u32 s64, s75, s76
s_bitcmp1_b32 34, s64
s_cbranch_scc0 L_nobearly
s_barrier
L_nobearly:
s_waitcnt lgkmcnt(4)
v_mfma_f32_16x16x32_bf16 v[132:135], a[64:67], v[52:55], v[132:135]
ds_read_b64_tr_b16 v[166:167], v162 offset:8192
v_mfma_f32_16x16x32_bf16 v[132:135], a[68:71], v[60:63], v[132:135]
ds_read_b64_tr_b16 v[168:169], v162 offset:10240
v_mfma_f32_16x16x32_bf16 v[128:131], a[68:71], v[56:59], v[128:131]
ds_read_b64_tr_b16 v[170:171], v162 offset:12288
v_mfma_f32_16x16x32_bf16 v[128:131], a[64:67], v[48:51], v[128:131]
ds_read_b64_tr_b16 v[172:173], v162 offset:14336
s_waitcnt lgkmcnt(4)
v_mfma_f32_16x16x32_bf16 v[136:139], a[72:75], v[0:3], 0
ds_read_b64_tr_b16 a[64:65], v162 offset:16384
v_mfma_f32_16x16x32_bf16 v[136:139], a[76:79], v[8:11], v[136:139]
ds_read_b64_tr_b16 a[66:67], v162 offset:18432
v_mfma_f32_16x16x32_bf16 v[140:143], a[76:79], v[12:15], 0
ds_read_b64_tr_b16 a[68:69], v162 offset:20480
v_mfma_f32_16x16x32_bf16 v[140:143], a[72:75], v[4:7], v[140:143]
ds_read_b64_tr_b16 a[70:71], v162 offset:22528
s_waitcnt lgkmcnt(4)
v_mfma_f32_16x16x32_bf16 v[140:143], v[166:169], v[20:23], v[140:143]
ds_read_b64_tr_b16 a[72:73], v162 offset:24576
v_mfma_f32_16x16x32_bf16 v[140:143], v[170:173], v[28:31], v[140:143]
ds_read_b64_tr_b16 a[74:75], v162 offset:26624
v_mfma_f32_16x16x32_bf16 v[136:139], v[170:173], v[24:27], v[136:139]
ds_read_b64_tr_b16 a[76:77], v162 offset:28672
v_mfma_f32_16x16x32_bf16 v[136:139], v[166:169], v[16:19], v[136:139]
ds_read_b64_tr_b16 a[78:79], v162 offset:30720
s_waitcnt lgkmcnt(4)
v_mfma_f32_16x16x32_bf16 v[136:139], a[64:67], v[32:35], v[136:139]
ds_read_b64_tr_b16 v[166:167], v163 offset:0
v_mfma_f32_16x16x32_bf16 v[136:139], a[68:71], v[40:43], v[136:139]
ds_read_b64_tr_b16 v[168:169], v163 offset:2048
v_mfma_f32_16x16x32_bf16 v[140:143], a[68:71], v[44:47], v[140:143]
ds_read_b64_tr_b16 v[170:171], v163 offset:4096
v_mfma_f32_16x16x32_bf16 v[140:143], a[64:67], v[36:39], v[140:143]
ds_read_b64_tr_b16 v[172:173], v163 offset:6144
s_waitcnt lgkmcnt(4)
v_mfma_f32_16x16x32_bf16 v[140:143], a[72:75], v[52:55], v[140:143]
ds_read_b64_tr_b16 a[64:65], v163 offset:8192
v_mfma_f32_16x16x32_bf16 v[140:143], a[76:79], v[60:63], v[140:143]
ds_read_b64_tr_b16 a[66:67], v163 offset:10240
v_mfma_f32_16x16x32_bf16 v[136:139], a[76:79], v[56:59], v[136:139]
ds_read_b64_tr_b16 a[68:69], v163 offset:12288
v_mfma_f32_16x16x32_bf16 v[136:139], a[72:75], v[48:51], v[136:139]
ds_read_b64_tr_b16 a[70:71], v163 offset:14336
s_waitcnt lgkmcnt(4)
v_mfma_f32_16x16x32_bf16 v[144:147], v[166:169], v[0:3], 0
ds_read_b64_tr_b16 a[72:73], v163 offset:16384
v_mfma_f32_16x16x32_bf16 v[144:147], v[170:173], v[8:11], v[144:147]
ds_read_b64_tr_b16 a[74:75], v163 offset:18432
v_mfma_f32_16x16x32_bf16 v[148:151], v[170:173], v[12:15], 0
ds_read_b64_tr_b16 a[76:77], v163 offset:20480
v_mfma_f32_16x16x32_bf16 v[148:151], v[166:169], v[4:7], v[148:151]
ds_read_b64_tr_b16 a[78:79], v163 offset:22528
s_waitcnt lgkmcnt(4)
v_mfma_f32_16x16x32_bf16 v[148:151], a[64:67], v[20:23], v[148:151]
ds_read_b64_tr_b16 v[166:167], v163 offset:24576
v_mfma_f32_16x16x32_bf16 v[148:151], a[68:71], v[28:31], v[148:151]
ds_read_b64_tr_b16 v[168:169], v163 offset:26624
v_mfma_f32_16x16x32_bf16 v[144:147], a[68:71], v[24:27], v[144:147]
ds_read_b64_tr_b16 v[170:171], v163 offset:28672
v_mfma_f32_16x16x32_bf16 v[144:147], a[64:67], v[16:19], v[144:147]
ds_read_b64_tr_b16 v[172:173], v163 offset:30720
s_waitcnt lgkmcnt(4)
v_mfma_f32_16x16x32_bf16 v[144:147], a[72:75], v[32:35], v[144:147]
ds_read_b64_tr_b16 a[64:65], v164 offset:0
v_mfma_f32_16x16x32_bf16 v[144:147], a[76:79], v[40:43], v[144:147]
ds_read_b64_tr_b16 a[66:67], v164 offset:2048
v_mfma_f32_16x16x32_bf16 v[148:151], a[76:79], v[44:47], v[148:151]
ds_read_b64_tr_b16 a[68:69], v164 offset:4096
v_mfma_f32_16x16x32_bf16 v[148:151], a[72:75], v[36:39], v[148:151]
ds_read_b64_tr_b16 a[70:71], v164 offset:6144
s_waitcnt lgkmcnt(4)
v_mfma_f32_16x16x32_bf16 v[148:151], v[166:169], v[52:55], v[148:151]
ds_read_b64_tr_b16 a[72:73], v164 offset:8192
v_mfma_f32_16x16x32_bf16 v[148:151], v[170:173], v[60:63], v[148:151]
ds_read_b64_tr_b16 a[74:75], v164 offset:10240
v_mfma_f32_16x16x32_bf16 v[144:147], v[170:173], v[56:59], v[144:147]
ds_read_b64_tr_b16 a[76:77], v164 offset:12288
v_mfma_f32_16x16x32_bf16 v[144:147], v[166:169], v[48:51], v[144:147]
ds_read_b64_tr_b16 a[78:79], v164 offset:14336
s_waitcnt lgkmcnt(4)
v_mfma_f32_16x16x32_bf16 v[152:155], a[64:67], v[0:3], 0
ds_read_b64_tr_b16 v[166:167], v164 offset:16384
v_mfma_f32_16x16x32_bf16 v[152:155], a[68:71], v[8:11], v[152:155]
ds_read_b64_tr_b16 v[168:169], v164 offset:18432
v_mfma_f32_16x16x32_bf16 v[156:159], a[68:71], v[12:15], 0
ds_read_b64_tr_b16 v[170:171], v164 offset:20480
v_mfma_f32_16x16x32_bf16 v[156:159], a[64:67], v[4:7], v[156:159]
ds_read_b64_tr_b16 v[172:173], v164 offset:22528
s_waitcnt lgkmcnt(4)
v_mfma_f32_16x16x32_bf16 v[156:159], a[72:75], v[20:23], v[156:159]
ds_read_b64_tr_b16 a[64:65], v164 offset:24576
v_mfma_f32_16x16x32_bf16 v[156:159], a[76:79], v[28:31], v[156:159]
ds_read_b64_tr_b16 a[66:67], v164 offset:26624
v_mfma_f32_16x16x32_bf16 v[152:155], a[76:79], v[24:27], v[152:155]
ds_read_b64_tr_b16 a[68:69], v164 offset:28672
v_mfma_f32_16x16x32_bf16 v[152:155], a[72:75], v[16:19], v[152:155]
ds_read_b64_tr_b16 a[70:71], v164 offset:30720
s_waitcnt lgkmcnt(4)
v_mfma_f32_16x16x32_bf16 v[152:155], v[166:169], v[32:35], v[152:155]
v_mfma_f32_16x16x32_bf16 v[152:155], v[170:173], v[40:43], v[152:155]
v_mfma_f32_16x16x32_bf16 v[156:159], v[170:173], v[44:47], v[156:159]
v_mfma_f32_16x16x32_bf16 v[156:159], v[166:169], v[36:39], v[156:159]
s_waitcnt lgkmcnt(0)
s_barrier
ds_read_b64_tr_b16 a[72:73], v161 offset:33792
ds_read_b64_tr_b16 a[74:75], v161 offset:35840
ds_read_b64_tr_b16 a[76:77], v161 offset:37888
ds_read_b64_tr_b16 a[78:79], v161 offset:39936
ds_read_b64_tr_b16 v[166:167], v161 offset:41984
ds_read_b64_tr_b16 v[168:169], v161 offset:44032
ds_read_b64_tr_b16 v[170:171], v161 offset:46080
ds_read_b64_tr_b16 v[172:173], v161 offset:48128
v_mfma_f32_16x16x32_bf16 v[156:159], a[64:67], v[52:55], v[156:159]
v_mfma_f32_16x16x32_bf16 v[156:159], a[68:71], v[60:63], v[156:159]
v_mfma_f32_16x16x32_bf16 v[152:155], a[68:71], v[56:59], v[152:155]
v_mfma_f32_16x16x32_bf16 v[152:155], a[64:67], v[48:51], v[152:155]
s_or_b32 s64, s75, s76
s_cbranch_scc1 L_noq2
v_add_u32 v165, s67, v165
ds_read_b128 a[0:3], v165 offset:0
ds_read_b128 a[4:7], v165 offset:4096
ds_read_b128 a[8:11], v165 offset:1024
ds_read_b128 a[12:15], v165 offset:5120
ds_read_b128 a[16:19], v165 offset:2048
ds_read_b128 a[20:23], v165 offset:6144
ds_read_b128 a[24:27], v165 offset:3072
ds_read_b128 a[28:31], v165 offset:7168
ds_read_b128 a[32:35], v165 offset:16384
ds_read_b128 a[36:39], v165 offset:20480
ds_read_b128 a[40:43], v165 offset:17408
ds_read_b128 a[44:47], v165 offset:21504
ds_read_b128 a[48:51], v165 offset:18432
ds_read_b128 a[52:55], v165 offset:22528
ds_read_b128 a[56:59], v165 offset:19456
ds_read_b128 a[60:63], v165 offset:23552
v_subrev_u32 v165, s67, v165
L_noq2:
s_waitcnt lgkmcnt(4)
v_mfma_f32_16x16x32_bf16 v[128:131], a[72:75], v[64:67], v[128:131]
ds_read_b64_tr_b16 a[64:65], v161 offset:50176
v_mfma_f32_16x16x32_bf16 v[128:131], a[76:79], v[72:75], v[128:131]
ds_read_b64_tr_b16 a[66:67], v161 offset:52224
v_mfma_f32_16x16x32_bf16 v[132:135], a[76:79], v[76:79], v[132:135]
ds_read_b64_tr_b16 a[68:69], v161 offset:54272
v_mfma_f32_16x16x32_bf16 v[132:135], a[72:75], v[68:71], v[132:135]
ds_read_b64_tr_b16 a[70:71], v161 offset:56320
s_waitcnt lgkmcnt(4)
v_mfma_f32_16x16x32_bf16 v[132:135], v[166:169], v[84:87], v[132:135]
ds_read_b64_tr_b16 a[72:73], v161 offset:58368
v_mfma_f32_16x16x32_bf16 v[132:135], v[170:173], v[92:95], v[132:135]
ds_read_b64_tr_b16 a[74:75], v161 offset:60416
v_mfma_f32_16x16x32_bf16 v[128:131], v[170:173], v[88:91], v[128:131]
ds_read_b64_tr_b16 a[76:77], v161 offset:62464
v_mfma_f32_16x16x32_bf16 v[128:131], v[166:169], v[80:83], v[128:131]
ds_read_b64_tr_b16 a[78:79], v161 offset:64512
s_waitcnt lgkmcnt(4)
v_mfma_f32_16x16x32_bf16 v[128:131], a[64:67], v[96:99], v[128:131]
ds_read_b64_tr_b16 v[166:167], v162 offset:33792
v_mfma_f32_16x16x32_bf16 v[128:131], a[68:71], v[104:107], v[128:131]
ds_read_b64_tr_b16 v[168:169], v162 offset:35840
v_mfma_f32_16x16x32_bf16 v[132:135], a[68:71], v[108:111], v[132:135]
ds_read_b64_tr_b16 v[170:171], v162 offset:37888
v_mfma_f32_16x16x32_bf16 v[132:135], a[64:67], v[100:103], v[132:135]
ds_read_b64_tr_b16 v[172:173], v162 offset:39936
s_cmp_eq_u32 s76, 0
s_cbranch_scc0 L_nqb
s_barrier
L_nqb:
s_waitcnt lgkmcnt(4)
v_mfma_f32_16x16x32_bf16 v[132:135], a[72:75], v[116:119], v[132:135]
ds_read_b64_tr_b16 a[64:65], v162 offset:41984
v_mfma_f32_16x16x32_bf16 v[132:135], a[76:79], v[124:127], v[132:135]
ds_read_b64_tr_b16 a[66:67], v162 offset:44032
v_mfma_f32_16x16x32_bf16 v[128:131], a[76:79], v[120:123], v[128:131]
ds_read_b64_tr_b16 a[68:69], v162 offset:46080
v_mfma_f32_16x16x32_bf16 v[128:131], a[72:75], v[112:115], v[128:131]
ds_read_b64_tr_b16 a[70:71], v162 offset:48128
s_waitcnt lgkmcnt(4)
v_mfma_f32_16x16x32_bf16 v[136:139], v[166:169], v[64:67], v[136:139]
ds_read_b64_tr_b16 a[72:73], v162 offset:50176
v_mfma_f32_16x16x32_bf16 v[136:139], v[170:173], v[72:75], v[136:139]
ds_read_b64_tr_b16 a[74:75], v162 offset:52224
v_mfma_f32_16x16x32_bf16 v[140:143], v[170:173], v[76:79], v[140:143]
ds_read_b64_tr_b16 a[76:77], v162 offset:54272
v_mfma_f32_16x16x32_bf16 v[140:143], v[166:169], v[68:71], v[140:143]
ds_read_b64_tr_b16 a[78:79], v162 offset:56320
s_waitcnt lgkmcnt(4)
v_mfma_f32_16x16x32_bf16 v[140:143], a[64:67], v[84:87], v[140:143]
ds_read_b64_tr_b16 v[166:167], v162 offset:58368
v_mfma_f32_16x16x32_bf16 v[140:143], a[68:71], v[92:95], v[140:143]
ds_read_b64_tr_b16 v[168:169], v162 offset:60416
v_mfma_f32_16x16x32_bf16 v[136:139], a[68:71], v[88:91], v[136:139]
ds_read_b64_tr_b16 v[170:171], v162 offset:62464
v_mfma_f32_16x16x32_bf16 v[136:139], a[64:67], v[80:83], v[136:139]
ds_read_b64_tr_b16 v[172:173], v162 offset:64512
s_waitcnt lgkmcnt(4)
v_mfma_f32_16x16x32_bf16 v[136:139], a[72:75], v[96:99], v[136:139]
ds_read_b64_tr_b16 a[64:65], v163 offset:33792
v_mfma_f32_16x16x32_bf16 v[136:139], a[76:79], v[104:107], v[136:139]
ds_read_b64_tr_b16 a[66:67], v163 offset:35840
v_mfma_f32_16x16x32_bf16 v[140:143], a[76:79], v[108:111], v[140:143]
ds_read_b64_tr_b16 a[68:69], v163 offset:37888
v_mfma_f32_16x16x32_bf16 v[140:143], a[72:75], v[100:103], v[140:143]
ds_read_b64_tr_b16 a[70:71], v163 offset:39936
s_waitcnt lgkmcnt(4)
v_mfma_f32_16x16x32_bf16 v[140:143], v[166:169], v[116:119], v[140:143]
ds_read_b64_tr_b16 a[72:73], v163 offset:41984
v_mfma_f32_16x16x32_bf16 v[140:143], v[170:173], v[124:127], v[140:143]
ds_read_b64_tr_b16 a[74:75], v163 offset:44032
v_mfma_f32_16x16x32_bf16 v[136:139], v[170:173], v[120:123], v[136:139]
ds_read_b64_tr_b16 a[76:77], v163 offset:46080
v_mfma_f32_16x16x32_bf16 v[136:139], v[166:169], v[112:115], v[136:139]
ds_read_b64_tr_b16 a[78:79], v163 offset:48128
s_waitcnt lgkmcnt(4)
v_mfma_f32_16x16x32_bf16 v[144:147], a[64:67], v[64:67], v[144:147]
ds_read_b64_tr_b16 v[166:167], v163 offset:50176
v_mfma_f32_16x16x32_bf16 v[144:147], a[68:71], v[72:75], v[144:147]
ds_read_b64_tr_b16 v[168:169], v163 offset:52224
v_mfma_f32_16x16x32_bf16 v[148:151], a[68:71], v[76:79], v[148:151]
ds_read_b64_tr_b16 v[170:171], v163 offset:54272
v_mfma_f32_16x16x32_bf16 v[148:151], a[64:67], v[68:71], v[148:151]
ds_read_b64_tr_b16 v[172:173], v163 offset:56320
s_waitcnt lgkmcnt(4)
v_mfma_f32_16x16x32_bf16 v[148:151], a[72:75], v[84:87], v[148:151]
ds_read_b64_tr_b16 a[64:65], v163 offset:58368
v_mfma_f32_16x16x32_bf16 v[148:151], a[76:79], v[92:95], v[148:151]
ds_read_b64_tr_b16 a[66:67], v163 offset:60416
v_mfma_f32_16x16x32_bf16 v[144:147], a[76:79], v[88:91], v[144:147]
ds_read_b64_tr_b16 a[68:69], v163 offset:62464
v_mfma_f32_16x16x32_bf16 v[144:147], a[72:75], v[80:83], v[144:147]
ds_read_b64_tr_b16 a[70:71], v163 offset:64512
s_waitcnt lgkmcnt(4)
v_mfma_f32_16x16x32_bf16 v[144:147], v[166:169], v[96:99], v[144:147]
ds_read_b64_tr_b16 a[72:73], v164 offset:33792
v_mfma_f32_16x16x32_bf16 v[144:147], v[170:173], v[104:107], v[144:147]
ds_read_b64_tr_b16 a[74:75], v164 offset:35840
v_mfma_f32_16x16x32_bf16 v[148:151], v[170:173], v[108:111], v[148:151]
ds_read_b64_tr_b16 a[76:77], v164 offset:37888
v_mfma_f32_16x16x32_bf16 v[148:151], v[166:169], v[100:103], v[148:151]
ds_read_b64_tr_b16 a[78:79], v164 offset:39936
s_waitcnt lgkmcnt(4)
v_mfma_f32_16x16x32_bf16 v[148:151], a[64:67], v[116:119], v[148:151]
ds_read_b64_tr_b16 v[166:167], v164 offset:41984
v_mfma_f32_16x16x32_bf16 v[148:151], a[68:71], v[124:127], v[148:151]
ds_read_b64_tr_b16 v[168:169], v164 offset:44032
v_mfma_f32_16x16x32_bf16 v[144:147], a[68:71], v[120:123], v[144:147]
ds_read_b64_tr_b16 v[170:171], v164 offset:46080
v_mfma_f32_16x16x32_bf16 v[144:147], a[64:67], v[112:115], v[144:147]
ds_read_b64_tr_b16 v[172:173], v164 offset:48128
s_waitcnt lgkmcnt(4)
v_mfma_f32_16x16x32_bf16 v[152:155], a[72:75], v[64:67], v[152:155]
ds_read_b64_tr_b16 a[64:65], v164 offset:50176
v_mfma_f32_16x16x32_bf16 v[152:155], a[76:79], v[72:75], v[152:155]
ds_read_b64_tr_b16 a[66:67], v164 offset:52224
v_mfma_f32_16x16x32_bf16 v[156:159], a[76:79], v[76:79], v[156:159]
ds_read_b64_tr_b16 a[68:69], v164 offset:54272
v_mfma_f32_16x16x32_bf16 v[156:159], a[72:75], v[68:71], v[156:159]
ds_read_b64_tr_b16 a[70:71], v164 offset:56320
s_waitcnt lgkmcnt(4)
v_mfma_f32_16x16x32_bf16 v[156:159], v[166:169], v[84:87], v[156:159]
ds_read_b64_tr_b16 a[72:73], v164 offset:58368
v_mfma_f32_16x16x32_bf16 v[156:159], v[170:173], v[92:95], v[156:159]
ds_read_b64_tr_b16 a[74:75], v164 offset:60416
v_mfma_f32_16x16x32_bf16 v[152:155], v[170:173], v[88:91], v[152:155]
ds_read_b64_tr_b16 a[76:77], v164 offset:62464
v_mfma_f32_16x16x32_bf16 v[152:155], v[166:169], v[80:83], v[152:155]
ds_read_b64_tr_b16 a[78:79], v164 offset:64512
s_waitcnt lgkmcnt(4)
v_mfma_f32_16x16x32_bf16 v[152:155], a[64:67], v[96:99], v[152:155]
v_mul_f32 v128, v128, v174
v_mul_f32 v129, v129, v174
v_mfma_f32_16x16x32_bf16 v[152:155], a[68:71], v[104:107], v[152:155]
v_mul_f32 v130, v130, v174
v_mul_f32 v131, v131, v174
v_mfma_f32_16x16x32_bf16 v[156:159], a[68:71], v[108:111], v[156:159]
v_mul_f32 v136, v136, v174
v_mul_f32 v137, v137, v174
v_mfma_f32_16x16x32_bf16 v[156:159], a[64:67], v[100:103], v[156:159]
v_mul_f32 v138, v138, v174
v_mul_f32 v139, v139, v174
s_waitcnt lgkmcnt(0)
s_barrier
s_cmp_eq_u32 s76, 3
s_cbranch_scc1 L_nka
ds_read_b64_tr_b16 a[64:65], v161 offset:0
ds_read_b64_tr_b16 a[66:67], v161 offset:2048
ds_read_b64_tr_b16 a[68:69], v161 offset:4096
ds_read_b64_tr_b16 a[70:71], v161 offset:6144
s_branch L_nk2a
L_nka:
ds_read_b128 a[64:67], v160 offset:0
ds_read_b128 a[68:71], v160 offset:64
L_nk2a:
v_mfma_f32_16x16x32_bf16 v[156:159], a[72:75], v[116:119], v[156:159]
v_cvt_pk_bf16_f32 v128, v128, v129
v_cvt_pk_bf16_f32 v129, v130, v131
v_mfma_f32_16x16x32_bf16 v[156:159], a[76:79], v[124:127], v[156:159]
v_cvt_pk_bf16_f32 v130, v136, v137
v_cvt_pk_bf16_f32 v131, v138, v139
v_mfma_f32_16x16x32_bf16 v[152:155], a[76:79], v[120:123], v[152:155]
v_mul_f32 v132, v132, v175
v_mul_f32 v133, v133, v175
v_mfma_f32_16x16x32_bf16 v[152:155], a[72:75], v[112:115], v[152:155]
v_mul_f32 v134, v134, v175
v_mul_f32 v135, v135, v175
s_cmp_eq_u32 s76, 3
s_cbranch_scc1 L_nkb
ds_read_b64_tr_b16 a[72:73], v161 offset:8192
ds_read_b64_tr_b16 a[74:75], v161 offset:10240
ds_read_b64_tr_b16 a[76:77], v161 offset:12288
ds_read_b64_tr_b16 a[78:79], v161 offset:14336
s_branch L_nk2b
L_nkb:
ds_read_b128 a[72:75], v160 offset:128
ds_read_b128 a[76:79], v160 offset:192
L_nk2b:
s_setprio 0
v_mul_f32 v140, v140, v175
v_mul_f32 v141, v141, v175
v_mul_f32 v142, v142, v175
v_mul_f32 v143, v143, v175
v_cvt_pk_bf16_f32 v132, v132, v133
v_cvt_pk_bf16_f32 v133, v134, v135
v_cvt_pk_bf16_f32 v134, v140, v141
v_cvt_pk_bf16_f32 v135, v142, v143
ds_write_b128 v165, v[128:131] offset:0
ds_write_b128 v165, v[132:135] offset:1024
v_mul_f32 v144, v144, v174
v_mul_f32 v145, v145, v174
v_mul_f32 v146, v146, v174
v_mul_f32 v147, v147, v174
v_mul_f32 v152, v152, v174
v_mul_f32 v153, v153, v174
v_mul_f32 v154, v154, v174
v_mul_f32 v155, v155, v174
v_cvt_pk_bf16_f32 v144, v144, v145
v_cvt_pk_bf16_f32 v145, v146, v147
v_cvt_pk_bf16_f32 v146, v152, v153
v_cvt_pk_bf16_f32 v147, v154, v155
v_mul_f32 v148, v148, v175
v_mul_f32 v149, v149, v175
v_mul_f32 v150, v150, v175
v_mul_f32 v151, v151, v175
v_mul_f32 v156, v156, v175
v_mul_f32 v157, v157, v175
v_mul_f32 v158, v158, v175
v_mul_f32 v159, v159, v175
v_cvt_pk_bf16_f32 v148, v148, v149
v_cvt_pk_bf16_f32 v149, v150, v151
v_cvt_pk_bf16_f32 v150, v156, v157
v_cvt_pk_bf16_f32 v151, v158, v159
ds_write_b128 v165, v[144:147] offset:4096
ds_write_b128 v165, v[148:151] offset:5120
s_add_u32 s76, s76, 1
s_cmp_lt_u32 s76, 4
s_cbranch_scc1 L_chunk
s_add_u32 s75, s75, 1
s_cmp_lt_u32 s75, 2
s_cbranch_scc1 L_item
s_waitcnt lgkmcnt(0)
s_barrier
s_endpgm
L_rescale:
v_max3_f32 v144, v128, v129, v130
v_max3_f32 v144, v144, v131, v136
v_max3_f32 v144, v144, v137, v138
v_max_f32 v144, v144, v139
v_mov_b32 v146, v144
s_nop 1
v_permlane32_swap_b32 v146, v144
s_nop 1
v_max_f32 v144, v144, v146
v_mov_b32 v146, v144
s_nop 1
v_permlane16_swap_b32 v146, v144
s_nop 1
v_max_f32 v144, v144, v146
v_fma_f32 v144, v144, s73, v168
v_ceil_f32 v144, v144
v_max_f32 v144, 0, v144
v_sub_f32 v168, v168, v144
v_min_f32 v144, 0x43800000, v144
v_cvt_i32_f32 v144, v144
v_sub_u32 v144, 0, v144
v_ldexp_f32 v174, v174, v144
v_lshlrev_b32 v148, 16, v0
v_and_b32 v149, 0xffff0000, v0
v_ldexp_f32 v148, v148, v144
v_ldexp_f32 v149, v149, v144
v_cvt_pk_bf16_f32 v0, v148, v149
v_lshlrev_b32 v148, 16, v1
v_and_b32 v149, 0xffff0000, v1
v_ldexp_f32 v148, v148, v144
v_ldexp_f32 v149, v149, v144
v_cvt_pk_bf16_f32 v1, v148, v149
v_lshlrev_b32 v148, 16, v2
v_and_b32 v149, 0xffff0000, v2
v_ldexp_f32 v148, v148, v144
v_ldexp_f32 v149, v149, v144
v_cvt_pk_bf16_f32 v2, v148, v149
v_lshlrev_b32 v148, 16, v3
v_and_b32 v149, 0xffff0000, v3
v_ldexp_f32 v148, v148, v144
v_ldexp_f32 v149, v149, v144
v_cvt_pk_bf16_f32 v3, v148, v149
s_cmp_le_u32 s65, 1
s_cbranch_scc1 L_rsd0
v_lshlrev_b32 v148, 16, v8
v_and_b32 v149, 0xffff0000, v8
v_ldexp_f32 v148, v148, v144
v_ldexp_f32 v149, v149, v144
v_cvt_pk_bf16_f32 v8, v148, v149
v_lshlrev_b32 v148, 16, v9
v_and_b32 v149, 0xffff0000, v9
v_ldexp_f32 v148, v148, v144
v_ldexp_f32 v149, v149, v144
v_cvt_pk_bf16_f32 v9, v148, v149
v_lshlrev_b32 v148, 16, v10
v_and_b32 v149, 0xffff0000, v10
v_ldexp_f32 v148, v148, v144
v_ldexp_f32 v149, v149, v144
v_cvt_pk_bf16_f32 v10, v148, v149
v_lshlrev_b32 v148, 16, v11
v_and_b32 v149, 0xffff0000, v11
v_ldexp_f32 v148, v148, v144
v_ldexp_f32 v149, v149, v144
v_cvt_pk_bf16_f32 v11, v148, v149
s_cmp_le_u32 s65, 2
s_cbranch_scc1 L_rsd0
v_lshlrev_b32 v148, 16, v16
v_and_b32 v149, 0xffff0000, v16
v_ldexp_f32 v148, v148, v144
v_ldexp_f32 v149, v149, v144
v_cvt_pk_bf16_f32 v16, v148, v149
v_lshlrev_b32 v148, 16, v17
v_and_b32 v149, 0xffff0000, v17
v_ldexp_f32 v148, v148, v144
v_ldexp_f32 v149, v149, v144
v_cvt_pk_bf16_f32 v17, v148, v149
v_lshlrev_b32 v148, 16, v18
v_and_b32 v149, 0xffff0000, v18
v_ldexp_f32 v148, v148, v144
v_ldexp_f32 v149, v149, v144
v_cvt_pk_bf16_f32 v18, v148, v149
v_lshlrev_b32 v148, 16, v19
v_and_b32 v149, 0xffff0000, v19
v_ldexp_f32 v148, v148, v144
v_ldexp_f32 v149, v149, v144
v_cvt_pk_bf16_f32 v19, v148, v149
s_cmp_le_u32 s65, 3
s_cbranch_scc1 L_rsd0
v_lshlrev_b32 v148, 16, v24
v_and_b32 v149, 0xffff0000, v24
v_ldexp_f32 v148, v148, v144
v_ldexp_f32 v149, v149, v144
v_cvt_pk_bf16_f32 v24, v148, v149
v_lshlrev_b32 v148, 16, v25
v_and_b32 v149, 0xffff0000, v25
v_ldexp_f32 v148, v148, v144
v_ldexp_f32 v149, v149, v144
v_cvt_pk_bf16_f32 v25, v148, v149
v_lshlrev_b32 v148, 16, v26
v_and_b32 v149, 0xffff0000, v26
v_ldexp_f32 v148, v148, v144
v_ldexp_f32 v149, v149, v144
v_cvt_pk_bf16_f32 v26, v148, v149
v_lshlrev_b32 v148, 16, v27
v_and_b32 v149, 0xffff0000, v27
v_ldexp_f32 v148, v148, v144
v_ldexp_f32 v149, v149, v144
v_cvt_pk_bf16_f32 v27, v148, v149
s_cmp_le_u32 s65, 4
s_cbranch_scc1 L_rsd0
v_lshlrev_b32 v148, 16, v32
v_and_b32 v149, 0xffff0000, v32
v_ldexp_f32 v148, v148, v144
v_ldexp_f32 v149, v149, v144
v_cvt_pk_bf16_f32 v32, v148, v149
v_lshlrev_b32 v148, 16, v33
v_and_b32 v149, 0xffff0000, v33
v_ldexp_f32 v148, v148, v144
v_ldexp_f32 v149, v149, v144
v_cvt_pk_bf16_f32 v33, v148, v149
v_lshlrev_b32 v148, 16, v34
v_and_b32 v149, 0xffff0000, v34
v_ldexp_f32 v148, v148, v144
v_ldexp_f32 v149, v149, v144
v_cvt_pk_bf16_f32 v34, v148, v149
v_lshlrev_b32 v148, 16, v35
v_and_b32 v149, 0xffff0000, v35
v_ldexp_f32 v148, v148, v144
v_ldexp_f32 v149, v149, v144
v_cvt_pk_bf16_f32 v35, v148, v149
s_cmp_le_u32 s65, 5
s_cbranch_scc1 L_rsd0
v_lshlrev_b32 v148, 16, v40
v_and_b32 v149, 0xffff0000, v40
v_ldexp_f32 v148, v148, v144
v_ldexp_f32 v149, v149, v144
v_cvt_pk_bf16_f32 v40, v148, v149
v_lshlrev_b32 v148, 16, v41
v_and_b32 v149, 0xffff0000, v41
v_ldexp_f32 v148, v148, v144
v_ldexp_f32 v149, v149, v144
v_cvt_pk_bf16_f32 v41, v148, v149
v_lshlrev_b32 v148, 16, v42
v_and_b32 v149, 0xffff0000, v42
v_ldexp_f32 v148, v148, v144
v_ldexp_f32 v149, v149, v144
v_cvt_pk_bf16_f32 v42, v148, v149
v_lshlrev_b32 v148, 16, v43
v_and_b32 v149, 0xffff0000, v43
v_ldexp_f32 v148, v148, v144
v_ldexp_f32 v149, v149, v144
v_cvt_pk_bf16_f32 v43, v148, v149
s_cmp_le_u32 s65, 6
s_cbranch_scc1 L_rsd0
v_lshlrev_b32 v148, 16, v48
v_and_b32 v149, 0xffff0000, v48
v_ldexp_f32 v148, v148, v144
v_ldexp_f32 v149, v149, v144
v_cvt_pk_bf16_f32 v48, v148, v149
v_lshlrev_b32 v148, 16, v49
v_and_b32 v149, 0xffff0000, v49
v_ldexp_f32 v148, v148, v144
v_ldexp_f32 v149, v149, v144
v_cvt_pk_bf16_f32 v49, v148, v149
v_lshlrev_b32 v148, 16, v50
v_and_b32 v149, 0xffff0000, v50
v_ldexp_f32 v148, v148, v144
v_ldexp_f32 v149, v149, v144
v_cvt_pk_bf16_f32 v50, v148, v149
v_lshlrev_b32 v148, 16, v51
v_and_b32 v149, 0xffff0000, v51
v_ldexp_f32 v148, v148, v144
v_ldexp_f32 v149, v149, v144
v_cvt_pk_bf16_f32 v51, v148, v149
s_cmp_le_u32 s65, 7
s_cbranch_scc1 L_rsd0
v_lshlrev_b32 v148, 16, v56
v_and_b32 v149, 0xffff0000, v56
v_ldexp_f32 v148, v148, v144
v_ldexp_f32 v149, v149, v144
v_cvt_pk_bf16_f32 v56, v148, v149
v_lshlrev_b32 v148, 16, v57
v_and_b32 v149, 0xffff0000, v57
v_ldexp_f32 v148, v148, v144
v_ldexp_f32 v149, v149, v144
v_cvt_pk_bf16_f32 v57, v148, v149
v_lshlrev_b32 v148, 16, v58
v_and_b32 v149, 0xffff0000, v58
v_ldexp_f32 v148, v148, v144
v_ldexp_f32 v149, v149, v144
v_cvt_pk_bf16_f32 v58, v148, v149
v_lshlrev_b32 v148, 16, v59
v_and_b32 v149, 0xffff0000, v59
v_ldexp_f32 v148, v148, v144
v_ldexp_f32 v149, v149, v144
v_cvt_pk_bf16_f32 v59, v148, v149
s_cmp_le_u32 s65, 8
s_cbranch_scc1 L_rsd0
v_lshlrev_b32 v148, 16, v64
v_and_b32 v149, 0xffff0000, v64
v_ldexp_f32 v148, v148, v144
v_ldexp_f32 v149, v149, v144
v_cvt_pk_bf16_f32 v64, v148, v149
v_lshlrev_b32 v148, 16, v65
v_and_b32 v149, 0xffff0000, v65
v_ldexp_f32 v148, v148, v144
v_ldexp_f32 v149, v149, v144
v_cvt_pk_bf16_f32 v65, v148, v149
v_lshlrev_b32 v148, 16, v66
v_and_b32 v149, 0xffff0000, v66
v_ldexp_f32 v148, v148, v144
v_ldexp_f32 v149, v149, v144
v_cvt_pk_bf16_f32 v66, v148, v149
v_lshlrev_b32 v148, 16, v67
v_and_b32 v149, 0xffff0000, v67
v_ldexp_f32 v148, v148, v144
v_ldexp_f32 v149, v149, v144
v_cvt_pk_bf16_f32 v67, v148, v149
s_cmp_le_u32 s65, 9
s_cbranch_scc1 L_rsd0
v_lshlrev_b32 v148, 16, v72
v_and_b32 v149, 0xffff0000, v72
v_ldexp_f32 v148, v148, v144
v_ldexp_f32 v149, v149, v144
v_cvt_pk_bf16_f32 v72, v148, v149
v_lshlrev_b32 v148, 16, v73
v_and_b32 v149, 0xffff0000, v73
v_ldexp_f32 v148, v148, v144
v_ldexp_f32 v149, v149, v144
v_cvt_pk_bf16_f32 v73, v148, v149
v_lshlrev_b32 v148, 16, v74
v_and_b32 v149, 0xffff0000, v74
v_ldexp_f32 v148, v148, v144
v_ldexp_f32 v149, v149, v144
v_cvt_pk_bf16_f32 v74, v148, v149
v_lshlrev_b32 v148, 16, v75
v_and_b32 v149, 0xffff0000, v75
v_ldexp_f32 v148, v148, v144
v_ldexp_f32 v149, v149, v144
v_cvt_pk_bf16_f32 v75, v148, v149
s_cmp_le_u32 s65, 10
s_cbranch_scc1 L_rsd0
v_lshlrev_b32 v148, 16, v80
v_and_b32 v149, 0xffff0000, v80
v_ldexp_f32 v148, v148, v144
v_ldexp_f32 v149, v149, v144
v_cvt_pk_bf16_f32 v80, v148, v149
v_lshlrev_b32 v148, 16, v81
v_and_b32 v149, 0xffff0000, v81
v_ldexp_f32 v148, v148, v144
v_ldexp_f32 v149, v149, v144
v_cvt_pk_bf16_f32 v81, v148, v149
v_lshlrev_b32 v148, 16, v82
v_and_b32 v149, 0xffff0000, v82
v_ldexp_f32 v148, v148, v144
v_ldexp_f32 v149, v149, v144
v_cvt_pk_bf16_f32 v82, v148, v149
v_lshlrev_b32 v148, 16, v83
v_and_b32 v149, 0xffff0000, v83
v_ldexp_f32 v148, v148, v144
v_ldexp_f32 v149, v149, v144
v_cvt_pk_bf16_f32 v83, v148, v149
s_cmp_le_u32 s65, 11
s_cbranch_scc1 L_rsd0
v_lshlrev_b32 v148, 16, v88
v_and_b32 v149, 0xffff0000, v88
v_ldexp_f32 v148, v148, v144
v_ldexp_f32 v149, v149, v144
v_cvt_pk_bf16_f32 v88, v148, v149
v_lshlrev_b32 v148, 16, v89
v_and_b32 v149, 0xffff0000, v89
v_ldexp_f32 v148, v148, v144
v_ldexp_f32 v149, v149, v144
v_cvt_pk_bf16_f32 v89, v148, v149
v_lshlrev_b32 v148, 16, v90
v_and_b32 v149, 0xffff0000, v90
v_ldexp_f32 v148, v148, v144
v_ldexp_f32 v149, v149, v144
v_cvt_pk_bf16_f32 v90, v148, v149
v_lshlrev_b32 v148, 16, v91
v_and_b32 v149, 0xffff0000, v91
v_ldexp_f32 v148, v148, v144
v_ldexp_f32 v149, v149, v144
v_cvt_pk_bf16_f32 v91, v148, v149
s_cmp_le_u32 s65, 12
s_cbranch_scc1 L_rsd0
v_lshlrev_b32 v148, 16, v96
v_and_b32 v149, 0xffff0000, v96
v_ldexp_f32 v148, v148, v144
v_ldexp_f32 v149, v149, v144
v_cvt_pk_bf16_f32 v96, v148, v149
v_lshlrev_b32 v148, 16, v97
v_and_b32 v149, 0xffff0000, v97
v_ldexp_f32 v148, v148, v144
v_ldexp_f32 v149, v149, v144
v_cvt_pk_bf16_f32 v97, v148, v149
v_lshlrev_b32 v148, 16, v98
v_and_b32 v149, 0xffff0000, v98
v_ldexp_f32 v148, v148, v144
v_ldexp_f32 v149, v149, v144
v_cvt_pk_bf16_f32 v98, v148, v149
v_lshlrev_b32 v148, 16, v99
v_and_b32 v149, 0xffff0000, v99
v_ldexp_f32 v148, v148, v144
v_ldexp_f32 v149, v149, v144
v_cvt_pk_bf16_f32 v99, v148, v149
s_cmp_le_u32 s65, 13
s_cbranch_scc1 L_rsd0
v_lshlrev_b32 v148, 16, v104
v_and_b32 v149, 0xffff0000, v104
v_ldexp_f32 v148, v148, v144
v_ldexp_f32 v149, v149, v144
v_cvt_pk_bf16_f32 v104, v148, v149
v_lshlrev_b32 v148, 16, v105
v_and_b32 v149, 0xffff0000, v105
v_ldexp_f32 v148, v148, v144
v_ldexp_f32 v149, v149, v144
v_cvt_pk_bf16_f32 v105, v148, v149
v_lshlrev_b32 v148, 16, v106
v_and_b32 v149, 0xffff0000, v106
v_ldexp_f32 v148, v148, v144
v_ldexp_f32 v149, v149, v144
v_cvt_pk_bf16_f32 v106, v148, v149
v_lshlrev_b32 v148, 16, v107
v_and_b32 v149, 0xffff0000, v107
v_ldexp_f32 v148, v148, v144
v_ldexp_f32 v149, v149, v144
v_cvt_pk_bf16_f32 v107, v148, v149
s_cmp_le_u32 s65, 14
s_cbranch_scc1 L_rsd0
v_lshlrev_b32 v148, 16, v112
v_and_b32 v149, 0xffff0000, v112
v_ldexp_f32 v148, v148, v144
v_ldexp_f32 v149, v149, v144
v_cvt_pk_bf16_f32 v112, v148, v149
v_lshlrev_b32 v148, 16, v113
v_and_b32 v149, 0xffff0000, v113
v_ldexp_f32 v148, v148, v144
v_ldexp_f32 v149, v149, v144
v_cvt_pk_bf16_f32 v113, v148, v149
v_lshlrev_b32 v148, 16, v114
v_and_b32 v149, 0xffff0000, v114
v_ldexp_f32 v148, v148, v144
v_ldexp_f32 v149, v149, v144
v_cvt_pk_bf16_f32 v114, v148, v149
v_lshlrev_b32 v148, 16, v115
v_and_b32 v149, 0xffff0000, v115
v_ldexp_f32 v148, v148, v144
v_ldexp_f32 v149, v149, v144
v_cvt_pk_bf16_f32 v115, v148, v149
L_rsd0:
v_max3_f32 v144, v132, v133, v134
v_max3_f32 v144, v144, v135, v140
v_max3_f32 v144, v144, v141, v142
v_max_f32 v144, v144, v143
v_mov_b32 v146, v144
s_nop 1
v_permlane32_swap_b32 v146, v144
s_nop 1
v_max_f32 v144, v144, v146
v_mov_b32 v146, v144
s_nop 1
v_permlane16_swap_b32 v146, v144
s_nop 1
v_max_f32 v144, v144, v146
v_fma_f32 v144, v144, s73, v169
v_ceil_f32 v144, v144
v_max_f32 v144, 0, v144
v_sub_f32 v169, v169, v144
v_min_f32 v144, 0x43800000, v144
v_cvt_i32_f32 v144, v144
v_sub_u32 v144, 0, v144
v_ldexp_f32 v175, v175, v144
v_lshlrev_b32 v148, 16, v4
v_and_b32 v149, 0xffff0000, v4
v_ldexp_f32 v148, v148, v144
v_ldexp_f32 v149, v149, v144
v_cvt_pk_bf16_f32 v4, v148, v149
v_lshlrev_b32 v148, 16, v5
v_and_b32 v149, 0xffff0000, v5
v_ldexp_f32 v148, v148, v144
v_ldexp_f32 v149, v149, v144
v_cvt_pk_bf16_f32 v5, v148, v149
v_lshlrev_b32 v148, 16, v6
v_and_b32 v149, 0xffff0000, v6
v_ldexp_f32 v148, v148, v144
v_ldexp_f32 v149, v149, v144
v_cvt_pk_bf16_f32 v6, v148, v149
v_lshlrev_b32 v148, 16, v7
v_and_b32 v149, 0xffff0000, v7
v_ldexp_f32 v148, v148, v144
v_ldexp_f32 v149, v149, v144
v_cvt_pk_bf16_f32 v7, v148, v149
s_cmp_le_u32 s65, 1
s_cbranch_scc1 L_rsd1
v_lshlrev_b32 v148, 16, v12
v_and_b32 v149, 0xffff0000, v12
v_ldexp_f32 v148, v148, v144
v_ldexp_f32 v149, v149, v144
v_cvt_pk_bf16_f32 v12, v148, v149
v_lshlrev_b32 v148, 16, v13
v_and_b32 v149, 0xffff0000, v13
v_ldexp_f32 v148, v148, v144
v_ldexp_f32 v149, v149, v144
v_cvt_pk_bf16_f32 v13, v148, v149
v_lshlrev_b32 v148, 16, v14
v_and_b32 v149, 0xffff0000, v14
v_ldexp_f32 v148, v148, v144
v_ldexp_f32 v149, v149, v144
v_cvt_pk_bf16_f32 v14, v148, v149
v_lshlrev_b32 v148, 16, v15
v_and_b32 v149, 0xffff0000, v15
v_ldexp_f32 v148, v148, v144
v_ldexp_f32 v149, v149, v144
v_cvt_pk_bf16_f32 v15, v148, v149
s_cmp_le_u32 s65, 2
s_cbranch_scc1 L_rsd1
v_lshlrev_b32 v148, 16, v20
v_and_b32 v149, 0xffff0000, v20
v_ldexp_f32 v148, v148, v144
v_ldexp_f32 v149, v149, v144
v_cvt_pk_bf16_f32 v20, v148, v149
v_lshlrev_b32 v148, 16, v21
v_and_b32 v149, 0xffff0000, v21
v_ldexp_f32 v148, v148, v144
v_ldexp_f32 v149, v149, v144
v_cvt_pk_bf16_f32 v21, v148, v149
v_lshlrev_b32 v148, 16, v22
v_and_b32 v149, 0xffff0000, v22
v_ldexp_f32 v148, v148, v144
v_ldexp_f32 v149, v149, v144
v_cvt_pk_bf16_f32 v22, v148, v149
v_lshlrev_b32 v148, 16, v23
v_and_b32 v149, 0xffff0000, v23
v_ldexp_f32 v148, v148, v144
v_ldexp_f32 v149, v149, v144
v_cvt_pk_bf16_f32 v23, v148, v149
s_cmp_le_u32 s65, 3
s_cbranch_scc1 L_rsd1
v_lshlrev_b32 v148, 16, v28
v_and_b32 v149, 0xffff0000, v28
v_ldexp_f32 v148, v148, v144
v_ldexp_f32 v149, v149, v144
v_cvt_pk_bf16_f32 v28, v148, v149
v_lshlrev_b32 v148, 16, v29
v_and_b32 v149, 0xffff0000, v29
v_ldexp_f32 v148, v148, v144
v_ldexp_f32 v149, v149, v144
v_cvt_pk_bf16_f32 v29, v148, v149
v_lshlrev_b32 v148, 16, v30
v_and_b32 v149, 0xffff0000, v30
v_ldexp_f32 v148, v148, v144
v_ldexp_f32 v149, v149, v144
v_cvt_pk_bf16_f32 v30, v148, v149
v_lshlrev_b32 v148, 16, v31
v_and_b32 v149, 0xffff0000, v31
v_ldexp_f32 v148, v148, v144
v_ldexp_f32 v149, v149, v144
v_cvt_pk_bf16_f32 v31, v148, v149
s_cmp_le_u32 s65, 4
s_cbranch_scc1 L_rsd1
v_lshlrev_b32 v148, 16, v36
v_and_b32 v149, 0xffff0000, v36
v_ldexp_f32 v148, v148, v144
v_ldexp_f32 v149, v149, v144
v_cvt_pk_bf16_f32 v36, v148, v149
v_lshlrev_b32 v148, 16, v37
v_and_b32 v149, 0xffff0000, v37
v_ldexp_f32 v148, v148, v144
v_ldexp_f32 v149, v149, v144
v_cvt_pk_bf16_f32 v37, v148, v149
v_lshlrev_b32 v148, 16, v38
v_and_b32 v149, 0xffff0000, v38
v_ldexp_f32 v148, v148, v144
v_ldexp_f32 v149, v149, v144
v_cvt_pk_bf16_f32 v38, v148, v149
v_lshlrev_b32 v148, 16, v39
v_and_b32 v149, 0xffff0000, v39
v_ldexp_f32 v148, v148, v144
v_ldexp_f32 v149, v149, v144
v_cvt_pk_bf16_f32 v39, v148, v149
s_cmp_le_u32 s65, 5
s_cbranch_scc1 L_rsd1
v_lshlrev_b32 v148, 16, v44
v_and_b32 v149, 0xffff0000, v44
v_ldexp_f32 v148, v148, v144
v_ldexp_f32 v149, v149, v144
v_cvt_pk_bf16_f32 v44, v148, v149
v_lshlrev_b32 v148, 16, v45
v_and_b32 v149, 0xffff0000, v45
v_ldexp_f32 v148, v148, v144
v_ldexp_f32 v149, v149, v144
v_cvt_pk_bf16_f32 v45, v148, v149
v_lshlrev_b32 v148, 16, v46
v_and_b32 v149, 0xffff0000, v46
v_ldexp_f32 v148, v148, v144
v_ldexp_f32 v149, v149, v144
v_cvt_pk_bf16_f32 v46, v148, v149
v_lshlrev_b32 v148, 16, v47
v_and_b32 v149, 0xffff0000, v47
v_ldexp_f32 v148, v148, v144
v_ldexp_f32 v149, v149, v144
v_cvt_pk_bf16_f32 v47, v148, v149
s_cmp_le_u32 s65, 6
s_cbranch_scc1 L_rsd1
v_lshlrev_b32 v148, 16, v52
v_and_b32 v149, 0xffff0000, v52
v_ldexp_f32 v148, v148, v144
v_ldexp_f32 v149, v149, v144
v_cvt_pk_bf16_f32 v52, v148, v149
v_lshlrev_b32 v148, 16, v53
v_and_b32 v149, 0xffff0000, v53
v_ldexp_f32 v148, v148, v144
v_ldexp_f32 v149, v149, v144
v_cvt_pk_bf16_f32 v53, v148, v149
v_lshlrev_b32 v148, 16, v54
v_and_b32 v149, 0xffff0000, v54
v_ldexp_f32 v148, v148, v144
v_ldexp_f32 v149, v149, v144
v_cvt_pk_bf16_f32 v54, v148, v149
v_lshlrev_b32 v148, 16, v55
v_and_b32 v149, 0xffff0000, v55
v_ldexp_f32 v148, v148, v144
v_ldexp_f32 v149, v149, v144
v_cvt_pk_bf16_f32 v55, v148, v149
s_cmp_le_u32 s65, 7
s_cbranch_scc1 L_rsd1
v_lshlrev_b32 v148, 16, v60
v_and_b32 v149, 0xffff0000, v60
v_ldexp_f32 v148, v148, v144
v_ldexp_f32 v149, v149, v144
v_cvt_pk_bf16_f32 v60, v148, v149
v_lshlrev_b32 v148, 16, v61
v_and_b32 v149, 0xffff0000, v61
v_ldexp_f32 v148, v148, v144
v_ldexp_f32 v149, v149, v144
v_cvt_pk_bf16_f32 v61, v148, v149
v_lshlrev_b32 v148, 16, v62
v_and_b32 v149, 0xffff0000, v62
v_ldexp_f32 v148, v148, v144
v_ldexp_f32 v149, v149, v144
v_cvt_pk_bf16_f32 v62, v148, v149
v_lshlrev_b32 v148, 16, v63
v_and_b32 v149, 0xffff0000, v63
v_ldexp_f32 v148, v148, v144
v_ldexp_f32 v149, v149, v144
v_cvt_pk_bf16_f32 v63, v148, v149
s_cmp_le_u32 s65, 8
s_cbranch_scc1 L_rsd1
v_lshlrev_b32 v148, 16, v68
v_and_b32 v149, 0xffff0000, v68
v_ldexp_f32 v148, v148, v144
v_ldexp_f32 v149, v149, v144
v_cvt_pk_bf16_f32 v68, v148, v149
v_lshlrev_b32 v148, 16, v69
v_and_b32 v149, 0xffff0000, v69
v_ldexp_f32 v148, v148, v144
v_ldexp_f32 v149, v149, v144
v_cvt_pk_bf16_f32 v69, v148, v149
v_lshlrev_b32 v148, 16, v70
v_and_b32 v149, 0xffff0000, v70
v_ldexp_f32 v148, v148, v144
v_ldexp_f32 v149, v149, v144
v_cvt_pk_bf16_f32 v70, v148, v149
v_lshlrev_b32 v148, 16, v71
v_and_b32 v149, 0xffff0000, v71
v_ldexp_f32 v148, v148, v144
v_ldexp_f32 v149, v149, v144
v_cvt_pk_bf16_f32 v71, v148, v149
s_cmp_le_u32 s65, 9
s_cbranch_scc1 L_rsd1
v_lshlrev_b32 v148, 16, v76
v_and_b32 v149, 0xffff0000, v76
v_ldexp_f32 v148, v148, v144
v_ldexp_f32 v149, v149, v144
v_cvt_pk_bf16_f32 v76, v148, v149
v_lshlrev_b32 v148, 16, v77
v_and_b32 v149, 0xffff0000, v77
v_ldexp_f32 v148, v148, v144
v_ldexp_f32 v149, v149, v144
v_cvt_pk_bf16_f32 v77, v148, v149
v_lshlrev_b32 v148, 16, v78
v_and_b32 v149, 0xffff0000, v78
v_ldexp_f32 v148, v148, v144
v_ldexp_f32 v149, v149, v144
v_cvt_pk_bf16_f32 v78, v148, v149
v_lshlrev_b32 v148, 16, v79
v_and_b32 v149, 0xffff0000, v79
v_ldexp_f32 v148, v148, v144
v_ldexp_f32 v149, v149, v144
v_cvt_pk_bf16_f32 v79, v148, v149
s_cmp_le_u32 s65, 10
s_cbranch_scc1 L_rsd1
v_lshlrev_b32 v148, 16, v84
v_and_b32 v149, 0xffff0000, v84
v_ldexp_f32 v148, v148, v144
v_ldexp_f32 v149, v149, v144
v_cvt_pk_bf16_f32 v84, v148, v149
v_lshlrev_b32 v148, 16, v85
v_and_b32 v149, 0xffff0000, v85
v_ldexp_f32 v148, v148, v144
v_ldexp_f32 v149, v149, v144
v_cvt_pk_bf16_f32 v85, v148, v149
v_lshlrev_b32 v148, 16, v86
v_and_b32 v149, 0xffff0000, v86
v_ldexp_f32 v148, v148, v144
v_ldexp_f32 v149, v149, v144
v_cvt_pk_bf16_f32 v86, v148, v149
v_lshlrev_b32 v148, 16, v87
v_and_b32 v149, 0xffff0000, v87
v_ldexp_f32 v148, v148, v144
v_ldexp_f32 v149, v149, v144
v_cvt_pk_bf16_f32 v87, v148, v149
s_cmp_le_u32 s65, 11
s_cbranch_scc1 L_rsd1
v_lshlrev_b32 v148, 16, v92
v_and_b32 v149, 0xffff0000, v92
v_ldexp_f32 v148, v148, v144
v_ldexp_f32 v149, v149, v144
v_cvt_pk_bf16_f32 v92, v148, v149
v_lshlrev_b32 v148, 16, v93
v_and_b32 v149, 0xffff0000, v93
v_ldexp_f32 v148, v148, v144
v_ldexp_f32 v149, v149, v144
v_cvt_pk_bf16_f32 v93, v148, v149
v_lshlrev_b32 v148, 16, v94
v_and_b32 v149, 0xffff0000, v94
v_ldexp_f32 v148, v148, v144
v_ldexp_f32 v149, v149, v144
v_cvt_pk_bf16_f32 v94, v148, v149
v_lshlrev_b32 v148, 16, v95
v_and_b32 v149, 0xffff0000, v95
v_ldexp_f32 v148, v148, v144
v_ldexp_f32 v149, v149, v144
v_cvt_pk_bf16_f32 v95, v148, v149
s_cmp_le_u32 s65, 12
s_cbranch_scc1 L_rsd1
v_lshlrev_b32 v148, 16, v100
v_and_b32 v149, 0xffff0000, v100
v_ldexp_f32 v148, v148, v144
v_ldexp_f32 v149, v149, v144
v_cvt_pk_bf16_f32 v100, v148, v149
v_lshlrev_b32 v148, 16, v101
v_and_b32 v149, 0xffff0000, v101
v_ldexp_f32 v148, v148, v144
v_ldexp_f32 v149, v149, v144
v_cvt_pk_bf16_f32 v101, v148, v149
v_lshlrev_b32 v148, 16, v102
v_and_b32 v149, 0xffff0000, v102
v_ldexp_f32 v148, v148, v144
v_ldexp_f32 v149, v149, v144
v_cvt_pk_bf16_f32 v102, v148, v149
v_lshlrev_b32 v148, 16, v103
v_and_b32 v149, 0xffff0000, v103
v_ldexp_f32 v148, v148, v144
v_ldexp_f32 v149, v149, v144
v_cvt_pk_bf16_f32 v103, v148, v149
s_cmp_le_u32 s65, 13
s_cbranch_scc1 L_rsd1
v_lshlrev_b32 v148, 16, v108
v_and_b32 v149, 0xffff0000, v108
v_ldexp_f32 v148, v148, v144
v_ldexp_f32 v149, v149, v144
v_cvt_pk_bf16_f32 v108, v148, v149
v_lshlrev_b32 v148, 16, v109
v_and_b32 v149, 0xffff0000, v109
v_ldexp_f32 v148, v148, v144
v_ldexp_f32 v149, v149, v144
v_cvt_pk_bf16_f32 v109, v148, v149
v_lshlrev_b32 v148, 16, v110
v_and_b32 v149, 0xffff0000, v110
v_ldexp_f32 v148, v148, v144
v_ldexp_f32 v149, v149, v144
v_cvt_pk_bf16_f32 v110, v148, v149
v_lshlrev_b32 v148, 16, v111
v_and_b32 v149, 0xffff0000, v111
v_ldexp_f32 v148, v148, v144
v_ldexp_f32 v149, v149, v144
v_cvt_pk_bf16_f32 v111, v148, v149
s_cmp_le_u32 s65, 14
s_cbranch_scc1 L_rsd1
v_lshlrev_b32 v148, 16, v116
v_and_b32 v149, 0xffff0000, v116
v_ldexp_f32 v148, v148, v144
v_ldexp_f32 v149, v149, v144
v_cvt_pk_bf16_f32 v116, v148, v149
v_lshlrev_b32 v148, 16, v117
v_and_b32 v149, 0xffff0000, v117
v_ldexp_f32 v148, v148, v144
v_ldexp_f32 v149, v149, v144
v_cvt_pk_bf16_f32 v117, v148, v149
v_lshlrev_b32 v148, 16, v118
v_and_b32 v149, 0xffff0000, v118
v_ldexp_f32 v148, v148, v144
v_ldexp_f32 v149, v149, v144
v_cvt_pk_bf16_f32 v118, v148, v149
v_lshlrev_b32 v148, 16, v119
v_and_b32 v149, 0xffff0000, v119
v_ldexp_f32 v148, v148, v144
v_ldexp_f32 v149, v149, v144
v_cvt_pk_bf16_f32 v119, v148, v149
L_rsd1:
s_mov_b32 s74, 0x7f800000
s_setpc_b64 s[78:79]
L_end:
s_endpgm
.section .rodata,"a"
.p2align 6
.amdhsa_kernel concat_heads__gqa_block_cached__gqa_block_cached__near_ridge_kernel
  .amdhsa_next_free_vgpr 256
  .amdhsa_next_free_sgpr 96
  .amdhsa_accum_offset 176
  .amdhsa_group_segment_fixed_size 0
  .amdhsa_kernarg_size 104
  .amdhsa_user_sgpr_count 2
  .amdhsa_user_sgpr_kernarg_segment_ptr 1
  .amdhsa_system_sgpr_workgroup_id_x 1
.end_amdhsa_kernel
```
